```python
import torch

def _softmax(x, axis=-1):
    return torch.softmax(x, dim=axis)
def _gelu(x):
    return torch.nn.functional.gelu(x, approximate="tanh")
def _silu(x):
    return torch.nn.functional.silu(x)
def _sigmoid(x):
    return torch.sigmoid(x)
def _layernorm(x, axis=-1, eps=1e-5):
    m = x.mean(dim=axis, keepdim=True)
    v = x.var(dim=axis, keepdim=True, unbiased=False)
    return (x - m) / torch.sqrt(v + eps)
def _scatter_add(tgt, idx, src, axis=0):
    return tgt.clone().index_add_(axis, idx, src)
def _segment_sum(src, seg, n):
    out = torch.zeros((n,) + src.shape[1:], dtype=src.dtype)
    return out.index_add_(0, seg, src)
def _pad(x, pw):
    flat = tuple(v for pair in reversed(pw) for v in pair)
    return torch.nn.functional.pad(x, flat)

kernel_name = 'concat_heads__compressed_kv_cla__linear_kernel_hedgehog__prompt'

def setup_inputs():

    _w = (lambda a: (lambda t: t.to(torch.bfloat16) if t.is_floating_point() else t)(torch.as_tensor(a)))
    def _A_setup():
        B, H, Sq, Sk, D, M = 1, 32, 2048, 2048, 128, 512
        Dc = 4 * D
        return {
            "x": _w((lambda *s: torch.randn(*s, dtype=torch.bfloat16) * 0.8)(B, Sq, M)),
            "c_kv": _w((lambda *s: torch.randn(*s, dtype=torch.bfloat16) * 0.4)(B, Sk, Dc)),
            "w_q": _w((lambda *s: torch.randn(*s, dtype=torch.bfloat16) * 6.4)(M, H, D) * (M ** -0.5)),
            "w_uk": _w((lambda *s: torch.randn(*s, dtype=torch.bfloat16) * 6.4)(Dc, H, D) * (Dc ** -0.5)),
            "w_uv": _w((lambda *s: torch.randn(*s, dtype=torch.bfloat16) * 0.4)(Dc, H, D) * (Dc ** -0.5)),
            "w_o": _w((lambda *s: torch.randn(*s, dtype=torch.bfloat16) * 0.4)(H, D, M) * ((H * D) ** -0.5)),
        }
    _A_in = _A_setup()

    def _B_setup():
        B, S, D, H = 1, 2048, 512, 32
        Dh = D // H
        return {
            "x": _w((lambda *s: torch.randn(*s, dtype=torch.bfloat16) * 0.4)(B, S, D)),
            "wqkv": _w((lambda *s: torch.randn(*s, dtype=torch.bfloat16) * 0.4)(D, 3 * D)),
            "w_phi": _w((lambda *s: torch.randn(*s, dtype=torch.bfloat16) * 0.4)(H, Dh, Dh) * (Dh ** -0.5)),
            "wo": _w((lambda *s: torch.randn(*s, dtype=torch.bfloat16) * 0.05)(D, D)),
        }
    _B_in = _B_setup()

    return {
        "A_x": _A_in["x"],
        "A_c_kv": _A_in["c_kv"],
        "A_w_q": _A_in["w_q"],
        "A_w_uk": _A_in["w_uk"],
        "A_w_uv": _A_in["w_uv"],
        "A_w_o": _A_in["w_o"],
        "B_x": _B_in["x"],
        "B_wqkv": _B_in["wqkv"],
        "B_w_phi": _B_in["w_phi"],
        "B_wo": _B_in["wo"],
    }

def reference(A_x, A_c_kv, A_w_q, A_w_uk, A_w_uv, A_w_o, B_x, B_wqkv, B_w_phi, B_wo):
    def _A_ref(x, c_kv, w_q, w_uk, w_uv, w_o):
        B, Sq, M = x.shape[0], x.shape[1], x.shape[2]
        Sk = c_kv.shape[1]
        H, D = w_q.shape[1], w_q.shape[2]
        q = torch.einsum("bqm,mhd->bhqd", x, w_q)
        k = torch.einsum("bkc,chd->bhkd", c_kv, w_uk)
        v = torch.einsum("bkc,chd->bhkd", c_kv, w_uv)
        scores = torch.einsum("bhqd,bhkd->bhqk", q, k) * (D ** -0.5)
        off = Sk - Sq
        qi = torch.arange(Sq)[:, None]
        kj = torch.arange(Sk)[None, :]
        cmask = kj <= (qi + off)
        scores = torch.where(cmask[None, None], scores, -1e9)
        p = _softmax(scores, axis=-1)
        ctx = torch.einsum("bhqk,bhkd->bhqd", p, v)
        return torch.einsum("bhqd,hdm->bqm", ctx, w_o)

    def _B_ref(x, wqkv, w_phi, wo):
        B, S, D = x.shape
        H = 32; Dh = D // H
        qkv = (lambda x, *d: x.permute(*d))((x @ wqkv).reshape(B, S, 3, H, Dh), 2, 0, 3, 1, 4)
        q, k, v = qkv[0], qkv[1], qkv[2]
        pq = torch.einsum("bhsd,hdf->bhsf", q, w_phi)
        pk = torch.einsum("bhsd,hdf->bhsf", k, w_phi)
        phi_q = torch.concatenate([_softmax(pq, axis=-1), _softmax(-pq, axis=-1)], axis=-1)
        phi_k = torch.concatenate([_softmax(pk, axis=-1), _softmax(-pk, axis=-1)], axis=-1)
        kv = torch.einsum("bhsf,bhsd->bhfd", phi_k, v)
        z  = torch.einsum("bhsf->bhf", phi_k)
        num = torch.einsum("bhqf,bhfd->bhqd", phi_q, kv)
        den = torch.einsum("bhqf,bhf->bhq", phi_q, z)[..., None] + 1e-6
        o = num / den
        return (lambda x, *d: x.permute(*d))(o, 0, 2, 1, 3).reshape(B, S, D) @ wo

    a = _A_ref(A_x, A_c_kv, A_w_q, A_w_uk, A_w_uv, A_w_o)
    b = _B_ref(B_x, B_wqkv, B_w_phi, B_wo)
    return torch.concatenate([a, b], axis=-1)
```

```asm
; @launch grid=(256,1,1) block=(256,1,1) lds=163840
.amdgcn_target "amdgcn-amd-amdhsa--gfx950"
.text
.globl concat_heads__compressed_kv_cla__linear_kernel_hedgehog__prompt_kernel
.p2align 8
.type concat_heads__compressed_kv_cla__linear_kernel_hedgehog__prompt_kernel,@function
concat_heads__compressed_kv_cla__linear_kernel_hedgehog__prompt_kernel:
s_cmp_ge_u32 s2, 256
s_cbranch_scc1 KA_end
s_load_dwordx16 s[76:91], s[0:1], 0
s_load_dwordx4 s[92:95], s[0:1], 64
s_load_dwordx4 s[52:55], s[0:1], 88
v_lshrrev_b32 v240, 6, v0
v_and_b32 v253, 63, v0
v_lshlrev_b32 v252, 4, v253
v_readfirstlane_b32 s20, v240
s_and_b32 s21, s2, 7
s_lshl_b32 s21, s21, 2
s_bfe_u32 s37, s2, 0x20003
s_add_u32 s21, s21, s37
s_lshr_b32 s22, s2, 5
s_lshl_b32 s37, s37, 1
s_add_u32 s36, s22, s37
s_lshl_b32 s36, s36, 7
s_lshl_b32 s29, s20, 13
s_lshl_b32 s31, s20, 12
s_lshl_b32 s48, s22, 18
s_lshl_b32 s37, s20, 16
s_add_u32 s48, s48, s37
s_lshl_b32 s49, s21, 8
s_lshl_b32 s37, s20, 17
s_add_u32 s49, s49, s37
v_lshrrev_b32 v240, 4, v253
v_and_b32 v241, 7, v253
v_xor_b32 v240, v240, v241
v_lshlrev_b32 v240, 4, v240
v_lshrrev_b32 v241, 3, v253
v_lshlrev_b32 v241, 10, v241
v_add_u32 v128, v240, v241
v_xor_b32 v240, 64, v128
v_add_u32 v129, 7168, v240
v_add_u32 v130, 14336, v128
v_add_u32 v131, 21504, v240
v_lshrrev_b32 v240, 4, v253
v_lshlrev_b32 v241, 1, v240
v_and_b32 v242, 15, v253
v_xor_b32 v241, v241, v242
v_lshlrev_b32 v241, 4, v241
v_lshlrev_b32 v240, 13, v240
v_add_u32 v132, v240, v241
v_xor_b32 v240, 128, v132
v_add_u32 v133, 31744, v132
v_add_u32 v134, 63488, v240
v_add_u32 v135, 95232, v240
s_waitcnt lgkmcnt(0)
s_mov_b32 s8, s78
s_and_b32 s9, s79, 0xffff
s_mov_b32 s10, 0x200000
s_mov_b32 s11, 0x00020000
s_mov_b32 s12, s82
s_and_b32 s13, s83, 0xffff
s_mov_b32 s14, 0x400000
s_mov_b32 s15, 0x00020000
s_mov_b32 s16, s84
s_and_b32 s17, s85, 0xffff
s_mov_b32 s18, 0x400000
s_mov_b32 s19, 0x00020000
s_mov_b32 s4, s54
s_and_b32 s5, s55, 0xffff
s_mov_b32 s6, 0x10000000
s_mov_b32 s7, 0x00020000
s_mov_b32 s33, s52
s_mov_b32 s34, s53
s_add_u32 m0, s29, 131072
s_add_u32 s30, s48, 0
buffer_load_dwordx4 v128, s[8:11], s30 offen offset:0  lds
buffer_load_dwordx4 v129, s[8:11], s30 offen offset:1024  lds
buffer_load_dwordx4 v130, s[8:11], s30 offen offset:2048  lds
buffer_load_dwordx4 v131, s[8:11], s30 offen offset:3072  lds
s_add_u32 m0, s29, 135168
s_add_u32 s30, s48, 32768
buffer_load_dwordx4 v128, s[8:11], s30 offen offset:0  lds
buffer_load_dwordx4 v129, s[8:11], s30 offen offset:1024  lds
buffer_load_dwordx4 v130, s[8:11], s30 offen offset:2048  lds
buffer_load_dwordx4 v131, s[8:11], s30 offen offset:3072  lds
s_add_u32 m0, s31, 0
s_add_u32 s30, s49, 0
buffer_load_dwordx4 v132, s[12:15], s30 offen offset:0 nt lds
buffer_load_dwordx4 v133, s[12:15], s30 offen offset:1024 nt lds
buffer_load_dwordx4 v134, s[12:15], s30 offen offset:2048 nt lds
buffer_load_dwordx4 v135, s[12:15], s30 offen offset:3072 nt lds
s_add_u32 m0, s31, 16384
s_add_u32 s30, s49, 0
buffer_load_dwordx4 v132, s[16:19], s30 offen offset:0 nt lds
buffer_load_dwordx4 v133, s[16:19], s30 offen offset:1024 nt lds
buffer_load_dwordx4 v134, s[16:19], s30 offen offset:2048 nt lds
buffer_load_dwordx4 v135, s[16:19], s30 offen offset:3072 nt lds
s_getpc_b64 s[50:51]
KA_pc:
s_lshr_b32 s3, s2, 3
s_lshl_b32 s3, s3, 2
s_add_u32 s3, s3, s20
s_lshl_b32 s3, s3, 10
s_min_u32 s3, s3, KA_end-KA_pc-1024
s_add_u32 s50, s50, s3
s_addc_u32 s51, s51, 0
v_mov_b32 v241, s51
v_add_co_u32 v240, vcc, s50, v252
s_nop 1
v_addc_co_u32 v241, vcc, 0, v241, vcc
v_mov_b32 v150, v240
v_mov_b32 v151, v241
s_mov_b32 s64, s88
s_and_b32 s65, s89, 0xffff
s_mov_b32 s66, 0x200000
s_mov_b32 s67, 0x00020000
s_mov_b32 s68, s90
s_and_b32 s69, s91, 0xffff
s_mov_b32 s70, 0x180000
s_mov_b32 s71, 0x00020000
s_mov_b32 s72, s92
s_and_b32 s73, s93, 0xffff
s_mov_b32 s74, 0x4000
s_mov_b32 s75, 0x00020000
v_and_b32 v240, 15, v253
v_lshrrev_b32 v241, 1, v240
v_lshrrev_b32 v242, 4, v253
v_xor_b32 v241, v241, v242
v_lshlrev_b32 v241, 4, v241
v_lshlrev_b32 v240, 7, v240
v_add3_u32 v136, v240, v241, s29
v_add_u32 v136, 131072, v136
v_xor_b32 v137, 64, v136
v_bfe_u32 v240, v253, 2, 2
v_lshrrev_b32 v241, 4, v253
v_lshlrev_b32 v241, 3, v241
v_add_u32 v241, v241, v240
v_lshlrev_b32 v241, 8, v241
v_bfe_u32 v240, v253, 2, 3
v_lshlrev_b32 v240, 5, v240
v_add_u32 v241, v241, v240
v_and_b32 v240, 3, v253
v_lshlrev_b32 v240, 3, v240
v_add_u32 v241, v241, v240
v_add_u32 v138, 0, v241
v_xor_b32 v139, 32, v138
v_xor_b32 v140, 64, v138
v_xor_b32 v141, 96, v138
v_xor_b32 v142, 128, v138
v_xor_b32 v143, 160, v138
v_xor_b32 v144, 192, v138
v_xor_b32 v145, 224, v138
s_lshl_b32 s32, s21, 20
s_lshl_b32 s37, s22, 17
s_add_u32 s32, s32, s37
s_lshl_b32 s37, s20, 15
s_add_u32 s32, s32, s37
s_sub_u32 s23, 15, s22
s_lshl_b32 s40, s23, 17
s_add_u32 s40, s40, s37
s_lshl_b32 s41, s22, 17
s_add_u32 s41, s41, s37
s_lshl_b32 s26, s21, 16
s_lshl_b32 s37, s20, 14
s_add_u32 s26, s26, s37
s_mul_i32 s27, s20, 49152
s_lshl_b32 s37, s22, 7
s_add_u32 s27, s27, s37
v_bfe_u32 v240, v253, 4, 1
v_lshlrev_b32 v240, 2, v240
v_and_b32 v241, 7, v253
v_xor_b32 v240, v240, v241
v_lshlrev_b32 v240, 4, v240
v_lshrrev_b32 v241, 3, v253
v_mul_u32_u24 v241, 3072, v241
v_add_u32 v156, v240, v241
v_add_u32 v157, 23552, v156
s_lshr_b32 s37, s20, 1
s_lshl_b32 s37, s37, 12
s_add_u32 s37, s37, 98304
v_and_b32 v240, 31, v253
v_bfe_u32 v241, v253, 1, 3
v_lshrrev_b32 v242, 5, v253
v_xor_b32 v241, v241, v242
v_lshlrev_b32 v241, 4, v241
v_lshlrev_b32 v240, 7, v240
v_add3_u32 v158, v240, v241, s37
v_xor_b32 v159, 32, v158
v_xor_b32 v160, 64, v158
v_xor_b32 v161, 96, v158
s_and_b32 s37, s20, 1
v_bfe_u32 v240, v253, 2, 2
v_lshrrev_b32 v241, 5, v253
v_lshl_add_u32 v240, v241, 3, v240
v_lshlrev_b32 v240, 7, v240
v_bfe_u32 v241, v253, 3, 1
v_xor_b32 v241, s37, v241
v_lshl_add_u32 v240, v241, 6, v240
v_bfe_u32 v241, v253, 4, 1
v_lshl_add_u32 v240, v241, 5, v240
v_and_b32 v241, 3, v253
v_lshl_add_u32 v240, v241, 3, v240
v_add_u32 v162, 106496, v240
v_and_b32 v240, 15, v253
v_lshlrev_b32 v240, 1, v240
v_lshrrev_b32 v241, 5, v253
v_lshl_add_u32 v163, v241, 7, v240
v_mov_b32 v254, 0x3e0293ee
s_lshl_b32 s37, s21, 7
s_add_u32 s37, s37, 0x3c02000
s_lshl_b32 s38, s22, 2
s_add_u32 s38, s38, s37
s_lshl_b32 s39, s22, 7
s_lshl_b32 s3, s21, 2
s_add_u32 s39, s39, s3
s_add_u32 s39, s39, 0x3c03000
s_cmp_eq_u32 s20, 0
s_cselect_b32 s38, s38, 0x7ffffff0
s_cselect_b32 s37, s37, 0x70000000
s_cselect_b32 s39, s39, 0x7ffffff0
s_cselect_b32 s3, 0, 0x1000
v_mov_b32 v164, 0x7ffffff0
v_writelane_b32 v164, s38, 0
v_mov_b32 v255, 0x7ffffff0
v_writelane_b32 v255, s39, 0
v_and_b32 v240, 7, v253
v_lshl_add_u32 v146, v240, 2, s37
v_mov_b32 v165, 1
v_mov_b32 v167, s3
s_mul_i32 s37, s20, 6144
s_add_u32 s37, s37, 0x3c00000
s_cmp_eq_u32 s2, 0
s_cselect_b32 s37, s37, 0x70000000
s_cselect_b32 s3, s3, 0x1000
v_mov_b32 v244, 0
v_mov_b32 v245, 0
v_mov_b32 v246, 0
v_mov_b32 v247, 0
v_mov_b32 v173, 0x1000
v_writelane_b32 v173, s3, 0
v_add_u32 v148, s37, v252
v_add_u32 v149, 3072, v148
s_mov_b32 s96, s33
s_and_b32 s97, s34, 0xffff
s_mov_b32 s98, 0x100
s_mov_b32 s99, 0x00020000
s_lshl_b32 s28, s2, 2
s_add_u32 s28, s28, s20
s_mov_b32 s47, 0x00020000
v_mul_u32_u24 v168, 24, v253
v_lshlrev_b32 v169, 3, v253
v_mul_u32_u24 v168, 24, v253
v_lshlrev_b32 v171, 5, v253
v_lshrrev_b32 v10, 3, v253
v_lshlrev_b32 v10, 13, v10
v_and_b32 v11, 7, v253
v_lshl_add_u32 v250, v11, 7, v10
v_lshlrev_b32 v249, 6, v253
s_waitcnt vmcnt(0)
s_barrier
ds_read_b128 a[192:195], v136 offset:0
ds_read_b128 a[196:199], v137 offset:0
ds_read_b128 a[200:203], v136 offset:2048
ds_read_b128 a[204:207], v137 offset:2048
ds_read_b128 a[208:211], v136 offset:4096
ds_read_b128 a[212:215], v137 offset:4096
ds_read_b128 a[216:219], v136 offset:6144
ds_read_b128 a[220:223], v137 offset:6144
ds_read_b64_tr_b16 a[128:129], v138 offset:0
ds_read_b64_tr_b16 a[130:131], v138 offset:1024
ds_read_b64_tr_b16 a[132:133], v138 offset:8192
ds_read_b64_tr_b16 a[134:135], v138 offset:9216
ds_read_b64_tr_b16 a[136:137], v139 offset:0
ds_read_b64_tr_b16 a[138:139], v139 offset:1024
ds_read_b64_tr_b16 a[140:141], v139 offset:8192
ds_read_b64_tr_b16 a[142:143], v139 offset:9216
ds_read_b64_tr_b16 a[144:145], v140 offset:0
ds_read_b64_tr_b16 a[146:147], v140 offset:1024
ds_read_b64_tr_b16 a[148:149], v140 offset:8192
ds_read_b64_tr_b16 a[150:151], v140 offset:9216
ds_read_b64_tr_b16 a[152:153], v141 offset:0
ds_read_b64_tr_b16 a[154:155], v141 offset:1024
ds_read_b64_tr_b16 a[156:157], v141 offset:8192
ds_read_b64_tr_b16 a[158:159], v141 offset:9216
s_waitcnt lgkmcnt(0)
v_mfma_f32_16x16x32_bf16 v[0:3], a[128:131], a[192:195], 0
s_add_u32 m0, s29, 32768
ds_read_b64_tr_b16 a[160:161], v142 offset:0
ds_read_b64_tr_b16 a[162:163], v142 offset:1024
v_mfma_f32_16x16x32_bf16 v[0:3], a[132:135], a[196:199], v[0:3]
s_add_u32 s30, s48, 128
ds_read_b64_tr_b16 a[164:165], v142 offset:8192
ds_read_b64_tr_b16 a[166:167], v142 offset:9216
v_mfma_f32_16x16x32_bf16 v[32:35], a[128:131], a[200:203], 0
buffer_load_dwordx4 v128, s[8:11], s30 offen offset:0  lds
v_mfma_f32_16x16x32_bf16 v[32:35], a[132:135], a[204:207], v[32:35]
ds_read_b64_tr_b16 a[168:169], v143 offset:0
ds_read_b64_tr_b16 a[170:171], v143 offset:1024
v_mfma_f32_16x16x32_bf16 v[64:67], a[128:131], a[208:211], 0
ds_read_b64_tr_b16 a[172:173], v143 offset:8192
ds_read_b64_tr_b16 a[174:175], v143 offset:9216
v_mfma_f32_16x16x32_bf16 v[64:67], a[132:135], a[212:215], v[64:67]
buffer_load_dwordx4 v129, s[8:11], s30 offen offset:1024  lds
v_mfma_f32_16x16x32_bf16 v[96:99], a[128:131], a[216:219], 0
ds_read_b64_tr_b16 a[176:177], v144 offset:0
ds_read_b64_tr_b16 a[178:179], v144 offset:1024
v_mfma_f32_16x16x32_bf16 v[96:99], a[132:135], a[220:223], v[96:99]
ds_read_b64_tr_b16 a[180:181], v144 offset:8192
ds_read_b64_tr_b16 a[182:183], v144 offset:9216
v_mfma_f32_16x16x32_bf16 v[4:7], a[136:139], a[192:195], 0
buffer_load_dwordx4 v130, s[8:11], s30 offen offset:2048  lds
v_mfma_f32_16x16x32_bf16 v[4:7], a[140:143], a[196:199], v[4:7]
ds_read_b64_tr_b16 a[184:185], v145 offset:0
ds_read_b64_tr_b16 a[186:187], v145 offset:1024
v_mfma_f32_16x16x32_bf16 v[36:39], a[136:139], a[200:203], 0
ds_read_b64_tr_b16 a[188:189], v145 offset:8192
ds_read_b64_tr_b16 a[190:191], v145 offset:9216
v_mfma_f32_16x16x32_bf16 v[36:39], a[140:143], a[204:207], v[36:39]
buffer_load_dwordx4 v131, s[8:11], s30 offen offset:3072  lds
v_mfma_f32_16x16x32_bf16 v[68:71], a[136:139], a[208:211], 0
s_add_u32 m0, s29, 36864
v_mfma_f32_16x16x32_bf16 v[68:71], a[140:143], a[212:215], v[68:71]
s_add_u32 s30, s48, 32896
v_mfma_f32_16x16x32_bf16 v[100:103], a[136:139], a[216:219], 0
buffer_load_dwordx4 v128, s[8:11], s30 offen offset:0  lds
v_mfma_f32_16x16x32_bf16 v[100:103], a[140:143], a[220:223], v[100:103]
v_mfma_f32_16x16x32_bf16 v[8:11], a[144:147], a[192:195], 0
v_mfma_f32_16x16x32_bf16 v[8:11], a[148:151], a[196:199], v[8:11]
v_mfma_f32_16x16x32_bf16 v[40:43], a[144:147], a[200:203], 0
buffer_load_dwordx4 v129, s[8:11], s30 offen offset:1024  lds
v_mfma_f32_16x16x32_bf16 v[40:43], a[148:151], a[204:207], v[40:43]
v_mfma_f32_16x16x32_bf16 v[72:75], a[144:147], a[208:211], 0
v_mfma_f32_16x16x32_bf16 v[72:75], a[148:151], a[212:215], v[72:75]
buffer_load_dwordx4 v130, s[8:11], s30 offen offset:2048  lds
v_mfma_f32_16x16x32_bf16 v[104:107], a[144:147], a[216:219], 0
v_mfma_f32_16x16x32_bf16 v[104:107], a[148:151], a[220:223], v[104:107]
v_mfma_f32_16x16x32_bf16 v[12:15], a[152:155], a[192:195], 0
buffer_load_dwordx4 v131, s[8:11], s30 offen offset:3072  lds
v_mfma_f32_16x16x32_bf16 v[12:15], a[156:159], a[196:199], v[12:15]
v_mfma_f32_16x16x32_bf16 v[44:47], a[152:155], a[200:203], 0
v_mfma_f32_16x16x32_bf16 v[44:47], a[156:159], a[204:207], v[44:47]
global_load_dword v170, v[150:151], off
v_mfma_f32_16x16x32_bf16 v[76:79], a[152:155], a[208:211], 0
v_mfma_f32_16x16x32_bf16 v[76:79], a[156:159], a[212:215], v[76:79]
v_mfma_f32_16x16x32_bf16 v[108:111], a[152:155], a[216:219], 0
v_mfma_f32_16x16x32_bf16 v[108:111], a[156:159], a[220:223], v[108:111]
s_waitcnt lgkmcnt(0)
v_mfma_f32_16x16x32_bf16 v[16:19], a[160:163], a[192:195], 0
s_add_u32 m0, s31, 65536
ds_read_b64_tr_b16 a[128:129], v138 offset:16384
ds_read_b64_tr_b16 a[130:131], v138 offset:17408
v_mfma_f32_16x16x32_bf16 v[16:19], a[164:167], a[196:199], v[16:19]
s_add_u32 s30, s49, 524288
ds_read_b64_tr_b16 a[132:133], v138 offset:24576
ds_read_b64_tr_b16 a[134:135], v138 offset:25600
v_mfma_f32_16x16x32_bf16 v[48:51], a[160:163], a[200:203], 0
buffer_load_dwordx4 v132, s[12:15], s30 offen offset:0 nt lds
v_mfma_f32_16x16x32_bf16 v[48:51], a[164:167], a[204:207], v[48:51]
ds_read_b64_tr_b16 a[136:137], v139 offset:16384
ds_read_b64_tr_b16 a[138:139], v139 offset:17408
v_mfma_f32_16x16x32_bf16 v[80:83], a[160:163], a[208:211], 0
ds_read_b64_tr_b16 a[140:141], v139 offset:24576
ds_read_b64_tr_b16 a[142:143], v139 offset:25600
v_mfma_f32_16x16x32_bf16 v[80:83], a[164:167], a[212:215], v[80:83]
buffer_load_dwordx4 v133, s[12:15], s30 offen offset:1024 nt lds
v_mfma_f32_16x16x32_bf16 v[112:115], a[160:163], a[216:219], 0
ds_read_b64_tr_b16 a[144:145], v140 offset:16384
ds_read_b64_tr_b16 a[146:147], v140 offset:17408
v_mfma_f32_16x16x32_bf16 v[112:115], a[164:167], a[220:223], v[112:115]
ds_read_b64_tr_b16 a[148:149], v140 offset:24576
ds_read_b64_tr_b16 a[150:151], v140 offset:25600
v_mfma_f32_16x16x32_bf16 v[20:23], a[168:171], a[192:195], 0
ds_read_b64_tr_b16 a[152:153], v141 offset:16384
ds_read_b64_tr_b16 a[154:155], v141 offset:17408
v_mfma_f32_16x16x32_bf16 v[20:23], a[172:175], a[196:199], v[20:23]
buffer_load_dwordx4 v134, s[12:15], s30 offen offset:2048 nt lds
v_mfma_f32_16x16x32_bf16 v[52:55], a[168:171], a[200:203], 0
ds_read_b64_tr_b16 a[156:157], v141 offset:24576
ds_read_b64_tr_b16 a[158:159], v141 offset:25600
v_mfma_f32_16x16x32_bf16 v[52:55], a[172:175], a[204:207], v[52:55]
v_mfma_f32_16x16x32_bf16 v[84:87], a[168:171], a[208:211], 0
buffer_load_dwordx4 v135, s[12:15], s30 offen offset:3072 nt lds
v_mfma_f32_16x16x32_bf16 v[84:87], a[172:175], a[212:215], v[84:87]
v_mfma_f32_16x16x32_bf16 v[116:119], a[168:171], a[216:219], 0
s_add_u32 m0, s31, 81920
v_mfma_f32_16x16x32_bf16 v[116:119], a[172:175], a[220:223], v[116:119]
s_add_u32 s30, s49, 524288
v_mfma_f32_16x16x32_bf16 v[24:27], a[176:179], a[192:195], 0
buffer_load_dwordx4 v132, s[16:19], s30 offen offset:0 nt lds
v_mfma_f32_16x16x32_bf16 v[24:27], a[180:183], a[196:199], v[24:27]
v_mfma_f32_16x16x32_bf16 v[56:59], a[176:179], a[200:203], 0
v_mfma_f32_16x16x32_bf16 v[56:59], a[180:183], a[204:207], v[56:59]
v_mfma_f32_16x16x32_bf16 v[88:91], a[176:179], a[208:211], 0
buffer_load_dwordx4 v133, s[16:19], s30 offen offset:1024 nt lds
v_mfma_f32_16x16x32_bf16 v[88:91], a[180:183], a[212:215], v[88:91]
v_mfma_f32_16x16x32_bf16 v[120:123], a[176:179], a[216:219], 0
v_mfma_f32_16x16x32_bf16 v[120:123], a[180:183], a[220:223], v[120:123]
buffer_load_dwordx4 v134, s[16:19], s30 offen offset:2048 nt lds
v_mfma_f32_16x16x32_bf16 v[28:31], a[184:187], a[192:195], 0
v_mfma_f32_16x16x32_bf16 v[28:31], a[188:191], a[196:199], v[28:31]
v_mfma_f32_16x16x32_bf16 v[60:63], a[184:187], a[200:203], 0
v_mfma_f32_16x16x32_bf16 v[60:63], a[188:191], a[204:207], v[60:63]
buffer_load_dwordx4 v135, s[16:19], s30 offen offset:3072 nt lds
v_mfma_f32_16x16x32_bf16 v[92:95], a[184:187], a[208:211], 0
v_mfma_f32_16x16x32_bf16 v[92:95], a[188:191], a[212:215], v[92:95]
v_mfma_f32_16x16x32_bf16 v[124:127], a[184:187], a[216:219], 0
v_mfma_f32_16x16x32_bf16 v[124:127], a[188:191], a[220:223], v[124:127]
s_waitcnt lgkmcnt(0)
v_mfma_f32_16x16x32_bf16 a[0:3], a[192:195], a[128:131], 0
s_add_u32 m0, s29, 98304
ds_read_b64_tr_b16 a[160:161], v142 offset:16384
ds_read_b64_tr_b16 a[162:163], v142 offset:17408
v_mfma_f32_16x16x32_bf16 a[0:3], a[196:199], a[132:135], a[0:3]
s_add_u32 s30, s48, 256
ds_read_b64_tr_b16 a[164:165], v142 offset:24576
ds_read_b64_tr_b16 a[166:167], v142 offset:25600
v_mfma_f32_16x16x32_bf16 a[4:7], a[200:203], a[128:131], 0
buffer_load_dwordx4 v128, s[8:11], s30 offen offset:0  lds
v_mfma_f32_16x16x32_bf16 a[4:7], a[204:207], a[132:135], a[4:7]
ds_read_b64_tr_b16 a[168:169], v143 offset:16384
ds_read_b64_tr_b16 a[170:171], v143 offset:17408
v_mfma_f32_16x16x32_bf16 a[64:67], a[208:211], a[128:131], 0
ds_read_b64_tr_b16 a[172:173], v143 offset:24576
ds_read_b64_tr_b16 a[174:175], v143 offset:25600
v_mfma_f32_16x16x32_bf16 a[64:67], a[212:215], a[132:135], a[64:67]
buffer_load_dwordx4 v129, s[8:11], s30 offen offset:1024  lds
v_mfma_f32_16x16x32_bf16 a[68:71], a[216:219], a[128:131], 0
ds_read_b64_tr_b16 a[176:177], v144 offset:16384
ds_read_b64_tr_b16 a[178:179], v144 offset:17408
v_mfma_f32_16x16x32_bf16 a[68:71], a[220:223], a[132:135], a[68:71]
ds_read_b64_tr_b16 a[180:181], v144 offset:24576
ds_read_b64_tr_b16 a[182:183], v144 offset:25600
v_mfma_f32_16x16x32_bf16 a[8:11], a[192:195], a[136:139], 0
ds_read_b64_tr_b16 a[184:185], v145 offset:16384
ds_read_b64_tr_b16 a[186:187], v145 offset:17408
v_mfma_f32_16x16x32_bf16 a[8:11], a[196:199], a[140:143], a[8:11]
buffer_load_dwordx4 v130, s[8:11], s30 offen offset:2048  lds
v_mfma_f32_16x16x32_bf16 a[12:15], a[200:203], a[136:139], 0
ds_read_b64_tr_b16 a[188:189], v145 offset:24576
ds_read_b64_tr_b16 a[190:191], v145 offset:25600
v_mfma_f32_16x16x32_bf16 a[12:15], a[204:207], a[140:143], a[12:15]
v_add_u32 v136, 0xfffe8000, v136
v_add_u32 v137, 0xfffe8000, v137
v_mfma_f32_16x16x32_bf16 a[72:75], a[208:211], a[136:139], 0
buffer_load_dwordx4 v131, s[8:11], s30 offen offset:3072  lds
v_mfma_f32_16x16x32_bf16 a[72:75], a[212:215], a[140:143], a[72:75]
v_add_u32 v138, 0x10000, v138
v_add_u32 v139, 0x10000, v139
v_mfma_f32_16x16x32_bf16 a[76:79], a[216:219], a[136:139], 0
s_add_u32 m0, s29, 102400
v_add_u32 v140, 0x10000, v140
v_add_u32 v141, 0x10000, v141
v_mfma_f32_16x16x32_bf16 a[76:79], a[220:223], a[140:143], a[76:79]
s_add_u32 s30, s48, 33024
v_add_u32 v142, 0x10000, v142
v_add_u32 v143, 0x10000, v143
v_mfma_f32_16x16x32_bf16 a[16:19], a[192:195], a[144:147], 0
buffer_load_dwordx4 v128, s[8:11], s30 offen offset:0  lds
v_mfma_f32_16x16x32_bf16 a[16:19], a[196:199], a[148:151], a[16:19]
v_add_u32 v144, 0x10000, v144
v_add_u32 v145, 0x10000, v145
v_mfma_f32_16x16x32_bf16 a[20:23], a[200:203], a[144:147], 0
v_mfma_f32_16x16x32_bf16 a[20:23], a[204:207], a[148:151], a[20:23]
v_mfma_f32_16x16x32_bf16 a[80:83], a[208:211], a[144:147], 0
buffer_load_dwordx4 v129, s[8:11], s30 offen offset:1024  lds
v_mfma_f32_16x16x32_bf16 a[80:83], a[212:215], a[148:151], a[80:83]
v_mfma_f32_16x16x32_bf16 a[84:87], a[216:219], a[144:147], 0
v_mfma_f32_16x16x32_bf16 a[84:87], a[220:223], a[148:151], a[84:87]
buffer_load_dwordx4 v130, s[8:11], s30 offen offset:2048  lds
v_mfma_f32_16x16x32_bf16 a[24:27], a[192:195], a[152:155], 0
v_mfma_f32_16x16x32_bf16 a[24:27], a[196:199], a[156:159], a[24:27]
v_mfma_f32_16x16x32_bf16 a[28:31], a[200:203], a[152:155], 0
v_mfma_f32_16x16x32_bf16 a[28:31], a[204:207], a[156:159], a[28:31]
buffer_load_dwordx4 v131, s[8:11], s30 offen offset:3072  lds
v_mfma_f32_16x16x32_bf16 a[88:91], a[208:211], a[152:155], 0
v_mfma_f32_16x16x32_bf16 a[88:91], a[212:215], a[156:159], a[88:91]
v_mfma_f32_16x16x32_bf16 a[92:95], a[216:219], a[152:155], 0
v_mfma_f32_16x16x32_bf16 a[92:95], a[220:223], a[156:159], a[92:95]
s_waitcnt vmcnt(8) lgkmcnt(0)
s_barrier
v_mfma_f32_16x16x32_bf16 a[32:35], a[192:195], a[160:163], 0
s_add_u32 m0, s31, 131072
ds_read_b128 a[224:227], v136 offset:0
v_mfma_f32_16x16x32_bf16 a[32:35], a[196:199], a[164:167], a[32:35]
s_add_u32 s30, s49, 1048576
ds_read_b128 a[228:231], v137 offset:0
v_mfma_f32_16x16x32_bf16 a[36:39], a[200:203], a[160:163], 0
buffer_load_dwordx4 v132, s[12:15], s30 offen offset:0 nt lds
v_mfma_f32_16x16x32_bf16 a[36:39], a[204:207], a[164:167], a[36:39]
ds_read_b128 a[232:235], v136 offset:2048
v_mfma_f32_16x16x32_bf16 a[96:99], a[208:211], a[160:163], 0
ds_read_b128 a[236:239], v137 offset:2048
v_mfma_f32_16x16x32_bf16 a[96:99], a[212:215], a[164:167], a[96:99]
ds_read_b128 a[240:243], v136 offset:4096
v_mfma_f32_16x16x32_bf16 a[100:103], a[216:219], a[160:163], 0
ds_read_b128 a[244:247], v137 offset:4096
v_mfma_f32_16x16x32_bf16 a[100:103], a[220:223], a[164:167], a[100:103]
ds_read_b128 a[248:251], v136 offset:6144
v_mfma_f32_16x16x32_bf16 a[40:43], a[192:195], a[168:171], 0
ds_read_b128 a[252:255], v137 offset:6144
v_mfma_f32_16x16x32_bf16 a[40:43], a[196:199], a[172:175], a[40:43]
buffer_load_dwordx4 v133, s[12:15], s30 offen offset:1024 nt lds
v_mfma_f32_16x16x32_bf16 a[44:47], a[200:203], a[168:171], 0
ds_read_b64_tr_b16 a[128:129], v138 offset:0
ds_read_b64_tr_b16 a[130:131], v138 offset:1024
v_mfma_f32_16x16x32_bf16 a[44:47], a[204:207], a[172:175], a[44:47]
ds_read_b64_tr_b16 a[132:133], v138 offset:8192
ds_read_b64_tr_b16 a[134:135], v138 offset:9216
v_mfma_f32_16x16x32_bf16 a[104:107], a[208:211], a[168:171], 0
ds_read_b64_tr_b16 a[136:137], v139 offset:0
ds_read_b64_tr_b16 a[138:139], v139 offset:1024
v_mfma_f32_16x16x32_bf16 a[104:107], a[212:215], a[172:175], a[104:107]
ds_read_b64_tr_b16 a[140:141], v139 offset:8192
ds_read_b64_tr_b16 a[142:143], v139 offset:9216
v_mfma_f32_16x16x32_bf16 a[108:111], a[216:219], a[168:171], 0
ds_read_b64_tr_b16 a[144:145], v140 offset:0
ds_read_b64_tr_b16 a[146:147], v140 offset:1024
v_mfma_f32_16x16x32_bf16 a[108:111], a[220:223], a[172:175], a[108:111]
ds_read_b64_tr_b16 a[148:149], v140 offset:8192
ds_read_b64_tr_b16 a[150:151], v140 offset:9216
v_mfma_f32_16x16x32_bf16 a[48:51], a[192:195], a[176:179], 0
buffer_load_dwordx4 v134, s[12:15], s30 offen offset:2048 nt lds
v_mfma_f32_16x16x32_bf16 a[48:51], a[196:199], a[180:183], a[48:51]
ds_read_b64_tr_b16 a[152:153], v141 offset:0
ds_read_b64_tr_b16 a[154:155], v141 offset:1024
v_mfma_f32_16x16x32_bf16 a[52:55], a[200:203], a[176:179], 0
ds_read_b64_tr_b16 a[156:157], v141 offset:8192
ds_read_b64_tr_b16 a[158:159], v141 offset:9216
v_mfma_f32_16x16x32_bf16 a[52:55], a[204:207], a[180:183], a[52:55]
v_mfma_f32_16x16x32_bf16 a[112:115], a[208:211], a[176:179], 0
v_mfma_f32_16x16x32_bf16 a[112:115], a[212:215], a[180:183], a[112:115]
v_mfma_f32_16x16x32_bf16 a[116:119], a[216:219], a[176:179], 0
v_mfma_f32_16x16x32_bf16 a[116:119], a[220:223], a[180:183], a[116:119]
buffer_load_dwordx4 v135, s[12:15], s30 offen offset:3072 nt lds
v_mfma_f32_16x16x32_bf16 a[56:59], a[192:195], a[184:187], 0
v_mfma_f32_16x16x32_bf16 a[56:59], a[196:199], a[188:191], a[56:59]
v_mfma_f32_16x16x32_bf16 a[60:63], a[200:203], a[184:187], 0
v_mfma_f32_16x16x32_bf16 a[60:63], a[204:207], a[188:191], a[60:63]
v_mfma_f32_16x16x32_bf16 a[120:123], a[208:211], a[184:187], 0
v_mfma_f32_16x16x32_bf16 a[120:123], a[212:215], a[188:191], a[120:123]
v_mfma_f32_16x16x32_bf16 a[124:127], a[216:219], a[184:187], 0
v_mfma_f32_16x16x32_bf16 a[124:127], a[220:223], a[188:191], a[124:127]
s_waitcnt lgkmcnt(0)
v_mfma_f32_16x16x32_bf16 v[0:3], a[128:131], a[224:227], v[0:3]
s_add_u32 m0, s31, 147456
ds_read_b64_tr_b16 a[160:161], v142 offset:0
ds_read_b64_tr_b16 a[162:163], v142 offset:1024
v_mfma_f32_16x16x32_bf16 v[0:3], a[132:135], a[228:231], v[0:3]
s_add_u32 s30, s49, 1048576
ds_read_b64_tr_b16 a[164:165], v142 offset:8192
ds_read_b64_tr_b16 a[166:167], v142 offset:9216
v_mfma_f32_16x16x32_bf16 v[32:35], a[128:131], a[232:235], v[32:35]
buffer_load_dwordx4 v132, s[16:19], s30 offen offset:0 nt lds
v_mfma_f32_16x16x32_bf16 v[32:35], a[132:135], a[236:239], v[32:35]
ds_read_b64_tr_b16 a[168:169], v143 offset:0
ds_read_b64_tr_b16 a[170:171], v143 offset:1024
v_mfma_f32_16x16x32_bf16 v[64:67], a[128:131], a[240:243], v[64:67]
buffer_load_dwordx4 v133, s[16:19], s30 offen offset:1024 nt lds
v_mfma_f32_16x16x32_bf16 v[64:67], a[132:135], a[244:247], v[64:67]
ds_read_b64_tr_b16 a[172:173], v143 offset:8192
ds_read_b64_tr_b16 a[174:175], v143 offset:9216
v_mfma_f32_16x16x32_bf16 v[96:99], a[128:131], a[248:251], v[96:99]
ds_read_b64_tr_b16 a[176:177], v144 offset:0
ds_read_b64_tr_b16 a[178:179], v144 offset:1024
v_mfma_f32_16x16x32_bf16 v[96:99], a[132:135], a[252:255], v[96:99]
buffer_load_dwordx4 v134, s[16:19], s30 offen offset:2048 nt lds
v_mfma_f32_16x16x32_bf16 v[4:7], a[136:139], a[224:227], v[4:7]
ds_read_b64_tr_b16 a[180:181], v144 offset:8192
ds_read_b64_tr_b16 a[182:183], v144 offset:9216
v_mfma_f32_16x16x32_bf16 v[4:7], a[140:143], a[228:231], v[4:7]
ds_read_b64_tr_b16 a[184:185], v145 offset:0
ds_read_b64_tr_b16 a[186:187], v145 offset:1024
v_mfma_f32_16x16x32_bf16 v[36:39], a[136:139], a[232:235], v[36:39]
buffer_load_dwordx4 v135, s[16:19], s30 offen offset:3072 nt lds
v_mfma_f32_16x16x32_bf16 v[36:39], a[140:143], a[236:239], v[36:39]
ds_read_b64_tr_b16 a[188:189], v145 offset:8192
ds_read_b64_tr_b16 a[190:191], v145 offset:9216
v_mfma_f32_16x16x32_bf16 v[68:71], a[136:139], a[240:243], v[68:71]
v_mfma_f32_16x16x32_bf16 v[68:71], a[140:143], a[244:247], v[68:71]
buffer_store_dwordx4 v[244:247], v148, s[4:7], 0 offen offset:0 sc1
v_mfma_f32_16x16x32_bf16 v[100:103], a[136:139], a[248:251], v[100:103]
v_mfma_f32_16x16x32_bf16 v[100:103], a[140:143], a[252:255], v[100:103]
v_mfma_f32_16x16x32_bf16 v[8:11], a[144:147], a[224:227], v[8:11]
buffer_store_dwordx4 v[244:247], v148, s[4:7], 0 offen offset:1024 sc1
v_mfma_f32_16x16x32_bf16 v[8:11], a[148:151], a[228:231], v[8:11]
v_mfma_f32_16x16x32_bf16 v[40:43], a[144:147], a[232:235], v[40:43]
v_mfma_f32_16x16x32_bf16 v[40:43], a[148:151], a[236:239], v[40:43]
buffer_store_dwordx4 v[244:247], v148, s[4:7], 0 offen offset:2048 sc1
v_mfma_f32_16x16x32_bf16 v[72:75], a[144:147], a[240:243], v[72:75]
v_mfma_f32_16x16x32_bf16 v[72:75], a[148:151], a[244:247], v[72:75]
v_mfma_f32_16x16x32_bf16 v[104:107], a[144:147], a[248:251], v[104:107]
buffer_store_dwordx4 v[244:247], v149, s[4:7], 0 offen offset:0 sc1
v_mfma_f32_16x16x32_bf16 v[104:107], a[148:151], a[252:255], v[104:107]
v_mfma_f32_16x16x32_bf16 v[12:15], a[152:155], a[224:227], v[12:15]
v_mfma_f32_16x16x32_bf16 v[12:15], a[156:159], a[228:231], v[12:15]
buffer_store_dwordx4 v[244:247], v149, s[4:7], 0 offen offset:1024 sc1
v_mfma_f32_16x16x32_bf16 v[44:47], a[152:155], a[232:235], v[44:47]
v_mfma_f32_16x16x32_bf16 v[44:47], a[156:159], a[236:239], v[44:47]
v_mfma_f32_16x16x32_bf16 v[76:79], a[152:155], a[240:243], v[76:79]
buffer_store_dwordx4 v[244:247], v149, s[4:7], 0 offen offset:2048 sc1
v_mfma_f32_16x16x32_bf16 v[76:79], a[156:159], a[244:247], v[76:79]
v_mfma_f32_16x16x32_bf16 v[108:111], a[152:155], a[248:251], v[108:111]
v_mfma_f32_16x16x32_bf16 v[108:111], a[156:159], a[252:255], v[108:111]
s_waitcnt lgkmcnt(0)
v_mfma_f32_16x16x32_bf16 v[16:19], a[160:163], a[224:227], v[16:19]
s_add_u32 m0, s29, 0
ds_read_b64_tr_b16 a[128:129], v138 offset:16384
ds_read_b64_tr_b16 a[130:131], v138 offset:17408
v_mfma_f32_16x16x32_bf16 v[16:19], a[164:167], a[228:231], v[16:19]
s_add_u32 s30, s48, 384
ds_read_b64_tr_b16 a[132:133], v138 offset:24576
ds_read_b64_tr_b16 a[134:135], v138 offset:25600
v_mfma_f32_16x16x32_bf16 v[48:51], a[160:163], a[232:235], v[48:51]
buffer_load_dwordx4 v128, s[8:11], s30 offen offset:0  lds
v_mfma_f32_16x16x32_bf16 v[48:51], a[164:167], a[236:239], v[48:51]
ds_read_b64_tr_b16 a[136:137], v139 offset:16384
ds_read_b64_tr_b16 a[138:139], v139 offset:17408
v_mfma_f32_16x16x32_bf16 v[80:83], a[160:163], a[240:243], v[80:83]
ds_read_b64_tr_b16 a[140:141], v139 offset:24576
ds_read_b64_tr_b16 a[142:143], v139 offset:25600
v_mfma_f32_16x16x32_bf16 v[80:83], a[164:167], a[244:247], v[80:83]
ds_read_b64_tr_b16 a[144:145], v140 offset:16384
ds_read_b64_tr_b16 a[146:147], v140 offset:17408
v_mfma_f32_16x16x32_bf16 v[112:115], a[160:163], a[248:251], v[112:115]
ds_read_b64_tr_b16 a[148:149], v140 offset:24576
ds_read_b64_tr_b16 a[150:151], v140 offset:25600
v_mfma_f32_16x16x32_bf16 v[112:115], a[164:167], a[252:255], v[112:115]
ds_read_b64_tr_b16 a[152:153], v141 offset:16384
ds_read_b64_tr_b16 a[154:155], v141 offset:17408
v_mfma_f32_16x16x32_bf16 v[20:23], a[168:171], a[224:227], v[20:23]
ds_read_b64_tr_b16 a[156:157], v141 offset:24576
ds_read_b64_tr_b16 a[158:159], v141 offset:25600
v_mfma_f32_16x16x32_bf16 v[20:23], a[172:175], a[228:231], v[20:23]
buffer_load_dwordx4 v129, s[8:11], s30 offen offset:1024  lds
v_mfma_f32_16x16x32_bf16 v[52:55], a[168:171], a[232:235], v[52:55]
v_mfma_f32_16x16x32_bf16 v[52:55], a[172:175], a[236:239], v[52:55]
v_mfma_f32_16x16x32_bf16 v[84:87], a[168:171], a[240:243], v[84:87]
v_mfma_f32_16x16x32_bf16 v[84:87], a[172:175], a[244:247], v[84:87]
v_mfma_f32_16x16x32_bf16 v[116:119], a[168:171], a[248:251], v[116:119]
v_mfma_f32_16x16x32_bf16 v[116:119], a[172:175], a[252:255], v[116:119]
v_mfma_f32_16x16x32_bf16 v[24:27], a[176:179], a[224:227], v[24:27]
buffer_load_dwordx4 v130, s[8:11], s30 offen offset:2048  lds
v_mfma_f32_16x16x32_bf16 v[24:27], a[180:183], a[228:231], v[24:27]
v_mfma_f32_16x16x32_bf16 v[56:59], a[176:179], a[232:235], v[56:59]
v_mfma_f32_16x16x32_bf16 v[56:59], a[180:183], a[236:239], v[56:59]
v_mfma_f32_16x16x32_bf16 v[88:91], a[176:179], a[240:243], v[88:91]
v_mfma_f32_16x16x32_bf16 v[88:91], a[180:183], a[244:247], v[88:91]
v_mfma_f32_16x16x32_bf16 v[120:123], a[176:179], a[248:251], v[120:123]
v_mfma_f32_16x16x32_bf16 v[120:123], a[180:183], a[252:255], v[120:123]
buffer_load_dwordx4 v131, s[8:11], s30 offen offset:3072  lds
v_mfma_f32_16x16x32_bf16 v[28:31], a[184:187], a[224:227], v[28:31]
v_mfma_f32_16x16x32_bf16 v[28:31], a[188:191], a[228:231], v[28:31]
v_mfma_f32_16x16x32_bf16 v[60:63], a[184:187], a[232:235], v[60:63]
v_mfma_f32_16x16x32_bf16 v[60:63], a[188:191], a[236:239], v[60:63]
v_mfma_f32_16x16x32_bf16 v[92:95], a[184:187], a[240:243], v[92:95]
v_mfma_f32_16x16x32_bf16 v[92:95], a[188:191], a[244:247], v[92:95]
v_mfma_f32_16x16x32_bf16 v[124:127], a[184:187], a[248:251], v[124:127]
v_mfma_f32_16x16x32_bf16 v[124:127], a[188:191], a[252:255], v[124:127]
s_waitcnt lgkmcnt(0)
v_mfma_f32_16x16x32_bf16 a[0:3], a[224:227], a[128:131], a[0:3]
s_add_u32 m0, s29, 4096
ds_read_b64_tr_b16 a[160:161], v142 offset:16384
ds_read_b64_tr_b16 a[162:163], v142 offset:17408
v_mfma_f32_16x16x32_bf16 a[0:3], a[228:231], a[132:135], a[0:3]
s_add_u32 s30, s48, 33152
ds_read_b64_tr_b16 a[164:165], v142 offset:24576
ds_read_b64_tr_b16 a[166:167], v142 offset:25600
v_mfma_f32_16x16x32_bf16 a[4:7], a[232:235], a[128:131], a[4:7]
buffer_load_dwordx4 v128, s[8:11], s30 offen offset:0  lds
v_mfma_f32_16x16x32_bf16 a[4:7], a[236:239], a[132:135], a[4:7]
ds_read_b64_tr_b16 a[168:169], v143 offset:16384
ds_read_b64_tr_b16 a[170:171], v143 offset:17408
v_mfma_f32_16x16x32_bf16 a[64:67], a[240:243], a[128:131], a[64:67]
ds_read_b64_tr_b16 a[172:173], v143 offset:24576
ds_read_b64_tr_b16 a[174:175], v143 offset:25600
v_mfma_f32_16x16x32_bf16 a[64:67], a[244:247], a[132:135], a[64:67]
ds_read_b64_tr_b16 a[176:177], v144 offset:16384
ds_read_b64_tr_b16 a[178:179], v144 offset:17408
v_mfma_f32_16x16x32_bf16 a[68:71], a[248:251], a[128:131], a[68:71]
ds_read_b64_tr_b16 a[180:181], v144 offset:24576
ds_read_b64_tr_b16 a[182:183], v144 offset:25600
v_mfma_f32_16x16x32_bf16 a[68:71], a[252:255], a[132:135], a[68:71]
ds_read_b64_tr_b16 a[184:185], v145 offset:16384
ds_read_b64_tr_b16 a[186:187], v145 offset:17408
v_mfma_f32_16x16x32_bf16 a[8:11], a[224:227], a[136:139], a[8:11]
ds_read_b64_tr_b16 a[188:189], v145 offset:24576
ds_read_b64_tr_b16 a[190:191], v145 offset:25600
v_mfma_f32_16x16x32_bf16 a[8:11], a[228:231], a[140:143], a[8:11]
buffer_load_dwordx4 v129, s[8:11], s30 offen offset:1024  lds
v_mfma_f32_16x16x32_bf16 a[12:15], a[232:235], a[136:139], a[12:15]
v_add_u32 v136, 0x10000, v136
v_add_u32 v137, 0x10000, v137
v_mfma_f32_16x16x32_bf16 a[12:15], a[236:239], a[140:143], a[12:15]
v_add_u32 v138, 0x10000, v138
v_add_u32 v139, 0x10000, v139
v_mfma_f32_16x16x32_bf16 a[72:75], a[240:243], a[136:139], a[72:75]
v_add_u32 v140, 0x10000, v140
v_add_u32 v141, 0x10000, v141
v_mfma_f32_16x16x32_bf16 a[72:75], a[244:247], a[140:143], a[72:75]
v_add_u32 v142, 0x10000, v142
v_add_u32 v143, 0x10000, v143
v_mfma_f32_16x16x32_bf16 a[76:79], a[248:251], a[136:139], a[76:79]
v_add_u32 v144, 0x10000, v144
v_add_u32 v145, 0x10000, v145
v_mfma_f32_16x16x32_bf16 a[76:79], a[252:255], a[140:143], a[76:79]
v_mfma_f32_16x16x32_bf16 a[16:19], a[224:227], a[144:147], a[16:19]
buffer_load_dwordx4 v130, s[8:11], s30 offen offset:2048  lds
v_mfma_f32_16x16x32_bf16 a[16:19], a[228:231], a[148:151], a[16:19]
v_mfma_f32_16x16x32_bf16 a[20:23], a[232:235], a[144:147], a[20:23]
v_mfma_f32_16x16x32_bf16 a[20:23], a[236:239], a[148:151], a[20:23]
v_mfma_f32_16x16x32_bf16 a[80:83], a[240:243], a[144:147], a[80:83]
v_mfma_f32_16x16x32_bf16 a[80:83], a[244:247], a[148:151], a[80:83]
v_mfma_f32_16x16x32_bf16 a[84:87], a[248:251], a[144:147], a[84:87]
v_mfma_f32_16x16x32_bf16 a[84:87], a[252:255], a[148:151], a[84:87]
buffer_load_dwordx4 v131, s[8:11], s30 offen offset:3072  lds
v_mfma_f32_16x16x32_bf16 a[24:27], a[224:227], a[152:155], a[24:27]
v_mfma_f32_16x16x32_bf16 a[24:27], a[228:231], a[156:159], a[24:27]
v_mfma_f32_16x16x32_bf16 a[28:31], a[232:235], a[152:155], a[28:31]
v_mfma_f32_16x16x32_bf16 a[28:31], a[236:239], a[156:159], a[28:31]
v_mfma_f32_16x16x32_bf16 a[88:91], a[240:243], a[152:155], a[88:91]
v_mfma_f32_16x16x32_bf16 a[88:91], a[244:247], a[156:159], a[88:91]
v_mfma_f32_16x16x32_bf16 a[92:95], a[248:251], a[152:155], a[92:95]
v_mfma_f32_16x16x32_bf16 a[92:95], a[252:255], a[156:159], a[92:95]
s_waitcnt vmcnt(14) lgkmcnt(0)
s_barrier
v_mfma_f32_16x16x32_bf16 a[32:35], a[224:227], a[160:163], a[32:35]
s_add_u32 m0, s31, 32768
ds_read_b128 a[192:195], v136 offset:0
v_mfma_f32_16x16x32_bf16 a[32:35], a[228:231], a[164:167], a[32:35]
s_add_u32 s30, s49, 1572864
ds_read_b128 a[196:199], v137 offset:0
v_mfma_f32_16x16x32_bf16 a[36:39], a[232:235], a[160:163], a[36:39]
buffer_load_dwordx4 v132, s[12:15], s30 offen offset:0 nt lds
v_mfma_f32_16x16x32_bf16 a[36:39], a[236:239], a[164:167], a[36:39]
ds_read_b128 a[200:203], v136 offset:2048
v_mfma_f32_16x16x32_bf16 a[96:99], a[240:243], a[160:163], a[96:99]
ds_read_b128 a[204:207], v137 offset:2048
v_mfma_f32_16x16x32_bf16 a[96:99], a[244:247], a[164:167], a[96:99]
ds_read_b128 a[208:211], v136 offset:4096
v_mfma_f32_16x16x32_bf16 a[100:103], a[248:251], a[160:163], a[100:103]
ds_read_b128 a[212:215], v137 offset:4096
v_mfma_f32_16x16x32_bf16 a[100:103], a[252:255], a[164:167], a[100:103]
ds_read_b128 a[216:219], v136 offset:6144
v_mfma_f32_16x16x32_bf16 a[40:43], a[224:227], a[168:171], a[40:43]
ds_read_b128 a[220:223], v137 offset:6144
v_mfma_f32_16x16x32_bf16 a[40:43], a[228:231], a[172:175], a[40:43]
buffer_load_dwordx4 v133, s[12:15], s30 offen offset:1024 nt lds
v_mfma_f32_16x16x32_bf16 a[44:47], a[232:235], a[168:171], a[44:47]
ds_read_b64_tr_b16 a[128:129], v138 offset:0
ds_read_b64_tr_b16 a[130:131], v138 offset:1024
v_mfma_f32_16x16x32_bf16 a[44:47], a[236:239], a[172:175], a[44:47]
ds_read_b64_tr_b16 a[132:133], v138 offset:8192
ds_read_b64_tr_b16 a[134:135], v138 offset:9216
v_mfma_f32_16x16x32_bf16 a[104:107], a[240:243], a[168:171], a[104:107]
ds_read_b64_tr_b16 a[136:137], v139 offset:0
ds_read_b64_tr_b16 a[138:139], v139 offset:1024
v_mfma_f32_16x16x32_bf16 a[104:107], a[244:247], a[172:175], a[104:107]
ds_read_b64_tr_b16 a[140:141], v139 offset:8192
ds_read_b64_tr_b16 a[142:143], v139 offset:9216
v_mfma_f32_16x16x32_bf16 a[108:111], a[248:251], a[168:171], a[108:111]
ds_read_b64_tr_b16 a[144:145], v140 offset:0
ds_read_b64_tr_b16 a[146:147], v140 offset:1024
v_mfma_f32_16x16x32_bf16 a[108:111], a[252:255], a[172:175], a[108:111]
ds_read_b64_tr_b16 a[148:149], v140 offset:8192
ds_read_b64_tr_b16 a[150:151], v140 offset:9216
v_mfma_f32_16x16x32_bf16 a[48:51], a[224:227], a[176:179], a[48:51]
buffer_load_dwordx4 v134, s[12:15], s30 offen offset:2048 nt lds
v_mfma_f32_16x16x32_bf16 a[48:51], a[228:231], a[180:183], a[48:51]
ds_read_b64_tr_b16 a[152:153], v141 offset:0
ds_read_b64_tr_b16 a[154:155], v141 offset:1024
v_mfma_f32_16x16x32_bf16 a[52:55], a[232:235], a[176:179], a[52:55]
ds_read_b64_tr_b16 a[156:157], v141 offset:8192
ds_read_b64_tr_b16 a[158:159], v141 offset:9216
v_mfma_f32_16x16x32_bf16 a[52:55], a[236:239], a[180:183], a[52:55]
v_mfma_f32_16x16x32_bf16 a[112:115], a[240:243], a[176:179], a[112:115]
v_mfma_f32_16x16x32_bf16 a[112:115], a[244:247], a[180:183], a[112:115]
v_mfma_f32_16x16x32_bf16 a[116:119], a[248:251], a[176:179], a[116:119]
v_mfma_f32_16x16x32_bf16 a[116:119], a[252:255], a[180:183], a[116:119]
buffer_load_dwordx4 v135, s[12:15], s30 offen offset:3072 nt lds
v_mfma_f32_16x16x32_bf16 a[56:59], a[224:227], a[184:187], a[56:59]
v_mfma_f32_16x16x32_bf16 a[56:59], a[228:231], a[188:191], a[56:59]
v_mfma_f32_16x16x32_bf16 a[60:63], a[232:235], a[184:187], a[60:63]
v_mfma_f32_16x16x32_bf16 a[60:63], a[236:239], a[188:191], a[60:63]
v_mfma_f32_16x16x32_bf16 a[120:123], a[240:243], a[184:187], a[120:123]
v_mfma_f32_16x16x32_bf16 a[120:123], a[244:247], a[188:191], a[120:123]
v_mfma_f32_16x16x32_bf16 a[124:127], a[248:251], a[184:187], a[124:127]
v_mfma_f32_16x16x32_bf16 a[124:127], a[252:255], a[188:191], a[124:127]
s_waitcnt lgkmcnt(0)
v_mfma_f32_16x16x32_bf16 v[0:3], a[128:131], a[192:195], v[0:3]
s_add_u32 m0, s31, 49152
ds_read_b64_tr_b16 a[160:161], v142 offset:0
ds_read_b64_tr_b16 a[162:163], v142 offset:1024
v_mfma_f32_16x16x32_bf16 v[0:3], a[132:135], a[196:199], v[0:3]
s_add_u32 s30, s49, 1572864
ds_read_b64_tr_b16 a[164:165], v142 offset:8192
ds_read_b64_tr_b16 a[166:167], v142 offset:9216
v_mfma_f32_16x16x32_bf16 v[32:35], a[128:131], a[200:203], v[32:35]
buffer_load_dwordx4 v132, s[16:19], s30 offen offset:0 nt lds
v_mfma_f32_16x16x32_bf16 v[32:35], a[132:135], a[204:207], v[32:35]
ds_read_b64_tr_b16 a[168:169], v143 offset:0
ds_read_b64_tr_b16 a[170:171], v143 offset:1024
v_mfma_f32_16x16x32_bf16 v[64:67], a[128:131], a[208:211], v[64:67]
ds_read_b64_tr_b16 a[172:173], v143 offset:8192
ds_read_b64_tr_b16 a[174:175], v143 offset:9216
v_mfma_f32_16x16x32_bf16 v[64:67], a[132:135], a[212:215], v[64:67]
ds_read_b64_tr_b16 a[176:177], v144 offset:0
ds_read_b64_tr_b16 a[178:179], v144 offset:1024
v_mfma_f32_16x16x32_bf16 v[96:99], a[128:131], a[216:219], v[96:99]
ds_read_b64_tr_b16 a[180:181], v144 offset:8192
ds_read_b64_tr_b16 a[182:183], v144 offset:9216
v_mfma_f32_16x16x32_bf16 v[96:99], a[132:135], a[220:223], v[96:99]
buffer_load_dwordx4 v133, s[16:19], s30 offen offset:1024 nt lds
v_mfma_f32_16x16x32_bf16 v[4:7], a[136:139], a[192:195], v[4:7]
ds_read_b64_tr_b16 a[184:185], v145 offset:0
ds_read_b64_tr_b16 a[186:187], v145 offset:1024
v_mfma_f32_16x16x32_bf16 v[4:7], a[140:143], a[196:199], v[4:7]
ds_read_b64_tr_b16 a[188:189], v145 offset:8192
ds_read_b64_tr_b16 a[190:191], v145 offset:9216
v_mfma_f32_16x16x32_bf16 v[36:39], a[136:139], a[200:203], v[36:39]
v_mfma_f32_16x16x32_bf16 v[36:39], a[140:143], a[204:207], v[36:39]
v_mfma_f32_16x16x32_bf16 v[68:71], a[136:139], a[208:211], v[68:71]
v_mfma_f32_16x16x32_bf16 v[68:71], a[140:143], a[212:215], v[68:71]
buffer_load_dwordx4 v134, s[16:19], s30 offen offset:2048 nt lds
v_mfma_f32_16x16x32_bf16 v[100:103], a[136:139], a[216:219], v[100:103]
v_mfma_f32_16x16x32_bf16 v[100:103], a[140:143], a[220:223], v[100:103]
v_mfma_f32_16x16x32_bf16 v[8:11], a[144:147], a[192:195], v[8:11]
v_mfma_f32_16x16x32_bf16 v[8:11], a[148:151], a[196:199], v[8:11]
v_mfma_f32_16x16x32_bf16 v[40:43], a[144:147], a[200:203], v[40:43]
v_mfma_f32_16x16x32_bf16 v[40:43], a[148:151], a[204:207], v[40:43]
buffer_load_dwordx4 v135, s[16:19], s30 offen offset:3072 nt lds
v_mfma_f32_16x16x32_bf16 v[72:75], a[144:147], a[208:211], v[72:75]
v_mfma_f32_16x16x32_bf16 v[72:75], a[148:151], a[212:215], v[72:75]
s_mov_b32 s44, s76
v_mfma_f32_16x16x32_bf16 v[104:107], a[144:147], a[216:219], v[104:107]
s_and_b32 s45, s77, 0xffff
v_mfma_f32_16x16x32_bf16 v[104:107], a[148:151], a[220:223], v[104:107]
s_mov_b32 s46, 2097152
v_mfma_f32_16x16x32_bf16 v[12:15], a[152:155], a[192:195], v[12:15]
s_mul_i32 s25, s28, 2048
v_mfma_f32_16x16x32_bf16 v[12:15], a[156:159], a[196:199], v[12:15]
buffer_load_dword v170, v252, s[44:47], s25 offen offset:0
v_mfma_f32_16x16x32_bf16 v[44:47], a[152:155], a[200:203], v[44:47]
v_mfma_f32_16x16x32_bf16 v[44:47], a[156:159], a[204:207], v[44:47]
v_mfma_f32_16x16x32_bf16 v[76:79], a[152:155], a[208:211], v[76:79]
v_mfma_f32_16x16x32_bf16 v[76:79], a[156:159], a[212:215], v[76:79]
v_mfma_f32_16x16x32_bf16 v[108:111], a[152:155], a[216:219], v[108:111]
v_mfma_f32_16x16x32_bf16 v[108:111], a[156:159], a[220:223], v[108:111]
s_waitcnt lgkmcnt(0)
v_mfma_f32_16x16x32_bf16 v[16:19], a[160:163], a[192:195], v[16:19]
s_add_u32 m0, s29, 65536
ds_read_b64_tr_b16 a[128:129], v138 offset:16384
ds_read_b64_tr_b16 a[130:131], v138 offset:17408
v_mfma_f32_16x16x32_bf16 v[16:19], a[164:167], a[196:199], v[16:19]
s_add_u32 s30, s48, 512
ds_read_b64_tr_b16 a[132:133], v138 offset:24576
ds_read_b64_tr_b16 a[134:135], v138 offset:25600
v_mfma_f32_16x16x32_bf16 v[48:51], a[160:163], a[200:203], v[48:51]
buffer_load_dwordx4 v128, s[8:11], s30 offen offset:0  lds
v_mfma_f32_16x16x32_bf16 v[48:51], a[164:167], a[204:207], v[48:51]
ds_read_b64_tr_b16 a[136:137], v139 offset:16384
ds_read_b64_tr_b16 a[138:139], v139 offset:17408
v_mfma_f32_16x16x32_bf16 v[80:83], a[160:163], a[208:211], v[80:83]
ds_read_b64_tr_b16 a[140:141], v139 offset:24576
ds_read_b64_tr_b16 a[142:143], v139 offset:25600
v_mfma_f32_16x16x32_bf16 v[80:83], a[164:167], a[212:215], v[80:83]
ds_read_b64_tr_b16 a[144:145], v140 offset:16384
ds_read_b64_tr_b16 a[146:147], v140 offset:17408
v_mfma_f32_16x16x32_bf16 v[112:115], a[160:163], a[216:219], v[112:115]
ds_read_b64_tr_b16 a[148:149], v140 offset:24576
ds_read_b64_tr_b16 a[150:151], v140 offset:25600
v_mfma_f32_16x16x32_bf16 v[112:115], a[164:167], a[220:223], v[112:115]
ds_read_b64_tr_b16 a[152:153], v141 offset:16384
ds_read_b64_tr_b16 a[154:155], v141 offset:17408
v_mfma_f32_16x16x32_bf16 v[20:23], a[168:171], a[192:195], v[20:23]
ds_read_b64_tr_b16 a[156:157], v141 offset:24576
ds_read_b64_tr_b16 a[158:159], v141 offset:25600
v_mfma_f32_16x16x32_bf16 v[20:23], a[172:175], a[196:199], v[20:23]
buffer_load_dwordx4 v129, s[8:11], s30 offen offset:1024  lds
v_mfma_f32_16x16x32_bf16 v[52:55], a[168:171], a[200:203], v[52:55]
v_mfma_f32_16x16x32_bf16 v[52:55], a[172:175], a[204:207], v[52:55]
v_mfma_f32_16x16x32_bf16 v[84:87], a[168:171], a[208:211], v[84:87]
v_mfma_f32_16x16x32_bf16 v[84:87], a[172:175], a[212:215], v[84:87]
v_mfma_f32_16x16x32_bf16 v[116:119], a[168:171], a[216:219], v[116:119]
v_mfma_f32_16x16x32_bf16 v[116:119], a[172:175], a[220:223], v[116:119]
v_mfma_f32_16x16x32_bf16 v[24:27], a[176:179], a[192:195], v[24:27]
buffer_load_dwordx4 v130, s[8:11], s30 offen offset:2048  lds
v_mfma_f32_16x16x32_bf16 v[24:27], a[180:183], a[196:199], v[24:27]
v_mfma_f32_16x16x32_bf16 v[56:59], a[176:179], a[200:203], v[56:59]
v_mfma_f32_16x16x32_bf16 v[56:59], a[180:183], a[204:207], v[56:59]
v_mfma_f32_16x16x32_bf16 v[88:91], a[176:179], a[208:211], v[88:91]
v_mfma_f32_16x16x32_bf16 v[88:91], a[180:183], a[212:215], v[88:91]
v_mfma_f32_16x16x32_bf16 v[120:123], a[176:179], a[216:219], v[120:123]
v_mfma_f32_16x16x32_bf16 v[120:123], a[180:183], a[220:223], v[120:123]
buffer_load_dwordx4 v131, s[8:11], s30 offen offset:3072  lds
v_mfma_f32_16x16x32_bf16 v[28:31], a[184:187], a[192:195], v[28:31]
v_mfma_f32_16x16x32_bf16 v[28:31], a[188:191], a[196:199], v[28:31]
v_mfma_f32_16x16x32_bf16 v[60:63], a[184:187], a[200:203], v[60:63]
v_mfma_f32_16x16x32_bf16 v[60:63], a[188:191], a[204:207], v[60:63]
v_mfma_f32_16x16x32_bf16 v[92:95], a[184:187], a[208:211], v[92:95]
v_mfma_f32_16x16x32_bf16 v[92:95], a[188:191], a[212:215], v[92:95]
v_mfma_f32_16x16x32_bf16 v[124:127], a[184:187], a[216:219], v[124:127]
v_mfma_f32_16x16x32_bf16 v[124:127], a[188:191], a[220:223], v[124:127]
s_waitcnt lgkmcnt(0)
v_mfma_f32_16x16x32_bf16 a[0:3], a[192:195], a[128:131], a[0:3]
s_add_u32 m0, s29, 69632
ds_read_b64_tr_b16 a[160:161], v142 offset:16384
ds_read_b64_tr_b16 a[162:163], v142 offset:17408
v_mfma_f32_16x16x32_bf16 a[0:3], a[196:199], a[132:135], a[0:3]
s_add_u32 s30, s48, 33280
ds_read_b64_tr_b16 a[164:165], v142 offset:24576
ds_read_b64_tr_b16 a[166:167], v142 offset:25600
v_mfma_f32_16x16x32_bf16 a[4:7], a[200:203], a[128:131], a[4:7]
buffer_load_dwordx4 v128, s[8:11], s30 offen offset:0  lds
v_mfma_f32_16x16x32_bf16 a[4:7], a[204:207], a[132:135], a[4:7]
ds_read_b64_tr_b16 a[168:169], v143 offset:16384
ds_read_b64_tr_b16 a[170:171], v143 offset:17408
v_mfma_f32_16x16x32_bf16 a[64:67], a[208:211], a[128:131], a[64:67]
ds_read_b64_tr_b16 a[172:173], v143 offset:24576
ds_read_b64_tr_b16 a[174:175], v143 offset:25600
v_mfma_f32_16x16x32_bf16 a[64:67], a[212:215], a[132:135], a[64:67]
ds_read_b64_tr_b16 a[176:177], v144 offset:16384
ds_read_b64_tr_b16 a[178:179], v144 offset:17408
v_mfma_f32_16x16x32_bf16 a[68:71], a[216:219], a[128:131], a[68:71]
ds_read_b64_tr_b16 a[180:181], v144 offset:24576
ds_read_b64_tr_b16 a[182:183], v144 offset:25600
v_mfma_f32_16x16x32_bf16 a[68:71], a[220:223], a[132:135], a[68:71]
buffer_load_dwordx4 v129, s[8:11], s30 offen offset:1024  lds
v_mfma_f32_16x16x32_bf16 a[8:11], a[192:195], a[136:139], a[8:11]
ds_read_b64_tr_b16 a[184:185], v145 offset:16384
ds_read_b64_tr_b16 a[186:187], v145 offset:17408
v_mfma_f32_16x16x32_bf16 a[8:11], a[196:199], a[140:143], a[8:11]
ds_read_b64_tr_b16 a[188:189], v145 offset:24576
ds_read_b64_tr_b16 a[190:191], v145 offset:25600
v_mfma_f32_16x16x32_bf16 a[12:15], a[200:203], a[136:139], a[12:15]
v_add_u32 v136, 0xfffe8000, v136
v_add_u32 v137, 0xfffe8000, v137
v_mfma_f32_16x16x32_bf16 a[12:15], a[204:207], a[140:143], a[12:15]
v_add_u32 v138, 0xfffe8000, v138
v_add_u32 v139, 0xfffe8000, v139
v_mfma_f32_16x16x32_bf16 a[72:75], a[208:211], a[136:139], a[72:75]
v_add_u32 v140, 0xfffe8000, v140
v_add_u32 v141, 0xfffe8000, v141
v_mfma_f32_16x16x32_bf16 a[72:75], a[212:215], a[140:143], a[72:75]
buffer_load_dwordx4 v130, s[8:11], s30 offen offset:2048  lds
v_mfma_f32_16x16x32_bf16 a[76:79], a[216:219], a[136:139], a[76:79]
v_add_u32 v142, 0xfffe8000, v142
v_add_u32 v143, 0xfffe8000, v143
v_mfma_f32_16x16x32_bf16 a[76:79], a[220:223], a[140:143], a[76:79]
v_add_u32 v144, 0xfffe8000, v144
v_add_u32 v145, 0xfffe8000, v145
v_mfma_f32_16x16x32_bf16 a[16:19], a[192:195], a[144:147], a[16:19]
v_mfma_f32_16x16x32_bf16 a[16:19], a[196:199], a[148:151], a[16:19]
v_mfma_f32_16x16x32_bf16 a[20:23], a[200:203], a[144:147], a[20:23]
v_mfma_f32_16x16x32_bf16 a[20:23], a[204:207], a[148:151], a[20:23]
buffer_load_dwordx4 v131, s[8:11], s30 offen offset:3072  lds
v_mfma_f32_16x16x32_bf16 a[80:83], a[208:211], a[144:147], a[80:83]
v_mfma_f32_16x16x32_bf16 a[80:83], a[212:215], a[148:151], a[80:83]
v_mfma_f32_16x16x32_bf16 a[84:87], a[216:219], a[144:147], a[84:87]
v_mfma_f32_16x16x32_bf16 a[84:87], a[220:223], a[148:151], a[84:87]
v_mfma_f32_16x16x32_bf16 a[24:27], a[192:195], a[152:155], a[24:27]
v_mfma_f32_16x16x32_bf16 a[24:27], a[196:199], a[156:159], a[24:27]
buffer_load_dword v170, v252, s[44:47], s25 offen offset:1024
v_mfma_f32_16x16x32_bf16 a[28:31], a[200:203], a[152:155], a[28:31]
v_mfma_f32_16x16x32_bf16 a[28:31], a[204:207], a[156:159], a[28:31]
v_mfma_f32_16x16x32_bf16 a[88:91], a[208:211], a[152:155], a[88:91]
v_mfma_f32_16x16x32_bf16 a[88:91], a[212:215], a[156:159], a[88:91]
v_mfma_f32_16x16x32_bf16 a[92:95], a[216:219], a[152:155], a[92:95]
v_mfma_f32_16x16x32_bf16 a[92:95], a[220:223], a[156:159], a[92:95]
s_waitcnt vmcnt(10) lgkmcnt(0)
s_barrier
v_mfma_f32_16x16x32_bf16 a[32:35], a[192:195], a[160:163], a[32:35]
ds_read_b128 a[224:227], v136 offset:0
v_mfma_f32_16x16x32_bf16 a[32:35], a[196:199], a[164:167], a[32:35]
ds_read_b128 a[228:231], v137 offset:0
v_mfma_f32_16x16x32_bf16 a[36:39], a[200:203], a[160:163], a[36:39]
buffer_store_dword v165, v173, s[96:99], 0 offen sc1
v_mfma_f32_16x16x32_bf16 a[36:39], a[204:207], a[164:167], a[36:39]
ds_read_b128 a[232:235], v136 offset:2048
v_mfma_f32_16x16x32_bf16 a[96:99], a[208:211], a[160:163], a[96:99]
ds_read_b128 a[236:239], v137 offset:2048
v_mfma_f32_16x16x32_bf16 a[96:99], a[212:215], a[164:167], a[96:99]
s_add_u32 m0, s31, 98304
ds_read_b128 a[240:243], v136 offset:4096
v_mfma_f32_16x16x32_bf16 a[100:103], a[216:219], a[160:163], a[100:103]
s_add_u32 s30, s49, 2097152
ds_read_b128 a[244:247], v137 offset:4096
v_mfma_f32_16x16x32_bf16 a[100:103], a[220:223], a[164:167], a[100:103]
buffer_load_dwordx4 v132, s[12:15], s30 offen offset:0 nt lds
v_mfma_f32_16x16x32_bf16 a[40:43], a[192:195], a[168:171], a[40:43]
ds_read_b128 a[248:251], v136 offset:6144
v_mfma_f32_16x16x32_bf16 a[40:43], a[196:199], a[172:175], a[40:43]
ds_read_b128 a[252:255], v137 offset:6144
v_mfma_f32_16x16x32_bf16 a[44:47], a[200:203], a[168:171], a[44:47]
ds_read_b64_tr_b16 a[128:129], v138 offset:0
ds_read_b64_tr_b16 a[130:131], v138 offset:1024
v_mfma_f32_16x16x32_bf16 a[44:47], a[204:207], a[172:175], a[44:47]
ds_read_b64_tr_b16 a[132:133], v138 offset:8192
ds_read_b64_tr_b16 a[134:135], v138 offset:9216
v_mfma_f32_16x16x32_bf16 a[104:107], a[208:211], a[168:171], a[104:107]
ds_read_b64_tr_b16 a[136:137], v139 offset:0
ds_read_b64_tr_b16 a[138:139], v139 offset:1024
v_mfma_f32_16x16x32_bf16 a[104:107], a[212:215], a[172:175], a[104:107]
buffer_load_dwordx4 v133, s[12:15], s30 offen offset:1024 nt lds
v_mfma_f32_16x16x32_bf16 a[108:111], a[216:219], a[168:171], a[108:111]
ds_read_b64_tr_b16 a[140:141], v139 offset:8192
ds_read_b64_tr_b16 a[142:143], v139 offset:9216
v_mfma_f32_16x16x32_bf16 a[108:111], a[220:223], a[172:175], a[108:111]
ds_read_b64_tr_b16 a[144:145], v140 offset:0
ds_read_b64_tr_b16 a[146:147], v140 offset:1024
v_mfma_f32_16x16x32_bf16 a[48:51], a[192:195], a[176:179], a[48:51]
ds_read_b64_tr_b16 a[148:149], v140 offset:8192
ds_read_b64_tr_b16 a[150:151], v140 offset:9216
v_mfma_f32_16x16x32_bf16 a[48:51], a[196:199], a[180:183], a[48:51]
ds_read_b64_tr_b16 a[152:153], v141 offset:0
ds_read_b64_tr_b16 a[154:155], v141 offset:1024
v_mfma_f32_16x16x32_bf16 a[52:55], a[200:203], a[176:179], a[52:55]
ds_read_b64_tr_b16 a[156:157], v141 offset:8192
ds_read_b64_tr_b16 a[158:159], v141 offset:9216
v_mfma_f32_16x16x32_bf16 a[52:55], a[204:207], a[180:183], a[52:55]
buffer_load_dwordx4 v134, s[12:15], s30 offen offset:2048 nt lds
v_mfma_f32_16x16x32_bf16 a[112:115], a[208:211], a[176:179], a[112:115]
v_mfma_f32_16x16x32_bf16 a[112:115], a[212:215], a[180:183], a[112:115]
v_mfma_f32_16x16x32_bf16 a[116:119], a[216:219], a[176:179], a[116:119]
v_mfma_f32_16x16x32_bf16 a[116:119], a[220:223], a[180:183], a[116:119]
v_mfma_f32_16x16x32_bf16 a[56:59], a[192:195], a[184:187], a[56:59]
v_mfma_f32_16x16x32_bf16 a[56:59], a[196:199], a[188:191], a[56:59]
buffer_load_dwordx4 v135, s[12:15], s30 offen offset:3072 nt lds
v_mfma_f32_16x16x32_bf16 a[60:63], a[200:203], a[184:187], a[60:63]
v_mfma_f32_16x16x32_bf16 a[60:63], a[204:207], a[188:191], a[60:63]
v_mfma_f32_16x16x32_bf16 a[120:123], a[208:211], a[184:187], a[120:123]
v_mfma_f32_16x16x32_bf16 a[120:123], a[212:215], a[188:191], a[120:123]
v_mfma_f32_16x16x32_bf16 a[124:127], a[216:219], a[184:187], a[124:127]
v_mfma_f32_16x16x32_bf16 a[124:127], a[220:223], a[188:191], a[124:127]
s_waitcnt lgkmcnt(0)
v_mfma_f32_16x16x32_bf16 v[0:3], a[128:131], a[224:227], v[0:3]
s_add_u32 m0, s31, 114688
ds_read_b64_tr_b16 a[160:161], v142 offset:0
ds_read_b64_tr_b16 a[162:163], v142 offset:1024
v_mfma_f32_16x16x32_bf16 v[0:3], a[132:135], a[228:231], v[0:3]
s_add_u32 s30, s49, 2097152
ds_read_b64_tr_b16 a[164:165], v142 offset:8192
ds_read_b64_tr_b16 a[166:167], v142 offset:9216
v_mfma_f32_16x16x32_bf16 v[32:35], a[128:131], a[232:235], v[32:35]
buffer_load_dwordx4 v132, s[16:19], s30 offen offset:0 nt lds
v_mfma_f32_16x16x32_bf16 v[32:35], a[132:135], a[236:239], v[32:35]
ds_read_b64_tr_b16 a[168:169], v143 offset:0
ds_read_b64_tr_b16 a[170:171], v143 offset:1024
v_mfma_f32_16x16x32_bf16 v[64:67], a[128:131], a[240:243], v[64:67]
ds_read_b64_tr_b16 a[172:173], v143 offset:8192
ds_read_b64_tr_b16 a[174:175], v143 offset:9216
v_mfma_f32_16x16x32_bf16 v[64:67], a[132:135], a[244:247], v[64:67]
ds_read_b64_tr_b16 a[176:177], v144 offset:0
ds_read_b64_tr_b16 a[178:179], v144 offset:1024
v_mfma_f32_16x16x32_bf16 v[96:99], a[128:131], a[248:251], v[96:99]
ds_read_b64_tr_b16 a[180:181], v144 offset:8192
ds_read_b64_tr_b16 a[182:183], v144 offset:9216
v_mfma_f32_16x16x32_bf16 v[96:99], a[132:135], a[252:255], v[96:99]
buffer_load_dwordx4 v133, s[16:19], s30 offen offset:1024 nt lds
v_mfma_f32_16x16x32_bf16 v[4:7], a[136:139], a[224:227], v[4:7]
ds_read_b64_tr_b16 a[184:185], v145 offset:0
ds_read_b64_tr_b16 a[186:187], v145 offset:1024
v_mfma_f32_16x16x32_bf16 v[4:7], a[140:143], a[228:231], v[4:7]
ds_read_b64_tr_b16 a[188:189], v145 offset:8192
ds_read_b64_tr_b16 a[190:191], v145 offset:9216
v_mfma_f32_16x16x32_bf16 v[36:39], a[136:139], a[232:235], v[36:39]
v_mfma_f32_16x16x32_bf16 v[36:39], a[140:143], a[236:239], v[36:39]
v_mfma_f32_16x16x32_bf16 v[68:71], a[136:139], a[240:243], v[68:71]
v_mfma_f32_16x16x32_bf16 v[68:71], a[140:143], a[244:247], v[68:71]
buffer_load_dwordx4 v134, s[16:19], s30 offen offset:2048 nt lds
v_mfma_f32_16x16x32_bf16 v[100:103], a[136:139], a[248:251], v[100:103]
v_mfma_f32_16x16x32_bf16 v[100:103], a[140:143], a[252:255], v[100:103]
v_mfma_f32_16x16x32_bf16 v[8:11], a[144:147], a[224:227], v[8:11]
v_mfma_f32_16x16x32_bf16 v[8:11], a[148:151], a[228:231], v[8:11]
v_mfma_f32_16x16x32_bf16 v[40:43], a[144:147], a[232:235], v[40:43]
v_mfma_f32_16x16x32_bf16 v[40:43], a[148:151], a[236:239], v[40:43]
buffer_load_dwordx4 v135, s[16:19], s30 offen offset:3072 nt lds
v_mfma_f32_16x16x32_bf16 v[72:75], a[144:147], a[240:243], v[72:75]
v_mfma_f32_16x16x32_bf16 v[72:75], a[148:151], a[244:247], v[72:75]
s_mov_b32 s44, s80
v_mfma_f32_16x16x32_bf16 v[104:107], a[144:147], a[248:251], v[104:107]
s_and_b32 s45, s81, 0xffff
v_mfma_f32_16x16x32_bf16 v[104:107], a[148:151], a[252:255], v[104:107]
s_mov_b32 s46, 4194304
v_mfma_f32_16x16x32_bf16 v[12:15], a[152:155], a[224:227], v[12:15]
s_mul_i32 s25, s28, 4096
v_mfma_f32_16x16x32_bf16 v[12:15], a[156:159], a[228:231], v[12:15]
buffer_load_dword v170, v252, s[44:47], s25 offen offset:0
v_mfma_f32_16x16x32_bf16 v[44:47], a[152:155], a[232:235], v[44:47]
v_mfma_f32_16x16x32_bf16 v[44:47], a[156:159], a[236:239], v[44:47]
v_mfma_f32_16x16x32_bf16 v[76:79], a[152:155], a[240:243], v[76:79]
v_mfma_f32_16x16x32_bf16 v[76:79], a[156:159], a[244:247], v[76:79]
v_mfma_f32_16x16x32_bf16 v[108:111], a[152:155], a[248:251], v[108:111]
v_mfma_f32_16x16x32_bf16 v[108:111], a[156:159], a[252:255], v[108:111]
s_waitcnt lgkmcnt(0)
v_mfma_f32_16x16x32_bf16 v[16:19], a[160:163], a[224:227], v[16:19]
s_add_u32 m0, s29, 131072
ds_read_b64_tr_b16 a[128:129], v138 offset:16384
ds_read_b64_tr_b16 a[130:131], v138 offset:17408
v_mfma_f32_16x16x32_bf16 v[16:19], a[164:167], a[228:231], v[16:19]
s_add_u32 s30, s48, 640
ds_read_b64_tr_b16 a[132:133], v138 offset:24576
ds_read_b64_tr_b16 a[134:135], v138 offset:25600
v_mfma_f32_16x16x32_bf16 v[48:51], a[160:163], a[232:235], v[48:51]
buffer_load_dwordx4 v128, s[8:11], s30 offen offset:0  lds
v_mfma_f32_16x16x32_bf16 v[48:51], a[164:167], a[236:239], v[48:51]
ds_read_b64_tr_b16 a[136:137], v139 offset:16384
ds_read_b64_tr_b16 a[138:139], v139 offset:17408
v_mfma_f32_16x16x32_bf16 v[80:83], a[160:163], a[240:243], v[80:83]
ds_read_b64_tr_b16 a[140:141], v139 offset:24576
ds_read_b64_tr_b16 a[142:143], v139 offset:25600
v_mfma_f32_16x16x32_bf16 v[80:83], a[164:167], a[244:247], v[80:83]
ds_read_b64_tr_b16 a[144:145], v140 offset:16384
ds_read_b64_tr_b16 a[146:147], v140 offset:17408
v_mfma_f32_16x16x32_bf16 v[112:115], a[160:163], a[248:251], v[112:115]
ds_read_b64_tr_b16 a[148:149], v140 offset:24576
ds_read_b64_tr_b16 a[150:151], v140 offset:25600
v_mfma_f32_16x16x32_bf16 v[112:115], a[164:167], a[252:255], v[112:115]
ds_read_b64_tr_b16 a[152:153], v141 offset:16384
ds_read_b64_tr_b16 a[154:155], v141 offset:17408
v_mfma_f32_16x16x32_bf16 v[20:23], a[168:171], a[224:227], v[20:23]
ds_read_b64_tr_b16 a[156:157], v141 offset:24576
ds_read_b64_tr_b16 a[158:159], v141 offset:25600
v_mfma_f32_16x16x32_bf16 v[20:23], a[172:175], a[228:231], v[20:23]
buffer_load_dwordx4 v129, s[8:11], s30 offen offset:1024  lds
v_mfma_f32_16x16x32_bf16 v[52:55], a[168:171], a[232:235], v[52:55]
v_mfma_f32_16x16x32_bf16 v[52:55], a[172:175], a[236:239], v[52:55]
v_mfma_f32_16x16x32_bf16 v[84:87], a[168:171], a[240:243], v[84:87]
v_mfma_f32_16x16x32_bf16 v[84:87], a[172:175], a[244:247], v[84:87]
v_mfma_f32_16x16x32_bf16 v[116:119], a[168:171], a[248:251], v[116:119]
v_mfma_f32_16x16x32_bf16 v[116:119], a[172:175], a[252:255], v[116:119]
v_mfma_f32_16x16x32_bf16 v[24:27], a[176:179], a[224:227], v[24:27]
buffer_load_dwordx4 v130, s[8:11], s30 offen offset:2048  lds
v_mfma_f32_16x16x32_bf16 v[24:27], a[180:183], a[228:231], v[24:27]
v_mfma_f32_16x16x32_bf16 v[56:59], a[176:179], a[232:235], v[56:59]
v_mfma_f32_16x16x32_bf16 v[56:59], a[180:183], a[236:239], v[56:59]
v_mfma_f32_16x16x32_bf16 v[88:91], a[176:179], a[240:243], v[88:91]
v_mfma_f32_16x16x32_bf16 v[88:91], a[180:183], a[244:247], v[88:91]
v_mfma_f32_16x16x32_bf16 v[120:123], a[176:179], a[248:251], v[120:123]
v_mfma_f32_16x16x32_bf16 v[120:123], a[180:183], a[252:255], v[120:123]
buffer_load_dwordx4 v131, s[8:11], s30 offen offset:3072  lds
v_mfma_f32_16x16x32_bf16 v[28:31], a[184:187], a[224:227], v[28:31]
v_mfma_f32_16x16x32_bf16 v[28:31], a[188:191], a[228:231], v[28:31]
v_mfma_f32_16x16x32_bf16 v[60:63], a[184:187], a[232:235], v[60:63]
v_mfma_f32_16x16x32_bf16 v[60:63], a[188:191], a[236:239], v[60:63]
v_mfma_f32_16x16x32_bf16 v[92:95], a[184:187], a[240:243], v[92:95]
v_mfma_f32_16x16x32_bf16 v[92:95], a[188:191], a[244:247], v[92:95]
v_mfma_f32_16x16x32_bf16 v[124:127], a[184:187], a[248:251], v[124:127]
v_mfma_f32_16x16x32_bf16 v[124:127], a[188:191], a[252:255], v[124:127]
s_waitcnt lgkmcnt(0)
v_mfma_f32_16x16x32_bf16 a[0:3], a[224:227], a[128:131], a[0:3]
s_add_u32 m0, s29, 135168
ds_read_b64_tr_b16 a[160:161], v142 offset:16384
ds_read_b64_tr_b16 a[162:163], v142 offset:17408
v_mfma_f32_16x16x32_bf16 a[0:3], a[228:231], a[132:135], a[0:3]
s_add_u32 s30, s48, 33408
ds_read_b64_tr_b16 a[164:165], v142 offset:24576
ds_read_b64_tr_b16 a[166:167], v142 offset:25600
v_mfma_f32_16x16x32_bf16 a[4:7], a[232:235], a[128:131], a[4:7]
buffer_load_dwordx4 v128, s[8:11], s30 offen offset:0  lds
v_mfma_f32_16x16x32_bf16 a[4:7], a[236:239], a[132:135], a[4:7]
ds_read_b64_tr_b16 a[168:169], v143 offset:16384
ds_read_b64_tr_b16 a[170:171], v143 offset:17408
v_mfma_f32_16x16x32_bf16 a[64:67], a[240:243], a[128:131], a[64:67]
ds_read_b64_tr_b16 a[172:173], v143 offset:24576
ds_read_b64_tr_b16 a[174:175], v143 offset:25600
v_mfma_f32_16x16x32_bf16 a[64:67], a[244:247], a[132:135], a[64:67]
ds_read_b64_tr_b16 a[176:177], v144 offset:16384
ds_read_b64_tr_b16 a[178:179], v144 offset:17408
v_mfma_f32_16x16x32_bf16 a[68:71], a[248:251], a[128:131], a[68:71]
ds_read_b64_tr_b16 a[180:181], v144 offset:24576
ds_read_b64_tr_b16 a[182:183], v144 offset:25600
v_mfma_f32_16x16x32_bf16 a[68:71], a[252:255], a[132:135], a[68:71]
buffer_load_dwordx4 v129, s[8:11], s30 offen offset:1024  lds
v_mfma_f32_16x16x32_bf16 a[8:11], a[224:227], a[136:139], a[8:11]
ds_read_b64_tr_b16 a[184:185], v145 offset:16384
ds_read_b64_tr_b16 a[186:187], v145 offset:17408
v_mfma_f32_16x16x32_bf16 a[8:11], a[228:231], a[140:143], a[8:11]
ds_read_b64_tr_b16 a[188:189], v145 offset:24576
ds_read_b64_tr_b16 a[190:191], v145 offset:25600
v_mfma_f32_16x16x32_bf16 a[12:15], a[232:235], a[136:139], a[12:15]
v_add_u32 v136, 0x10000, v136
v_add_u32 v137, 0x10000, v137
v_mfma_f32_16x16x32_bf16 a[12:15], a[236:239], a[140:143], a[12:15]
v_add_u32 v138, 0x10000, v138
v_add_u32 v139, 0x10000, v139
v_mfma_f32_16x16x32_bf16 a[72:75], a[240:243], a[136:139], a[72:75]
v_add_u32 v140, 0x10000, v140
v_add_u32 v141, 0x10000, v141
v_mfma_f32_16x16x32_bf16 a[72:75], a[244:247], a[140:143], a[72:75]
buffer_load_dwordx4 v130, s[8:11], s30 offen offset:2048  lds
v_mfma_f32_16x16x32_bf16 a[76:79], a[248:251], a[136:139], a[76:79]
v_add_u32 v142, 0x10000, v142
v_add_u32 v143, 0x10000, v143
v_mfma_f32_16x16x32_bf16 a[76:79], a[252:255], a[140:143], a[76:79]
v_add_u32 v144, 0x10000, v144
v_add_u32 v145, 0x10000, v145
v_mfma_f32_16x16x32_bf16 a[16:19], a[224:227], a[144:147], a[16:19]
v_mfma_f32_16x16x32_bf16 a[16:19], a[228:231], a[148:151], a[16:19]
v_mfma_f32_16x16x32_bf16 a[20:23], a[232:235], a[144:147], a[20:23]
v_mfma_f32_16x16x32_bf16 a[20:23], a[236:239], a[148:151], a[20:23]
buffer_load_dwordx4 v131, s[8:11], s30 offen offset:3072  lds
v_mfma_f32_16x16x32_bf16 a[80:83], a[240:243], a[144:147], a[80:83]
v_mfma_f32_16x16x32_bf16 a[80:83], a[244:247], a[148:151], a[80:83]
v_mfma_f32_16x16x32_bf16 a[84:87], a[248:251], a[144:147], a[84:87]
v_mfma_f32_16x16x32_bf16 a[84:87], a[252:255], a[148:151], a[84:87]
v_mfma_f32_16x16x32_bf16 a[24:27], a[224:227], a[152:155], a[24:27]
v_mfma_f32_16x16x32_bf16 a[24:27], a[228:231], a[156:159], a[24:27]
buffer_load_dword v170, v252, s[44:47], s25 offen offset:1024
v_mfma_f32_16x16x32_bf16 a[28:31], a[232:235], a[152:155], a[28:31]
v_mfma_f32_16x16x32_bf16 a[28:31], a[236:239], a[156:159], a[28:31]
v_mfma_f32_16x16x32_bf16 a[88:91], a[240:243], a[152:155], a[88:91]
v_mfma_f32_16x16x32_bf16 a[88:91], a[244:247], a[156:159], a[88:91]
v_mfma_f32_16x16x32_bf16 a[92:95], a[248:251], a[152:155], a[92:95]
v_mfma_f32_16x16x32_bf16 a[92:95], a[252:255], a[156:159], a[92:95]
s_waitcnt vmcnt(10) lgkmcnt(0)
s_barrier
v_mfma_f32_16x16x32_bf16 a[32:35], a[224:227], a[160:163], a[32:35]
s_add_u32 m0, s31, 0
ds_read_b128 a[192:195], v136 offset:0
v_mfma_f32_16x16x32_bf16 a[32:35], a[228:231], a[164:167], a[32:35]
s_add_u32 s30, s49, 2621440
ds_read_b128 a[196:199], v137 offset:0
v_mfma_f32_16x16x32_bf16 a[36:39], a[232:235], a[160:163], a[36:39]
buffer_load_dwordx4 v132, s[12:15], s30 offen offset:0 nt lds
v_mfma_f32_16x16x32_bf16 a[36:39], a[236:239], a[164:167], a[36:39]
ds_read_b128 a[200:203], v136 offset:2048
v_mfma_f32_16x16x32_bf16 a[96:99], a[240:243], a[160:163], a[96:99]
ds_read_b128 a[204:207], v137 offset:2048
v_mfma_f32_16x16x32_bf16 a[96:99], a[244:247], a[164:167], a[96:99]
ds_read_b128 a[208:211], v136 offset:4096
v_mfma_f32_16x16x32_bf16 a[100:103], a[248:251], a[160:163], a[100:103]
ds_read_b128 a[212:215], v137 offset:4096
v_mfma_f32_16x16x32_bf16 a[100:103], a[252:255], a[164:167], a[100:103]
ds_read_b128 a[216:219], v136 offset:6144
v_mfma_f32_16x16x32_bf16 a[40:43], a[224:227], a[168:171], a[40:43]
ds_read_b128 a[220:223], v137 offset:6144
v_mfma_f32_16x16x32_bf16 a[40:43], a[228:231], a[172:175], a[40:43]
buffer_load_dwordx4 v133, s[12:15], s30 offen offset:1024 nt lds
v_mfma_f32_16x16x32_bf16 a[44:47], a[232:235], a[168:171], a[44:47]
ds_read_b64_tr_b16 a[128:129], v138 offset:0
ds_read_b64_tr_b16 a[130:131], v138 offset:1024
v_mfma_f32_16x16x32_bf16 a[44:47], a[236:239], a[172:175], a[44:47]
ds_read_b64_tr_b16 a[132:133], v138 offset:8192
ds_read_b64_tr_b16 a[134:135], v138 offset:9216
v_mfma_f32_16x16x32_bf16 a[104:107], a[240:243], a[168:171], a[104:107]
ds_read_b64_tr_b16 a[136:137], v139 offset:0
ds_read_b64_tr_b16 a[138:139], v139 offset:1024
v_mfma_f32_16x16x32_bf16 a[104:107], a[244:247], a[172:175], a[104:107]
ds_read_b64_tr_b16 a[140:141], v139 offset:8192
ds_read_b64_tr_b16 a[142:143], v139 offset:9216
v_mfma_f32_16x16x32_bf16 a[108:111], a[248:251], a[168:171], a[108:111]
ds_read_b64_tr_b16 a[144:145], v140 offset:0
ds_read_b64_tr_b16 a[146:147], v140 offset:1024
v_mfma_f32_16x16x32_bf16 a[108:111], a[252:255], a[172:175], a[108:111]
ds_read_b64_tr_b16 a[148:149], v140 offset:8192
ds_read_b64_tr_b16 a[150:151], v140 offset:9216
v_mfma_f32_16x16x32_bf16 a[48:51], a[224:227], a[176:179], a[48:51]
buffer_load_dwordx4 v134, s[12:15], s30 offen offset:2048 nt lds
v_mfma_f32_16x16x32_bf16 a[48:51], a[228:231], a[180:183], a[48:51]
ds_read_b64_tr_b16 a[152:153], v141 offset:0
ds_read_b64_tr_b16 a[154:155], v141 offset:1024
v_mfma_f32_16x16x32_bf16 a[52:55], a[232:235], a[176:179], a[52:55]
ds_read_b64_tr_b16 a[156:157], v141 offset:8192
ds_read_b64_tr_b16 a[158:159], v141 offset:9216
v_mfma_f32_16x16x32_bf16 a[52:55], a[236:239], a[180:183], a[52:55]
v_mfma_f32_16x16x32_bf16 a[112:115], a[240:243], a[176:179], a[112:115]
v_mfma_f32_16x16x32_bf16 a[112:115], a[244:247], a[180:183], a[112:115]
v_mfma_f32_16x16x32_bf16 a[116:119], a[248:251], a[176:179], a[116:119]
v_mfma_f32_16x16x32_bf16 a[116:119], a[252:255], a[180:183], a[116:119]
buffer_load_dwordx4 v135, s[12:15], s30 offen offset:3072 nt lds
v_mfma_f32_16x16x32_bf16 a[56:59], a[224:227], a[184:187], a[56:59]
v_mfma_f32_16x16x32_bf16 a[56:59], a[228:231], a[188:191], a[56:59]
v_mfma_f32_16x16x32_bf16 a[60:63], a[232:235], a[184:187], a[60:63]
v_mfma_f32_16x16x32_bf16 a[60:63], a[236:239], a[188:191], a[60:63]
v_mfma_f32_16x16x32_bf16 a[120:123], a[240:243], a[184:187], a[120:123]
v_mfma_f32_16x16x32_bf16 a[120:123], a[244:247], a[188:191], a[120:123]
v_mfma_f32_16x16x32_bf16 a[124:127], a[248:251], a[184:187], a[124:127]
v_mfma_f32_16x16x32_bf16 a[124:127], a[252:255], a[188:191], a[124:127]
s_waitcnt lgkmcnt(0)
v_mfma_f32_16x16x32_bf16 v[0:3], a[128:131], a[192:195], v[0:3]
s_add_u32 m0, s31, 16384
ds_read_b64_tr_b16 a[160:161], v142 offset:0
ds_read_b64_tr_b16 a[162:163], v142 offset:1024
v_mfma_f32_16x16x32_bf16 v[0:3], a[132:135], a[196:199], v[0:3]
s_add_u32 s30, s49, 2621440
ds_read_b64_tr_b16 a[164:165], v142 offset:8192
ds_read_b64_tr_b16 a[166:167], v142 offset:9216
v_mfma_f32_16x16x32_bf16 v[32:35], a[128:131], a[200:203], v[32:35]
buffer_load_dwordx4 v132, s[16:19], s30 offen offset:0 nt lds
v_mfma_f32_16x16x32_bf16 v[32:35], a[132:135], a[204:207], v[32:35]
ds_read_b64_tr_b16 a[168:169], v143 offset:0
ds_read_b64_tr_b16 a[170:171], v143 offset:1024
v_mfma_f32_16x16x32_bf16 v[64:67], a[128:131], a[208:211], v[64:67]
ds_read_b64_tr_b16 a[172:173], v143 offset:8192
ds_read_b64_tr_b16 a[174:175], v143 offset:9216
v_mfma_f32_16x16x32_bf16 v[64:67], a[132:135], a[212:215], v[64:67]
ds_read_b64_tr_b16 a[176:177], v144 offset:0
ds_read_b64_tr_b16 a[178:179], v144 offset:1024
v_mfma_f32_16x16x32_bf16 v[96:99], a[128:131], a[216:219], v[96:99]
ds_read_b64_tr_b16 a[180:181], v144 offset:8192
ds_read_b64_tr_b16 a[182:183], v144 offset:9216
v_mfma_f32_16x16x32_bf16 v[96:99], a[132:135], a[220:223], v[96:99]
buffer_load_dwordx4 v133, s[16:19], s30 offen offset:1024 nt lds
v_mfma_f32_16x16x32_bf16 v[4:7], a[136:139], a[192:195], v[4:7]
ds_read_b64_tr_b16 a[184:185], v145 offset:0
ds_read_b64_tr_b16 a[186:187], v145 offset:1024
v_mfma_f32_16x16x32_bf16 v[4:7], a[140:143], a[196:199], v[4:7]
ds_read_b64_tr_b16 a[188:189], v145 offset:8192
ds_read_b64_tr_b16 a[190:191], v145 offset:9216
v_mfma_f32_16x16x32_bf16 v[36:39], a[136:139], a[200:203], v[36:39]
v_mfma_f32_16x16x32_bf16 v[36:39], a[140:143], a[204:207], v[36:39]
v_mfma_f32_16x16x32_bf16 v[68:71], a[136:139], a[208:211], v[68:71]
v_mfma_f32_16x16x32_bf16 v[68:71], a[140:143], a[212:215], v[68:71]
buffer_load_dwordx4 v134, s[16:19], s30 offen offset:2048 nt lds
v_mfma_f32_16x16x32_bf16 v[100:103], a[136:139], a[216:219], v[100:103]
v_mfma_f32_16x16x32_bf16 v[100:103], a[140:143], a[220:223], v[100:103]
v_mfma_f32_16x16x32_bf16 v[8:11], a[144:147], a[192:195], v[8:11]
v_mfma_f32_16x16x32_bf16 v[8:11], a[148:151], a[196:199], v[8:11]
v_mfma_f32_16x16x32_bf16 v[40:43], a[144:147], a[200:203], v[40:43]
v_mfma_f32_16x16x32_bf16 v[40:43], a[148:151], a[204:207], v[40:43]
buffer_load_dwordx4 v135, s[16:19], s30 offen offset:3072 nt lds
v_mfma_f32_16x16x32_bf16 v[72:75], a[144:147], a[208:211], v[72:75]
v_mfma_f32_16x16x32_bf16 v[72:75], a[148:151], a[212:215], v[72:75]
v_mfma_f32_16x16x32_bf16 v[104:107], a[144:147], a[216:219], v[104:107]
v_mfma_f32_16x16x32_bf16 v[104:107], a[148:151], a[220:223], v[104:107]
v_mfma_f32_16x16x32_bf16 v[12:15], a[152:155], a[192:195], v[12:15]
v_mfma_f32_16x16x32_bf16 v[12:15], a[156:159], a[196:199], v[12:15]
buffer_load_dword v170, v252, s[44:47], s25 offen offset:2048
v_mfma_f32_16x16x32_bf16 v[44:47], a[152:155], a[200:203], v[44:47]
v_mfma_f32_16x16x32_bf16 v[44:47], a[156:159], a[204:207], v[44:47]
v_mfma_f32_16x16x32_bf16 v[76:79], a[152:155], a[208:211], v[76:79]
v_mfma_f32_16x16x32_bf16 v[76:79], a[156:159], a[212:215], v[76:79]
v_mfma_f32_16x16x32_bf16 v[108:111], a[152:155], a[216:219], v[108:111]
v_mfma_f32_16x16x32_bf16 v[108:111], a[156:159], a[220:223], v[108:111]
s_waitcnt lgkmcnt(0)
v_mfma_f32_16x16x32_bf16 v[16:19], a[160:163], a[192:195], v[16:19]
s_add_u32 m0, s29, 32768
ds_read_b64_tr_b16 a[128:129], v138 offset:16384
ds_read_b64_tr_b16 a[130:131], v138 offset:17408
v_mfma_f32_16x16x32_bf16 v[16:19], a[164:167], a[196:199], v[16:19]
s_add_u32 s30, s48, 768
ds_read_b64_tr_b16 a[132:133], v138 offset:24576
ds_read_b64_tr_b16 a[134:135], v138 offset:25600
v_mfma_f32_16x16x32_bf16 v[48:51], a[160:163], a[200:203], v[48:51]
buffer_load_dwordx4 v128, s[8:11], s30 offen offset:0  lds
v_mfma_f32_16x16x32_bf16 v[48:51], a[164:167], a[204:207], v[48:51]
ds_read_b64_tr_b16 a[136:137], v139 offset:16384
ds_read_b64_tr_b16 a[138:139], v139 offset:17408
v_mfma_f32_16x16x32_bf16 v[80:83], a[160:163], a[208:211], v[80:83]
ds_read_b64_tr_b16 a[140:141], v139 offset:24576
ds_read_b64_tr_b16 a[142:143], v139 offset:25600
v_mfma_f32_16x16x32_bf16 v[80:83], a[164:167], a[212:215], v[80:83]
ds_read_b64_tr_b16 a[144:145], v140 offset:16384
ds_read_b64_tr_b16 a[146:147], v140 offset:17408
v_mfma_f32_16x16x32_bf16 v[112:115], a[160:163], a[216:219], v[112:115]
ds_read_b64_tr_b16 a[148:149], v140 offset:24576
ds_read_b64_tr_b16 a[150:151], v140 offset:25600
v_mfma_f32_16x16x32_bf16 v[112:115], a[164:167], a[220:223], v[112:115]
ds_read_b64_tr_b16 a[152:153], v141 offset:16384
ds_read_b64_tr_b16 a[154:155], v141 offset:17408
v_mfma_f32_16x16x32_bf16 v[20:23], a[168:171], a[192:195], v[20:23]
ds_read_b64_tr_b16 a[156:157], v141 offset:24576
ds_read_b64_tr_b16 a[158:159], v141 offset:25600
v_mfma_f32_16x16x32_bf16 v[20:23], a[172:175], a[196:199], v[20:23]
buffer_load_dwordx4 v129, s[8:11], s30 offen offset:1024  lds
v_mfma_f32_16x16x32_bf16 v[52:55], a[168:171], a[200:203], v[52:55]
v_mfma_f32_16x16x32_bf16 v[52:55], a[172:175], a[204:207], v[52:55]
v_mfma_f32_16x16x32_bf16 v[84:87], a[168:171], a[208:211], v[84:87]
v_mfma_f32_16x16x32_bf16 v[84:87], a[172:175], a[212:215], v[84:87]
v_mfma_f32_16x16x32_bf16 v[116:119], a[168:171], a[216:219], v[116:119]
v_mfma_f32_16x16x32_bf16 v[116:119], a[172:175], a[220:223], v[116:119]
v_mfma_f32_16x16x32_bf16 v[24:27], a[176:179], a[192:195], v[24:27]
buffer_load_dwordx4 v130, s[8:11], s30 offen offset:2048  lds
v_mfma_f32_16x16x32_bf16 v[24:27], a[180:183], a[196:199], v[24:27]
v_mfma_f32_16x16x32_bf16 v[56:59], a[176:179], a[200:203], v[56:59]
v_mfma_f32_16x16x32_bf16 v[56:59], a[180:183], a[204:207], v[56:59]
v_mfma_f32_16x16x32_bf16 v[88:91], a[176:179], a[208:211], v[88:91]
v_mfma_f32_16x16x32_bf16 v[88:91], a[180:183], a[212:215], v[88:91]
v_mfma_f32_16x16x32_bf16 v[120:123], a[176:179], a[216:219], v[120:123]
v_mfma_f32_16x16x32_bf16 v[120:123], a[180:183], a[220:223], v[120:123]
buffer_load_dwordx4 v131, s[8:11], s30 offen offset:3072  lds
v_mfma_f32_16x16x32_bf16 v[28:31], a[184:187], a[192:195], v[28:31]
v_mfma_f32_16x16x32_bf16 v[28:31], a[188:191], a[196:199], v[28:31]
v_mfma_f32_16x16x32_bf16 v[60:63], a[184:187], a[200:203], v[60:63]
v_mfma_f32_16x16x32_bf16 v[60:63], a[188:191], a[204:207], v[60:63]
v_mfma_f32_16x16x32_bf16 v[92:95], a[184:187], a[208:211], v[92:95]
v_mfma_f32_16x16x32_bf16 v[92:95], a[188:191], a[212:215], v[92:95]
v_mfma_f32_16x16x32_bf16 v[124:127], a[184:187], a[216:219], v[124:127]
v_mfma_f32_16x16x32_bf16 v[124:127], a[188:191], a[220:223], v[124:127]
s_waitcnt lgkmcnt(0)
v_mfma_f32_16x16x32_bf16 a[0:3], a[192:195], a[128:131], a[0:3]
s_add_u32 m0, s29, 36864
ds_read_b64_tr_b16 a[160:161], v142 offset:16384
ds_read_b64_tr_b16 a[162:163], v142 offset:17408
v_mfma_f32_16x16x32_bf16 a[0:3], a[196:199], a[132:135], a[0:3]
s_add_u32 s30, s48, 33536
ds_read_b64_tr_b16 a[164:165], v142 offset:24576
ds_read_b64_tr_b16 a[166:167], v142 offset:25600
v_mfma_f32_16x16x32_bf16 a[4:7], a[200:203], a[128:131], a[4:7]
buffer_load_dwordx4 v128, s[8:11], s30 offen offset:0  lds
v_mfma_f32_16x16x32_bf16 a[4:7], a[204:207], a[132:135], a[4:7]
ds_read_b64_tr_b16 a[168:169], v143 offset:16384
ds_read_b64_tr_b16 a[170:171], v143 offset:17408
v_mfma_f32_16x16x32_bf16 a[64:67], a[208:211], a[128:131], a[64:67]
ds_read_b64_tr_b16 a[172:173], v143 offset:24576
ds_read_b64_tr_b16 a[174:175], v143 offset:25600
v_mfma_f32_16x16x32_bf16 a[64:67], a[212:215], a[132:135], a[64:67]
ds_read_b64_tr_b16 a[176:177], v144 offset:16384
ds_read_b64_tr_b16 a[178:179], v144 offset:17408
v_mfma_f32_16x16x32_bf16 a[68:71], a[216:219], a[128:131], a[68:71]
ds_read_b64_tr_b16 a[180:181], v144 offset:24576
ds_read_b64_tr_b16 a[182:183], v144 offset:25600
v_mfma_f32_16x16x32_bf16 a[68:71], a[220:223], a[132:135], a[68:71]
buffer_load_dwordx4 v129, s[8:11], s30 offen offset:1024  lds
v_mfma_f32_16x16x32_bf16 a[8:11], a[192:195], a[136:139], a[8:11]
ds_read_b64_tr_b16 a[184:185], v145 offset:16384
ds_read_b64_tr_b16 a[186:187], v145 offset:17408
v_mfma_f32_16x16x32_bf16 a[8:11], a[196:199], a[140:143], a[8:11]
ds_read_b64_tr_b16 a[188:189], v145 offset:24576
ds_read_b64_tr_b16 a[190:191], v145 offset:25600
v_mfma_f32_16x16x32_bf16 a[12:15], a[200:203], a[136:139], a[12:15]
v_add_u32 v136, 0x10000, v136
v_add_u32 v137, 0x10000, v137
v_mfma_f32_16x16x32_bf16 a[12:15], a[204:207], a[140:143], a[12:15]
v_add_u32 v138, 0xfffe8000, v138
v_add_u32 v139, 0xfffe8000, v139
v_mfma_f32_16x16x32_bf16 a[72:75], a[208:211], a[136:139], a[72:75]
v_add_u32 v140, 0xfffe8000, v140
v_add_u32 v141, 0xfffe8000, v141
v_mfma_f32_16x16x32_bf16 a[72:75], a[212:215], a[140:143], a[72:75]
buffer_load_dwordx4 v130, s[8:11], s30 offen offset:2048  lds
v_mfma_f32_16x16x32_bf16 a[76:79], a[216:219], a[136:139], a[76:79]
v_add_u32 v142, 0xfffe8000, v142
v_add_u32 v143, 0xfffe8000, v143
v_mfma_f32_16x16x32_bf16 a[76:79], a[220:223], a[140:143], a[76:79]
v_add_u32 v144, 0xfffe8000, v144
v_add_u32 v145, 0xfffe8000, v145
v_mfma_f32_16x16x32_bf16 a[16:19], a[192:195], a[144:147], a[16:19]
v_mfma_f32_16x16x32_bf16 a[16:19], a[196:199], a[148:151], a[16:19]
v_mfma_f32_16x16x32_bf16 a[20:23], a[200:203], a[144:147], a[20:23]
v_mfma_f32_16x16x32_bf16 a[20:23], a[204:207], a[148:151], a[20:23]
buffer_load_dwordx4 v131, s[8:11], s30 offen offset:3072  lds
v_mfma_f32_16x16x32_bf16 a[80:83], a[208:211], a[144:147], a[80:83]
v_mfma_f32_16x16x32_bf16 a[80:83], a[212:215], a[148:151], a[80:83]
v_mfma_f32_16x16x32_bf16 a[84:87], a[216:219], a[144:147], a[84:87]
v_mfma_f32_16x16x32_bf16 a[84:87], a[220:223], a[148:151], a[84:87]
v_mfma_f32_16x16x32_bf16 a[24:27], a[192:195], a[152:155], a[24:27]
v_mfma_f32_16x16x32_bf16 a[24:27], a[196:199], a[156:159], a[24:27]
buffer_load_dword v170, v252, s[44:47], s25 offen offset:3072
v_mfma_f32_16x16x32_bf16 a[28:31], a[200:203], a[152:155], a[28:31]
v_mfma_f32_16x16x32_bf16 a[28:31], a[204:207], a[156:159], a[28:31]
v_mfma_f32_16x16x32_bf16 a[88:91], a[208:211], a[152:155], a[88:91]
v_mfma_f32_16x16x32_bf16 a[88:91], a[212:215], a[156:159], a[88:91]
v_mfma_f32_16x16x32_bf16 a[92:95], a[216:219], a[152:155], a[92:95]
v_mfma_f32_16x16x32_bf16 a[92:95], a[220:223], a[156:159], a[92:95]
s_waitcnt vmcnt(10) lgkmcnt(0)
s_barrier
v_mfma_f32_16x16x32_bf16 a[32:35], a[192:195], a[160:163], a[32:35]
s_add_u32 m0, s31, 65536
ds_read_b128 a[224:227], v136 offset:0
v_mfma_f32_16x16x32_bf16 a[32:35], a[196:199], a[164:167], a[32:35]
s_add_u32 s30, s49, 3145728
ds_read_b128 a[228:231], v137 offset:0
v_mfma_f32_16x16x32_bf16 a[36:39], a[200:203], a[160:163], a[36:39]
buffer_load_dwordx4 v132, s[12:15], s30 offen offset:0 nt lds
v_mfma_f32_16x16x32_bf16 a[36:39], a[204:207], a[164:167], a[36:39]
ds_read_b128 a[232:235], v136 offset:2048
v_mfma_f32_16x16x32_bf16 a[96:99], a[208:211], a[160:163], a[96:99]
ds_read_b128 a[236:239], v137 offset:2048
v_mfma_f32_16x16x32_bf16 a[96:99], a[212:215], a[164:167], a[96:99]
ds_read_b128 a[240:243], v136 offset:4096
v_mfma_f32_16x16x32_bf16 a[100:103], a[216:219], a[160:163], a[100:103]
ds_read_b128 a[244:247], v137 offset:4096
v_mfma_f32_16x16x32_bf16 a[100:103], a[220:223], a[164:167], a[100:103]
ds_read_b128 a[248:251], v136 offset:6144
v_mfma_f32_16x16x32_bf16 a[40:43], a[192:195], a[168:171], a[40:43]
ds_read_b128 a[252:255], v137 offset:6144
v_mfma_f32_16x16x32_bf16 a[40:43], a[196:199], a[172:175], a[40:43]
buffer_load_dwordx4 v133, s[12:15], s30 offen offset:1024 nt lds
v_mfma_f32_16x16x32_bf16 a[44:47], a[200:203], a[168:171], a[44:47]
ds_read_b64_tr_b16 a[128:129], v138 offset:0
ds_read_b64_tr_b16 a[130:131], v138 offset:1024
v_mfma_f32_16x16x32_bf16 a[44:47], a[204:207], a[172:175], a[44:47]
ds_read_b64_tr_b16 a[132:133], v138 offset:8192
ds_read_b64_tr_b16 a[134:135], v138 offset:9216
v_mfma_f32_16x16x32_bf16 a[104:107], a[208:211], a[168:171], a[104:107]
ds_read_b64_tr_b16 a[136:137], v139 offset:0
ds_read_b64_tr_b16 a[138:139], v139 offset:1024
v_mfma_f32_16x16x32_bf16 a[104:107], a[212:215], a[172:175], a[104:107]
ds_read_b64_tr_b16 a[140:141], v139 offset:8192
ds_read_b64_tr_b16 a[142:143], v139 offset:9216
v_mfma_f32_16x16x32_bf16 a[108:111], a[216:219], a[168:171], a[108:111]
ds_read_b64_tr_b16 a[144:145], v140 offset:0
ds_read_b64_tr_b16 a[146:147], v140 offset:1024
v_mfma_f32_16x16x32_bf16 a[108:111], a[220:223], a[172:175], a[108:111]
ds_read_b64_tr_b16 a[148:149], v140 offset:8192
ds_read_b64_tr_b16 a[150:151], v140 offset:9216
v_mfma_f32_16x16x32_bf16 a[48:51], a[192:195], a[176:179], a[48:51]
buffer_load_dwordx4 v134, s[12:15], s30 offen offset:2048 nt lds
v_mfma_f32_16x16x32_bf16 a[48:51], a[196:199], a[180:183], a[48:51]
ds_read_b64_tr_b16 a[152:153], v141 offset:0
ds_read_b64_tr_b16 a[154:155], v141 offset:1024
v_mfma_f32_16x16x32_bf16 a[52:55], a[200:203], a[176:179], a[52:55]
ds_read_b64_tr_b16 a[156:157], v141 offset:8192
ds_read_b64_tr_b16 a[158:159], v141 offset:9216
v_mfma_f32_16x16x32_bf16 a[52:55], a[204:207], a[180:183], a[52:55]
v_mfma_f32_16x16x32_bf16 a[112:115], a[208:211], a[176:179], a[112:115]
v_mfma_f32_16x16x32_bf16 a[112:115], a[212:215], a[180:183], a[112:115]
v_mfma_f32_16x16x32_bf16 a[116:119], a[216:219], a[176:179], a[116:119]
v_mfma_f32_16x16x32_bf16 a[116:119], a[220:223], a[180:183], a[116:119]
buffer_load_dwordx4 v135, s[12:15], s30 offen offset:3072 nt lds
v_mfma_f32_16x16x32_bf16 a[56:59], a[192:195], a[184:187], a[56:59]
v_mfma_f32_16x16x32_bf16 a[56:59], a[196:199], a[188:191], a[56:59]
v_mfma_f32_16x16x32_bf16 a[60:63], a[200:203], a[184:187], a[60:63]
v_mfma_f32_16x16x32_bf16 a[60:63], a[204:207], a[188:191], a[60:63]
v_mfma_f32_16x16x32_bf16 a[120:123], a[208:211], a[184:187], a[120:123]
v_mfma_f32_16x16x32_bf16 a[120:123], a[212:215], a[188:191], a[120:123]
v_mfma_f32_16x16x32_bf16 a[124:127], a[216:219], a[184:187], a[124:127]
v_mfma_f32_16x16x32_bf16 a[124:127], a[220:223], a[188:191], a[124:127]
s_waitcnt lgkmcnt(0)
v_mfma_f32_16x16x32_bf16 v[0:3], a[128:131], a[224:227], v[0:3]
s_add_u32 m0, s31, 81920
ds_read_b64_tr_b16 a[160:161], v142 offset:0
ds_read_b64_tr_b16 a[162:163], v142 offset:1024
v_mfma_f32_16x16x32_bf16 v[0:3], a[132:135], a[228:231], v[0:3]
s_add_u32 s30, s49, 3145728
ds_read_b64_tr_b16 a[164:165], v142 offset:8192
ds_read_b64_tr_b16 a[166:167], v142 offset:9216
v_mfma_f32_16x16x32_bf16 v[32:35], a[128:131], a[232:235], v[32:35]
buffer_load_dwordx4 v132, s[16:19], s30 offen offset:0 nt lds
v_mfma_f32_16x16x32_bf16 v[32:35], a[132:135], a[236:239], v[32:35]
ds_read_b64_tr_b16 a[168:169], v143 offset:0
ds_read_b64_tr_b16 a[170:171], v143 offset:1024
v_mfma_f32_16x16x32_bf16 v[64:67], a[128:131], a[240:243], v[64:67]
ds_read_b64_tr_b16 a[172:173], v143 offset:8192
ds_read_b64_tr_b16 a[174:175], v143 offset:9216
v_mfma_f32_16x16x32_bf16 v[64:67], a[132:135], a[244:247], v[64:67]
ds_read_b64_tr_b16 a[176:177], v144 offset:0
ds_read_b64_tr_b16 a[178:179], v144 offset:1024
v_mfma_f32_16x16x32_bf16 v[96:99], a[128:131], a[248:251], v[96:99]
ds_read_b64_tr_b16 a[180:181], v144 offset:8192
ds_read_b64_tr_b16 a[182:183], v144 offset:9216
v_mfma_f32_16x16x32_bf16 v[96:99], a[132:135], a[252:255], v[96:99]
buffer_load_dwordx4 v133, s[16:19], s30 offen offset:1024 nt lds
v_mfma_f32_16x16x32_bf16 v[4:7], a[136:139], a[224:227], v[4:7]
ds_read_b64_tr_b16 a[184:185], v145 offset:0
ds_read_b64_tr_b16 a[186:187], v145 offset:1024
v_mfma_f32_16x16x32_bf16 v[4:7], a[140:143], a[228:231], v[4:7]
ds_read_b64_tr_b16 a[188:189], v145 offset:8192
ds_read_b64_tr_b16 a[190:191], v145 offset:9216
v_mfma_f32_16x16x32_bf16 v[36:39], a[136:139], a[232:235], v[36:39]
v_mfma_f32_16x16x32_bf16 v[36:39], a[140:143], a[236:239], v[36:39]
v_mfma_f32_16x16x32_bf16 v[68:71], a[136:139], a[240:243], v[68:71]
v_mfma_f32_16x16x32_bf16 v[68:71], a[140:143], a[244:247], v[68:71]
buffer_load_dwordx4 v134, s[16:19], s30 offen offset:2048 nt lds
v_mfma_f32_16x16x32_bf16 v[100:103], a[136:139], a[248:251], v[100:103]
v_mfma_f32_16x16x32_bf16 v[100:103], a[140:143], a[252:255], v[100:103]
v_mfma_f32_16x16x32_bf16 v[8:11], a[144:147], a[224:227], v[8:11]
v_mfma_f32_16x16x32_bf16 v[8:11], a[148:151], a[228:231], v[8:11]
v_mfma_f32_16x16x32_bf16 v[40:43], a[144:147], a[232:235], v[40:43]
v_mfma_f32_16x16x32_bf16 v[40:43], a[148:151], a[236:239], v[40:43]
buffer_load_dwordx4 v135, s[16:19], s30 offen offset:3072 nt lds
v_mfma_f32_16x16x32_bf16 v[72:75], a[144:147], a[240:243], v[72:75]
v_mfma_f32_16x16x32_bf16 v[72:75], a[148:151], a[244:247], v[72:75]
s_mov_b32 s44, s88
v_mfma_f32_16x16x32_bf16 v[104:107], a[144:147], a[248:251], v[104:107]
s_and_b32 s45, s89, 0xffff
v_mfma_f32_16x16x32_bf16 v[104:107], a[148:151], a[252:255], v[104:107]
s_mov_b32 s46, 2097152
v_mfma_f32_16x16x32_bf16 v[12:15], a[152:155], a[224:227], v[12:15]
s_mul_i32 s25, s28, 2048
v_mfma_f32_16x16x32_bf16 v[12:15], a[156:159], a[228:231], v[12:15]
buffer_load_dword v170, v252, s[44:47], s25 offen offset:0
v_mfma_f32_16x16x32_bf16 v[44:47], a[152:155], a[232:235], v[44:47]
v_mfma_f32_16x16x32_bf16 v[44:47], a[156:159], a[236:239], v[44:47]
v_mfma_f32_16x16x32_bf16 v[76:79], a[152:155], a[240:243], v[76:79]
v_mfma_f32_16x16x32_bf16 v[76:79], a[156:159], a[244:247], v[76:79]
v_mfma_f32_16x16x32_bf16 v[108:111], a[152:155], a[248:251], v[108:111]
v_mfma_f32_16x16x32_bf16 v[108:111], a[156:159], a[252:255], v[108:111]
s_waitcnt lgkmcnt(0)
v_mfma_f32_16x16x32_bf16 v[16:19], a[160:163], a[224:227], v[16:19]
s_add_u32 m0, s29, 98304
ds_read_b64_tr_b16 a[128:129], v138 offset:16384
ds_read_b64_tr_b16 a[130:131], v138 offset:17408
v_mfma_f32_16x16x32_bf16 v[16:19], a[164:167], a[228:231], v[16:19]
s_add_u32 s30, s48, 896
ds_read_b64_tr_b16 a[132:133], v138 offset:24576
ds_read_b64_tr_b16 a[134:135], v138 offset:25600
v_mfma_f32_16x16x32_bf16 v[48:51], a[160:163], a[232:235], v[48:51]
buffer_load_dwordx4 v128, s[8:11], s30 offen offset:0  lds
v_mfma_f32_16x16x32_bf16 v[48:51], a[164:167], a[236:239], v[48:51]
ds_read_b64_tr_b16 a[136:137], v139 offset:16384
ds_read_b64_tr_b16 a[138:139], v139 offset:17408
v_mfma_f32_16x16x32_bf16 v[80:83], a[160:163], a[240:243], v[80:83]
ds_read_b64_tr_b16 a[140:141], v139 offset:24576
ds_read_b64_tr_b16 a[142:143], v139 offset:25600
v_mfma_f32_16x16x32_bf16 v[80:83], a[164:167], a[244:247], v[80:83]
ds_read_b64_tr_b16 a[144:145], v140 offset:16384
ds_read_b64_tr_b16 a[146:147], v140 offset:17408
v_mfma_f32_16x16x32_bf16 v[112:115], a[160:163], a[248:251], v[112:115]
ds_read_b64_tr_b16 a[148:149], v140 offset:24576
ds_read_b64_tr_b16 a[150:151], v140 offset:25600
v_mfma_f32_16x16x32_bf16 v[112:115], a[164:167], a[252:255], v[112:115]
ds_read_b64_tr_b16 a[152:153], v141 offset:16384
ds_read_b64_tr_b16 a[154:155], v141 offset:17408
v_mfma_f32_16x16x32_bf16 v[20:23], a[168:171], a[224:227], v[20:23]
ds_read_b64_tr_b16 a[156:157], v141 offset:24576
ds_read_b64_tr_b16 a[158:159], v141 offset:25600
v_mfma_f32_16x16x32_bf16 v[20:23], a[172:175], a[228:231], v[20:23]
buffer_load_dwordx4 v129, s[8:11], s30 offen offset:1024  lds
v_mfma_f32_16x16x32_bf16 v[52:55], a[168:171], a[232:235], v[52:55]
v_mfma_f32_16x16x32_bf16 v[52:55], a[172:175], a[236:239], v[52:55]
v_mfma_f32_16x16x32_bf16 v[84:87], a[168:171], a[240:243], v[84:87]
v_mfma_f32_16x16x32_bf16 v[84:87], a[172:175], a[244:247], v[84:87]
v_mfma_f32_16x16x32_bf16 v[116:119], a[168:171], a[248:251], v[116:119]
v_mfma_f32_16x16x32_bf16 v[116:119], a[172:175], a[252:255], v[116:119]
v_mfma_f32_16x16x32_bf16 v[24:27], a[176:179], a[224:227], v[24:27]
buffer_load_dwordx4 v130, s[8:11], s30 offen offset:2048  lds
v_mfma_f32_16x16x32_bf16 v[24:27], a[180:183], a[228:231], v[24:27]
v_mfma_f32_16x16x32_bf16 v[56:59], a[176:179], a[232:235], v[56:59]
v_mfma_f32_16x16x32_bf16 v[56:59], a[180:183], a[236:239], v[56:59]
v_mfma_f32_16x16x32_bf16 v[88:91], a[176:179], a[240:243], v[88:91]
v_mfma_f32_16x16x32_bf16 v[88:91], a[180:183], a[244:247], v[88:91]
v_mfma_f32_16x16x32_bf16 v[120:123], a[176:179], a[248:251], v[120:123]
v_mfma_f32_16x16x32_bf16 v[120:123], a[180:183], a[252:255], v[120:123]
buffer_load_dwordx4 v131, s[8:11], s30 offen offset:3072  lds
v_mfma_f32_16x16x32_bf16 v[28:31], a[184:187], a[224:227], v[28:31]
v_mfma_f32_16x16x32_bf16 v[28:31], a[188:191], a[228:231], v[28:31]
v_mfma_f32_16x16x32_bf16 v[60:63], a[184:187], a[232:235], v[60:63]
v_mfma_f32_16x16x32_bf16 v[60:63], a[188:191], a[236:239], v[60:63]
v_mfma_f32_16x16x32_bf16 v[92:95], a[184:187], a[240:243], v[92:95]
v_mfma_f32_16x16x32_bf16 v[92:95], a[188:191], a[244:247], v[92:95]
v_mfma_f32_16x16x32_bf16 v[124:127], a[184:187], a[248:251], v[124:127]
v_mfma_f32_16x16x32_bf16 v[124:127], a[188:191], a[252:255], v[124:127]
s_waitcnt lgkmcnt(0)
v_mfma_f32_16x16x32_bf16 a[0:3], a[224:227], a[128:131], a[0:3]
s_add_u32 m0, s29, 102400
ds_read_b64_tr_b16 a[160:161], v142 offset:16384
ds_read_b64_tr_b16 a[162:163], v142 offset:17408
v_mfma_f32_16x16x32_bf16 a[0:3], a[228:231], a[132:135], a[0:3]
s_add_u32 s30, s48, 33664
ds_read_b64_tr_b16 a[164:165], v142 offset:24576
ds_read_b64_tr_b16 a[166:167], v142 offset:25600
v_mfma_f32_16x16x32_bf16 a[4:7], a[232:235], a[128:131], a[4:7]
buffer_load_dwordx4 v128, s[8:11], s30 offen offset:0  lds
v_mfma_f32_16x16x32_bf16 a[4:7], a[236:239], a[132:135], a[4:7]
ds_read_b64_tr_b16 a[168:169], v143 offset:16384
ds_read_b64_tr_b16 a[170:171], v143 offset:17408
v_mfma_f32_16x16x32_bf16 a[64:67], a[240:243], a[128:131], a[64:67]
ds_read_b64_tr_b16 a[172:173], v143 offset:24576
ds_read_b64_tr_b16 a[174:175], v143 offset:25600
v_mfma_f32_16x16x32_bf16 a[64:67], a[244:247], a[132:135], a[64:67]
ds_read_b64_tr_b16 a[176:177], v144 offset:16384
ds_read_b64_tr_b16 a[178:179], v144 offset:17408
v_mfma_f32_16x16x32_bf16 a[68:71], a[248:251], a[128:131], a[68:71]
ds_read_b64_tr_b16 a[180:181], v144 offset:24576
ds_read_b64_tr_b16 a[182:183], v144 offset:25600
v_mfma_f32_16x16x32_bf16 a[68:71], a[252:255], a[132:135], a[68:71]
buffer_load_dwordx4 v129, s[8:11], s30 offen offset:1024  lds
v_mfma_f32_16x16x32_bf16 a[8:11], a[224:227], a[136:139], a[8:11]
ds_read_b64_tr_b16 a[184:185], v145 offset:16384
ds_read_b64_tr_b16 a[186:187], v145 offset:17408
v_mfma_f32_16x16x32_bf16 a[8:11], a[228:231], a[140:143], a[8:11]
ds_read_b64_tr_b16 a[188:189], v145 offset:24576
ds_read_b64_tr_b16 a[190:191], v145 offset:25600
v_mfma_f32_16x16x32_bf16 a[12:15], a[232:235], a[136:139], a[12:15]
v_add_u32 v136, 0xfffe8000, v136
v_add_u32 v137, 0xfffe8000, v137
v_mfma_f32_16x16x32_bf16 a[12:15], a[236:239], a[140:143], a[12:15]
v_add_u32 v138, 0x10000, v138
v_add_u32 v139, 0x10000, v139
v_mfma_f32_16x16x32_bf16 a[72:75], a[240:243], a[136:139], a[72:75]
v_add_u32 v140, 0x10000, v140
v_add_u32 v141, 0x10000, v141
v_mfma_f32_16x16x32_bf16 a[72:75], a[244:247], a[140:143], a[72:75]
buffer_load_dwordx4 v130, s[8:11], s30 offen offset:2048  lds
v_mfma_f32_16x16x32_bf16 a[76:79], a[248:251], a[136:139], a[76:79]
v_add_u32 v142, 0x10000, v142
v_add_u32 v143, 0x10000, v143
v_mfma_f32_16x16x32_bf16 a[76:79], a[252:255], a[140:143], a[76:79]
v_add_u32 v144, 0x10000, v144
v_add_u32 v145, 0x10000, v145
v_mfma_f32_16x16x32_bf16 a[16:19], a[224:227], a[144:147], a[16:19]
v_mfma_f32_16x16x32_bf16 a[16:19], a[228:231], a[148:151], a[16:19]
v_mfma_f32_16x16x32_bf16 a[20:23], a[232:235], a[144:147], a[20:23]
v_mfma_f32_16x16x32_bf16 a[20:23], a[236:239], a[148:151], a[20:23]
buffer_load_dwordx4 v131, s[8:11], s30 offen offset:3072  lds
v_mfma_f32_16x16x32_bf16 a[80:83], a[240:243], a[144:147], a[80:83]
v_mfma_f32_16x16x32_bf16 a[80:83], a[244:247], a[148:151], a[80:83]
v_mfma_f32_16x16x32_bf16 a[84:87], a[248:251], a[144:147], a[84:87]
v_mfma_f32_16x16x32_bf16 a[84:87], a[252:255], a[148:151], a[84:87]
v_mfma_f32_16x16x32_bf16 a[24:27], a[224:227], a[152:155], a[24:27]
v_mfma_f32_16x16x32_bf16 a[24:27], a[228:231], a[156:159], a[24:27]
buffer_load_dword v170, v252, s[44:47], s25 offen offset:1024
v_mfma_f32_16x16x32_bf16 a[28:31], a[232:235], a[152:155], a[28:31]
v_mfma_f32_16x16x32_bf16 a[28:31], a[236:239], a[156:159], a[28:31]
v_mfma_f32_16x16x32_bf16 a[88:91], a[240:243], a[152:155], a[88:91]
v_mfma_f32_16x16x32_bf16 a[88:91], a[244:247], a[156:159], a[88:91]
v_mfma_f32_16x16x32_bf16 a[92:95], a[248:251], a[152:155], a[92:95]
v_mfma_f32_16x16x32_bf16 a[92:95], a[252:255], a[156:159], a[92:95]
s_waitcnt vmcnt(10) lgkmcnt(0)
s_barrier
v_mfma_f32_16x16x32_bf16 a[32:35], a[224:227], a[160:163], a[32:35]
s_add_u32 m0, s31, 131072
ds_read_b128 a[192:195], v136 offset:0
v_mfma_f32_16x16x32_bf16 a[32:35], a[228:231], a[164:167], a[32:35]
s_add_u32 s30, s49, 3670016
ds_read_b128 a[196:199], v137 offset:0
v_mfma_f32_16x16x32_bf16 a[36:39], a[232:235], a[160:163], a[36:39]
buffer_load_dwordx4 v132, s[12:15], s30 offen offset:0 nt lds
v_mfma_f32_16x16x32_bf16 a[36:39], a[236:239], a[164:167], a[36:39]
ds_read_b128 a[200:203], v136 offset:2048
v_mfma_f32_16x16x32_bf16 a[96:99], a[240:243], a[160:163], a[96:99]
ds_read_b128 a[204:207], v137 offset:2048
v_mfma_f32_16x16x32_bf16 a[96:99], a[244:247], a[164:167], a[96:99]
ds_read_b128 a[208:211], v136 offset:4096
v_mfma_f32_16x16x32_bf16 a[100:103], a[248:251], a[160:163], a[100:103]
ds_read_b128 a[212:215], v137 offset:4096
v_mfma_f32_16x16x32_bf16 a[100:103], a[252:255], a[164:167], a[100:103]
ds_read_b128 a[216:219], v136 offset:6144
v_mfma_f32_16x16x32_bf16 a[40:43], a[224:227], a[168:171], a[40:43]
ds_read_b128 a[220:223], v137 offset:6144
v_mfma_f32_16x16x32_bf16 a[40:43], a[228:231], a[172:175], a[40:43]
buffer_load_dwordx4 v133, s[12:15], s30 offen offset:1024 nt lds
v_mfma_f32_16x16x32_bf16 a[44:47], a[232:235], a[168:171], a[44:47]
ds_read_b64_tr_b16 a[128:129], v138 offset:0
ds_read_b64_tr_b16 a[130:131], v138 offset:1024
v_mfma_f32_16x16x32_bf16 a[44:47], a[236:239], a[172:175], a[44:47]
ds_read_b64_tr_b16 a[132:133], v138 offset:8192
ds_read_b64_tr_b16 a[134:135], v138 offset:9216
v_mfma_f32_16x16x32_bf16 a[104:107], a[240:243], a[168:171], a[104:107]
ds_read_b64_tr_b16 a[136:137], v139 offset:0
ds_read_b64_tr_b16 a[138:139], v139 offset:1024
v_mfma_f32_16x16x32_bf16 a[104:107], a[244:247], a[172:175], a[104:107]
ds_read_b64_tr_b16 a[140:141], v139 offset:8192
ds_read_b64_tr_b16 a[142:143], v139 offset:9216
v_mfma_f32_16x16x32_bf16 a[108:111], a[248:251], a[168:171], a[108:111]
ds_read_b64_tr_b16 a[144:145], v140 offset:0
ds_read_b64_tr_b16 a[146:147], v140 offset:1024
v_mfma_f32_16x16x32_bf16 a[108:111], a[252:255], a[172:175], a[108:111]
ds_read_b64_tr_b16 a[148:149], v140 offset:8192
ds_read_b64_tr_b16 a[150:151], v140 offset:9216
v_mfma_f32_16x16x32_bf16 a[48:51], a[224:227], a[176:179], a[48:51]
buffer_load_dwordx4 v134, s[12:15], s30 offen offset:2048 nt lds
v_mfma_f32_16x16x32_bf16 a[48:51], a[228:231], a[180:183], a[48:51]
ds_read_b64_tr_b16 a[152:153], v141 offset:0
ds_read_b64_tr_b16 a[154:155], v141 offset:1024
v_mfma_f32_16x16x32_bf16 a[52:55], a[232:235], a[176:179], a[52:55]
ds_read_b64_tr_b16 a[156:157], v141 offset:8192
ds_read_b64_tr_b16 a[158:159], v141 offset:9216
v_mfma_f32_16x16x32_bf16 a[52:55], a[236:239], a[180:183], a[52:55]
v_mfma_f32_16x16x32_bf16 a[112:115], a[240:243], a[176:179], a[112:115]
v_mfma_f32_16x16x32_bf16 a[112:115], a[244:247], a[180:183], a[112:115]
v_mfma_f32_16x16x32_bf16 a[116:119], a[248:251], a[176:179], a[116:119]
v_mfma_f32_16x16x32_bf16 a[116:119], a[252:255], a[180:183], a[116:119]
buffer_load_dwordx4 v135, s[12:15], s30 offen offset:3072 nt lds
v_mfma_f32_16x16x32_bf16 a[56:59], a[224:227], a[184:187], a[56:59]
v_mfma_f32_16x16x32_bf16 a[56:59], a[228:231], a[188:191], a[56:59]
v_mfma_f32_16x16x32_bf16 a[60:63], a[232:235], a[184:187], a[60:63]
v_mfma_f32_16x16x32_bf16 a[60:63], a[236:239], a[188:191], a[60:63]
v_mfma_f32_16x16x32_bf16 a[120:123], a[240:243], a[184:187], a[120:123]
v_mfma_f32_16x16x32_bf16 a[120:123], a[244:247], a[188:191], a[120:123]
v_mfma_f32_16x16x32_bf16 a[124:127], a[248:251], a[184:187], a[124:127]
v_mfma_f32_16x16x32_bf16 a[124:127], a[252:255], a[188:191], a[124:127]
s_waitcnt lgkmcnt(0)
v_mfma_f32_16x16x32_bf16 v[0:3], a[128:131], a[192:195], v[0:3]
s_add_u32 m0, s31, 147456
ds_read_b64_tr_b16 a[160:161], v142 offset:0
ds_read_b64_tr_b16 a[162:163], v142 offset:1024
v_mfma_f32_16x16x32_bf16 v[0:3], a[132:135], a[196:199], v[0:3]
s_add_u32 s30, s49, 3670016
ds_read_b64_tr_b16 a[164:165], v142 offset:8192
ds_read_b64_tr_b16 a[166:167], v142 offset:9216
v_mfma_f32_16x16x32_bf16 v[32:35], a[128:131], a[200:203], v[32:35]
buffer_load_dwordx4 v132, s[16:19], s30 offen offset:0 nt lds
v_mfma_f32_16x16x32_bf16 v[32:35], a[132:135], a[204:207], v[32:35]
ds_read_b64_tr_b16 a[168:169], v143 offset:0
ds_read_b64_tr_b16 a[170:171], v143 offset:1024
v_mfma_f32_16x16x32_bf16 v[64:67], a[128:131], a[208:211], v[64:67]
ds_read_b64_tr_b16 a[172:173], v143 offset:8192
ds_read_b64_tr_b16 a[174:175], v143 offset:9216
v_mfma_f32_16x16x32_bf16 v[64:67], a[132:135], a[212:215], v[64:67]
ds_read_b64_tr_b16 a[176:177], v144 offset:0
ds_read_b64_tr_b16 a[178:179], v144 offset:1024
v_mfma_f32_16x16x32_bf16 v[96:99], a[128:131], a[216:219], v[96:99]
ds_read_b64_tr_b16 a[180:181], v144 offset:8192
ds_read_b64_tr_b16 a[182:183], v144 offset:9216
v_mfma_f32_16x16x32_bf16 v[96:99], a[132:135], a[220:223], v[96:99]
buffer_load_dwordx4 v133, s[16:19], s30 offen offset:1024 nt lds
v_mfma_f32_16x16x32_bf16 v[4:7], a[136:139], a[192:195], v[4:7]
ds_read_b64_tr_b16 a[184:185], v145 offset:0
ds_read_b64_tr_b16 a[186:187], v145 offset:1024
v_mfma_f32_16x16x32_bf16 v[4:7], a[140:143], a[196:199], v[4:7]
ds_read_b64_tr_b16 a[188:189], v145 offset:8192
ds_read_b64_tr_b16 a[190:191], v145 offset:9216
v_mfma_f32_16x16x32_bf16 v[36:39], a[136:139], a[200:203], v[36:39]
v_mfma_f32_16x16x32_bf16 v[36:39], a[140:143], a[204:207], v[36:39]
v_mfma_f32_16x16x32_bf16 v[68:71], a[136:139], a[208:211], v[68:71]
v_mfma_f32_16x16x32_bf16 v[68:71], a[140:143], a[212:215], v[68:71]
buffer_load_dwordx4 v134, s[16:19], s30 offen offset:2048 nt lds
v_mfma_f32_16x16x32_bf16 v[100:103], a[136:139], a[216:219], v[100:103]
v_mfma_f32_16x16x32_bf16 v[100:103], a[140:143], a[220:223], v[100:103]
v_mfma_f32_16x16x32_bf16 v[8:11], a[144:147], a[192:195], v[8:11]
v_mfma_f32_16x16x32_bf16 v[8:11], a[148:151], a[196:199], v[8:11]
v_mfma_f32_16x16x32_bf16 v[40:43], a[144:147], a[200:203], v[40:43]
v_mfma_f32_16x16x32_bf16 v[40:43], a[148:151], a[204:207], v[40:43]
buffer_load_dwordx4 v135, s[16:19], s30 offen offset:3072 nt lds
v_mfma_f32_16x16x32_bf16 v[72:75], a[144:147], a[208:211], v[72:75]
v_mfma_f32_16x16x32_bf16 v[72:75], a[148:151], a[212:215], v[72:75]
s_mov_b32 s44, s90
v_mfma_f32_16x16x32_bf16 v[104:107], a[144:147], a[216:219], v[104:107]
s_and_b32 s45, s91, 0xffff
v_mfma_f32_16x16x32_bf16 v[104:107], a[148:151], a[220:223], v[104:107]
s_mov_b32 s46, 1572864
v_mfma_f32_16x16x32_bf16 v[12:15], a[152:155], a[192:195], v[12:15]
s_mul_i32 s25, s28, 1536
v_mfma_f32_16x16x32_bf16 v[12:15], a[156:159], a[196:199], v[12:15]
buffer_load_dword v170, v168, s[44:47], s25 offen
v_mfma_f32_16x16x32_bf16 v[44:47], a[152:155], a[200:203], v[44:47]
v_mfma_f32_16x16x32_bf16 v[44:47], a[156:159], a[204:207], v[44:47]
v_mfma_f32_16x16x32_bf16 v[76:79], a[152:155], a[208:211], v[76:79]
v_mfma_f32_16x16x32_bf16 v[76:79], a[156:159], a[212:215], v[76:79]
v_mfma_f32_16x16x32_bf16 v[108:111], a[152:155], a[216:219], v[108:111]
v_mfma_f32_16x16x32_bf16 v[108:111], a[156:159], a[220:223], v[108:111]
s_waitcnt lgkmcnt(0)
v_mfma_f32_16x16x32_bf16 v[16:19], a[160:163], a[192:195], v[16:19]
s_mov_b32 s8, s76
s_and_b32 s9, s77, 0xffff
s_mov_b32 s12, s80
s_and_b32 s13, s81, 0xffff
s_add_u32 m0, s29, 0
v_mfma_f32_16x16x32_bf16 v[16:19], a[164:167], a[196:199], v[16:19]
s_add_u32 s30, s40, 0
ds_read_b64_tr_b16 a[128:129], v138 offset:16384
ds_read_b64_tr_b16 a[130:131], v138 offset:17408
v_mfma_f32_16x16x32_bf16 v[48:51], a[160:163], a[200:203], v[48:51]
buffer_load_dwordx4 v128, s[8:11], s30 offen offset:0 lds
v_mfma_f32_16x16x32_bf16 v[48:51], a[164:167], a[204:207], v[48:51]
ds_read_b64_tr_b16 a[132:133], v138 offset:24576
ds_read_b64_tr_b16 a[134:135], v138 offset:25600
v_mfma_f32_16x16x32_bf16 v[80:83], a[160:163], a[208:211], v[80:83]
ds_read_b64_tr_b16 a[136:137], v139 offset:16384
ds_read_b64_tr_b16 a[138:139], v139 offset:17408
v_mfma_f32_16x16x32_bf16 v[80:83], a[164:167], a[212:215], v[80:83]
ds_read_b64_tr_b16 a[140:141], v139 offset:24576
ds_read_b64_tr_b16 a[142:143], v139 offset:25600
v_mfma_f32_16x16x32_bf16 v[112:115], a[160:163], a[216:219], v[112:115]
ds_read_b64_tr_b16 a[144:145], v140 offset:16384
ds_read_b64_tr_b16 a[146:147], v140 offset:17408
v_mfma_f32_16x16x32_bf16 v[112:115], a[164:167], a[220:223], v[112:115]
ds_read_b64_tr_b16 a[148:149], v140 offset:24576
ds_read_b64_tr_b16 a[150:151], v140 offset:25600
v_mfma_f32_16x16x32_bf16 v[20:23], a[168:171], a[192:195], v[20:23]
ds_read_b64_tr_b16 a[152:153], v141 offset:16384
ds_read_b64_tr_b16 a[154:155], v141 offset:17408
v_mfma_f32_16x16x32_bf16 v[20:23], a[172:175], a[196:199], v[20:23]
buffer_load_dwordx4 v129, s[8:11], s30 offen offset:1024 lds
v_mfma_f32_16x16x32_bf16 v[52:55], a[168:171], a[200:203], v[52:55]
ds_read_b64_tr_b16 a[156:157], v141 offset:24576
ds_read_b64_tr_b16 a[158:159], v141 offset:25600
v_mfma_f32_16x16x32_bf16 v[52:55], a[172:175], a[204:207], v[52:55]
v_mfma_f32_16x16x32_bf16 v[84:87], a[168:171], a[208:211], v[84:87]
v_mfma_f32_16x16x32_bf16 v[84:87], a[172:175], a[212:215], v[84:87]
v_mfma_f32_16x16x32_bf16 v[116:119], a[168:171], a[216:219], v[116:119]
v_mfma_f32_16x16x32_bf16 v[116:119], a[172:175], a[220:223], v[116:119]
v_mfma_f32_16x16x32_bf16 v[24:27], a[176:179], a[192:195], v[24:27]
buffer_load_dwordx4 v130, s[8:11], s30 offen offset:2048 lds
v_mfma_f32_16x16x32_bf16 v[24:27], a[180:183], a[196:199], v[24:27]
v_mfma_f32_16x16x32_bf16 v[56:59], a[176:179], a[200:203], v[56:59]
v_mfma_f32_16x16x32_bf16 v[56:59], a[180:183], a[204:207], v[56:59]
v_mfma_f32_16x16x32_bf16 v[88:91], a[176:179], a[208:211], v[88:91]
v_mfma_f32_16x16x32_bf16 v[88:91], a[180:183], a[212:215], v[88:91]
v_mfma_f32_16x16x32_bf16 v[120:123], a[176:179], a[216:219], v[120:123]
v_mfma_f32_16x16x32_bf16 v[120:123], a[180:183], a[220:223], v[120:123]
buffer_load_dwordx4 v131, s[8:11], s30 offen offset:3072 lds
v_mfma_f32_16x16x32_bf16 v[28:31], a[184:187], a[192:195], v[28:31]
v_mfma_f32_16x16x32_bf16 v[28:31], a[188:191], a[196:199], v[28:31]
v_mfma_f32_16x16x32_bf16 v[60:63], a[184:187], a[200:203], v[60:63]
v_mfma_f32_16x16x32_bf16 v[60:63], a[188:191], a[204:207], v[60:63]
v_mfma_f32_16x16x32_bf16 v[92:95], a[184:187], a[208:211], v[92:95]
v_mfma_f32_16x16x32_bf16 v[92:95], a[188:191], a[212:215], v[92:95]
v_mfma_f32_16x16x32_bf16 v[124:127], a[184:187], a[216:219], v[124:127]
v_mfma_f32_16x16x32_bf16 v[124:127], a[188:191], a[220:223], v[124:127]
s_waitcnt lgkmcnt(0)
v_mfma_f32_16x16x32_bf16 a[0:3], a[192:195], a[128:131], a[0:3]
s_add_u32 m0, s29, 4096
ds_read_b64_tr_b16 a[160:161], v142 offset:16384
ds_read_b64_tr_b16 a[162:163], v142 offset:17408
v_mfma_f32_16x16x32_bf16 a[0:3], a[196:199], a[132:135], a[0:3]
s_add_u32 s30, s41, 0
ds_read_b64_tr_b16 a[164:165], v142 offset:24576
ds_read_b64_tr_b16 a[166:167], v142 offset:25600
v_mfma_f32_16x16x32_bf16 a[4:7], a[200:203], a[128:131], a[4:7]
buffer_load_dwordx4 v128, s[8:11], s30 offen offset:0 lds
v_mfma_f32_16x16x32_bf16 a[4:7], a[204:207], a[132:135], a[4:7]
ds_read_b64_tr_b16 a[168:169], v143 offset:16384
ds_read_b64_tr_b16 a[170:171], v143 offset:17408
v_mfma_f32_16x16x32_bf16 a[64:67], a[208:211], a[128:131], a[64:67]
ds_read_b64_tr_b16 a[172:173], v143 offset:24576
ds_read_b64_tr_b16 a[174:175], v143 offset:25600
v_mfma_f32_16x16x32_bf16 a[64:67], a[212:215], a[132:135], a[64:67]
ds_read_b64_tr_b16 a[176:177], v144 offset:16384
ds_read_b64_tr_b16 a[178:179], v144 offset:17408
v_mfma_f32_16x16x32_bf16 a[68:71], a[216:219], a[128:131], a[68:71]
ds_read_b64_tr_b16 a[180:181], v144 offset:24576
ds_read_b64_tr_b16 a[182:183], v144 offset:25600
v_mfma_f32_16x16x32_bf16 a[68:71], a[220:223], a[132:135], a[68:71]
ds_read_b64_tr_b16 a[184:185], v145 offset:16384
ds_read_b64_tr_b16 a[186:187], v145 offset:17408
v_mfma_f32_16x16x32_bf16 a[8:11], a[192:195], a[136:139], a[8:11]
ds_read_b64_tr_b16 a[188:189], v145 offset:24576
ds_read_b64_tr_b16 a[190:191], v145 offset:25600
v_mfma_f32_16x16x32_bf16 a[8:11], a[196:199], a[140:143], a[8:11]
buffer_load_dwordx4 v129, s[8:11], s30 offen offset:1024 lds
v_mfma_f32_16x16x32_bf16 a[12:15], a[200:203], a[136:139], a[12:15]
v_add_u32 v136, 0x10000, v136
v_add_u32 v137, 0x10000, v137
v_mfma_f32_16x16x32_bf16 a[12:15], a[204:207], a[140:143], a[12:15]
v_add_u32 v138, 0x10000, v138
v_add_u32 v139, 0x10000, v139
v_mfma_f32_16x16x32_bf16 a[72:75], a[208:211], a[136:139], a[72:75]
v_add_u32 v140, 0x10000, v140
v_add_u32 v141, 0x10000, v141
v_mfma_f32_16x16x32_bf16 a[72:75], a[212:215], a[140:143], a[72:75]
v_add_u32 v142, 0x10000, v142
v_add_u32 v143, 0x10000, v143
v_mfma_f32_16x16x32_bf16 a[76:79], a[216:219], a[136:139], a[76:79]
v_add_u32 v144, 0x10000, v144
v_add_u32 v145, 0x10000, v145
v_mfma_f32_16x16x32_bf16 a[76:79], a[220:223], a[140:143], a[76:79]
v_mfma_f32_16x16x32_bf16 a[16:19], a[192:195], a[144:147], a[16:19]
buffer_load_dwordx4 v130, s[8:11], s30 offen offset:2048 lds
v_mfma_f32_16x16x32_bf16 a[16:19], a[196:199], a[148:151], a[16:19]
v_mfma_f32_16x16x32_bf16 a[20:23], a[200:203], a[144:147], a[20:23]
v_mfma_f32_16x16x32_bf16 a[20:23], a[204:207], a[148:151], a[20:23]
v_mfma_f32_16x16x32_bf16 a[80:83], a[208:211], a[144:147], a[80:83]
v_mfma_f32_16x16x32_bf16 a[80:83], a[212:215], a[148:151], a[80:83]
v_mfma_f32_16x16x32_bf16 a[84:87], a[216:219], a[144:147], a[84:87]
v_mfma_f32_16x16x32_bf16 a[84:87], a[220:223], a[148:151], a[84:87]
buffer_load_dwordx4 v131, s[8:11], s30 offen offset:3072 lds
v_mfma_f32_16x16x32_bf16 a[24:27], a[192:195], a[152:155], a[24:27]
v_mfma_f32_16x16x32_bf16 a[24:27], a[196:199], a[156:159], a[24:27]
v_mfma_f32_16x16x32_bf16 a[28:31], a[200:203], a[152:155], a[28:31]
v_mfma_f32_16x16x32_bf16 a[28:31], a[204:207], a[156:159], a[28:31]
v_mfma_f32_16x16x32_bf16 a[88:91], a[208:211], a[152:155], a[88:91]
v_mfma_f32_16x16x32_bf16 a[88:91], a[212:215], a[156:159], a[88:91]
v_mfma_f32_16x16x32_bf16 a[92:95], a[216:219], a[152:155], a[92:95]
v_mfma_f32_16x16x32_bf16 a[92:95], a[220:223], a[156:159], a[92:95]
s_waitcnt vmcnt(9) lgkmcnt(0)
s_barrier
v_mfma_f32_16x16x32_bf16 a[32:35], a[192:195], a[160:163], a[32:35]
s_add_u32 m0, s31, 32768
ds_read_b128 a[224:227], v136 offset:0
v_mfma_f32_16x16x32_bf16 a[32:35], a[196:199], a[164:167], a[32:35]
s_add_u32 s30, s49, 0
ds_read_b128 a[228:231], v137 offset:0
v_mfma_f32_16x16x32_bf16 a[36:39], a[200:203], a[160:163], a[36:39]
buffer_load_dwordx4 v132, s[12:15], s30 offen offset:0  lds
v_mfma_f32_16x16x32_bf16 a[36:39], a[204:207], a[164:167], a[36:39]
ds_read_b128 a[232:235], v136 offset:2048
v_mfma_f32_16x16x32_bf16 a[96:99], a[208:211], a[160:163], a[96:99]
ds_read_b128 a[236:239], v137 offset:2048
v_mfma_f32_16x16x32_bf16 a[96:99], a[212:215], a[164:167], a[96:99]
ds_read_b128 a[240:243], v136 offset:4096
v_mfma_f32_16x16x32_bf16 a[100:103], a[216:219], a[160:163], a[100:103]
ds_read_b128 a[244:247], v137 offset:4096
v_mfma_f32_16x16x32_bf16 a[100:103], a[220:223], a[164:167], a[100:103]
ds_read_b128 a[248:251], v136 offset:6144
v_mfma_f32_16x16x32_bf16 a[40:43], a[192:195], a[168:171], a[40:43]
ds_read_b128 a[252:255], v137 offset:6144
v_mfma_f32_16x16x32_bf16 a[40:43], a[196:199], a[172:175], a[40:43]
buffer_load_dwordx4 v133, s[12:15], s30 offen offset:1024  lds
v_mfma_f32_16x16x32_bf16 a[44:47], a[200:203], a[168:171], a[44:47]
ds_read_b64_tr_b16 a[128:129], v138 offset:0
ds_read_b64_tr_b16 a[130:131], v138 offset:1024
v_mfma_f32_16x16x32_bf16 a[44:47], a[204:207], a[172:175], a[44:47]
ds_read_b64_tr_b16 a[132:133], v138 offset:8192
ds_read_b64_tr_b16 a[134:135], v138 offset:9216
v_mfma_f32_16x16x32_bf16 a[104:107], a[208:211], a[168:171], a[104:107]
ds_read_b64_tr_b16 a[136:137], v139 offset:0
ds_read_b64_tr_b16 a[138:139], v139 offset:1024
v_mfma_f32_16x16x32_bf16 a[104:107], a[212:215], a[172:175], a[104:107]
ds_read_b64_tr_b16 a[140:141], v139 offset:8192
ds_read_b64_tr_b16 a[142:143], v139 offset:9216
v_mfma_f32_16x16x32_bf16 a[108:111], a[216:219], a[168:171], a[108:111]
ds_read_b64_tr_b16 a[144:145], v140 offset:0
ds_read_b64_tr_b16 a[146:147], v140 offset:1024
v_mfma_f32_16x16x32_bf16 a[108:111], a[220:223], a[172:175], a[108:111]
ds_read_b64_tr_b16 a[148:149], v140 offset:8192
ds_read_b64_tr_b16 a[150:151], v140 offset:9216
v_mfma_f32_16x16x32_bf16 a[48:51], a[192:195], a[176:179], a[48:51]
buffer_load_dwordx4 v134, s[12:15], s30 offen offset:2048  lds
v_mfma_f32_16x16x32_bf16 a[48:51], a[196:199], a[180:183], a[48:51]
ds_read_b64_tr_b16 a[152:153], v141 offset:0
ds_read_b64_tr_b16 a[154:155], v141 offset:1024
v_mfma_f32_16x16x32_bf16 a[52:55], a[200:203], a[176:179], a[52:55]
ds_read_b64_tr_b16 a[156:157], v141 offset:8192
ds_read_b64_tr_b16 a[158:159], v141 offset:9216
v_mfma_f32_16x16x32_bf16 a[52:55], a[204:207], a[180:183], a[52:55]
v_mfma_f32_16x16x32_bf16 a[112:115], a[208:211], a[176:179], a[112:115]
v_mfma_f32_16x16x32_bf16 a[112:115], a[212:215], a[180:183], a[112:115]
v_mfma_f32_16x16x32_bf16 a[116:119], a[216:219], a[176:179], a[116:119]
v_mfma_f32_16x16x32_bf16 a[116:119], a[220:223], a[180:183], a[116:119]
buffer_load_dwordx4 v135, s[12:15], s30 offen offset:3072  lds
v_mfma_f32_16x16x32_bf16 a[56:59], a[192:195], a[184:187], a[56:59]
v_mfma_f32_16x16x32_bf16 a[56:59], a[196:199], a[188:191], a[56:59]
v_mfma_f32_16x16x32_bf16 a[60:63], a[200:203], a[184:187], a[60:63]
v_mfma_f32_16x16x32_bf16 a[60:63], a[204:207], a[188:191], a[60:63]
v_mfma_f32_16x16x32_bf16 a[120:123], a[208:211], a[184:187], a[120:123]
v_mfma_f32_16x16x32_bf16 a[120:123], a[212:215], a[188:191], a[120:123]
v_mfma_f32_16x16x32_bf16 a[124:127], a[216:219], a[184:187], a[124:127]
v_mfma_f32_16x16x32_bf16 a[124:127], a[220:223], a[188:191], a[124:127]
s_waitcnt lgkmcnt(0)
v_mfma_f32_16x16x32_bf16 v[0:3], a[128:131], a[224:227], v[0:3]
s_add_u32 m0, s29, 49152
ds_read_b64_tr_b16 a[160:161], v142 offset:0
ds_read_b64_tr_b16 a[162:163], v142 offset:1024
v_mfma_f32_16x16x32_bf16 v[0:3], a[132:135], a[228:231], v[0:3]
s_add_u32 s30, s40, 128
ds_read_b64_tr_b16 a[164:165], v142 offset:8192
ds_read_b64_tr_b16 a[166:167], v142 offset:9216
v_mfma_f32_16x16x32_bf16 v[32:35], a[128:131], a[232:235], v[32:35]
buffer_load_dwordx4 v128, s[8:11], s30 offen offset:0 lds
v_mfma_f32_16x16x32_bf16 v[32:35], a[132:135], a[236:239], v[32:35]
ds_read_b64_tr_b16 a[168:169], v143 offset:0
ds_read_b64_tr_b16 a[170:171], v143 offset:1024
v_mfma_f32_16x16x32_bf16 v[64:67], a[128:131], a[240:243], v[64:67]
ds_read_b64_tr_b16 a[172:173], v143 offset:8192
ds_read_b64_tr_b16 a[174:175], v143 offset:9216
v_mfma_f32_16x16x32_bf16 v[64:67], a[132:135], a[244:247], v[64:67]
ds_read_b64_tr_b16 a[176:177], v144 offset:0
ds_read_b64_tr_b16 a[178:179], v144 offset:1024
v_mfma_f32_16x16x32_bf16 v[96:99], a[128:131], a[248:251], v[96:99]
ds_read_b64_tr_b16 a[180:181], v144 offset:8192
ds_read_b64_tr_b16 a[182:183], v144 offset:9216
v_mfma_f32_16x16x32_bf16 v[96:99], a[132:135], a[252:255], v[96:99]
buffer_load_dwordx4 v129, s[8:11], s30 offen offset:1024 lds
v_mfma_f32_16x16x32_bf16 v[4:7], a[136:139], a[224:227], v[4:7]
ds_read_b64_tr_b16 a[184:185], v145 offset:0
ds_read_b64_tr_b16 a[186:187], v145 offset:1024
v_mfma_f32_16x16x32_bf16 v[4:7], a[140:143], a[228:231], v[4:7]
ds_read_b64_tr_b16 a[188:189], v145 offset:8192
ds_read_b64_tr_b16 a[190:191], v145 offset:9216
v_mfma_f32_16x16x32_bf16 v[36:39], a[136:139], a[232:235], v[36:39]
v_mfma_f32_16x16x32_bf16 v[36:39], a[140:143], a[236:239], v[36:39]
v_mfma_f32_16x16x32_bf16 v[68:71], a[136:139], a[240:243], v[68:71]
v_mfma_f32_16x16x32_bf16 v[68:71], a[140:143], a[244:247], v[68:71]
buffer_load_dwordx4 v130, s[8:11], s30 offen offset:2048 lds
v_mfma_f32_16x16x32_bf16 v[100:103], a[136:139], a[248:251], v[100:103]
v_mfma_f32_16x16x32_bf16 v[100:103], a[140:143], a[252:255], v[100:103]
v_mfma_f32_16x16x32_bf16 v[8:11], a[144:147], a[224:227], v[8:11]
v_mfma_f32_16x16x32_bf16 v[8:11], a[148:151], a[228:231], v[8:11]
v_mfma_f32_16x16x32_bf16 v[40:43], a[144:147], a[232:235], v[40:43]
v_mfma_f32_16x16x32_bf16 v[40:43], a[148:151], a[236:239], v[40:43]
buffer_load_dwordx4 v131, s[8:11], s30 offen offset:3072 lds
v_mfma_f32_16x16x32_bf16 v[72:75], a[144:147], a[240:243], v[72:75]
v_mfma_f32_16x16x32_bf16 v[72:75], a[148:151], a[244:247], v[72:75]
v_mfma_f32_16x16x32_bf16 v[104:107], a[144:147], a[248:251], v[104:107]
v_mfma_f32_16x16x32_bf16 v[104:107], a[148:151], a[252:255], v[104:107]
v_mfma_f32_16x16x32_bf16 v[12:15], a[152:155], a[224:227], v[12:15]
v_mfma_f32_16x16x32_bf16 v[12:15], a[156:159], a[228:231], v[12:15]
buffer_load_dword v166, v167, s[96:99], 0 offen sc1
v_mfma_f32_16x16x32_bf16 v[44:47], a[152:155], a[232:235], v[44:47]
v_mfma_f32_16x16x32_bf16 v[44:47], a[156:159], a[236:239], v[44:47]
v_mfma_f32_16x16x32_bf16 v[76:79], a[152:155], a[240:243], v[76:79]
v_mfma_f32_16x16x32_bf16 v[76:79], a[156:159], a[244:247], v[76:79]
v_mfma_f32_16x16x32_bf16 v[108:111], a[152:155], a[248:251], v[108:111]
v_mfma_f32_16x16x32_bf16 v[108:111], a[156:159], a[252:255], v[108:111]
s_waitcnt lgkmcnt(0)
v_mfma_f32_16x16x32_bf16 v[16:19], a[160:163], a[224:227], v[16:19]
s_add_u32 m0, s29, 53248
ds_read_b64_tr_b16 a[128:129], v138 offset:16384
ds_read_b64_tr_b16 a[130:131], v138 offset:17408
v_mfma_f32_16x16x32_bf16 v[16:19], a[164:167], a[228:231], v[16:19]
s_add_u32 s30, s41, 128
ds_read_b64_tr_b16 a[132:133], v138 offset:24576
ds_read_b64_tr_b16 a[134:135], v138 offset:25600
v_mfma_f32_16x16x32_bf16 v[48:51], a[160:163], a[232:235], v[48:51]
buffer_load_dwordx4 v128, s[8:11], s30 offen offset:0 lds
v_mfma_f32_16x16x32_bf16 v[48:51], a[164:167], a[236:239], v[48:51]
ds_read_b64_tr_b16 a[136:137], v139 offset:16384
ds_read_b64_tr_b16 a[138:139], v139 offset:17408
v_mfma_f32_16x16x32_bf16 v[80:83], a[160:163], a[240:243], v[80:83]
ds_read_b64_tr_b16 a[140:141], v139 offset:24576
ds_read_b64_tr_b16 a[142:143], v139 offset:25600
v_mfma_f32_16x16x32_bf16 v[80:83], a[164:167], a[244:247], v[80:83]
ds_read_b64_tr_b16 a[144:145], v140 offset:16384
ds_read_b64_tr_b16 a[146:147], v140 offset:17408
v_mfma_f32_16x16x32_bf16 v[112:115], a[160:163], a[248:251], v[112:115]
ds_read_b64_tr_b16 a[148:149], v140 offset:24576
ds_read_b64_tr_b16 a[150:151], v140 offset:25600
v_mfma_f32_16x16x32_bf16 v[112:115], a[164:167], a[252:255], v[112:115]
ds_read_b64_tr_b16 a[152:153], v141 offset:16384
ds_read_b64_tr_b16 a[154:155], v141 offset:17408
v_mfma_f32_16x16x32_bf16 v[20:23], a[168:171], a[224:227], v[20:23]
ds_read_b64_tr_b16 a[156:157], v141 offset:24576
ds_read_b64_tr_b16 a[158:159], v141 offset:25600
v_mfma_f32_16x16x32_bf16 v[20:23], a[172:175], a[228:231], v[20:23]
buffer_load_dwordx4 v129, s[8:11], s30 offen offset:1024 lds
v_mfma_f32_16x16x32_bf16 v[52:55], a[168:171], a[232:235], v[52:55]
v_mfma_f32_16x16x32_bf16 v[52:55], a[172:175], a[236:239], v[52:55]
v_mfma_f32_16x16x32_bf16 v[84:87], a[168:171], a[240:243], v[84:87]
v_mfma_f32_16x16x32_bf16 v[84:87], a[172:175], a[244:247], v[84:87]
v_mfma_f32_16x16x32_bf16 v[116:119], a[168:171], a[248:251], v[116:119]
v_mfma_f32_16x16x32_bf16 v[116:119], a[172:175], a[252:255], v[116:119]
v_mfma_f32_16x16x32_bf16 v[24:27], a[176:179], a[224:227], v[24:27]
buffer_load_dwordx4 v130, s[8:11], s30 offen offset:2048 lds
v_mfma_f32_16x16x32_bf16 v[24:27], a[180:183], a[228:231], v[24:27]
v_mfma_f32_16x16x32_bf16 v[56:59], a[176:179], a[232:235], v[56:59]
v_mfma_f32_16x16x32_bf16 v[56:59], a[180:183], a[236:239], v[56:59]
v_mfma_f32_16x16x32_bf16 v[88:91], a[176:179], a[240:243], v[88:91]
v_mfma_f32_16x16x32_bf16 v[88:91], a[180:183], a[244:247], v[88:91]
v_mfma_f32_16x16x32_bf16 v[120:123], a[176:179], a[248:251], v[120:123]
v_mfma_f32_16x16x32_bf16 v[120:123], a[180:183], a[252:255], v[120:123]
buffer_load_dwordx4 v131, s[8:11], s30 offen offset:3072 lds
v_mfma_f32_16x16x32_bf16 v[28:31], a[184:187], a[224:227], v[28:31]
v_mfma_f32_16x16x32_bf16 v[28:31], a[188:191], a[228:231], v[28:31]
v_mfma_f32_16x16x32_bf16 v[60:63], a[184:187], a[232:235], v[60:63]
v_mfma_f32_16x16x32_bf16 v[60:63], a[188:191], a[236:239], v[60:63]
v_mfma_f32_16x16x32_bf16 v[92:95], a[184:187], a[240:243], v[92:95]
v_mfma_f32_16x16x32_bf16 v[92:95], a[188:191], a[244:247], v[92:95]
v_mfma_f32_16x16x32_bf16 v[124:127], a[184:187], a[248:251], v[124:127]
v_mfma_f32_16x16x32_bf16 v[124:127], a[188:191], a[252:255], v[124:127]
s_waitcnt lgkmcnt(0)
v_mfma_f32_16x16x32_bf16 a[0:3], a[224:227], a[128:131], a[0:3]
s_add_u32 m0, s31, 81920
ds_read_b64_tr_b16 a[160:161], v142 offset:16384
ds_read_b64_tr_b16 a[162:163], v142 offset:17408
v_mfma_f32_16x16x32_bf16 a[0:3], a[228:231], a[132:135], a[0:3]
s_add_u32 s30, s49, 524288
ds_read_b64_tr_b16 a[164:165], v142 offset:24576
ds_read_b64_tr_b16 a[166:167], v142 offset:25600
v_mfma_f32_16x16x32_bf16 a[4:7], a[232:235], a[128:131], a[4:7]
buffer_load_dwordx4 v132, s[12:15], s30 offen offset:0  lds
v_mfma_f32_16x16x32_bf16 a[4:7], a[236:239], a[132:135], a[4:7]
ds_read_b64_tr_b16 a[168:169], v143 offset:16384
ds_read_b64_tr_b16 a[170:171], v143 offset:17408
v_mfma_f32_16x16x32_bf16 a[64:67], a[240:243], a[128:131], a[64:67]
ds_read_b64_tr_b16 a[172:173], v143 offset:24576
ds_read_b64_tr_b16 a[174:175], v143 offset:25600
v_mfma_f32_16x16x32_bf16 a[64:67], a[244:247], a[132:135], a[64:67]
ds_read_b64_tr_b16 a[176:177], v144 offset:16384
ds_read_b64_tr_b16 a[178:179], v144 offset:17408
v_mfma_f32_16x16x32_bf16 a[68:71], a[248:251], a[128:131], a[68:71]
ds_read_b64_tr_b16 a[180:181], v144 offset:24576
ds_read_b64_tr_b16 a[182:183], v144 offset:25600
v_mfma_f32_16x16x32_bf16 a[68:71], a[252:255], a[132:135], a[68:71]
ds_read_b64_tr_b16 a[184:185], v145 offset:16384
ds_read_b64_tr_b16 a[186:187], v145 offset:17408
v_mfma_f32_16x16x32_bf16 a[8:11], a[224:227], a[136:139], a[8:11]
ds_read_b64_tr_b16 a[188:189], v145 offset:24576
ds_read_b64_tr_b16 a[190:191], v145 offset:25600
v_mfma_f32_16x16x32_bf16 a[8:11], a[228:231], a[140:143], a[8:11]
buffer_load_dwordx4 v133, s[12:15], s30 offen offset:1024  lds
v_mfma_f32_16x16x32_bf16 a[12:15], a[232:235], a[136:139], a[12:15]
v_add_u32 v136, 0xfffe8000, v136
v_add_u32 v137, 0xfffe8000, v137
v_mfma_f32_16x16x32_bf16 a[12:15], a[236:239], a[140:143], a[12:15]
v_add_u32 v138, 0xfffe8000, v138
v_add_u32 v139, 0xfffe8000, v139
v_mfma_f32_16x16x32_bf16 a[72:75], a[240:243], a[136:139], a[72:75]
v_add_u32 v140, 0xfffe8000, v140
v_add_u32 v141, 0xfffe8000, v141
v_mfma_f32_16x16x32_bf16 a[72:75], a[244:247], a[140:143], a[72:75]
v_add_u32 v142, 0xfffe8000, v142
v_add_u32 v143, 0xfffe8000, v143
v_mfma_f32_16x16x32_bf16 a[76:79], a[248:251], a[136:139], a[76:79]
v_add_u32 v144, 0xfffe8000, v144
v_add_u32 v145, 0xfffe8000, v145
v_mfma_f32_16x16x32_bf16 a[76:79], a[252:255], a[140:143], a[76:79]
v_cvt_pk_bf16_f32 v176, v0, v1
v_cvt_pk_bf16_f32 v177, v2, v3
v_mfma_f32_16x16x32_bf16 a[16:19], a[224:227], a[144:147], a[16:19]
buffer_load_dwordx4 v134, s[12:15], s30 offen offset:2048  lds
v_mfma_f32_16x16x32_bf16 a[16:19], a[228:231], a[148:151], a[16:19]
v_cvt_pk_bf16_f32 v178, v4, v5
v_cvt_pk_bf16_f32 v179, v6, v7
v_mfma_f32_16x16x32_bf16 a[20:23], a[232:235], a[144:147], a[20:23]
v_cvt_pk_bf16_f32 v180, v8, v9
v_cvt_pk_bf16_f32 v181, v10, v11
v_mfma_f32_16x16x32_bf16 a[20:23], a[236:239], a[148:151], a[20:23]
v_cvt_pk_bf16_f32 v182, v12, v13
v_cvt_pk_bf16_f32 v183, v14, v15
v_mfma_f32_16x16x32_bf16 a[80:83], a[240:243], a[144:147], a[80:83]
v_cvt_pk_bf16_f32 v184, v16, v17
v_cvt_pk_bf16_f32 v185, v18, v19
v_mfma_f32_16x16x32_bf16 a[80:83], a[244:247], a[148:151], a[80:83]
v_cvt_pk_bf16_f32 v186, v20, v21
v_cvt_pk_bf16_f32 v187, v22, v23
v_mfma_f32_16x16x32_bf16 a[84:87], a[248:251], a[144:147], a[84:87]
v_cvt_pk_bf16_f32 v188, v24, v25
v_cvt_pk_bf16_f32 v189, v26, v27
v_mfma_f32_16x16x32_bf16 a[84:87], a[252:255], a[148:151], a[84:87]
buffer_load_dwordx4 v135, s[12:15], s30 offen offset:3072  lds
v_mfma_f32_16x16x32_bf16 a[24:27], a[224:227], a[152:155], a[24:27]
v_cvt_pk_bf16_f32 v190, v28, v29
v_cvt_pk_bf16_f32 v191, v30, v31
v_mfma_f32_16x16x32_bf16 a[24:27], a[228:231], a[156:159], a[24:27]
v_cvt_pk_bf16_f32 v192, v32, v33
v_cvt_pk_bf16_f32 v193, v34, v35
v_mfma_f32_16x16x32_bf16 a[28:31], a[232:235], a[152:155], a[28:31]
v_cvt_pk_bf16_f32 v194, v36, v37
v_cvt_pk_bf16_f32 v195, v38, v39
v_mfma_f32_16x16x32_bf16 a[28:31], a[236:239], a[156:159], a[28:31]
v_cvt_pk_bf16_f32 v196, v40, v41
v_cvt_pk_bf16_f32 v197, v42, v43
v_mfma_f32_16x16x32_bf16 a[88:91], a[240:243], a[152:155], a[88:91]
v_cvt_pk_bf16_f32 v198, v44, v45
v_cvt_pk_bf16_f32 v199, v46, v47
v_mfma_f32_16x16x32_bf16 a[88:91], a[244:247], a[156:159], a[88:91]
v_cvt_pk_bf16_f32 v200, v48, v49
v_cvt_pk_bf16_f32 v201, v50, v51
v_mfma_f32_16x16x32_bf16 a[92:95], a[248:251], a[152:155], a[92:95]
v_cvt_pk_bf16_f32 v202, v52, v53
v_cvt_pk_bf16_f32 v203, v54, v55
v_mfma_f32_16x16x32_bf16 a[92:95], a[252:255], a[156:159], a[92:95]
v_cvt_pk_bf16_f32 v204, v56, v57
v_cvt_pk_bf16_f32 v205, v58, v59
v_cvt_pk_bf16_f32 v206, v60, v61
v_cvt_pk_bf16_f32 v207, v62, v63
s_waitcnt vmcnt(13) lgkmcnt(0)
s_barrier
v_mfma_f32_16x16x32_bf16 a[32:35], a[224:227], a[160:163], a[32:35]
s_add_u32 m0, s29, 98304
ds_read_b128 a[192:195], v136 offset:0
v_mfma_f32_16x16x32_bf16 a[32:35], a[228:231], a[164:167], a[32:35]
s_add_u32 s30, s40, 256
ds_read_b128 a[196:199], v137 offset:0
v_mfma_f32_16x16x32_bf16 a[36:39], a[232:235], a[160:163], a[36:39]
buffer_load_dwordx4 v128, s[8:11], s30 offen offset:0 lds
v_mfma_f32_16x16x32_bf16 a[36:39], a[236:239], a[164:167], a[36:39]
ds_read_b128 a[200:203], v136 offset:2048
v_mfma_f32_16x16x32_bf16 a[96:99], a[240:243], a[160:163], a[96:99]
ds_read_b128 a[204:207], v137 offset:2048
v_mfma_f32_16x16x32_bf16 a[96:99], a[244:247], a[164:167], a[96:99]
ds_read_b128 a[208:211], v136 offset:4096
v_mfma_f32_16x16x32_bf16 a[100:103], a[248:251], a[160:163], a[100:103]
buffer_load_dwordx4 v129, s[8:11], s30 offen offset:1024 lds
v_mfma_f32_16x16x32_bf16 a[100:103], a[252:255], a[164:167], a[100:103]
ds_read_b128 a[212:215], v137 offset:4096
v_mfma_f32_16x16x32_bf16 a[40:43], a[224:227], a[168:171], a[40:43]
ds_read_b128 a[216:219], v136 offset:6144
v_mfma_f32_16x16x32_bf16 a[40:43], a[228:231], a[172:175], a[40:43]
ds_read_b128 a[220:223], v137 offset:6144
v_mfma_f32_16x16x32_bf16 a[44:47], a[232:235], a[168:171], a[44:47]
ds_read_b64_tr_b16 a[128:129], v138 offset:0
ds_read_b64_tr_b16 a[130:131], v138 offset:1024
v_mfma_f32_16x16x32_bf16 a[44:47], a[236:239], a[172:175], a[44:47]
buffer_load_dwordx4 v130, s[8:11], s30 offen offset:2048 lds
v_mfma_f32_16x16x32_bf16 a[104:107], a[240:243], a[168:171], a[104:107]
ds_read_b64_tr_b16 a[132:133], v138 offset:8192
ds_read_b64_tr_b16 a[134:135], v138 offset:9216
v_mfma_f32_16x16x32_bf16 a[104:107], a[244:247], a[172:175], a[104:107]
ds_read_b64_tr_b16 a[136:137], v139 offset:0
ds_read_b64_tr_b16 a[138:139], v139 offset:1024
v_mfma_f32_16x16x32_bf16 a[108:111], a[248:251], a[168:171], a[108:111]
ds_read_b64_tr_b16 a[140:141], v139 offset:8192
ds_read_b64_tr_b16 a[142:143], v139 offset:9216
v_mfma_f32_16x16x32_bf16 a[108:111], a[252:255], a[172:175], a[108:111]
ds_read_b64_tr_b16 a[144:145], v140 offset:0
ds_read_b64_tr_b16 a[146:147], v140 offset:1024
v_mfma_f32_16x16x32_bf16 a[48:51], a[224:227], a[176:179], a[48:51]
buffer_load_dwordx4 v131, s[8:11], s30 offen offset:3072 lds
v_mfma_f32_16x16x32_bf16 a[48:51], a[228:231], a[180:183], a[48:51]
ds_read_b64_tr_b16 a[148:149], v140 offset:8192
ds_read_b64_tr_b16 a[150:151], v140 offset:9216
v_mfma_f32_16x16x32_bf16 a[52:55], a[232:235], a[176:179], a[52:55]
ds_read_b64_tr_b16 a[152:153], v141 offset:0
ds_read_b64_tr_b16 a[154:155], v141 offset:1024
v_mfma_f32_16x16x32_bf16 a[52:55], a[236:239], a[180:183], a[52:55]
s_add_u32 m0, s29, 102400
ds_read_b64_tr_b16 a[156:157], v141 offset:8192
ds_read_b64_tr_b16 a[158:159], v141 offset:9216
v_mfma_f32_16x16x32_bf16 a[112:115], a[240:243], a[176:179], a[112:115]
s_add_u32 s30, s41, 256
v_cvt_pk_bf16_f32 v208, v64, v65
v_cvt_pk_bf16_f32 v209, v66, v67
v_mfma_f32_16x16x32_bf16 a[112:115], a[244:247], a[180:183], a[112:115]
buffer_load_dwordx4 v128, s[8:11], s30 offen offset:0 lds
v_mfma_f32_16x16x32_bf16 a[116:119], a[248:251], a[176:179], a[116:119]
v_cvt_pk_bf16_f32 v210, v68, v69
v_cvt_pk_bf16_f32 v211, v70, v71
v_mfma_f32_16x16x32_bf16 a[116:119], a[252:255], a[180:183], a[116:119]
v_cvt_pk_bf16_f32 v212, v72, v73
v_cvt_pk_bf16_f32 v213, v74, v75
v_mfma_f32_16x16x32_bf16 a[56:59], a[224:227], a[184:187], a[56:59]
v_cvt_pk_bf16_f32 v214, v76, v77
v_cvt_pk_bf16_f32 v215, v78, v79
v_mfma_f32_16x16x32_bf16 a[56:59], a[228:231], a[188:191], a[56:59]
v_cvt_pk_bf16_f32 v216, v80, v81
v_cvt_pk_bf16_f32 v217, v82, v83
v_mfma_f32_16x16x32_bf16 a[60:63], a[232:235], a[184:187], a[60:63]
buffer_load_dwordx4 v129, s[8:11], s30 offen offset:1024 lds
v_mfma_f32_16x16x32_bf16 a[60:63], a[236:239], a[188:191], a[60:63]
v_cvt_pk_bf16_f32 v218, v84, v85
v_cvt_pk_bf16_f32 v219, v86, v87
v_mfma_f32_16x16x32_bf16 a[120:123], a[240:243], a[184:187], a[120:123]
v_cvt_pk_bf16_f32 v220, v88, v89
v_cvt_pk_bf16_f32 v221, v90, v91
v_mfma_f32_16x16x32_bf16 a[120:123], a[244:247], a[188:191], a[120:123]
v_cvt_pk_bf16_f32 v222, v92, v93
v_cvt_pk_bf16_f32 v223, v94, v95
v_mfma_f32_16x16x32_bf16 a[124:127], a[248:251], a[184:187], a[124:127]
v_cvt_pk_bf16_f32 v224, v96, v97
v_cvt_pk_bf16_f32 v225, v98, v99
v_mfma_f32_16x16x32_bf16 a[124:127], a[252:255], a[188:191], a[124:127]
v_cvt_pk_bf16_f32 v226, v100, v101
v_cvt_pk_bf16_f32 v227, v102, v103
v_cvt_pk_bf16_f32 v228, v104, v105
v_cvt_pk_bf16_f32 v229, v106, v107
v_cvt_pk_bf16_f32 v230, v108, v109
v_cvt_pk_bf16_f32 v231, v110, v111
v_cvt_pk_bf16_f32 v232, v112, v113
v_cvt_pk_bf16_f32 v233, v114, v115
v_cvt_pk_bf16_f32 v234, v116, v117
v_cvt_pk_bf16_f32 v235, v118, v119
v_cvt_pk_bf16_f32 v236, v120, v121
v_cvt_pk_bf16_f32 v237, v122, v123
v_cvt_pk_bf16_f32 v238, v124, v125
v_cvt_pk_bf16_f32 v239, v126, v127
s_waitcnt lgkmcnt(0)
v_mfma_f32_16x16x32_bf16 v[0:3], a[128:131], a[192:195], 0
ds_read_b64_tr_b16 a[160:161], v142 offset:0
ds_read_b64_tr_b16 a[162:163], v142 offset:1024
v_mfma_f32_16x16x32_bf16 v[0:3], a[132:135], a[196:199], v[0:3]
ds_read_b64_tr_b16 a[164:165], v142 offset:8192
ds_read_b64_tr_b16 a[166:167], v142 offset:9216
v_mfma_f32_16x16x32_bf16 v[32:35], a[128:131], a[200:203], 0
buffer_load_dwordx4 v130, s[8:11], s30 offen offset:2048 lds
v_mfma_f32_16x16x32_bf16 v[32:35], a[132:135], a[204:207], v[32:35]
ds_read_b64_tr_b16 a[168:169], v143 offset:0
ds_read_b64_tr_b16 a[170:171], v143 offset:1024
v_mfma_f32_16x16x32_bf16 v[64:67], a[128:131], a[208:211], 0
ds_read_b64_tr_b16 a[172:173], v143 offset:8192
ds_read_b64_tr_b16 a[174:175], v143 offset:9216
v_mfma_f32_16x16x32_bf16 v[64:67], a[132:135], a[212:215], v[64:67]
buffer_load_dwordx4 v131, s[8:11], s30 offen offset:3072 lds
v_mfma_f32_16x16x32_bf16 v[96:99], a[128:131], a[216:219], 0
ds_read_b64_tr_b16 a[176:177], v144 offset:0
ds_read_b64_tr_b16 a[178:179], v144 offset:1024
v_mfma_f32_16x16x32_bf16 v[96:99], a[132:135], a[220:223], v[96:99]
s_add_u32 m0, s31, 131072
ds_read_b64_tr_b16 a[180:181], v144 offset:8192
ds_read_b64_tr_b16 a[182:183], v144 offset:9216
v_mfma_f32_16x16x32_bf16 v[4:7], a[136:139], a[192:195], 0
s_add_u32 s30, s49, 1048576
ds_read_b64_tr_b16 a[184:185], v145 offset:0
ds_read_b64_tr_b16 a[186:187], v145 offset:1024
v_mfma_f32_16x16x32_bf16 v[4:7], a[140:143], a[196:199], v[4:7]
buffer_load_dwordx4 v132, s[12:15], s30 offen offset:0  lds
v_mfma_f32_16x16x32_bf16 v[36:39], a[136:139], a[200:203], 0
ds_read_b64_tr_b16 a[188:189], v145 offset:8192
ds_read_b64_tr_b16 a[190:191], v145 offset:9216
v_mfma_f32_16x16x32_bf16 v[36:39], a[140:143], a[204:207], v[36:39]
v_add_u32 v136, 0xc000, v136
v_add_u32 v137, 0xc000, v137
v_mfma_f32_16x16x32_bf16 v[68:71], a[136:139], a[208:211], 0
buffer_load_dwordx4 v133, s[12:15], s30 offen offset:1024  lds
v_mfma_f32_16x16x32_bf16 v[68:71], a[140:143], a[212:215], v[68:71]
v_add_u32 v138, 0xc000, v138
v_add_u32 v139, 0xc000, v139
v_mfma_f32_16x16x32_bf16 v[100:103], a[136:139], a[216:219], 0
v_add_u32 v140, 0xc000, v140
v_add_u32 v141, 0xc000, v141
v_mfma_f32_16x16x32_bf16 v[100:103], a[140:143], a[220:223], v[100:103]
v_add_u32 v142, 0xc000, v142
v_add_u32 v143, 0xc000, v143
v_mfma_f32_16x16x32_bf16 v[8:11], a[144:147], a[192:195], 0
buffer_load_dwordx4 v134, s[12:15], s30 offen offset:2048  lds
v_mfma_f32_16x16x32_bf16 v[8:11], a[148:151], a[196:199], v[8:11]
v_add_u32 v144, 0xc000, v144
v_add_u32 v145, 0xc000, v145
v_mfma_f32_16x16x32_bf16 v[40:43], a[144:147], a[200:203], 0
v_mfma_f32_16x16x32_bf16 v[40:43], a[148:151], a[204:207], v[40:43]
v_mfma_f32_16x16x32_bf16 v[72:75], a[144:147], a[208:211], 0
buffer_load_dwordx4 v135, s[12:15], s30 offen offset:3072  lds
v_mfma_f32_16x16x32_bf16 v[72:75], a[148:151], a[212:215], v[72:75]
v_mfma_f32_16x16x32_bf16 v[104:107], a[144:147], a[216:219], 0
s_add_u32 s43, s32, 0
v_mfma_f32_16x16x32_bf16 v[104:107], a[148:151], a[220:223], v[104:107]
buffer_store_dwordx4 v[176:179], v252, s[4:7], s43 offen offset:0 sc1
v_mfma_f32_16x16x32_bf16 v[12:15], a[152:155], a[192:195], 0
v_mfma_f32_16x16x32_bf16 v[12:15], a[156:159], a[196:199], v[12:15]
v_mfma_f32_16x16x32_bf16 v[44:47], a[152:155], a[200:203], 0
s_add_u32 s43, s32, 0
v_mfma_f32_16x16x32_bf16 v[44:47], a[156:159], a[204:207], v[44:47]
buffer_store_dwordx4 v[180:183], v252, s[4:7], s43 offen offset:1024 sc1
v_mfma_f32_16x16x32_bf16 v[76:79], a[152:155], a[208:211], 0
v_mfma_f32_16x16x32_bf16 v[76:79], a[156:159], a[212:215], v[76:79]
v_mfma_f32_16x16x32_bf16 v[108:111], a[152:155], a[216:219], 0
v_mfma_f32_16x16x32_bf16 v[108:111], a[156:159], a[220:223], v[108:111]
s_waitcnt vmcnt(14) lgkmcnt(0)
s_cmp_eq_u32 s20, 0
s_cbranch_scc0 KA_rdyZ
v_cmp_ne_u32 vcc, 1, v166
s_mov_b32 s37, 0
s_nop 3
s_cbranch_vccz KA_rdyZ
KA_pollZ:
s_sleep 2
buffer_load_dword v166, v167, s[96:99], 0 offen sc1
s_waitcnt vmcnt(0)
v_cmp_ne_u32 vcc, 1, v166
s_add_u32 s37, s37, 1
s_nop 3
s_cbranch_vccz KA_rdyZ
s_cmp_lt_u32 s37, 0x40000
s_cbranch_scc1 KA_pollZ
KA_rdyZ:
s_barrier
v_mfma_f32_16x16x32_bf16 v[16:19], a[160:163], a[192:195], 0
s_add_u32 m0, s29, 0
ds_read_b128 a[224:227], v136 offset:0
v_mfma_f32_16x16x32_bf16 v[16:19], a[164:167], a[196:199], v[16:19]
s_add_u32 s30, s40, 384
ds_read_b128 a[228:231], v137 offset:0
v_mfma_f32_16x16x32_bf16 v[48:51], a[160:163], a[200:203], 0
buffer_load_dwordx4 v128, s[8:11], s30 offen offset:0 lds
v_mfma_f32_16x16x32_bf16 v[48:51], a[164:167], a[204:207], v[48:51]
ds_read_b128 a[232:235], v136 offset:2048
v_mfma_f32_16x16x32_bf16 v[80:83], a[160:163], a[208:211], 0
ds_read_b128 a[236:239], v137 offset:2048
v_mfma_f32_16x16x32_bf16 v[80:83], a[164:167], a[212:215], v[80:83]
ds_read_b128 a[240:243], v136 offset:4096
v_mfma_f32_16x16x32_bf16 v[112:115], a[160:163], a[216:219], 0
buffer_load_dwordx4 v129, s[8:11], s30 offen offset:1024 lds
v_mfma_f32_16x16x32_bf16 v[112:115], a[164:167], a[220:223], v[112:115]
ds_read_b128 a[244:247], v137 offset:4096
v_mfma_f32_16x16x32_bf16 v[20:23], a[168:171], a[192:195], 0
ds_read_b128 a[248:251], v136 offset:6144
v_mfma_f32_16x16x32_bf16 v[20:23], a[172:175], a[196:199], v[20:23]
ds_read_b128 a[252:255], v137 offset:6144
v_mfma_f32_16x16x32_bf16 v[52:55], a[168:171], a[200:203], 0
buffer_load_dwordx4 v130, s[8:11], s30 offen offset:2048 lds
v_mfma_f32_16x16x32_bf16 v[52:55], a[172:175], a[204:207], v[52:55]
ds_read_b64_tr_b16 a[128:129], v138 offset:0
ds_read_b64_tr_b16 a[130:131], v138 offset:1024
v_mfma_f32_16x16x32_bf16 v[84:87], a[168:171], a[208:211], 0
ds_read_b64_tr_b16 a[132:133], v138 offset:8192
ds_read_b64_tr_b16 a[134:135], v138 offset:9216
v_mfma_f32_16x16x32_bf16 v[84:87], a[172:175], a[212:215], v[84:87]
ds_read_b64_tr_b16 a[136:137], v139 offset:0
ds_read_b64_tr_b16 a[138:139], v139 offset:1024
v_mfma_f32_16x16x32_bf16 v[116:119], a[168:171], a[216:219], 0
buffer_load_dwordx4 v131, s[8:11], s30 offen offset:3072 lds
v_mfma_f32_16x16x32_bf16 v[116:119], a[172:175], a[220:223], v[116:119]
ds_read_b64_tr_b16 a[140:141], v139 offset:8192
ds_read_b64_tr_b16 a[142:143], v139 offset:9216
v_mfma_f32_16x16x32_bf16 v[24:27], a[176:179], a[192:195], 0
s_add_u32 m0, s29, 4096
ds_read_b64_tr_b16 a[144:145], v140 offset:0
ds_read_b64_tr_b16 a[146:147], v140 offset:1024
v_mfma_f32_16x16x32_bf16 v[24:27], a[180:183], a[196:199], v[24:27]
s_add_u32 s30, s41, 384
ds_read_b64_tr_b16 a[148:149], v140 offset:8192
ds_read_b64_tr_b16 a[150:151], v140 offset:9216
v_mfma_f32_16x16x32_bf16 v[56:59], a[176:179], a[200:203], 0
buffer_load_dwordx4 v128, s[8:11], s30 offen offset:0 lds
v_mfma_f32_16x16x32_bf16 v[56:59], a[180:183], a[204:207], v[56:59]
ds_read_b64_tr_b16 a[152:153], v141 offset:0
ds_read_b64_tr_b16 a[154:155], v141 offset:1024
v_mfma_f32_16x16x32_bf16 v[88:91], a[176:179], a[208:211], 0
ds_read_b64_tr_b16 a[156:157], v141 offset:8192
ds_read_b64_tr_b16 a[158:159], v141 offset:9216
v_mfma_f32_16x16x32_bf16 v[88:91], a[180:183], a[212:215], v[88:91]
v_mfma_f32_16x16x32_bf16 v[120:123], a[176:179], a[216:219], 0
buffer_load_dwordx4 v129, s[8:11], s30 offen offset:1024 lds
v_mfma_f32_16x16x32_bf16 v[120:123], a[180:183], a[220:223], v[120:123]
v_mfma_f32_16x16x32_bf16 v[28:31], a[184:187], a[192:195], 0
v_mfma_f32_16x16x32_bf16 v[28:31], a[188:191], a[196:199], v[28:31]
s_add_u32 s43, s32, 0
v_mfma_f32_16x16x32_bf16 v[60:63], a[184:187], a[200:203], 0
buffer_store_dwordx4 v[184:187], v252, s[4:7], s43 offen offset:2048 sc1
v_mfma_f32_16x16x32_bf16 v[60:63], a[188:191], a[204:207], v[60:63]
v_mfma_f32_16x16x32_bf16 v[92:95], a[184:187], a[208:211], 0
v_mfma_f32_16x16x32_bf16 v[92:95], a[188:191], a[212:215], v[92:95]
v_mfma_f32_16x16x32_bf16 v[124:127], a[184:187], a[216:219], 0
v_mfma_f32_16x16x32_bf16 v[124:127], a[188:191], a[220:223], v[124:127]
s_waitcnt lgkmcnt(0)
v_mfma_f32_16x16x32_bf16 v[0:3], a[128:131], a[224:227], v[0:3]
ds_read_b64_tr_b16 a[160:161], v142 offset:0
ds_read_b64_tr_b16 a[162:163], v142 offset:1024
v_mfma_f32_16x16x32_bf16 v[0:3], a[132:135], a[228:231], v[0:3]
ds_read_b64_tr_b16 a[164:165], v142 offset:8192
ds_read_b64_tr_b16 a[166:167], v142 offset:9216
v_mfma_f32_16x16x32_bf16 v[32:35], a[128:131], a[232:235], v[32:35]
buffer_load_dwordx4 v130, s[8:11], s30 offen offset:2048 lds
v_mfma_f32_16x16x32_bf16 v[32:35], a[132:135], a[236:239], v[32:35]
ds_read_b64_tr_b16 a[168:169], v143 offset:0
ds_read_b64_tr_b16 a[170:171], v143 offset:1024
v_mfma_f32_16x16x32_bf16 v[64:67], a[128:131], a[240:243], v[64:67]
ds_read_b64_tr_b16 a[172:173], v143 offset:8192
ds_read_b64_tr_b16 a[174:175], v143 offset:9216
v_mfma_f32_16x16x32_bf16 v[64:67], a[132:135], a[244:247], v[64:67]
buffer_load_dwordx4 v131, s[8:11], s30 offen offset:3072 lds
v_mfma_f32_16x16x32_bf16 v[96:99], a[128:131], a[248:251], v[96:99]
ds_read_b64_tr_b16 a[176:177], v144 offset:0
ds_read_b64_tr_b16 a[178:179], v144 offset:1024
v_mfma_f32_16x16x32_bf16 v[96:99], a[132:135], a[252:255], v[96:99]
s_add_u32 m0, s31, 32768
ds_read_b64_tr_b16 a[180:181], v144 offset:8192
ds_read_b64_tr_b16 a[182:183], v144 offset:9216
v_mfma_f32_16x16x32_bf16 v[4:7], a[136:139], a[224:227], v[4:7]
s_add_u32 s30, s49, 1572864
ds_read_b64_tr_b16 a[184:185], v145 offset:0
ds_read_b64_tr_b16 a[186:187], v145 offset:1024
v_mfma_f32_16x16x32_bf16 v[4:7], a[140:143], a[228:231], v[4:7]
buffer_load_dwordx4 v132, s[12:15], s30 offen offset:0  lds
v_mfma_f32_16x16x32_bf16 v[36:39], a[136:139], a[232:235], v[36:39]
ds_read_b64_tr_b16 a[188:189], v145 offset:8192
ds_read_b64_tr_b16 a[190:191], v145 offset:9216
v_mfma_f32_16x16x32_bf16 v[36:39], a[140:143], a[236:239], v[36:39]
v_add_u32 v136, 0xc000, v136
v_add_u32 v137, 0xc000, v137
v_mfma_f32_16x16x32_bf16 v[68:71], a[136:139], a[240:243], v[68:71]
buffer_load_dwordx4 v133, s[12:15], s30 offen offset:1024  lds
v_mfma_f32_16x16x32_bf16 v[68:71], a[140:143], a[244:247], v[68:71]
v_add_u32 v138, 0xc000, v138
v_add_u32 v139, 0xc000, v139
v_mfma_f32_16x16x32_bf16 v[100:103], a[136:139], a[248:251], v[100:103]
v_add_u32 v140, 0xc000, v140
v_add_u32 v141, 0xc000, v141
v_mfma_f32_16x16x32_bf16 v[100:103], a[140:143], a[252:255], v[100:103]
v_add_u32 v142, 0xc000, v142
v_add_u32 v143, 0xc000, v143
v_mfma_f32_16x16x32_bf16 v[8:11], a[144:147], a[224:227], v[8:11]
buffer_load_dwordx4 v134, s[12:15], s30 offen offset:2048  lds
v_mfma_f32_16x16x32_bf16 v[8:11], a[148:151], a[228:231], v[8:11]
v_add_u32 v144, 0xc000, v144
v_add_u32 v145, 0xc000, v145
v_mfma_f32_16x16x32_bf16 v[40:43], a[144:147], a[232:235], v[40:43]
v_mfma_f32_16x16x32_bf16 v[40:43], a[148:151], a[236:239], v[40:43]
v_mfma_f32_16x16x32_bf16 v[72:75], a[144:147], a[240:243], v[72:75]
buffer_load_dwordx4 v135, s[12:15], s30 offen offset:3072  lds
v_mfma_f32_16x16x32_bf16 v[72:75], a[148:151], a[244:247], v[72:75]
v_mfma_f32_16x16x32_bf16 v[104:107], a[144:147], a[248:251], v[104:107]
s_add_u32 s43, s32, 0
v_mfma_f32_16x16x32_bf16 v[104:107], a[148:151], a[252:255], v[104:107]
buffer_store_dwordx4 v[188:191], v252, s[4:7], s43 offen offset:3072 sc1
v_mfma_f32_16x16x32_bf16 v[12:15], a[152:155], a[224:227], v[12:15]
v_mfma_f32_16x16x32_bf16 v[12:15], a[156:159], a[228:231], v[12:15]
v_mfma_f32_16x16x32_bf16 v[44:47], a[152:155], a[232:235], v[44:47]
s_add_u32 s43, s32, 4096
v_mfma_f32_16x16x32_bf16 v[44:47], a[156:159], a[236:239], v[44:47]
buffer_store_dwordx4 v[192:195], v252, s[4:7], s43 offen offset:0 sc1
v_mfma_f32_16x16x32_bf16 v[76:79], a[152:155], a[240:243], v[76:79]
v_mfma_f32_16x16x32_bf16 v[76:79], a[156:159], a[244:247], v[76:79]
v_mfma_f32_16x16x32_bf16 v[108:111], a[152:155], a[248:251], v[108:111]
v_mfma_f32_16x16x32_bf16 v[108:111], a[156:159], a[252:255], v[108:111]
s_waitcnt vmcnt(17) lgkmcnt(0)
s_barrier
v_mfma_f32_16x16x32_bf16 v[16:19], a[160:163], a[224:227], v[16:19]
s_add_u32 m0, s29, 49152
ds_read_b128 a[192:195], v136 offset:0
v_mfma_f32_16x16x32_bf16 v[16:19], a[164:167], a[228:231], v[16:19]
s_add_u32 s30, s40, 512
ds_read_b128 a[196:199], v137 offset:0
v_mfma_f32_16x16x32_bf16 v[48:51], a[160:163], a[232:235], v[48:51]
buffer_load_dwordx4 v128, s[8:11], s30 offen offset:0 lds
v_mfma_f32_16x16x32_bf16 v[48:51], a[164:167], a[236:239], v[48:51]
ds_read_b128 a[200:203], v136 offset:2048
v_mfma_f32_16x16x32_bf16 v[80:83], a[160:163], a[240:243], v[80:83]
ds_read_b128 a[204:207], v137 offset:2048
v_mfma_f32_16x16x32_bf16 v[80:83], a[164:167], a[244:247], v[80:83]
ds_read_b128 a[208:211], v136 offset:4096
v_mfma_f32_16x16x32_bf16 v[112:115], a[160:163], a[248:251], v[112:115]
buffer_load_dwordx4 v129, s[8:11], s30 offen offset:1024 lds
v_mfma_f32_16x16x32_bf16 v[112:115], a[164:167], a[252:255], v[112:115]
ds_read_b128 a[212:215], v137 offset:4096
v_mfma_f32_16x16x32_bf16 v[20:23], a[168:171], a[224:227], v[20:23]
ds_read_b128 a[216:219], v136 offset:6144
v_mfma_f32_16x16x32_bf16 v[20:23], a[172:175], a[228:231], v[20:23]
ds_read_b128 a[220:223], v137 offset:6144
v_mfma_f32_16x16x32_bf16 v[52:55], a[168:171], a[232:235], v[52:55]
buffer_load_dwordx4 v130, s[8:11], s30 offen offset:2048 lds
v_mfma_f32_16x16x32_bf16 v[52:55], a[172:175], a[236:239], v[52:55]
ds_read_b64_tr_b16 a[128:129], v138 offset:0
ds_read_b64_tr_b16 a[130:131], v138 offset:1024
v_mfma_f32_16x16x32_bf16 v[84:87], a[168:171], a[240:243], v[84:87]
ds_read_b64_tr_b16 a[132:133], v138 offset:8192
ds_read_b64_tr_b16 a[134:135], v138 offset:9216
v_mfma_f32_16x16x32_bf16 v[84:87], a[172:175], a[244:247], v[84:87]
ds_read_b64_tr_b16 a[136:137], v139 offset:0
ds_read_b64_tr_b16 a[138:139], v139 offset:1024
v_mfma_f32_16x16x32_bf16 v[116:119], a[168:171], a[248:251], v[116:119]
buffer_load_dwordx4 v131, s[8:11], s30 offen offset:3072 lds
v_mfma_f32_16x16x32_bf16 v[116:119], a[172:175], a[252:255], v[116:119]
ds_read_b64_tr_b16 a[140:141], v139 offset:8192
ds_read_b64_tr_b16 a[142:143], v139 offset:9216
v_mfma_f32_16x16x32_bf16 v[24:27], a[176:179], a[224:227], v[24:27]
s_add_u32 m0, s29, 53248
ds_read_b64_tr_b16 a[144:145], v140 offset:0
ds_read_b64_tr_b16 a[146:147], v140 offset:1024
v_mfma_f32_16x16x32_bf16 v[24:27], a[180:183], a[228:231], v[24:27]
s_add_u32 s30, s41, 512
ds_read_b64_tr_b16 a[148:149], v140 offset:8192
ds_read_b64_tr_b16 a[150:151], v140 offset:9216
v_mfma_f32_16x16x32_bf16 v[56:59], a[176:179], a[232:235], v[56:59]
buffer_load_dwordx4 v128, s[8:11], s30 offen offset:0 lds
v_mfma_f32_16x16x32_bf16 v[56:59], a[180:183], a[236:239], v[56:59]
ds_read_b64_tr_b16 a[152:153], v141 offset:0
ds_read_b64_tr_b16 a[154:155], v141 offset:1024
v_mfma_f32_16x16x32_bf16 v[88:91], a[176:179], a[240:243], v[88:91]
ds_read_b64_tr_b16 a[156:157], v141 offset:8192
ds_read_b64_tr_b16 a[158:159], v141 offset:9216
v_mfma_f32_16x16x32_bf16 v[88:91], a[180:183], a[244:247], v[88:91]
v_mfma_f32_16x16x32_bf16 v[120:123], a[176:179], a[248:251], v[120:123]
buffer_load_dwordx4 v129, s[8:11], s30 offen offset:1024 lds
v_mfma_f32_16x16x32_bf16 v[120:123], a[180:183], a[252:255], v[120:123]
v_mfma_f32_16x16x32_bf16 v[28:31], a[184:187], a[224:227], v[28:31]
v_mfma_f32_16x16x32_bf16 v[28:31], a[188:191], a[228:231], v[28:31]
s_add_u32 s43, s32, 4096
v_mfma_f32_16x16x32_bf16 v[60:63], a[184:187], a[232:235], v[60:63]
buffer_store_dwordx4 v[196:199], v252, s[4:7], s43 offen offset:1024 sc1
v_mfma_f32_16x16x32_bf16 v[60:63], a[188:191], a[236:239], v[60:63]
v_mfma_f32_16x16x32_bf16 v[92:95], a[184:187], a[240:243], v[92:95]
v_mfma_f32_16x16x32_bf16 v[92:95], a[188:191], a[244:247], v[92:95]
v_mfma_f32_16x16x32_bf16 v[124:127], a[184:187], a[248:251], v[124:127]
v_mfma_f32_16x16x32_bf16 v[124:127], a[188:191], a[252:255], v[124:127]
s_waitcnt lgkmcnt(0)
v_mfma_f32_16x16x32_bf16 v[0:3], a[128:131], a[192:195], v[0:3]
ds_read_b64_tr_b16 a[160:161], v142 offset:0
ds_read_b64_tr_b16 a[162:163], v142 offset:1024
v_mfma_f32_16x16x32_bf16 v[0:3], a[132:135], a[196:199], v[0:3]
ds_read_b64_tr_b16 a[164:165], v142 offset:8192
ds_read_b64_tr_b16 a[166:167], v142 offset:9216
v_mfma_f32_16x16x32_bf16 v[32:35], a[128:131], a[200:203], v[32:35]
buffer_load_dwordx4 v130, s[8:11], s30 offen offset:2048 lds
v_mfma_f32_16x16x32_bf16 v[32:35], a[132:135], a[204:207], v[32:35]
ds_read_b64_tr_b16 a[168:169], v143 offset:0
ds_read_b64_tr_b16 a[170:171], v143 offset:1024
v_mfma_f32_16x16x32_bf16 v[64:67], a[128:131], a[208:211], v[64:67]
ds_read_b64_tr_b16 a[172:173], v143 offset:8192
ds_read_b64_tr_b16 a[174:175], v143 offset:9216
v_mfma_f32_16x16x32_bf16 v[64:67], a[132:135], a[212:215], v[64:67]
ds_read_b64_tr_b16 a[176:177], v144 offset:0
ds_read_b64_tr_b16 a[178:179], v144 offset:1024
v_mfma_f32_16x16x32_bf16 v[96:99], a[128:131], a[216:219], v[96:99]
buffer_load_dwordx4 v131, s[8:11], s30 offen offset:3072 lds
v_mfma_f32_16x16x32_bf16 v[96:99], a[132:135], a[220:223], v[96:99]
ds_read_b64_tr_b16 a[180:181], v144 offset:8192
ds_read_b64_tr_b16 a[182:183], v144 offset:9216
v_mfma_f32_16x16x32_bf16 v[4:7], a[136:139], a[192:195], v[4:7]
s_add_u32 m0, s31, 81920
ds_read_b64_tr_b16 a[184:185], v145 offset:0
ds_read_b64_tr_b16 a[186:187], v145 offset:1024
v_mfma_f32_16x16x32_bf16 v[4:7], a[140:143], a[196:199], v[4:7]
s_add_u32 s30, s49, 2097152
ds_read_b64_tr_b16 a[188:189], v145 offset:8192
ds_read_b64_tr_b16 a[190:191], v145 offset:9216
v_mfma_f32_16x16x32_bf16 v[36:39], a[136:139], a[200:203], v[36:39]
buffer_load_dwordx4 v132, s[12:15], s30 offen offset:0  lds
v_mfma_f32_16x16x32_bf16 v[36:39], a[140:143], a[204:207], v[36:39]
v_add_u32 v136, 0xfffe8000, v136
v_add_u32 v137, 0xfffe8000, v137
v_mfma_f32_16x16x32_bf16 v[68:71], a[136:139], a[208:211], v[68:71]
v_add_u32 v138, 0xfffe8000, v138
v_add_u32 v139, 0xfffe8000, v139
v_mfma_f32_16x16x32_bf16 v[68:71], a[140:143], a[212:215], v[68:71]
v_add_u32 v140, 0xfffe8000, v140
v_add_u32 v141, 0xfffe8000, v141
v_mfma_f32_16x16x32_bf16 v[100:103], a[136:139], a[216:219], v[100:103]
buffer_load_dwordx4 v133, s[12:15], s30 offen offset:1024  lds
v_mfma_f32_16x16x32_bf16 v[100:103], a[140:143], a[220:223], v[100:103]
v_add_u32 v142, 0xfffe8000, v142
v_add_u32 v143, 0xfffe8000, v143
v_mfma_f32_16x16x32_bf16 v[8:11], a[144:147], a[192:195], v[8:11]
v_add_u32 v144, 0xfffe8000, v144
v_add_u32 v145, 0xfffe8000, v145
v_mfma_f32_16x16x32_bf16 v[8:11], a[148:151], a[196:199], v[8:11]
v_mfma_f32_16x16x32_bf16 v[40:43], a[144:147], a[200:203], v[40:43]
buffer_load_dwordx4 v134, s[12:15], s30 offen offset:2048  lds
v_mfma_f32_16x16x32_bf16 v[40:43], a[148:151], a[204:207], v[40:43]
v_mfma_f32_16x16x32_bf16 v[72:75], a[144:147], a[208:211], v[72:75]
v_mfma_f32_16x16x32_bf16 v[72:75], a[148:151], a[212:215], v[72:75]
v_mfma_f32_16x16x32_bf16 v[104:107], a[144:147], a[216:219], v[104:107]
buffer_load_dwordx4 v135, s[12:15], s30 offen offset:3072  lds
v_mfma_f32_16x16x32_bf16 v[104:107], a[148:151], a[220:223], v[104:107]
v_mfma_f32_16x16x32_bf16 v[12:15], a[152:155], a[192:195], v[12:15]
v_mfma_f32_16x16x32_bf16 v[12:15], a[156:159], a[196:199], v[12:15]
s_add_u32 s43, s32, 4096
v_mfma_f32_16x16x32_bf16 v[44:47], a[152:155], a[200:203], v[44:47]
buffer_store_dwordx4 v[200:203], v252, s[4:7], s43 offen offset:2048 sc1
v_mfma_f32_16x16x32_bf16 v[44:47], a[156:159], a[204:207], v[44:47]
v_mfma_f32_16x16x32_bf16 v[76:79], a[152:155], a[208:211], v[76:79]
v_mfma_f32_16x16x32_bf16 v[76:79], a[156:159], a[212:215], v[76:79]
v_mfma_f32_16x16x32_bf16 v[108:111], a[152:155], a[216:219], v[108:111]
v_mfma_f32_16x16x32_bf16 v[108:111], a[156:159], a[220:223], v[108:111]
s_waitcnt vmcnt(16) lgkmcnt(0)
s_barrier
v_mfma_f32_16x16x32_bf16 v[16:19], a[160:163], a[192:195], v[16:19]
s_add_u32 m0, s29, 98304
ds_read_b128 a[224:227], v136 offset:0
v_mfma_f32_16x16x32_bf16 v[16:19], a[164:167], a[196:199], v[16:19]
s_add_u32 s30, s40, 640
ds_read_b128 a[228:231], v137 offset:0
v_mfma_f32_16x16x32_bf16 v[48:51], a[160:163], a[200:203], v[48:51]
buffer_load_dwordx4 v128, s[8:11], s30 offen offset:0 lds
v_mfma_f32_16x16x32_bf16 v[48:51], a[164:167], a[204:207], v[48:51]
ds_read_b128 a[232:235], v136 offset:2048
v_mfma_f32_16x16x32_bf16 v[80:83], a[160:163], a[208:211], v[80:83]
ds_read_b128 a[236:239], v137 offset:2048
v_mfma_f32_16x16x32_bf16 v[80:83], a[164:167], a[212:215], v[80:83]
buffer_load_dwordx4 v129, s[8:11], s30 offen offset:1024 lds
v_mfma_f32_16x16x32_bf16 v[112:115], a[160:163], a[216:219], v[112:115]
ds_read_b128 a[240:243], v136 offset:4096
v_mfma_f32_16x16x32_bf16 v[112:115], a[164:167], a[220:223], v[112:115]
ds_read_b128 a[244:247], v137 offset:4096
v_mfma_f32_16x16x32_bf16 v[20:23], a[168:171], a[192:195], v[20:23]
ds_read_b128 a[248:251], v136 offset:6144
v_mfma_f32_16x16x32_bf16 v[20:23], a[172:175], a[196:199], v[20:23]
buffer_load_dwordx4 v130, s[8:11], s30 offen offset:2048 lds
v_mfma_f32_16x16x32_bf16 v[52:55], a[168:171], a[200:203], v[52:55]
ds_read_b128 a[252:255], v137 offset:6144
v_mfma_f32_16x16x32_bf16 v[52:55], a[172:175], a[204:207], v[52:55]
ds_read_b64_tr_b16 a[128:129], v138 offset:0
ds_read_b64_tr_b16 a[130:131], v138 offset:1024
v_mfma_f32_16x16x32_bf16 v[84:87], a[168:171], a[208:211], v[84:87]
buffer_load_dwordx4 v131, s[8:11], s30 offen offset:3072 lds
v_mfma_f32_16x16x32_bf16 v[84:87], a[172:175], a[212:215], v[84:87]
ds_read_b64_tr_b16 a[132:133], v138 offset:8192
ds_read_b64_tr_b16 a[134:135], v138 offset:9216
v_mfma_f32_16x16x32_bf16 v[116:119], a[168:171], a[216:219], v[116:119]
s_add_u32 m0, s29, 102400
ds_read_b64_tr_b16 a[136:137], v139 offset:0
ds_read_b64_tr_b16 a[138:139], v139 offset:1024
v_mfma_f32_16x16x32_bf16 v[116:119], a[172:175], a[220:223], v[116:119]
s_add_u32 s30, s41, 640
ds_read_b64_tr_b16 a[140:141], v139 offset:8192
ds_read_b64_tr_b16 a[142:143], v139 offset:9216
v_mfma_f32_16x16x32_bf16 v[24:27], a[176:179], a[192:195], v[24:27]
buffer_load_dwordx4 v128, s[8:11], s30 offen offset:0 lds
v_mfma_f32_16x16x32_bf16 v[24:27], a[180:183], a[196:199], v[24:27]
ds_read_b64_tr_b16 a[144:145], v140 offset:0
ds_read_b64_tr_b16 a[146:147], v140 offset:1024
v_mfma_f32_16x16x32_bf16 v[56:59], a[176:179], a[200:203], v[56:59]
ds_read_b64_tr_b16 a[148:149], v140 offset:8192
ds_read_b64_tr_b16 a[150:151], v140 offset:9216
v_mfma_f32_16x16x32_bf16 v[56:59], a[180:183], a[204:207], v[56:59]
ds_read_b64_tr_b16 a[152:153], v141 offset:0
ds_read_b64_tr_b16 a[154:155], v141 offset:1024
v_mfma_f32_16x16x32_bf16 v[88:91], a[176:179], a[208:211], v[88:91]
buffer_load_dwordx4 v129, s[8:11], s30 offen offset:1024 lds
v_mfma_f32_16x16x32_bf16 v[88:91], a[180:183], a[212:215], v[88:91]
ds_read_b64_tr_b16 a[156:157], v141 offset:8192
ds_read_b64_tr_b16 a[158:159], v141 offset:9216
v_mfma_f32_16x16x32_bf16 v[120:123], a[176:179], a[216:219], v[120:123]
s_add_u32 s43, s32, 4096
v_mfma_f32_16x16x32_bf16 v[120:123], a[180:183], a[220:223], v[120:123]
buffer_store_dwordx4 v[204:207], v252, s[4:7], s43 offen offset:3072 sc1
v_mfma_f32_16x16x32_bf16 v[28:31], a[184:187], a[192:195], v[28:31]
v_mfma_f32_16x16x32_bf16 v[28:31], a[188:191], a[196:199], v[28:31]
v_mfma_f32_16x16x32_bf16 v[60:63], a[184:187], a[200:203], v[60:63]
s_add_u32 s43, s32, 16384
v_mfma_f32_16x16x32_bf16 v[60:63], a[188:191], a[204:207], v[60:63]
buffer_store_dwordx4 v[208:211], v252, s[4:7], s43 offen offset:0 sc1
v_mfma_f32_16x16x32_bf16 v[92:95], a[184:187], a[208:211], v[92:95]
v_mfma_f32_16x16x32_bf16 v[92:95], a[188:191], a[212:215], v[92:95]
v_mfma_f32_16x16x32_bf16 v[124:127], a[184:187], a[216:219], v[124:127]
v_mfma_f32_16x16x32_bf16 v[124:127], a[188:191], a[220:223], v[124:127]
s_waitcnt lgkmcnt(0)
v_mfma_f32_16x16x32_bf16 v[0:3], a[128:131], a[224:227], v[0:3]
ds_read_b64_tr_b16 a[160:161], v142 offset:0
ds_read_b64_tr_b16 a[162:163], v142 offset:1024
v_mfma_f32_16x16x32_bf16 v[0:3], a[132:135], a[228:231], v[0:3]
ds_read_b64_tr_b16 a[164:165], v142 offset:8192
ds_read_b64_tr_b16 a[166:167], v142 offset:9216
v_mfma_f32_16x16x32_bf16 v[32:35], a[128:131], a[232:235], v[32:35]
buffer_load_dwordx4 v130, s[8:11], s30 offen offset:2048 lds
v_mfma_f32_16x16x32_bf16 v[32:35], a[132:135], a[236:239], v[32:35]
ds_read_b64_tr_b16 a[168:169], v143 offset:0
ds_read_b64_tr_b16 a[170:171], v143 offset:1024
v_mfma_f32_16x16x32_bf16 v[64:67], a[128:131], a[240:243], v[64:67]
ds_read_b64_tr_b16 a[172:173], v143 offset:8192
ds_read_b64_tr_b16 a[174:175], v143 offset:9216
v_mfma_f32_16x16x32_bf16 v[64:67], a[132:135], a[244:247], v[64:67]
ds_read_b64_tr_b16 a[176:177], v144 offset:0
ds_read_b64_tr_b16 a[178:179], v144 offset:1024
v_mfma_f32_16x16x32_bf16 v[96:99], a[128:131], a[248:251], v[96:99]
buffer_load_dwordx4 v131, s[8:11], s30 offen offset:3072 lds
v_mfma_f32_16x16x32_bf16 v[96:99], a[132:135], a[252:255], v[96:99]
ds_read_b64_tr_b16 a[180:181], v144 offset:8192
ds_read_b64_tr_b16 a[182:183], v144 offset:9216
v_mfma_f32_16x16x32_bf16 v[4:7], a[136:139], a[224:227], v[4:7]
s_add_u32 m0, s31, 131072
ds_read_b64_tr_b16 a[184:185], v145 offset:0
ds_read_b64_tr_b16 a[186:187], v145 offset:1024
v_mfma_f32_16x16x32_bf16 v[4:7], a[140:143], a[228:231], v[4:7]
s_add_u32 s30, s49, 2621440
ds_read_b64_tr_b16 a[188:189], v145 offset:8192
ds_read_b64_tr_b16 a[190:191], v145 offset:9216
v_mfma_f32_16x16x32_bf16 v[36:39], a[136:139], a[232:235], v[36:39]
buffer_load_dwordx4 v132, s[12:15], s30 offen offset:0  lds
v_mfma_f32_16x16x32_bf16 v[36:39], a[140:143], a[236:239], v[36:39]
v_add_u32 v136, 0xc000, v136
v_add_u32 v137, 0xc000, v137
v_mfma_f32_16x16x32_bf16 v[68:71], a[136:139], a[240:243], v[68:71]
v_add_u32 v138, 0xc000, v138
v_add_u32 v139, 0xc000, v139
v_mfma_f32_16x16x32_bf16 v[68:71], a[140:143], a[244:247], v[68:71]
v_add_u32 v140, 0xc000, v140
v_add_u32 v141, 0xc000, v141
v_mfma_f32_16x16x32_bf16 v[100:103], a[136:139], a[248:251], v[100:103]
buffer_load_dwordx4 v133, s[12:15], s30 offen offset:1024  lds
v_mfma_f32_16x16x32_bf16 v[100:103], a[140:143], a[252:255], v[100:103]
v_add_u32 v142, 0xc000, v142
v_add_u32 v143, 0xc000, v143
v_mfma_f32_16x16x32_bf16 v[8:11], a[144:147], a[224:227], v[8:11]
v_add_u32 v144, 0xc000, v144
v_add_u32 v145, 0xc000, v145
v_mfma_f32_16x16x32_bf16 v[8:11], a[148:151], a[228:231], v[8:11]
v_mfma_f32_16x16x32_bf16 v[40:43], a[144:147], a[232:235], v[40:43]
buffer_load_dwordx4 v134, s[12:15], s30 offen offset:2048  lds
v_mfma_f32_16x16x32_bf16 v[40:43], a[148:151], a[236:239], v[40:43]
v_mfma_f32_16x16x32_bf16 v[72:75], a[144:147], a[240:243], v[72:75]
v_mfma_f32_16x16x32_bf16 v[72:75], a[148:151], a[244:247], v[72:75]
v_mfma_f32_16x16x32_bf16 v[104:107], a[144:147], a[248:251], v[104:107]
buffer_load_dwordx4 v135, s[12:15], s30 offen offset:3072  lds
v_mfma_f32_16x16x32_bf16 v[104:107], a[148:151], a[252:255], v[104:107]
v_mfma_f32_16x16x32_bf16 v[12:15], a[152:155], a[224:227], v[12:15]
v_mfma_f32_16x16x32_bf16 v[12:15], a[156:159], a[228:231], v[12:15]
s_add_u32 s43, s32, 16384
v_mfma_f32_16x16x32_bf16 v[44:47], a[152:155], a[232:235], v[44:47]
buffer_store_dwordx4 v[212:215], v252, s[4:7], s43 offen offset:1024 sc1
v_mfma_f32_16x16x32_bf16 v[44:47], a[156:159], a[236:239], v[44:47]
v_mfma_f32_16x16x32_bf16 v[76:79], a[152:155], a[240:243], v[76:79]
v_mfma_f32_16x16x32_bf16 v[76:79], a[156:159], a[244:247], v[76:79]
v_mfma_f32_16x16x32_bf16 v[108:111], a[152:155], a[248:251], v[108:111]
v_mfma_f32_16x16x32_bf16 v[108:111], a[156:159], a[252:255], v[108:111]
s_waitcnt vmcnt(16) lgkmcnt(0)
s_barrier
v_mfma_f32_16x16x32_bf16 v[16:19], a[160:163], a[224:227], v[16:19]
s_add_u32 m0, s29, 0
ds_read_b128 a[192:195], v136 offset:0
v_mfma_f32_16x16x32_bf16 v[16:19], a[164:167], a[228:231], v[16:19]
s_add_u32 s30, s40, 768
ds_read_b128 a[196:199], v137 offset:0
v_mfma_f32_16x16x32_bf16 v[48:51], a[160:163], a[232:235], v[48:51]
buffer_load_dwordx4 v128, s[8:11], s30 offen offset:0 lds
v_mfma_f32_16x16x32_bf16 v[48:51], a[164:167], a[236:239], v[48:51]
ds_read_b128 a[200:203], v136 offset:2048
v_mfma_f32_16x16x32_bf16 v[80:83], a[160:163], a[240:243], v[80:83]
ds_read_b128 a[204:207], v137 offset:2048
v_mfma_f32_16x16x32_bf16 v[80:83], a[164:167], a[244:247], v[80:83]
ds_read_b128 a[208:211], v136 offset:4096
v_mfma_f32_16x16x32_bf16 v[112:115], a[160:163], a[248:251], v[112:115]
buffer_load_dwordx4 v129, s[8:11], s30 offen offset:1024 lds
v_mfma_f32_16x16x32_bf16 v[112:115], a[164:167], a[252:255], v[112:115]
ds_read_b128 a[212:215], v137 offset:4096
v_mfma_f32_16x16x32_bf16 v[20:23], a[168:171], a[224:227], v[20:23]
ds_read_b128 a[216:219], v136 offset:6144
v_mfma_f32_16x16x32_bf16 v[20:23], a[172:175], a[228:231], v[20:23]
ds_read_b128 a[220:223], v137 offset:6144
v_mfma_f32_16x16x32_bf16 v[52:55], a[168:171], a[232:235], v[52:55]
buffer_load_dwordx4 v130, s[8:11], s30 offen offset:2048 lds
v_mfma_f32_16x16x32_bf16 v[52:55], a[172:175], a[236:239], v[52:55]
ds_read_b64_tr_b16 a[128:129], v138 offset:0
ds_read_b64_tr_b16 a[130:131], v138 offset:1024
v_mfma_f32_16x16x32_bf16 v[84:87], a[168:171], a[240:243], v[84:87]
ds_read_b64_tr_b16 a[132:133], v138 offset:8192
ds_read_b64_tr_b16 a[134:135], v138 offset:9216
v_mfma_f32_16x16x32_bf16 v[84:87], a[172:175], a[244:247], v[84:87]
ds_read_b64_tr_b16 a[136:137], v139 offset:0
ds_read_b64_tr_b16 a[138:139], v139 offset:1024
v_mfma_f32_16x16x32_bf16 v[116:119], a[168:171], a[248:251], v[116:119]
buffer_load_dwordx4 v131, s[8:11], s30 offen offset:3072 lds
v_mfma_f32_16x16x32_bf16 v[116:119], a[172:175], a[252:255], v[116:119]
ds_read_b64_tr_b16 a[140:141], v139 offset:8192
ds_read_b64_tr_b16 a[142:143], v139 offset:9216
v_mfma_f32_16x16x32_bf16 v[24:27], a[176:179], a[224:227], v[24:27]
s_add_u32 m0, s29, 4096
ds_read_b64_tr_b16 a[144:145], v140 offset:0
ds_read_b64_tr_b16 a[146:147], v140 offset:1024
v_mfma_f32_16x16x32_bf16 v[24:27], a[180:183], a[228:231], v[24:27]
s_add_u32 s30, s41, 768
ds_read_b64_tr_b16 a[148:149], v140 offset:8192
ds_read_b64_tr_b16 a[150:151], v140 offset:9216
v_mfma_f32_16x16x32_bf16 v[56:59], a[176:179], a[232:235], v[56:59]
buffer_load_dwordx4 v128, s[8:11], s30 offen offset:0 lds
v_mfma_f32_16x16x32_bf16 v[56:59], a[180:183], a[236:239], v[56:59]
ds_read_b64_tr_b16 a[152:153], v141 offset:0
ds_read_b64_tr_b16 a[154:155], v141 offset:1024
v_mfma_f32_16x16x32_bf16 v[88:91], a[176:179], a[240:243], v[88:91]
ds_read_b64_tr_b16 a[156:157], v141 offset:8192
ds_read_b64_tr_b16 a[158:159], v141 offset:9216
v_mfma_f32_16x16x32_bf16 v[88:91], a[180:183], a[244:247], v[88:91]
v_mfma_f32_16x16x32_bf16 v[120:123], a[176:179], a[248:251], v[120:123]
buffer_load_dwordx4 v129, s[8:11], s30 offen offset:1024 lds
v_mfma_f32_16x16x32_bf16 v[120:123], a[180:183], a[252:255], v[120:123]
v_mfma_f32_16x16x32_bf16 v[28:31], a[184:187], a[224:227], v[28:31]
v_mfma_f32_16x16x32_bf16 v[28:31], a[188:191], a[228:231], v[28:31]
s_add_u32 s43, s32, 16384
v_mfma_f32_16x16x32_bf16 v[60:63], a[184:187], a[232:235], v[60:63]
buffer_store_dwordx4 v[216:219], v252, s[4:7], s43 offen offset:2048 sc1
v_mfma_f32_16x16x32_bf16 v[60:63], a[188:191], a[236:239], v[60:63]
v_mfma_f32_16x16x32_bf16 v[92:95], a[184:187], a[240:243], v[92:95]
v_mfma_f32_16x16x32_bf16 v[92:95], a[188:191], a[244:247], v[92:95]
v_mfma_f32_16x16x32_bf16 v[124:127], a[184:187], a[248:251], v[124:127]
v_mfma_f32_16x16x32_bf16 v[124:127], a[188:191], a[252:255], v[124:127]
s_waitcnt lgkmcnt(0)
v_mfma_f32_16x16x32_bf16 v[0:3], a[128:131], a[192:195], v[0:3]
ds_read_b64_tr_b16 a[160:161], v142 offset:0
ds_read_b64_tr_b16 a[162:163], v142 offset:1024
v_mfma_f32_16x16x32_bf16 v[0:3], a[132:135], a[196:199], v[0:3]
ds_read_b64_tr_b16 a[164:165], v142 offset:8192
ds_read_b64_tr_b16 a[166:167], v142 offset:9216
v_mfma_f32_16x16x32_bf16 v[32:35], a[128:131], a[200:203], v[32:35]
buffer_load_dwordx4 v130, s[8:11], s30 offen offset:2048 lds
v_mfma_f32_16x16x32_bf16 v[32:35], a[132:135], a[204:207], v[32:35]
ds_read_b64_tr_b16 a[168:169], v143 offset:0
ds_read_b64_tr_b16 a[170:171], v143 offset:1024
v_mfma_f32_16x16x32_bf16 v[64:67], a[128:131], a[208:211], v[64:67]
ds_read_b64_tr_b16 a[172:173], v143 offset:8192
ds_read_b64_tr_b16 a[174:175], v143 offset:9216
v_mfma_f32_16x16x32_bf16 v[64:67], a[132:135], a[212:215], v[64:67]
buffer_load_dwordx4 v131, s[8:11], s30 offen offset:3072 lds
v_mfma_f32_16x16x32_bf16 v[96:99], a[128:131], a[216:219], v[96:99]
ds_read_b64_tr_b16 a[176:177], v144 offset:0
ds_read_b64_tr_b16 a[178:179], v144 offset:1024
v_mfma_f32_16x16x32_bf16 v[96:99], a[132:135], a[220:223], v[96:99]
s_add_u32 m0, s31, 32768
ds_read_b64_tr_b16 a[180:181], v144 offset:8192
ds_read_b64_tr_b16 a[182:183], v144 offset:9216
v_mfma_f32_16x16x32_bf16 v[4:7], a[136:139], a[192:195], v[4:7]
s_add_u32 s30, s49, 3145728
ds_read_b64_tr_b16 a[184:185], v145 offset:0
ds_read_b64_tr_b16 a[186:187], v145 offset:1024
v_mfma_f32_16x16x32_bf16 v[4:7], a[140:143], a[196:199], v[4:7]
buffer_load_dwordx4 v132, s[12:15], s30 offen offset:0  lds
v_mfma_f32_16x16x32_bf16 v[36:39], a[136:139], a[200:203], v[36:39]
ds_read_b64_tr_b16 a[188:189], v145 offset:8192
ds_read_b64_tr_b16 a[190:191], v145 offset:9216
v_mfma_f32_16x16x32_bf16 v[36:39], a[140:143], a[204:207], v[36:39]
v_add_u32 v136, 0xc000, v136
v_add_u32 v137, 0xc000, v137
v_mfma_f32_16x16x32_bf16 v[68:71], a[136:139], a[208:211], v[68:71]
buffer_load_dwordx4 v133, s[12:15], s30 offen offset:1024  lds
v_mfma_f32_16x16x32_bf16 v[68:71], a[140:143], a[212:215], v[68:71]
v_add_u32 v138, 0xc000, v138
v_add_u32 v139, 0xc000, v139
v_mfma_f32_16x16x32_bf16 v[100:103], a[136:139], a[216:219], v[100:103]
v_add_u32 v140, 0xc000, v140
v_add_u32 v141, 0xc000, v141
v_mfma_f32_16x16x32_bf16 v[100:103], a[140:143], a[220:223], v[100:103]
v_add_u32 v142, 0xc000, v142
v_add_u32 v143, 0xc000, v143
v_mfma_f32_16x16x32_bf16 v[8:11], a[144:147], a[192:195], v[8:11]
buffer_load_dwordx4 v134, s[12:15], s30 offen offset:2048  lds
v_mfma_f32_16x16x32_bf16 v[8:11], a[148:151], a[196:199], v[8:11]
v_add_u32 v144, 0xc000, v144
v_add_u32 v145, 0xc000, v145
v_mfma_f32_16x16x32_bf16 v[40:43], a[144:147], a[200:203], v[40:43]
v_mfma_f32_16x16x32_bf16 v[40:43], a[148:151], a[204:207], v[40:43]
v_mfma_f32_16x16x32_bf16 v[72:75], a[144:147], a[208:211], v[72:75]
buffer_load_dwordx4 v135, s[12:15], s30 offen offset:3072  lds
v_mfma_f32_16x16x32_bf16 v[72:75], a[148:151], a[212:215], v[72:75]
v_mfma_f32_16x16x32_bf16 v[104:107], a[144:147], a[216:219], v[104:107]
s_add_u32 s43, s32, 16384
v_mfma_f32_16x16x32_bf16 v[104:107], a[148:151], a[220:223], v[104:107]
buffer_store_dwordx4 v[220:223], v252, s[4:7], s43 offen offset:3072 sc1
v_mfma_f32_16x16x32_bf16 v[12:15], a[152:155], a[192:195], v[12:15]
v_mfma_f32_16x16x32_bf16 v[12:15], a[156:159], a[196:199], v[12:15]
v_mfma_f32_16x16x32_bf16 v[44:47], a[152:155], a[200:203], v[44:47]
s_add_u32 s43, s32, 20480
v_mfma_f32_16x16x32_bf16 v[44:47], a[156:159], a[204:207], v[44:47]
buffer_store_dwordx4 v[224:227], v252, s[4:7], s43 offen offset:0 sc1
v_mfma_f32_16x16x32_bf16 v[76:79], a[152:155], a[208:211], v[76:79]
v_mfma_f32_16x16x32_bf16 v[76:79], a[156:159], a[212:215], v[76:79]
v_mfma_f32_16x16x32_bf16 v[108:111], a[152:155], a[216:219], v[108:111]
v_mfma_f32_16x16x32_bf16 v[108:111], a[156:159], a[220:223], v[108:111]
s_waitcnt vmcnt(16) lgkmcnt(0)
s_barrier
v_mfma_f32_16x16x32_bf16 v[16:19], a[160:163], a[192:195], v[16:19]
s_add_u32 m0, s29, 49152
ds_read_b128 a[224:227], v136 offset:0
v_mfma_f32_16x16x32_bf16 v[16:19], a[164:167], a[196:199], v[16:19]
s_add_u32 s30, s40, 896
ds_read_b128 a[228:231], v137 offset:0
v_mfma_f32_16x16x32_bf16 v[48:51], a[160:163], a[200:203], v[48:51]
buffer_load_dwordx4 v128, s[8:11], s30 offen offset:0 lds
v_mfma_f32_16x16x32_bf16 v[48:51], a[164:167], a[204:207], v[48:51]
ds_read_b128 a[232:235], v136 offset:2048
v_mfma_f32_16x16x32_bf16 v[80:83], a[160:163], a[208:211], v[80:83]
ds_read_b128 a[236:239], v137 offset:2048
v_mfma_f32_16x16x32_bf16 v[80:83], a[164:167], a[212:215], v[80:83]
ds_read_b128 a[240:243], v136 offset:4096
v_mfma_f32_16x16x32_bf16 v[112:115], a[160:163], a[216:219], v[112:115]
buffer_load_dwordx4 v129, s[8:11], s30 offen offset:1024 lds
v_mfma_f32_16x16x32_bf16 v[112:115], a[164:167], a[220:223], v[112:115]
ds_read_b128 a[244:247], v137 offset:4096
v_mfma_f32_16x16x32_bf16 v[20:23], a[168:171], a[192:195], v[20:23]
ds_read_b128 a[248:251], v136 offset:6144
v_mfma_f32_16x16x32_bf16 v[20:23], a[172:175], a[196:199], v[20:23]
ds_read_b128 a[252:255], v137 offset:6144
v_mfma_f32_16x16x32_bf16 v[52:55], a[168:171], a[200:203], v[52:55]
buffer_load_dwordx4 v130, s[8:11], s30 offen offset:2048 lds
v_mfma_f32_16x16x32_bf16 v[52:55], a[172:175], a[204:207], v[52:55]
ds_read_b64_tr_b16 a[128:129], v138 offset:0
ds_read_b64_tr_b16 a[130:131], v138 offset:1024
v_mfma_f32_16x16x32_bf16 v[84:87], a[168:171], a[208:211], v[84:87]
ds_read_b64_tr_b16 a[132:133], v138 offset:8192
ds_read_b64_tr_b16 a[134:135], v138 offset:9216
v_mfma_f32_16x16x32_bf16 v[84:87], a[172:175], a[212:215], v[84:87]
ds_read_b64_tr_b16 a[136:137], v139 offset:0
ds_read_b64_tr_b16 a[138:139], v139 offset:1024
v_mfma_f32_16x16x32_bf16 v[116:119], a[168:171], a[216:219], v[116:119]
buffer_load_dwordx4 v131, s[8:11], s30 offen offset:3072 lds
v_mfma_f32_16x16x32_bf16 v[116:119], a[172:175], a[220:223], v[116:119]
ds_read_b64_tr_b16 a[140:141], v139 offset:8192
ds_read_b64_tr_b16 a[142:143], v139 offset:9216
v_mfma_f32_16x16x32_bf16 v[24:27], a[176:179], a[192:195], v[24:27]
s_add_u32 m0, s29, 53248
ds_read_b64_tr_b16 a[144:145], v140 offset:0
ds_read_b64_tr_b16 a[146:147], v140 offset:1024
v_mfma_f32_16x16x32_bf16 v[24:27], a[180:183], a[196:199], v[24:27]
s_add_u32 s30, s41, 896
ds_read_b64_tr_b16 a[148:149], v140 offset:8192
ds_read_b64_tr_b16 a[150:151], v140 offset:9216
v_mfma_f32_16x16x32_bf16 v[56:59], a[176:179], a[200:203], v[56:59]
buffer_load_dwordx4 v128, s[8:11], s30 offen offset:0 lds
v_mfma_f32_16x16x32_bf16 v[56:59], a[180:183], a[204:207], v[56:59]
ds_read_b64_tr_b16 a[152:153], v141 offset:0
ds_read_b64_tr_b16 a[154:155], v141 offset:1024
v_mfma_f32_16x16x32_bf16 v[88:91], a[176:179], a[208:211], v[88:91]
ds_read_b64_tr_b16 a[156:157], v141 offset:8192
ds_read_b64_tr_b16 a[158:159], v141 offset:9216
v_mfma_f32_16x16x32_bf16 v[88:91], a[180:183], a[212:215], v[88:91]
v_mfma_f32_16x16x32_bf16 v[120:123], a[176:179], a[216:219], v[120:123]
buffer_load_dwordx4 v129, s[8:11], s30 offen offset:1024 lds
v_mfma_f32_16x16x32_bf16 v[120:123], a[180:183], a[220:223], v[120:123]
v_mfma_f32_16x16x32_bf16 v[28:31], a[184:187], a[192:195], v[28:31]
v_mfma_f32_16x16x32_bf16 v[28:31], a[188:191], a[196:199], v[28:31]
s_add_u32 s43, s32, 20480
v_mfma_f32_16x16x32_bf16 v[60:63], a[184:187], a[200:203], v[60:63]
buffer_store_dwordx4 v[228:231], v252, s[4:7], s43 offen offset:1024 sc1
v_mfma_f32_16x16x32_bf16 v[60:63], a[188:191], a[204:207], v[60:63]
v_mfma_f32_16x16x32_bf16 v[92:95], a[184:187], a[208:211], v[92:95]
v_mfma_f32_16x16x32_bf16 v[92:95], a[188:191], a[212:215], v[92:95]
v_mfma_f32_16x16x32_bf16 v[124:127], a[184:187], a[216:219], v[124:127]
v_mfma_f32_16x16x32_bf16 v[124:127], a[188:191], a[220:223], v[124:127]
s_waitcnt lgkmcnt(0)
v_mfma_f32_16x16x32_bf16 v[0:3], a[128:131], a[224:227], v[0:3]
ds_read_b64_tr_b16 a[160:161], v142 offset:0
ds_read_b64_tr_b16 a[162:163], v142 offset:1024
v_mfma_f32_16x16x32_bf16 v[0:3], a[132:135], a[228:231], v[0:3]
ds_read_b64_tr_b16 a[164:165], v142 offset:8192
ds_read_b64_tr_b16 a[166:167], v142 offset:9216
v_mfma_f32_16x16x32_bf16 v[32:35], a[128:131], a[232:235], v[32:35]
buffer_load_dwordx4 v130, s[8:11], s30 offen offset:2048 lds
v_mfma_f32_16x16x32_bf16 v[32:35], a[132:135], a[236:239], v[32:35]
ds_read_b64_tr_b16 a[168:169], v143 offset:0
ds_read_b64_tr_b16 a[170:171], v143 offset:1024
v_mfma_f32_16x16x32_bf16 v[64:67], a[128:131], a[240:243], v[64:67]
ds_read_b64_tr_b16 a[172:173], v143 offset:8192
ds_read_b64_tr_b16 a[174:175], v143 offset:9216
v_mfma_f32_16x16x32_bf16 v[64:67], a[132:135], a[244:247], v[64:67]
buffer_load_dwordx4 v131, s[8:11], s30 offen offset:3072 lds
v_mfma_f32_16x16x32_bf16 v[96:99], a[128:131], a[248:251], v[96:99]
ds_read_b64_tr_b16 a[176:177], v144 offset:0
ds_read_b64_tr_b16 a[178:179], v144 offset:1024
v_mfma_f32_16x16x32_bf16 v[96:99], a[132:135], a[252:255], v[96:99]
s_add_u32 m0, s31, 81920
ds_read_b64_tr_b16 a[180:181], v144 offset:8192
ds_read_b64_tr_b16 a[182:183], v144 offset:9216
v_mfma_f32_16x16x32_bf16 v[4:7], a[136:139], a[224:227], v[4:7]
s_add_u32 s30, s49, 3670016
ds_read_b64_tr_b16 a[184:185], v145 offset:0
ds_read_b64_tr_b16 a[186:187], v145 offset:1024
v_mfma_f32_16x16x32_bf16 v[4:7], a[140:143], a[228:231], v[4:7]
buffer_load_dwordx4 v132, s[12:15], s30 offen offset:0  lds
v_mfma_f32_16x16x32_bf16 v[36:39], a[136:139], a[232:235], v[36:39]
ds_read_b64_tr_b16 a[188:189], v145 offset:8192
ds_read_b64_tr_b16 a[190:191], v145 offset:9216
v_mfma_f32_16x16x32_bf16 v[36:39], a[140:143], a[236:239], v[36:39]
v_add_u32 v136, 0xfffe8000, v136
v_add_u32 v137, 0xfffe8000, v137
v_mfma_f32_16x16x32_bf16 v[68:71], a[136:139], a[240:243], v[68:71]
buffer_load_dwordx4 v133, s[12:15], s30 offen offset:1024  lds
v_mfma_f32_16x16x32_bf16 v[68:71], a[140:143], a[244:247], v[68:71]
v_add_u32 v138, 0xfffe8000, v138
v_add_u32 v139, 0xfffe8000, v139
v_mfma_f32_16x16x32_bf16 v[100:103], a[136:139], a[248:251], v[100:103]
v_add_u32 v140, 0xfffe8000, v140
v_add_u32 v141, 0xfffe8000, v141
v_mfma_f32_16x16x32_bf16 v[100:103], a[140:143], a[252:255], v[100:103]
v_add_u32 v142, 0xfffe8000, v142
v_add_u32 v143, 0xfffe8000, v143
v_mfma_f32_16x16x32_bf16 v[8:11], a[144:147], a[224:227], v[8:11]
buffer_load_dwordx4 v134, s[12:15], s30 offen offset:2048  lds
v_mfma_f32_16x16x32_bf16 v[8:11], a[148:151], a[228:231], v[8:11]
v_add_u32 v144, 0xfffe8000, v144
v_add_u32 v145, 0xfffe8000, v145
v_mfma_f32_16x16x32_bf16 v[40:43], a[144:147], a[232:235], v[40:43]
v_mfma_f32_16x16x32_bf16 v[40:43], a[148:151], a[236:239], v[40:43]
v_mfma_f32_16x16x32_bf16 v[72:75], a[144:147], a[240:243], v[72:75]
buffer_load_dwordx4 v135, s[12:15], s30 offen offset:3072  lds
v_mfma_f32_16x16x32_bf16 v[72:75], a[148:151], a[244:247], v[72:75]
v_mfma_f32_16x16x32_bf16 v[104:107], a[144:147], a[248:251], v[104:107]
s_add_u32 s43, s32, 20480
v_mfma_f32_16x16x32_bf16 v[104:107], a[148:151], a[252:255], v[104:107]
buffer_store_dwordx4 v[232:235], v252, s[4:7], s43 offen offset:2048 sc1
v_mfma_f32_16x16x32_bf16 v[12:15], a[152:155], a[224:227], v[12:15]
v_mfma_f32_16x16x32_bf16 v[12:15], a[156:159], a[228:231], v[12:15]
v_mfma_f32_16x16x32_bf16 v[44:47], a[152:155], a[232:235], v[44:47]
s_add_u32 s43, s32, 20480
v_mfma_f32_16x16x32_bf16 v[44:47], a[156:159], a[236:239], v[44:47]
buffer_store_dwordx4 v[236:239], v252, s[4:7], s43 offen offset:3072 sc1
v_mfma_f32_16x16x32_bf16 v[76:79], a[152:155], a[240:243], v[76:79]
v_mfma_f32_16x16x32_bf16 v[76:79], a[156:159], a[244:247], v[76:79]
v_mfma_f32_16x16x32_bf16 v[108:111], a[152:155], a[248:251], v[108:111]
v_mfma_f32_16x16x32_bf16 v[108:111], a[156:159], a[252:255], v[108:111]
s_waitcnt vmcnt(17) lgkmcnt(0)
s_barrier
v_mfma_f32_16x16x32_bf16 v[16:19], a[160:163], a[224:227], v[16:19]
s_lshr_b32 s38, s29, 2
s_add_u32 m0, s38, 98304
v_mfma_f32_16x16x32_bf16 v[16:19], a[164:167], a[228:231], v[16:19]
s_add_u32 s30, s26, 0
ds_read_b128 a[192:195], v136 offset:0
v_mfma_f32_16x16x32_bf16 v[48:51], a[160:163], a[232:235], v[48:51]
buffer_load_dwordx4 v128, s[64:67], s30 offen offset:0  lds
v_mfma_f32_16x16x32_bf16 v[48:51], a[164:167], a[236:239], v[48:51]
ds_read_b128 a[196:199], v137 offset:0
v_mfma_f32_16x16x32_bf16 v[80:83], a[160:163], a[240:243], v[80:83]
ds_read_b128 a[200:203], v136 offset:2048
v_mfma_f32_16x16x32_bf16 v[80:83], a[164:167], a[244:247], v[80:83]
buffer_load_dwordx4 v129, s[64:67], s30 offen offset:1024  lds
v_mfma_f32_16x16x32_bf16 v[112:115], a[160:163], a[248:251], v[112:115]
ds_read_b128 a[204:207], v137 offset:2048
v_mfma_f32_16x16x32_bf16 v[112:115], a[164:167], a[252:255], v[112:115]
s_add_u32 m0, s38, 106496
ds_read_b128 a[208:211], v136 offset:4096
v_mfma_f32_16x16x32_bf16 v[20:23], a[168:171], a[224:227], v[20:23]
s_add_u32 s30, s27, 0
ds_read_b128 a[212:215], v137 offset:4096
v_mfma_f32_16x16x32_bf16 v[20:23], a[172:175], a[228:231], v[20:23]
buffer_load_dwordx4 v156, s[68:71], s30 offen offset:0 lds
v_mfma_f32_16x16x32_bf16 v[52:55], a[168:171], a[232:235], v[52:55]
ds_read_b128 a[216:219], v136 offset:6144
v_mfma_f32_16x16x32_bf16 v[52:55], a[172:175], a[236:239], v[52:55]
ds_read_b128 a[220:223], v137 offset:6144
v_mfma_f32_16x16x32_bf16 v[84:87], a[168:171], a[240:243], v[84:87]
buffer_load_dwordx4 v157, s[68:71], s30 offen offset:1024 lds
v_mfma_f32_16x16x32_bf16 v[84:87], a[172:175], a[244:247], v[84:87]
ds_read_b64_tr_b16 a[128:129], v138 offset:0
ds_read_b64_tr_b16 a[130:131], v138 offset:1024
v_mfma_f32_16x16x32_bf16 v[116:119], a[168:171], a[248:251], v[116:119]
s_add_u32 m0, s38, 114688
ds_read_b64_tr_b16 a[132:133], v138 offset:8192
ds_read_b64_tr_b16 a[134:135], v138 offset:9216
v_mfma_f32_16x16x32_bf16 v[116:119], a[172:175], a[252:255], v[116:119]
s_add_u32 s30, s27, 1024
ds_read_b64_tr_b16 a[136:137], v139 offset:0
ds_read_b64_tr_b16 a[138:139], v139 offset:1024
v_mfma_f32_16x16x32_bf16 v[24:27], a[176:179], a[224:227], v[24:27]
buffer_load_dwordx4 v156, s[68:71], s30 offen offset:0 lds
v_mfma_f32_16x16x32_bf16 v[24:27], a[180:183], a[228:231], v[24:27]
ds_read_b64_tr_b16 a[140:141], v139 offset:8192
ds_read_b64_tr_b16 a[142:143], v139 offset:9216
v_mfma_f32_16x16x32_bf16 v[56:59], a[176:179], a[232:235], v[56:59]
ds_read_b64_tr_b16 a[144:145], v140 offset:0
ds_read_b64_tr_b16 a[146:147], v140 offset:1024
v_mfma_f32_16x16x32_bf16 v[56:59], a[180:183], a[236:239], v[56:59]
ds_read_b64_tr_b16 a[148:149], v140 offset:8192
ds_read_b64_tr_b16 a[150:151], v140 offset:9216
v_mfma_f32_16x16x32_bf16 v[88:91], a[176:179], a[240:243], v[88:91]
buffer_load_dwordx4 v157, s[68:71], s30 offen offset:1024 lds
v_mfma_f32_16x16x32_bf16 v[88:91], a[180:183], a[244:247], v[88:91]
s_add_u32 m0, s38, 122880
ds_read_b64_tr_b16 a[152:153], v141 offset:0
ds_read_b64_tr_b16 a[154:155], v141 offset:1024
v_mfma_f32_16x16x32_bf16 v[120:123], a[176:179], a[248:251], v[120:123]
s_add_u32 s30, s27, 2048
ds_read_b64_tr_b16 a[156:157], v141 offset:8192
ds_read_b64_tr_b16 a[158:159], v141 offset:9216
v_mfma_f32_16x16x32_bf16 v[120:123], a[180:183], a[252:255], v[120:123]
buffer_load_dwordx4 v156, s[68:71], s30 offen offset:0 lds
v_mfma_f32_16x16x32_bf16 v[28:31], a[184:187], a[224:227], v[28:31]
v_accvgpr_read_b32 v152, a68
v_accvgpr_read_b32 v153, a69
v_mfma_f32_16x16x32_bf16 v[28:31], a[188:191], a[228:231], v[28:31]
v_accvgpr_read_b32 v154, a70
v_accvgpr_read_b32 v155, a71
v_mfma_f32_16x16x32_bf16 v[60:63], a[184:187], a[232:235], v[60:63]
v_accvgpr_read_b32 v148, a64
v_accvgpr_read_b32 v149, a65
v_mfma_f32_16x16x32_bf16 v[60:63], a[188:191], a[236:239], v[60:63]
buffer_load_dwordx4 v157, s[68:71], s30 offen offset:1024 lds
v_mfma_f32_16x16x32_bf16 v[92:95], a[184:187], a[240:243], v[92:95]
v_accvgpr_read_b32 v150, a66
v_accvgpr_read_b32 v151, a67
v_mfma_f32_16x16x32_bf16 v[92:95], a[188:191], a[244:247], v[92:95]
v_cvt_pk_bf16_f32 v148, v148, v149
v_cvt_pk_bf16_f32 v149, v150, v151
v_mfma_f32_16x16x32_bf16 v[124:127], a[184:187], a[248:251], v[124:127]
v_cvt_pk_bf16_f32 v150, v152, v153
v_cvt_pk_bf16_f32 v151, v154, v155
v_mfma_f32_16x16x32_bf16 v[124:127], a[188:191], a[252:255], v[124:127]
s_add_u32 s43, s32, 24576
buffer_store_dwordx4 v[148:151], v252, s[4:7], s43 offen offset:0 sc1
s_waitcnt lgkmcnt(0)
v_mfma_f32_16x16x32_bf16 v[0:3], a[128:131], a[192:195], v[0:3]
s_lshr_b32 s38, s29, 2
s_add_u32 m0, s38, 131072
ds_read_b64_tr_b16 a[160:161], v142 offset:0
v_mfma_f32_16x16x32_bf16 v[0:3], a[132:135], a[196:199], v[0:3]
s_add_u32 s30, s26, 128
ds_read_b64_tr_b16 a[162:163], v142 offset:1024
ds_read_b64_tr_b16 a[164:165], v142 offset:8192
v_mfma_f32_16x16x32_bf16 v[32:35], a[128:131], a[200:203], v[32:35]
buffer_load_dwordx4 v128, s[64:67], s30 offen offset:0  lds
v_mfma_f32_16x16x32_bf16 v[32:35], a[132:135], a[204:207], v[32:35]
ds_read_b64_tr_b16 a[166:167], v142 offset:9216
ds_read_b64_tr_b16 a[168:169], v143 offset:0
v_mfma_f32_16x16x32_bf16 v[64:67], a[128:131], a[208:211], v[64:67]
ds_read_b64_tr_b16 a[170:171], v143 offset:1024
ds_read_b64_tr_b16 a[172:173], v143 offset:8192
v_mfma_f32_16x16x32_bf16 v[64:67], a[132:135], a[212:215], v[64:67]
buffer_load_dwordx4 v129, s[64:67], s30 offen offset:1024  lds
v_mfma_f32_16x16x32_bf16 v[96:99], a[128:131], a[216:219], v[96:99]
ds_read_b64_tr_b16 a[174:175], v143 offset:9216
ds_read_b64_tr_b16 a[176:177], v144 offset:0
v_mfma_f32_16x16x32_bf16 v[96:99], a[132:135], a[220:223], v[96:99]
s_add_u32 m0, s38, 139264
ds_read_b64_tr_b16 a[178:179], v144 offset:1024
ds_read_b64_tr_b16 a[180:181], v144 offset:8192
v_mfma_f32_16x16x32_bf16 v[4:7], a[136:139], a[192:195], v[4:7]
s_add_u32 s30, s27, 196608
ds_read_b64_tr_b16 a[182:183], v144 offset:9216
ds_read_b64_tr_b16 a[184:185], v145 offset:0
v_mfma_f32_16x16x32_bf16 v[4:7], a[140:143], a[196:199], v[4:7]
buffer_load_dwordx4 v156, s[68:71], s30 offen offset:0 lds
v_mfma_f32_16x16x32_bf16 v[36:39], a[136:139], a[200:203], v[36:39]
ds_read_b64_tr_b16 a[186:187], v145 offset:1024
ds_read_b64_tr_b16 a[188:189], v145 offset:8192
v_mfma_f32_16x16x32_bf16 v[36:39], a[140:143], a[204:207], v[36:39]
ds_read_b64_tr_b16 a[190:191], v145 offset:9216
v_mfma_f32_16x16x32_bf16 v[68:71], a[136:139], a[208:211], v[68:71]
buffer_load_dwordx4 v157, s[68:71], s30 offen offset:1024 lds
v_mfma_f32_16x16x32_bf16 v[68:71], a[140:143], a[212:215], v[68:71]
v_accvgpr_read_b32 v152, a76
v_accvgpr_read_b32 v153, a77
v_mfma_f32_16x16x32_bf16 v[100:103], a[136:139], a[216:219], v[100:103]
s_add_u32 m0, s38, 147456
v_accvgpr_read_b32 v154, a78
v_accvgpr_read_b32 v155, a79
v_mfma_f32_16x16x32_bf16 v[100:103], a[140:143], a[220:223], v[100:103]
s_add_u32 s30, s27, 197632
v_accvgpr_read_b32 v148, a72
v_accvgpr_read_b32 v149, a73
v_mfma_f32_16x16x32_bf16 v[8:11], a[144:147], a[192:195], v[8:11]
buffer_load_dwordx4 v156, s[68:71], s30 offen offset:0 lds
v_mfma_f32_16x16x32_bf16 v[8:11], a[148:151], a[196:199], v[8:11]
v_accvgpr_read_b32 v150, a74
v_accvgpr_read_b32 v151, a75
v_mfma_f32_16x16x32_bf16 v[40:43], a[144:147], a[200:203], v[40:43]
v_cvt_pk_bf16_f32 v148, v148, v149
v_cvt_pk_bf16_f32 v149, v150, v151
v_mfma_f32_16x16x32_bf16 v[40:43], a[148:151], a[204:207], v[40:43]
v_cvt_pk_bf16_f32 v150, v152, v153
v_cvt_pk_bf16_f32 v151, v154, v155
v_mfma_f32_16x16x32_bf16 v[72:75], a[144:147], a[208:211], v[72:75]
buffer_load_dwordx4 v157, s[68:71], s30 offen offset:1024 lds
v_mfma_f32_16x16x32_bf16 v[72:75], a[148:151], a[212:215], v[72:75]
s_add_u32 m0, s38, 155648
v_add_u32 v136, 0xc000, v136
v_add_u32 v137, 0xc000, v137
v_mfma_f32_16x16x32_bf16 v[104:107], a[144:147], a[216:219], v[104:107]
s_add_u32 s30, s27, 198656
v_add_u32 v138, 0xc000, v138
v_add_u32 v139, 0xc000, v139
v_mfma_f32_16x16x32_bf16 v[104:107], a[148:151], a[220:223], v[104:107]
buffer_load_dwordx4 v156, s[68:71], s30 offen offset:0 lds
v_mfma_f32_16x16x32_bf16 v[12:15], a[152:155], a[192:195], v[12:15]
v_add_u32 v140, 0xc000, v140
v_add_u32 v141, 0xc000, v141
v_mfma_f32_16x16x32_bf16 v[12:15], a[156:159], a[196:199], v[12:15]
v_add_u32 v142, 0xc000, v142
v_add_u32 v143, 0xc000, v143
v_mfma_f32_16x16x32_bf16 v[44:47], a[152:155], a[200:203], v[44:47]
v_add_u32 v144, 0xc000, v144
v_add_u32 v145, 0xc000, v145
v_mfma_f32_16x16x32_bf16 v[44:47], a[156:159], a[204:207], v[44:47]
buffer_load_dwordx4 v157, s[68:71], s30 offen offset:1024 lds
v_mfma_f32_16x16x32_bf16 v[76:79], a[152:155], a[208:211], v[76:79]
v_mfma_f32_16x16x32_bf16 v[76:79], a[156:159], a[212:215], v[76:79]
v_mfma_f32_16x16x32_bf16 v[108:111], a[152:155], a[216:219], v[108:111]
v_mfma_f32_16x16x32_bf16 v[108:111], a[156:159], a[220:223], v[108:111]
s_add_u32 s43, s32, 24576
buffer_store_dwordx4 v[148:151], v252, s[4:7], s43 offen offset:1024 sc1
s_waitcnt vmcnt(20) lgkmcnt(0)
s_barrier
v_mfma_f32_16x16x32_bf16 v[16:19], a[160:163], a[192:195], v[16:19]
s_lshr_b32 s38, s29, 2
s_add_u32 m0, s38, 0
v_mfma_f32_16x16x32_bf16 v[16:19], a[164:167], a[196:199], v[16:19]
s_add_u32 s30, s26, 256
ds_read_b128 a[224:227], v136 offset:0
v_mfma_f32_16x16x32_bf16 v[48:51], a[160:163], a[200:203], v[48:51]
buffer_load_dwordx4 v128, s[64:67], s30 offen offset:0  lds
v_mfma_f32_16x16x32_bf16 v[48:51], a[164:167], a[204:207], v[48:51]
ds_read_b128 a[228:231], v137 offset:0
v_mfma_f32_16x16x32_bf16 v[80:83], a[160:163], a[208:211], v[80:83]
ds_read_b128 a[232:235], v136 offset:2048
v_mfma_f32_16x16x32_bf16 v[80:83], a[164:167], a[212:215], v[80:83]
buffer_load_dwordx4 v129, s[64:67], s30 offen offset:1024  lds
v_mfma_f32_16x16x32_bf16 v[112:115], a[160:163], a[216:219], v[112:115]
ds_read_b128 a[236:239], v137 offset:2048
v_mfma_f32_16x16x32_bf16 v[112:115], a[164:167], a[220:223], v[112:115]
s_add_u32 m0, s38, 8192
ds_read_b128 a[240:243], v136 offset:4096
v_mfma_f32_16x16x32_bf16 v[20:23], a[168:171], a[192:195], v[20:23]
s_add_u32 s30, s27, 393216
ds_read_b128 a[244:247], v137 offset:4096
v_mfma_f32_16x16x32_bf16 v[20:23], a[172:175], a[196:199], v[20:23]
buffer_load_dwordx4 v156, s[68:71], s30 offen offset:0 lds
v_mfma_f32_16x16x32_bf16 v[52:55], a[168:171], a[200:203], v[52:55]
ds_read_b128 a[248:251], v136 offset:6144
v_mfma_f32_16x16x32_bf16 v[52:55], a[172:175], a[204:207], v[52:55]
ds_read_b128 a[252:255], v137 offset:6144
v_mfma_f32_16x16x32_bf16 v[84:87], a[168:171], a[208:211], v[84:87]
buffer_load_dwordx4 v157, s[68:71], s30 offen offset:1024 lds
v_mfma_f32_16x16x32_bf16 v[84:87], a[172:175], a[212:215], v[84:87]
ds_read_b64_tr_b16 a[128:129], v138 offset:0
ds_read_b64_tr_b16 a[130:131], v138 offset:1024
v_mfma_f32_16x16x32_bf16 v[116:119], a[168:171], a[216:219], v[116:119]
s_add_u32 m0, s38, 16384
ds_read_b64_tr_b16 a[132:133], v138 offset:8192
ds_read_b64_tr_b16 a[134:135], v138 offset:9216
v_mfma_f32_16x16x32_bf16 v[116:119], a[172:175], a[220:223], v[116:119]
s_add_u32 s30, s27, 394240
ds_read_b64_tr_b16 a[136:137], v139 offset:0
ds_read_b64_tr_b16 a[138:139], v139 offset:1024
v_mfma_f32_16x16x32_bf16 v[24:27], a[176:179], a[192:195], v[24:27]
buffer_load_dwordx4 v156, s[68:71], s30 offen offset:0 lds
v_mfma_f32_16x16x32_bf16 v[24:27], a[180:183], a[196:199], v[24:27]
ds_read_b64_tr_b16 a[140:141], v139 offset:8192
ds_read_b64_tr_b16 a[142:143], v139 offset:9216
v_mfma_f32_16x16x32_bf16 v[56:59], a[176:179], a[200:203], v[56:59]
ds_read_b64_tr_b16 a[144:145], v140 offset:0
ds_read_b64_tr_b16 a[146:147], v140 offset:1024
v_mfma_f32_16x16x32_bf16 v[56:59], a[180:183], a[204:207], v[56:59]
ds_read_b64_tr_b16 a[148:149], v140 offset:8192
ds_read_b64_tr_b16 a[150:151], v140 offset:9216
v_mfma_f32_16x16x32_bf16 v[88:91], a[176:179], a[208:211], v[88:91]
buffer_load_dwordx4 v157, s[68:71], s30 offen offset:1024 lds
v_mfma_f32_16x16x32_bf16 v[88:91], a[180:183], a[212:215], v[88:91]
s_add_u32 m0, s38, 24576
ds_read_b64_tr_b16 a[152:153], v141 offset:0
ds_read_b64_tr_b16 a[154:155], v141 offset:1024
v_mfma_f32_16x16x32_bf16 v[120:123], a[176:179], a[216:219], v[120:123]
s_add_u32 s30, s27, 395264
ds_read_b64_tr_b16 a[156:157], v141 offset:8192
ds_read_b64_tr_b16 a[158:159], v141 offset:9216
v_mfma_f32_16x16x32_bf16 v[120:123], a[180:183], a[220:223], v[120:123]
buffer_load_dwordx4 v156, s[68:71], s30 offen offset:0 lds
v_mfma_f32_16x16x32_bf16 v[28:31], a[184:187], a[192:195], v[28:31]
v_accvgpr_read_b32 v152, a84
v_accvgpr_read_b32 v153, a85
v_mfma_f32_16x16x32_bf16 v[28:31], a[188:191], a[196:199], v[28:31]
v_accvgpr_read_b32 v154, a86
v_accvgpr_read_b32 v155, a87
v_mfma_f32_16x16x32_bf16 v[60:63], a[184:187], a[200:203], v[60:63]
v_accvgpr_read_b32 v148, a80
v_accvgpr_read_b32 v149, a81
v_mfma_f32_16x16x32_bf16 v[60:63], a[188:191], a[204:207], v[60:63]
buffer_load_dwordx4 v157, s[68:71], s30 offen offset:1024 lds
v_mfma_f32_16x16x32_bf16 v[92:95], a[184:187], a[208:211], v[92:95]
v_accvgpr_read_b32 v150, a82
v_accvgpr_read_b32 v151, a83
v_mfma_f32_16x16x32_bf16 v[92:95], a[188:191], a[212:215], v[92:95]
v_cvt_pk_bf16_f32 v148, v148, v149
v_cvt_pk_bf16_f32 v149, v150, v151
v_mfma_f32_16x16x32_bf16 v[124:127], a[184:187], a[216:219], v[124:127]
v_cvt_pk_bf16_f32 v150, v152, v153
v_cvt_pk_bf16_f32 v151, v154, v155
v_mfma_f32_16x16x32_bf16 v[124:127], a[188:191], a[220:223], v[124:127]
s_add_u32 s43, s32, 24576
buffer_store_dwordx4 v[148:151], v252, s[4:7], s43 offen offset:2048 sc1
v_accvgpr_read_b32 v152, a92
v_accvgpr_read_b32 v153, a93
v_accvgpr_read_b32 v154, a94
v_accvgpr_read_b32 v155, a95
v_accvgpr_read_b32 v148, a88
v_accvgpr_read_b32 v149, a89
v_accvgpr_read_b32 v150, a90
v_accvgpr_read_b32 v151, a91
v_cvt_pk_bf16_f32 v148, v148, v149
v_cvt_pk_bf16_f32 v149, v150, v151
v_cvt_pk_bf16_f32 v150, v152, v153
v_cvt_pk_bf16_f32 v151, v154, v155
s_add_u32 s43, s32, 24576
buffer_store_dwordx4 v[148:151], v252, s[4:7], s43 offen offset:3072 sc1
s_waitcnt lgkmcnt(0)
v_mfma_f32_16x16x32_bf16 v[0:3], a[128:131], a[224:227], v[0:3]
s_lshl_b32 s28, s22, 11
s_and_b32 s39, s20, 1
s_lshl_b32 s39, s39, 10
v_mfma_f32_16x16x32_bf16 v[0:3], a[132:135], a[228:231], v[0:3]
s_add_u32 s28, s28, s39
ds_read_b64_tr_b16 a[160:161], v142 offset:0
ds_read_b64_tr_b16 a[162:163], v142 offset:1024
v_mfma_f32_16x16x32_bf16 v[32:35], a[128:131], a[232:235], v[32:35]
buffer_load_ushort v224, v163, s[72:75], s28 offen offset:0
v_mfma_f32_16x16x32_bf16 v[32:35], a[132:135], a[236:239], v[32:35]
ds_read_b64_tr_b16 a[164:165], v142 offset:8192
ds_read_b64_tr_b16 a[166:167], v142 offset:9216
v_mfma_f32_16x16x32_bf16 v[64:67], a[128:131], a[240:243], v[64:67]
ds_read_b64_tr_b16 a[168:169], v143 offset:0
ds_read_b64_tr_b16 a[170:171], v143 offset:1024
v_mfma_f32_16x16x32_bf16 v[64:67], a[132:135], a[244:247], v[64:67]
buffer_load_ushort v225, v163, s[72:75], s28 offen offset:32
v_mfma_f32_16x16x32_bf16 v[96:99], a[128:131], a[248:251], v[96:99]
ds_read_b64_tr_b16 a[172:173], v143 offset:8192
ds_read_b64_tr_b16 a[174:175], v143 offset:9216
v_mfma_f32_16x16x32_bf16 v[96:99], a[132:135], a[252:255], v[96:99]
ds_read_b64_tr_b16 a[176:177], v144 offset:0
ds_read_b64_tr_b16 a[178:179], v144 offset:1024
v_mfma_f32_16x16x32_bf16 v[4:7], a[136:139], a[224:227], v[4:7]
ds_read_b64_tr_b16 a[180:181], v144 offset:8192
ds_read_b64_tr_b16 a[182:183], v144 offset:9216
v_mfma_f32_16x16x32_bf16 v[4:7], a[140:143], a[228:231], v[4:7]
buffer_load_ushort v226, v163, s[72:75], s28 offen offset:64
v_mfma_f32_16x16x32_bf16 v[36:39], a[136:139], a[232:235], v[36:39]
ds_read_b64_tr_b16 a[184:185], v145 offset:0
ds_read_b64_tr_b16 a[186:187], v145 offset:1024
v_mfma_f32_16x16x32_bf16 v[36:39], a[140:143], a[236:239], v[36:39]
ds_read_b64_tr_b16 a[188:189], v145 offset:8192
ds_read_b64_tr_b16 a[190:191], v145 offset:9216
v_mfma_f32_16x16x32_bf16 v[68:71], a[136:139], a[240:243], v[68:71]
buffer_load_ushort v227, v163, s[72:75], s28 offen offset:96
v_mfma_f32_16x16x32_bf16 v[68:71], a[140:143], a[244:247], v[68:71]
v_accvgpr_read_b32 v152, a100
v_accvgpr_read_b32 v153, a101
v_mfma_f32_16x16x32_bf16 v[100:103], a[136:139], a[248:251], v[100:103]
v_accvgpr_read_b32 v154, a102
v_accvgpr_read_b32 v155, a103
v_mfma_f32_16x16x32_bf16 v[100:103], a[140:143], a[252:255], v[100:103]
v_accvgpr_read_b32 v148, a96
v_accvgpr_read_b32 v149, a97
v_mfma_f32_16x16x32_bf16 v[8:11], a[144:147], a[224:227], v[8:11]
buffer_load_ushort v228, v163, s[72:75], s28 offen offset:256
v_mfma_f32_16x16x32_bf16 v[8:11], a[148:151], a[228:231], v[8:11]
v_accvgpr_read_b32 v150, a98
v_accvgpr_read_b32 v151, a99
v_mfma_f32_16x16x32_bf16 v[40:43], a[144:147], a[232:235], v[40:43]
v_cvt_pk_bf16_f32 v148, v148, v149
v_cvt_pk_bf16_f32 v149, v150, v151
v_mfma_f32_16x16x32_bf16 v[40:43], a[148:151], a[236:239], v[40:43]
v_cvt_pk_bf16_f32 v150, v152, v153
v_cvt_pk_bf16_f32 v151, v154, v155
v_mfma_f32_16x16x32_bf16 v[72:75], a[144:147], a[240:243], v[72:75]
buffer_load_ushort v229, v163, s[72:75], s28 offen offset:288
v_mfma_f32_16x16x32_bf16 v[72:75], a[148:151], a[244:247], v[72:75]
v_mfma_f32_16x16x32_bf16 v[104:107], a[144:147], a[248:251], v[104:107]
v_mfma_f32_16x16x32_bf16 v[104:107], a[148:151], a[252:255], v[104:107]
buffer_load_ushort v230, v163, s[72:75], s28 offen offset:320
v_mfma_f32_16x16x32_bf16 v[12:15], a[152:155], a[224:227], v[12:15]
v_mfma_f32_16x16x32_bf16 v[12:15], a[156:159], a[228:231], v[12:15]
v_mfma_f32_16x16x32_bf16 v[44:47], a[152:155], a[232:235], v[44:47]
v_mfma_f32_16x16x32_bf16 v[44:47], a[156:159], a[236:239], v[44:47]
buffer_load_ushort v231, v163, s[72:75], s28 offen offset:352
v_mfma_f32_16x16x32_bf16 v[76:79], a[152:155], a[240:243], v[76:79]
v_mfma_f32_16x16x32_bf16 v[76:79], a[156:159], a[244:247], v[76:79]
v_mfma_f32_16x16x32_bf16 v[108:111], a[152:155], a[248:251], v[108:111]
v_mfma_f32_16x16x32_bf16 v[108:111], a[156:159], a[252:255], v[108:111]
s_add_u32 s43, s32, 28672
buffer_store_dwordx4 v[148:151], v252, s[4:7], s43 offen offset:0 sc1
s_waitcnt vmcnt(29) lgkmcnt(0)
s_barrier
v_mfma_f32_16x16x32_bf16 v[16:19], a[160:163], a[224:227], v[16:19]
s_lshr_b32 s38, s29, 2
s_add_u32 m0, s38, 32768
v_mfma_f32_16x16x32_bf16 v[16:19], a[164:167], a[228:231], v[16:19]
s_add_u32 s30, s26, 384
ds_read_b128 a[140:143], v158
v_mfma_f32_16x16x32_bf16 v[48:51], a[160:163], a[232:235], v[48:51]
buffer_load_dwordx4 v128, s[64:67], s30 offen offset:0  lds
v_mfma_f32_16x16x32_bf16 v[48:51], a[164:167], a[236:239], v[48:51]
ds_read_b64_tr_b16 a[128:129], v162 offset:0
ds_read_b64_tr_b16 a[130:131], v162 offset:512
v_mfma_f32_16x16x32_bf16 v[80:83], a[160:163], a[240:243], v[80:83]
ds_read_b64_tr_b16 a[132:133], v162 offset:8192
ds_read_b64_tr_b16 a[134:135], v162 offset:8704
v_mfma_f32_16x16x32_bf16 v[80:83], a[164:167], a[244:247], v[80:83]
buffer_load_dwordx4 v129, s[64:67], s30 offen offset:1024  lds
v_mfma_f32_16x16x32_bf16 v[112:115], a[160:163], a[248:251], v[112:115]
ds_read_b64_tr_b16 a[136:137], v162 offset:16384
ds_read_b64_tr_b16 a[138:139], v162 offset:16896
v_mfma_f32_16x16x32_bf16 v[112:115], a[164:167], a[252:255], v[112:115]
s_add_u32 m0, s38, 40960
ds_read_b128 a[156:159], v159
v_mfma_f32_16x16x32_bf16 v[20:23], a[168:171], a[224:227], v[20:23]
s_add_u32 s30, s27, 589824
ds_read_b64_tr_b16 a[144:145], v162 offset:2048
ds_read_b64_tr_b16 a[146:147], v162 offset:2560
v_mfma_f32_16x16x32_bf16 v[20:23], a[172:175], a[228:231], v[20:23]
buffer_load_dwordx4 v156, s[68:71], s30 offen offset:0 lds
v_mfma_f32_16x16x32_bf16 v[52:55], a[168:171], a[232:235], v[52:55]
ds_read_b64_tr_b16 a[148:149], v162 offset:10240
ds_read_b64_tr_b16 a[150:151], v162 offset:10752
v_mfma_f32_16x16x32_bf16 v[52:55], a[172:175], a[236:239], v[52:55]
ds_read_b64_tr_b16 a[152:153], v162 offset:18432
ds_read_b64_tr_b16 a[154:155], v162 offset:18944
v_mfma_f32_16x16x32_bf16 v[84:87], a[168:171], a[240:243], v[84:87]
buffer_load_dwordx4 v157, s[68:71], s30 offen offset:1024 lds
v_mfma_f32_16x16x32_bf16 v[84:87], a[172:175], a[244:247], v[84:87]
v_accvgpr_read_b32 v152, a108
v_accvgpr_read_b32 v153, a109
v_mfma_f32_16x16x32_bf16 v[116:119], a[168:171], a[248:251], v[116:119]
s_add_u32 m0, s38, 49152
v_accvgpr_read_b32 v154, a110
v_accvgpr_read_b32 v155, a111
v_mfma_f32_16x16x32_bf16 v[116:119], a[172:175], a[252:255], v[116:119]
s_add_u32 s30, s27, 590848
v_accvgpr_read_b32 v148, a104
v_accvgpr_read_b32 v149, a105
v_mfma_f32_16x16x32_bf16 v[24:27], a[176:179], a[224:227], v[24:27]
buffer_load_dwordx4 v156, s[68:71], s30 offen offset:0 lds
v_mfma_f32_16x16x32_bf16 v[24:27], a[180:183], a[228:231], v[24:27]
v_accvgpr_read_b32 v150, a106
v_accvgpr_read_b32 v151, a107
v_mfma_f32_16x16x32_bf16 v[56:59], a[176:179], a[232:235], v[56:59]
v_cvt_pk_bf16_f32 v148, v148, v149
v_cvt_pk_bf16_f32 v149, v150, v151
v_mfma_f32_16x16x32_bf16 v[56:59], a[180:183], a[236:239], v[56:59]
v_cvt_pk_bf16_f32 v150, v152, v153
v_cvt_pk_bf16_f32 v151, v154, v155
v_mfma_f32_16x16x32_bf16 v[88:91], a[176:179], a[240:243], v[88:91]
buffer_load_dwordx4 v157, s[68:71], s30 offen offset:1024 lds
v_mfma_f32_16x16x32_bf16 v[88:91], a[180:183], a[244:247], v[88:91]
s_add_u32 m0, s38, 57344
v_mfma_f32_16x16x32_bf16 v[120:123], a[176:179], a[248:251], v[120:123]
s_add_u32 s30, s27, 591872
v_mfma_f32_16x16x32_bf16 v[120:123], a[180:183], a[252:255], v[120:123]
buffer_load_dwordx4 v156, s[68:71], s30 offen offset:0 lds
v_mfma_f32_16x16x32_bf16 v[28:31], a[184:187], a[224:227], v[28:31]
v_mfma_f32_16x16x32_bf16 v[28:31], a[188:191], a[228:231], v[28:31]
v_mfma_f32_16x16x32_bf16 v[60:63], a[184:187], a[232:235], v[60:63]
v_mfma_f32_16x16x32_bf16 v[60:63], a[188:191], a[236:239], v[60:63]
buffer_load_dwordx4 v157, s[68:71], s30 offen offset:1024 lds
v_mfma_f32_16x16x32_bf16 v[92:95], a[184:187], a[240:243], v[92:95]
v_mfma_f32_16x16x32_bf16 v[92:95], a[188:191], a[244:247], v[92:95]
v_mfma_f32_16x16x32_bf16 v[124:127], a[184:187], a[248:251], v[124:127]
v_mfma_f32_16x16x32_bf16 v[124:127], a[188:191], a[252:255], v[124:127]
s_add_u32 s43, s32, 28672
buffer_store_dwordx4 v[148:151], v252, s[4:7], s43 offen offset:1024 sc1
s_mov_b32 s16, s4
s_and_b32 s17, s5, 0xffff
s_mov_b32 s18, 0x10000000
s_mov_b32 s19, 0x00020000
s_and_b32 s24, s20, 1
s_lshl_b32 s37, s24, 14
s_lshr_b32 s48, s20, 1
s_lshl_b32 s39, s48, 13
s_lshl_b32 s25, s21, 20
s_add_u32 s42, s23, 1
s_lshl_b32 s42, s42, 16
s_add_u32 s42, s42, s25
s_add_u32 s25, s25, s37
s_add_u32 s25, s25, s39
s_cmp_eq_u32 s48, 1
s_cselect_b32 s18, 0, s42
s_lshl_b32 s48, s48, 15
s_lshl_b32 s24, s24, 13
s_waitcnt lgkmcnt(7)
v_mfma_f32_32x32x16_bf16 v[176:191], a[128:131], a[140:143], 0
ds_read_b128 a[172:175], v160
ds_read_b64_tr_b16 a[160:161], v162 offset:4096
ds_read_b64_tr_b16 a[162:163], v162 offset:4608
ds_read_b64_tr_b16 a[164:165], v162 offset:12288
v_mfma_f32_32x32x16_bf16 v[192:207], a[132:135], a[140:143], 0
ds_read_b64_tr_b16 a[166:167], v162 offset:12800
ds_read_b64_tr_b16 a[168:169], v162 offset:20480
ds_read_b64_tr_b16 a[170:171], v162 offset:20992
s_lshr_b32 s38, s29, 2
s_add_u32 m0, s38, 65536
s_add_u32 s30, s26, 512
buffer_load_dwordx4 v128, s[64:67], s30 offen offset:0  lds
buffer_load_dwordx4 v129, s[64:67], s30 offen offset:1024  lds
s_add_u32 m0, s38, 73728
s_add_u32 s30, s27, 786432
buffer_load_dwordx4 v156, s[68:71], s30 offen offset:0 lds
buffer_load_dwordx4 v157, s[68:71], s30 offen offset:1024 lds
v_mfma_f32_32x32x16_bf16 v[208:223], a[140:143], a[136:139], 0
s_add_u32 m0, s38, 81920
s_add_u32 s30, s27, 787456
buffer_load_dwordx4 v156, s[68:71], s30 offen offset:0 lds
buffer_load_dwordx4 v157, s[68:71], s30 offen offset:1024 lds
s_add_u32 m0, s38, 90112
s_add_u32 s30, s27, 788480
buffer_load_dwordx4 v156, s[68:71], s30 offen offset:0 lds
buffer_load_dwordx4 v157, s[68:71], s30 offen offset:1024 lds
v_accvgpr_read_b32 v152, a116
v_accvgpr_read_b32 v153, a117
v_accvgpr_read_b32 v154, a118
v_accvgpr_read_b32 v155, a119
v_accvgpr_read_b32 v148, a112
v_accvgpr_read_b32 v149, a113
v_accvgpr_read_b32 v150, a114
v_accvgpr_read_b32 v151, a115
v_cvt_pk_bf16_f32 v148, v148, v149
v_cvt_pk_bf16_f32 v149, v150, v151
v_cvt_pk_bf16_f32 v150, v152, v153
v_cvt_pk_bf16_f32 v151, v154, v155
s_add_u32 s43, s32, 28672
buffer_store_dwordx4 v[148:151], v252, s[4:7], s43 offen offset:2048 sc1
s_waitcnt lgkmcnt(7)
v_mfma_f32_32x32x16_bf16 v[176:191], a[144:147], a[156:159], v[176:191]
ds_read_b128 a[188:191], v161
ds_read_b64_tr_b16 a[176:177], v162 offset:6144
ds_read_b64_tr_b16 a[178:179], v162 offset:6656
ds_read_b64_tr_b16 a[180:181], v162 offset:14336
v_mul_f32 v0, v254, v0
v_mul_f32 v1, v254, v1
v_mfma_f32_32x32x16_bf16 v[192:207], a[148:151], a[156:159], v[192:207]
ds_read_b64_tr_b16 a[182:183], v162 offset:14848
ds_read_b64_tr_b16 a[184:185], v162 offset:22528
ds_read_b64_tr_b16 a[186:187], v162 offset:23040
buffer_load_ushort v232, v163, s[72:75], s28 offen offset:512
buffer_load_ushort v233, v163, s[72:75], s28 offen offset:544
buffer_load_ushort v234, v163, s[72:75], s28 offen offset:576
buffer_load_ushort v235, v163, s[72:75], s28 offen offset:608
v_mul_f32 v2, v254, v2
v_mul_f32 v3, v254, v3
v_mul_f32 v4, v254, v4
v_mfma_f32_32x32x16_bf16 v[208:223], a[156:159], a[152:155], v[208:223]
buffer_load_ushort v236, v163, s[72:75], s28 offen offset:768
buffer_load_ushort v237, v163, s[72:75], s28 offen offset:800
buffer_load_ushort v238, v163, s[72:75], s28 offen offset:832
buffer_load_ushort v239, v163, s[72:75], s28 offen offset:864
v_mul_f32 v5, v254, v5
v_mul_f32 v6, v254, v6
v_mul_f32 v7, v254, v7
v_cvt_pk_bf16_f32 v0, v0, v1
v_cvt_pk_bf16_f32 v1, v2, v3
v_add_u32 v158, 0x8000, v158
v_add_u32 v159, 0x8000, v159
v_add_u32 v160, 0x8000, v160
v_add_u32 v161, 0x8000, v161
v_add_u32 v162, 0x8000, v162
s_waitcnt vmcnt(46) lgkmcnt(0)
s_barrier
v_mfma_f32_32x32x16_bf16 v[176:191], a[160:163], a[172:175], v[176:191]
ds_read_b128 a[140:143], v158
ds_read_b64_tr_b16 a[128:129], v162 offset:0
ds_read_b64_tr_b16 a[130:131], v162 offset:512
ds_read_b64_tr_b16 a[132:133], v162 offset:8192
v_cvt_pk_bf16_f32 v2, v4, v5
v_cvt_pk_bf16_f32 v3, v6, v7
v_mfma_f32_32x32x16_bf16 v[192:207], a[164:167], a[172:175], v[192:207]
ds_read_b64_tr_b16 a[134:135], v162 offset:8704
ds_read_b64_tr_b16 a[136:137], v162 offset:16384
ds_read_b64_tr_b16 a[138:139], v162 offset:16896
buffer_store_dword v165, v164, s[4:7], 0 offen offset:0 sc1
s_lshr_b32 s38, s29, 2
s_add_u32 m0, s38, 98304
s_add_u32 s30, s26, 640
buffer_load_dwordx4 v128, s[64:67], s30 offen offset:0  lds
buffer_load_dwordx4 v129, s[64:67], s30 offen offset:1024  lds
v_accvgpr_write_b32 a64, v0
v_accvgpr_write_b32 a65, v1
v_accvgpr_write_b32 a66, v2
v_mfma_f32_32x32x16_bf16 v[208:223], a[172:175], a[168:171], v[208:223]
s_add_u32 m0, s38, 106496
s_add_u32 s30, s27, 983040
buffer_load_dwordx4 v156, s[68:71], s30 offen offset:0 lds
buffer_load_dwordx4 v157, s[68:71], s30 offen offset:1024 lds
v_accvgpr_write_b32 a67, v3
v_mul_f32 v8, v254, v8
v_mul_f32 v9, v254, v9
v_mul_f32 v10, v254, v10
v_mul_f32 v11, v254, v11
v_accvgpr_read_b32 v152, a124
v_accvgpr_read_b32 v153, a125
v_accvgpr_read_b32 v154, a126
v_accvgpr_read_b32 v155, a127
v_accvgpr_read_b32 v148, a120
v_accvgpr_read_b32 v149, a121
v_accvgpr_read_b32 v150, a122
v_accvgpr_read_b32 v151, a123
v_cvt_pk_bf16_f32 v148, v148, v149
v_cvt_pk_bf16_f32 v149, v150, v151
v_cvt_pk_bf16_f32 v150, v152, v153
v_cvt_pk_bf16_f32 v151, v154, v155
s_add_u32 s43, s32, 28672
buffer_store_dwordx4 v[148:151], v252, s[4:7], s43 offen offset:3072 sc1
s_waitcnt lgkmcnt(7)
v_mfma_f32_32x32x16_bf16 v[176:191], a[176:179], a[188:191], v[176:191]
ds_read_b128 a[156:159], v159
ds_read_b64_tr_b16 a[144:145], v162 offset:2048
ds_read_b64_tr_b16 a[146:147], v162 offset:2560
ds_read_b64_tr_b16 a[148:149], v162 offset:10240
v_mul_f32 v12, v254, v12
v_mul_f32 v13, v254, v13
v_mfma_f32_32x32x16_bf16 v[192:207], a[180:183], a[188:191], v[192:207]
ds_read_b64_tr_b16 a[150:151], v162 offset:10752
ds_read_b64_tr_b16 a[152:153], v162 offset:18432
ds_read_b64_tr_b16 a[154:155], v162 offset:18944
s_add_u32 m0, s38, 114688
s_add_u32 s30, s27, 984064
buffer_load_dwordx4 v156, s[68:71], s30 offen offset:0 lds
buffer_load_dwordx4 v157, s[68:71], s30 offen offset:1024 lds
v_mul_f32 v14, v254, v14
v_mul_f32 v15, v254, v15
v_cvt_pk_bf16_f32 v8, v8, v9
v_mfma_f32_32x32x16_bf16 v[208:223], a[188:191], a[184:187], v[208:223]
s_add_u32 m0, s38, 122880
s_add_u32 s30, s27, 985088
buffer_load_dwordx4 v156, s[68:71], s30 offen offset:0 lds
buffer_load_dwordx4 v157, s[68:71], s30 offen offset:1024 lds
v_cvt_pk_bf16_f32 v9, v10, v11
v_cvt_pk_bf16_f32 v10, v12, v13
v_cvt_pk_bf16_f32 v11, v14, v15
v_accvgpr_write_b32 a68, v8
v_accvgpr_write_b32 a69, v9
s_waitcnt lgkmcnt(7)
v_mfma_f32_32x32x16_bf16 v[176:191], a[128:131], a[140:143], v[176:191]
ds_read_b128 a[172:175], v160
ds_read_b64_tr_b16 a[160:161], v162 offset:4096
ds_read_b64_tr_b16 a[162:163], v162 offset:4608
ds_read_b64_tr_b16 a[164:165], v162 offset:12288
v_accvgpr_write_b32 a70, v10
v_accvgpr_write_b32 a71, v11
v_mfma_f32_32x32x16_bf16 v[192:207], a[132:135], a[140:143], v[192:207]
ds_read_b64_tr_b16 a[166:167], v162 offset:12800
ds_read_b64_tr_b16 a[168:169], v162 offset:20480
ds_read_b64_tr_b16 a[170:171], v162 offset:20992
v_mul_f32 v16, v254, v16
v_mul_f32 v17, v254, v17
v_mul_f32 v18, v254, v18
v_mfma_f32_32x32x16_bf16 v[208:223], a[140:143], a[136:139], v[208:223]
v_mul_f32 v19, v254, v19
v_mul_f32 v20, v254, v20
v_mul_f32 v21, v254, v21
v_mul_f32 v22, v254, v22
v_mul_f32 v23, v254, v23
v_accvgpr_read_b32 v152, a4
v_accvgpr_read_b32 v153, a5
v_accvgpr_read_b32 v154, a6
v_accvgpr_read_b32 v155, a7
v_accvgpr_read_b32 v148, a0
v_accvgpr_read_b32 v149, a1
v_accvgpr_read_b32 v150, a2
v_accvgpr_read_b32 v151, a3
v_cvt_pk_bf16_f32 v148, v148, v149
v_cvt_pk_bf16_f32 v149, v150, v151
v_cvt_pk_bf16_f32 v150, v152, v153
v_cvt_pk_bf16_f32 v151, v154, v155
s_add_u32 s43, s32, 8192
buffer_store_dwordx4 v[148:151], v252, s[4:7], s43 offen offset:0 sc1
s_waitcnt lgkmcnt(7)
v_mfma_f32_32x32x16_bf16 v[176:191], a[144:147], a[156:159], v[176:191]
ds_read_b128 a[188:191], v161
ds_read_b64_tr_b16 a[176:177], v162 offset:6144
ds_read_b64_tr_b16 a[178:179], v162 offset:6656
ds_read_b64_tr_b16 a[180:181], v162 offset:14336
v_cvt_pk_bf16_f32 v16, v16, v17
v_cvt_pk_bf16_f32 v17, v18, v19
v_mfma_f32_32x32x16_bf16 v[192:207], a[148:151], a[156:159], v[192:207]
ds_read_b64_tr_b16 a[182:183], v162 offset:14848
ds_read_b64_tr_b16 a[184:185], v162 offset:22528
ds_read_b64_tr_b16 a[186:187], v162 offset:23040
v_cvt_pk_bf16_f32 v18, v20, v21
v_cvt_pk_bf16_f32 v19, v22, v23
v_accvgpr_write_b32 a72, v16
v_mfma_f32_32x32x16_bf16 v[208:223], a[156:159], a[152:155], v[208:223]
v_accvgpr_write_b32 a73, v17
v_accvgpr_write_b32 a74, v18
v_accvgpr_write_b32 a75, v19
v_mul_f32 v24, v254, v24
v_mul_f32 v25, v254, v25
v_add_u32 v158, 0xfffe0000, v158
v_add_u32 v159, 0xfffe0000, v159
v_add_u32 v160, 0xfffe0000, v160
v_add_u32 v161, 0xfffe0000, v161
v_add_u32 v162, 0xfffe0000, v162
s_waitcnt vmcnt(48) lgkmcnt(0)
s_barrier
v_mfma_f32_32x32x16_bf16 v[176:191], a[160:163], a[172:175], v[176:191]
ds_read_b128 a[140:143], v158
ds_read_b64_tr_b16 a[128:129], v162 offset:0
ds_read_b64_tr_b16 a[130:131], v162 offset:512
ds_read_b64_tr_b16 a[132:133], v162 offset:8192
v_mul_f32 v26, v254, v26
v_mul_f32 v27, v254, v27
v_mfma_f32_32x32x16_bf16 v[192:207], a[164:167], a[172:175], v[192:207]
ds_read_b64_tr_b16 a[134:135], v162 offset:8704
ds_read_b64_tr_b16 a[136:137], v162 offset:16384
ds_read_b64_tr_b16 a[138:139], v162 offset:16896
s_lshr_b32 s38, s29, 2
s_add_u32 m0, s38, 131072
s_add_u32 s30, s26, 768
buffer_load_dwordx4 v128, s[64:67], s30 offen offset:0  lds
buffer_load_dwordx4 v129, s[64:67], s30 offen offset:1024  lds
v_mul_f32 v28, v254, v28
v_mul_f32 v29, v254, v29
v_mul_f32 v30, v254, v30
v_mfma_f32_32x32x16_bf16 v[208:223], a[172:175], a[168:171], v[208:223]
s_add_u32 m0, s38, 139264
s_add_u32 s30, s27, 1179648
buffer_load_dwordx4 v156, s[68:71], s30 offen offset:0 lds
buffer_load_dwordx4 v157, s[68:71], s30 offen offset:1024 lds
v_mul_f32 v31, v254, v31
v_cvt_pk_bf16_f32 v24, v24, v25
v_cvt_pk_bf16_f32 v25, v26, v27
v_cvt_pk_bf16_f32 v26, v28, v29
v_cvt_pk_bf16_f32 v27, v30, v31
v_accvgpr_read_b32 v152, a12
v_accvgpr_read_b32 v153, a13
v_accvgpr_read_b32 v154, a14
v_accvgpr_read_b32 v155, a15
v_accvgpr_read_b32 v148, a8
v_accvgpr_read_b32 v149, a9
v_accvgpr_read_b32 v150, a10
v_accvgpr_read_b32 v151, a11
v_cvt_pk_bf16_f32 v148, v148, v149
v_cvt_pk_bf16_f32 v149, v150, v151
v_cvt_pk_bf16_f32 v150, v152, v153
v_cvt_pk_bf16_f32 v151, v154, v155
s_add_u32 s43, s32, 8192
buffer_store_dwordx4 v[148:151], v252, s[4:7], s43 offen offset:1024 sc1
s_waitcnt lgkmcnt(7)
v_mfma_f32_32x32x16_bf16 v[176:191], a[176:179], a[188:191], v[176:191]
ds_read_b128 a[156:159], v159
ds_read_b64_tr_b16 a[144:145], v162 offset:2048
ds_read_b64_tr_b16 a[146:147], v162 offset:2560
ds_read_b64_tr_b16 a[148:149], v162 offset:10240
v_accvgpr_write_b32 a76, v24
v_accvgpr_write_b32 a77, v25
v_mfma_f32_32x32x16_bf16 v[192:207], a[180:183], a[188:191], v[192:207]
ds_read_b64_tr_b16 a[150:151], v162 offset:10752
ds_read_b64_tr_b16 a[152:153], v162 offset:18432
ds_read_b64_tr_b16 a[154:155], v162 offset:18944
s_add_u32 m0, s38, 147456
s_add_u32 s30, s27, 1180672
buffer_load_dwordx4 v156, s[68:71], s30 offen offset:0 lds
buffer_load_dwordx4 v157, s[68:71], s30 offen offset:1024 lds
v_accvgpr_write_b32 a78, v26
v_accvgpr_write_b32 a79, v27
v_mul_f32 v32, v254, v32
v_mfma_f32_32x32x16_bf16 v[208:223], a[188:191], a[184:187], v[208:223]
s_add_u32 m0, s38, 155648
s_add_u32 s30, s27, 1181696
buffer_load_dwordx4 v156, s[68:71], s30 offen offset:0 lds
buffer_load_dwordx4 v157, s[68:71], s30 offen offset:1024 lds
v_mul_f32 v33, v254, v33
v_mul_f32 v34, v254, v34
v_mul_f32 v35, v254, v35
v_mul_f32 v36, v254, v36
v_mul_f32 v37, v254, v37
s_waitcnt lgkmcnt(7)
v_mfma_f32_32x32x16_bf16 v[176:191], a[128:131], a[140:143], v[176:191]
ds_read_b128 a[172:175], v160
ds_read_b64_tr_b16 a[160:161], v162 offset:4096
ds_read_b64_tr_b16 a[162:163], v162 offset:4608
ds_read_b64_tr_b16 a[164:165], v162 offset:12288
v_mul_f32 v38, v254, v38
v_mul_f32 v39, v254, v39
v_mfma_f32_32x32x16_bf16 v[192:207], a[132:135], a[140:143], v[192:207]
ds_read_b64_tr_b16 a[166:167], v162 offset:12800
ds_read_b64_tr_b16 a[168:169], v162 offset:20480
ds_read_b64_tr_b16 a[170:171], v162 offset:20992
v_cvt_pk_bf16_f32 v32, v32, v33
v_cvt_pk_bf16_f32 v33, v34, v35
v_cvt_pk_bf16_f32 v34, v36, v37
v_mfma_f32_32x32x16_bf16 v[208:223], a[140:143], a[136:139], v[208:223]
v_cvt_pk_bf16_f32 v35, v38, v39
v_accvgpr_write_b32 a80, v32
v_accvgpr_write_b32 a81, v33
v_accvgpr_write_b32 a82, v34
v_accvgpr_write_b32 a83, v35
v_accvgpr_read_b32 v152, a20
v_accvgpr_read_b32 v153, a21
v_accvgpr_read_b32 v154, a22
v_accvgpr_read_b32 v155, a23
v_accvgpr_read_b32 v148, a16
v_accvgpr_read_b32 v149, a17
v_accvgpr_read_b32 v150, a18
v_accvgpr_read_b32 v151, a19
v_cvt_pk_bf16_f32 v148, v148, v149
v_cvt_pk_bf16_f32 v149, v150, v151
v_cvt_pk_bf16_f32 v150, v152, v153
v_cvt_pk_bf16_f32 v151, v154, v155
s_add_u32 s43, s32, 8192
buffer_store_dwordx4 v[148:151], v252, s[4:7], s43 offen offset:2048 sc1
s_waitcnt lgkmcnt(7)
v_mfma_f32_32x32x16_bf16 v[176:191], a[144:147], a[156:159], v[176:191]
ds_read_b128 a[188:191], v161
ds_read_b64_tr_b16 a[176:177], v162 offset:6144
ds_read_b64_tr_b16 a[178:179], v162 offset:6656
ds_read_b64_tr_b16 a[180:181], v162 offset:14336
v_mul_f32 v40, v254, v40
v_mul_f32 v41, v254, v41
v_mfma_f32_32x32x16_bf16 v[192:207], a[148:151], a[156:159], v[192:207]
ds_read_b64_tr_b16 a[182:183], v162 offset:14848
ds_read_b64_tr_b16 a[184:185], v162 offset:22528
ds_read_b64_tr_b16 a[186:187], v162 offset:23040
v_mul_f32 v42, v254, v42
v_mul_f32 v43, v254, v43
v_mul_f32 v44, v254, v44
v_mfma_f32_32x32x16_bf16 v[208:223], a[156:159], a[152:155], v[208:223]
v_mul_f32 v45, v254, v45
v_mul_f32 v46, v254, v46
v_mul_f32 v47, v254, v47
v_cvt_pk_bf16_f32 v40, v40, v41
v_cvt_pk_bf16_f32 v41, v42, v43
v_add_u32 v158, 0x8000, v158
v_add_u32 v159, 0x8000, v159
v_add_u32 v160, 0x8000, v160
v_add_u32 v161, 0x8000, v161
v_add_u32 v162, 0x8000, v162
s_waitcnt vmcnt(39) lgkmcnt(0)
s_barrier
v_mfma_f32_32x32x16_bf16 v[176:191], a[160:163], a[172:175], v[176:191]
ds_read_b128 a[140:143], v158
ds_read_b64_tr_b16 a[128:129], v162 offset:0
ds_read_b64_tr_b16 a[130:131], v162 offset:512
ds_read_b64_tr_b16 a[132:133], v162 offset:8192
v_cvt_pk_bf16_f32 v42, v44, v45
v_cvt_pk_bf16_f32 v43, v46, v47
v_mfma_f32_32x32x16_bf16 v[192:207], a[164:167], a[172:175], v[192:207]
ds_read_b64_tr_b16 a[134:135], v162 offset:8704
ds_read_b64_tr_b16 a[136:137], v162 offset:16384
ds_read_b64_tr_b16 a[138:139], v162 offset:16896
s_lshr_b32 s38, s29, 2
s_add_u32 m0, s38, 0
s_add_u32 s30, s26, 896
buffer_load_dwordx4 v128, s[64:67], s30 offen offset:0  lds
buffer_load_dwordx4 v129, s[64:67], s30 offen offset:1024  lds
v_accvgpr_write_b32 a84, v40
v_accvgpr_write_b32 a85, v41
v_accvgpr_write_b32 a86, v42
v_mfma_f32_32x32x16_bf16 v[208:223], a[172:175], a[168:171], v[208:223]
s_add_u32 m0, s38, 8192
s_add_u32 s30, s27, 1376256
buffer_load_dwordx4 v156, s[68:71], s30 offen offset:0 lds
buffer_load_dwordx4 v157, s[68:71], s30 offen offset:1024 lds
v_accvgpr_write_b32 a87, v43
v_mul_f32 v48, v254, v48
v_mul_f32 v49, v254, v49
v_mul_f32 v50, v254, v50
v_mul_f32 v51, v254, v51
v_accvgpr_read_b32 v152, a28
v_accvgpr_read_b32 v153, a29
v_accvgpr_read_b32 v154, a30
v_accvgpr_read_b32 v155, a31
v_accvgpr_read_b32 v148, a24
v_accvgpr_read_b32 v149, a25
v_accvgpr_read_b32 v150, a26
v_accvgpr_read_b32 v151, a27
v_cvt_pk_bf16_f32 v148, v148, v149
v_cvt_pk_bf16_f32 v149, v150, v151
v_cvt_pk_bf16_f32 v150, v152, v153
v_cvt_pk_bf16_f32 v151, v154, v155
s_add_u32 s43, s32, 8192
buffer_store_dwordx4 v[148:151], v252, s[4:7], s43 offen offset:3072 sc1
s_waitcnt lgkmcnt(7)
v_mfma_f32_32x32x16_bf16 v[176:191], a[176:179], a[188:191], v[176:191]
ds_read_b128 a[156:159], v159
ds_read_b64_tr_b16 a[144:145], v162 offset:2048
ds_read_b64_tr_b16 a[146:147], v162 offset:2560
ds_read_b64_tr_b16 a[148:149], v162 offset:10240
v_mul_f32 v52, v254, v52
v_mul_f32 v53, v254, v53
v_mfma_f32_32x32x16_bf16 v[192:207], a[180:183], a[188:191], v[192:207]
ds_read_b64_tr_b16 a[150:151], v162 offset:10752
ds_read_b64_tr_b16 a[152:153], v162 offset:18432
ds_read_b64_tr_b16 a[154:155], v162 offset:18944
s_add_u32 m0, s38, 16384
s_add_u32 s30, s27, 1377280
buffer_load_dwordx4 v156, s[68:71], s30 offen offset:0 lds
buffer_load_dwordx4 v157, s[68:71], s30 offen offset:1024 lds
v_mul_f32 v54, v254, v54
v_mul_f32 v55, v254, v55
v_cvt_pk_bf16_f32 v48, v48, v49
v_mfma_f32_32x32x16_bf16 v[208:223], a[188:191], a[184:187], v[208:223]
s_add_u32 m0, s38, 24576
s_add_u32 s30, s27, 1378304
buffer_load_dwordx4 v156, s[68:71], s30 offen offset:0 lds
buffer_load_dwordx4 v157, s[68:71], s30 offen offset:1024 lds
v_cvt_pk_bf16_f32 v49, v50, v51
v_cvt_pk_bf16_f32 v50, v52, v53
v_cvt_pk_bf16_f32 v51, v54, v55
v_accvgpr_write_b32 a88, v48
v_accvgpr_write_b32 a89, v49
s_waitcnt lgkmcnt(7)
v_mfma_f32_32x32x16_bf16 v[176:191], a[128:131], a[140:143], v[176:191]
ds_read_b128 a[172:175], v160
ds_read_b64_tr_b16 a[160:161], v162 offset:4096
ds_read_b64_tr_b16 a[162:163], v162 offset:4608
ds_read_b64_tr_b16 a[164:165], v162 offset:12288
v_accvgpr_write_b32 a90, v50
v_accvgpr_write_b32 a91, v51
v_mfma_f32_32x32x16_bf16 v[192:207], a[132:135], a[140:143], v[192:207]
ds_read_b64_tr_b16 a[166:167], v162 offset:12800
ds_read_b64_tr_b16 a[168:169], v162 offset:20480
ds_read_b64_tr_b16 a[170:171], v162 offset:20992
v_mul_f32 v56, v254, v56
v_mul_f32 v57, v254, v57
v_mul_f32 v58, v254, v58
v_mfma_f32_32x32x16_bf16 v[208:223], a[140:143], a[136:139], v[208:223]
v_mul_f32 v59, v254, v59
v_mul_f32 v60, v254, v60
v_mul_f32 v61, v254, v61
v_mul_f32 v62, v254, v62
v_mul_f32 v63, v254, v63
v_accvgpr_read_b32 v152, a36
v_accvgpr_read_b32 v153, a37
v_accvgpr_read_b32 v154, a38
v_accvgpr_read_b32 v155, a39
v_accvgpr_read_b32 v148, a32
v_accvgpr_read_b32 v149, a33
v_accvgpr_read_b32 v150, a34
v_accvgpr_read_b32 v151, a35
v_cvt_pk_bf16_f32 v148, v148, v149
v_cvt_pk_bf16_f32 v149, v150, v151
v_cvt_pk_bf16_f32 v150, v152, v153
v_cvt_pk_bf16_f32 v151, v154, v155
s_add_u32 s43, s32, 12288
buffer_store_dwordx4 v[148:151], v252, s[4:7], s43 offen offset:0 sc1
s_waitcnt lgkmcnt(7)
v_mfma_f32_32x32x16_bf16 v[176:191], a[144:147], a[156:159], v[176:191]
ds_read_b128 a[188:191], v161
ds_read_b64_tr_b16 a[176:177], v162 offset:6144
ds_read_b64_tr_b16 a[178:179], v162 offset:6656
ds_read_b64_tr_b16 a[180:181], v162 offset:14336
v_cvt_pk_bf16_f32 v56, v56, v57
v_cvt_pk_bf16_f32 v57, v58, v59
v_mfma_f32_32x32x16_bf16 v[192:207], a[148:151], a[156:159], v[192:207]
ds_read_b64_tr_b16 a[182:183], v162 offset:14848
ds_read_b64_tr_b16 a[184:185], v162 offset:22528
ds_read_b64_tr_b16 a[186:187], v162 offset:23040
v_cvt_pk_bf16_f32 v58, v60, v61
v_cvt_pk_bf16_f32 v59, v62, v63
v_accvgpr_write_b32 a92, v56
v_mfma_f32_32x32x16_bf16 v[208:223], a[156:159], a[152:155], v[208:223]
v_accvgpr_write_b32 a93, v57
v_accvgpr_write_b32 a94, v58
v_accvgpr_write_b32 a95, v59
v_mul_f32 v64, v254, v64
v_mul_f32 v65, v254, v65
v_add_u32 v158, 0x8000, v158
v_add_u32 v159, 0x8000, v159
v_add_u32 v160, 0x8000, v160
v_add_u32 v161, 0x8000, v161
v_add_u32 v162, 0x8000, v162
s_waitcnt vmcnt(40) lgkmcnt(0)
s_barrier
v_mfma_f32_32x32x16_bf16 v[176:191], a[160:163], a[172:175], v[176:191]
ds_read_b128 a[140:143], v158
ds_read_b64_tr_b16 a[128:129], v162 offset:0
ds_read_b64_tr_b16 a[130:131], v162 offset:512
ds_read_b64_tr_b16 a[132:133], v162 offset:8192
v_mul_f32 v66, v254, v66
v_mul_f32 v67, v254, v67
v_mfma_f32_32x32x16_bf16 v[192:207], a[164:167], a[172:175], v[192:207]
ds_read_b64_tr_b16 a[134:135], v162 offset:8704
ds_read_b64_tr_b16 a[136:137], v162 offset:16384
ds_read_b64_tr_b16 a[138:139], v162 offset:16896
buffer_load_dword v166, v146, s[4:7], 0 offen offset:0 sc1
v_mul_f32 v68, v254, v68
v_mul_f32 v69, v254, v69
v_mul_f32 v70, v254, v70
v_mfma_f32_32x32x16_bf16 v[208:223], a[172:175], a[168:171], v[208:223]
v_mul_f32 v71, v254, v71
v_cvt_pk_bf16_f32 v64, v64, v65
v_cvt_pk_bf16_f32 v65, v66, v67
v_cvt_pk_bf16_f32 v66, v68, v69
v_cvt_pk_bf16_f32 v67, v70, v71
v_accvgpr_read_b32 v152, a44
v_accvgpr_read_b32 v153, a45
v_accvgpr_read_b32 v154, a46
v_accvgpr_read_b32 v155, a47
v_accvgpr_read_b32 v148, a40
v_accvgpr_read_b32 v149, a41
v_accvgpr_read_b32 v150, a42
v_accvgpr_read_b32 v151, a43
v_cvt_pk_bf16_f32 v148, v148, v149
v_cvt_pk_bf16_f32 v149, v150, v151
v_cvt_pk_bf16_f32 v150, v152, v153
v_cvt_pk_bf16_f32 v151, v154, v155
s_add_u32 s43, s32, 12288
buffer_store_dwordx4 v[148:151], v252, s[4:7], s43 offen offset:1024 sc1
s_waitcnt lgkmcnt(7)
v_mfma_f32_32x32x16_bf16 v[176:191], a[176:179], a[188:191], v[176:191]
ds_read_b128 a[156:159], v159
ds_read_b64_tr_b16 a[144:145], v162 offset:2048
ds_read_b64_tr_b16 a[146:147], v162 offset:2560
ds_read_b64_tr_b16 a[148:149], v162 offset:10240
v_accvgpr_write_b32 a96, v64
v_accvgpr_write_b32 a97, v65
v_mfma_f32_32x32x16_bf16 v[192:207], a[180:183], a[188:191], v[192:207]
ds_read_b64_tr_b16 a[150:151], v162 offset:10752
ds_read_b64_tr_b16 a[152:153], v162 offset:18432
ds_read_b64_tr_b16 a[154:155], v162 offset:18944
v_accvgpr_write_b32 a98, v66
v_accvgpr_write_b32 a99, v67
v_accvgpr_write_b32 a208, v64
v_mfma_f32_32x32x16_bf16 v[208:223], a[188:191], a[184:187], v[208:223]
v_accvgpr_write_b32 a209, v65
v_accvgpr_write_b32 a210, v66
v_accvgpr_write_b32 a211, v67
v_mul_f32 v72, v254, v72
v_mul_f32 v73, v254, v73
s_waitcnt lgkmcnt(7)
v_mfma_f32_32x32x16_bf16 v[176:191], a[128:131], a[140:143], v[176:191]
ds_read_b128 a[172:175], v160
ds_read_b64_tr_b16 a[160:161], v162 offset:4096
ds_read_b64_tr_b16 a[162:163], v162 offset:4608
ds_read_b64_tr_b16 a[164:165], v162 offset:12288
v_mul_f32 v74, v254, v74
v_mul_f32 v75, v254, v75
v_mfma_f32_32x32x16_bf16 v[192:207], a[132:135], a[140:143], v[192:207]
ds_read_b64_tr_b16 a[166:167], v162 offset:12800
ds_read_b64_tr_b16 a[168:169], v162 offset:20480
ds_read_b64_tr_b16 a[170:171], v162 offset:20992
v_mul_f32 v76, v254, v76
v_mul_f32 v77, v254, v77
v_mul_f32 v78, v254, v78
v_mfma_f32_32x32x16_bf16 v[208:223], a[140:143], a[136:139], v[208:223]
v_mul_f32 v79, v254, v79
v_cvt_pk_bf16_f32 v72, v72, v73
v_cvt_pk_bf16_f32 v73, v74, v75
v_cvt_pk_bf16_f32 v74, v76, v77
v_cvt_pk_bf16_f32 v75, v78, v79
v_accvgpr_read_b32 v152, a52
v_accvgpr_read_b32 v153, a53
v_accvgpr_read_b32 v154, a54
v_accvgpr_read_b32 v155, a55
v_accvgpr_read_b32 v148, a48
v_accvgpr_read_b32 v149, a49
v_accvgpr_read_b32 v150, a50
v_accvgpr_read_b32 v151, a51
v_cvt_pk_bf16_f32 v148, v148, v149
v_cvt_pk_bf16_f32 v149, v150, v151
v_cvt_pk_bf16_f32 v150, v152, v153
v_cvt_pk_bf16_f32 v151, v154, v155
s_add_u32 s43, s32, 12288
buffer_store_dwordx4 v[148:151], v252, s[4:7], s43 offen offset:2048 sc1
s_waitcnt lgkmcnt(7)
v_mfma_f32_32x32x16_bf16 v[176:191], a[144:147], a[156:159], v[176:191]
ds_read_b128 a[188:191], v161
ds_read_b64_tr_b16 a[176:177], v162 offset:6144
ds_read_b64_tr_b16 a[178:179], v162 offset:6656
ds_read_b64_tr_b16 a[180:181], v162 offset:14336
v_accvgpr_write_b32 a100, v72
v_accvgpr_write_b32 a101, v73
v_mfma_f32_32x32x16_bf16 v[192:207], a[148:151], a[156:159], v[192:207]
ds_read_b64_tr_b16 a[182:183], v162 offset:14848
ds_read_b64_tr_b16 a[184:185], v162 offset:22528
ds_read_b64_tr_b16 a[186:187], v162 offset:23040
v_accvgpr_write_b32 a102, v74
v_accvgpr_write_b32 a103, v75
v_accvgpr_write_b32 a212, v72
v_mfma_f32_32x32x16_bf16 v[208:223], a[156:159], a[152:155], v[208:223]
v_accvgpr_write_b32 a213, v73
v_accvgpr_write_b32 a214, v74
v_accvgpr_write_b32 a215, v75
v_mul_f32 v80, v254, v80
v_mul_f32 v81, v254, v81
v_add_u32 v158, 0x8000, v158
v_add_u32 v159, 0x8000, v159
v_add_u32 v160, 0x8000, v160
v_add_u32 v161, 0x8000, v161
v_add_u32 v162, 0x8000, v162
s_waitcnt vmcnt(24) lgkmcnt(0)
s_barrier
v_mfma_f32_32x32x16_bf16 v[176:191], a[160:163], a[172:175], v[176:191]
ds_read_b128 a[140:143], v158
ds_read_b64_tr_b16 a[128:129], v162 offset:0
ds_read_b64_tr_b16 a[130:131], v162 offset:512
ds_read_b64_tr_b16 a[132:133], v162 offset:8192
v_mul_f32 v82, v254, v82
v_mul_f32 v83, v254, v83
v_mfma_f32_32x32x16_bf16 v[192:207], a[164:167], a[172:175], v[192:207]
ds_read_b64_tr_b16 a[134:135], v162 offset:8704
ds_read_b64_tr_b16 a[136:137], v162 offset:16384
ds_read_b64_tr_b16 a[138:139], v162 offset:16896
v_mul_f32 v84, v254, v84
v_mul_f32 v85, v254, v85
v_mul_f32 v86, v254, v86
v_mfma_f32_32x32x16_bf16 v[208:223], a[172:175], a[168:171], v[208:223]
v_mul_f32 v87, v254, v87
v_cvt_pk_bf16_f32 v80, v80, v81
v_cvt_pk_bf16_f32 v81, v82, v83
v_cvt_pk_bf16_f32 v82, v84, v85
v_cvt_pk_bf16_f32 v83, v86, v87
v_accvgpr_read_b32 v152, a60
v_accvgpr_read_b32 v153, a61
v_accvgpr_read_b32 v154, a62
v_accvgpr_read_b32 v155, a63
v_accvgpr_read_b32 v148, a56
v_accvgpr_read_b32 v149, a57
v_accvgpr_read_b32 v150, a58
v_accvgpr_read_b32 v151, a59
v_cvt_pk_bf16_f32 v148, v148, v149
v_cvt_pk_bf16_f32 v149, v150, v151
v_cvt_pk_bf16_f32 v150, v152, v153
v_cvt_pk_bf16_f32 v151, v154, v155
s_add_u32 s43, s32, 12288
buffer_store_dwordx4 v[148:151], v252, s[4:7], s43 offen offset:3072 sc1
s_waitcnt lgkmcnt(7)
v_mfma_f32_32x32x16_bf16 v[176:191], a[176:179], a[188:191], v[176:191]
ds_read_b128 a[156:159], v159
ds_read_b64_tr_b16 a[144:145], v162 offset:2048
ds_read_b64_tr_b16 a[146:147], v162 offset:2560
ds_read_b64_tr_b16 a[148:149], v162 offset:10240
v_accvgpr_write_b32 a104, v80
v_accvgpr_write_b32 a105, v81
v_mfma_f32_32x32x16_bf16 v[192:207], a[180:183], a[188:191], v[192:207]
ds_read_b64_tr_b16 a[150:151], v162 offset:10752
ds_read_b64_tr_b16 a[152:153], v162 offset:18432
ds_read_b64_tr_b16 a[154:155], v162 offset:18944
v_accvgpr_write_b32 a106, v82
v_accvgpr_write_b32 a107, v83
v_accvgpr_write_b32 a216, v80
v_mfma_f32_32x32x16_bf16 v[208:223], a[188:191], a[184:187], v[208:223]
v_accvgpr_write_b32 a217, v81
v_accvgpr_write_b32 a218, v82
v_accvgpr_write_b32 a219, v83
v_mul_f32 v88, v254, v88
v_mul_f32 v89, v254, v89
s_waitcnt lgkmcnt(7)
v_mfma_f32_32x32x16_bf16 v[176:191], a[128:131], a[140:143], v[176:191]
ds_read_b128 a[172:175], v160
ds_read_b64_tr_b16 a[160:161], v162 offset:4096
ds_read_b64_tr_b16 a[162:163], v162 offset:4608
ds_read_b64_tr_b16 a[164:165], v162 offset:12288
v_mul_f32 v90, v254, v90
v_mul_f32 v91, v254, v91
v_mfma_f32_32x32x16_bf16 v[192:207], a[132:135], a[140:143], v[192:207]
ds_read_b64_tr_b16 a[166:167], v162 offset:12800
ds_read_b64_tr_b16 a[168:169], v162 offset:20480
ds_read_b64_tr_b16 a[170:171], v162 offset:20992
v_mul_f32 v92, v254, v92
v_mul_f32 v93, v254, v93
v_mul_f32 v94, v254, v94
v_mfma_f32_32x32x16_bf16 v[208:223], a[140:143], a[136:139], v[208:223]
v_mul_f32 v95, v254, v95
v_cvt_pk_bf16_f32 v88, v88, v89
v_cvt_pk_bf16_f32 v89, v90, v91
v_cvt_pk_bf16_f32 v90, v92, v93
v_cvt_pk_bf16_f32 v91, v94, v95
s_waitcnt lgkmcnt(7)
v_mfma_f32_32x32x16_bf16 v[176:191], a[144:147], a[156:159], v[176:191]
ds_read_b128 a[188:191], v161
ds_read_b64_tr_b16 a[176:177], v162 offset:6144
ds_read_b64_tr_b16 a[178:179], v162 offset:6656
ds_read_b64_tr_b16 a[180:181], v162 offset:14336
v_accvgpr_write_b32 a108, v88
v_accvgpr_write_b32 a109, v89
v_mfma_f32_32x32x16_bf16 v[192:207], a[148:151], a[156:159], v[192:207]
ds_read_b64_tr_b16 a[182:183], v162 offset:14848
ds_read_b64_tr_b16 a[184:185], v162 offset:22528
ds_read_b64_tr_b16 a[186:187], v162 offset:23040
v_accvgpr_write_b32 a110, v90
v_accvgpr_write_b32 a111, v91
v_accvgpr_write_b32 a220, v88
v_mfma_f32_32x32x16_bf16 v[208:223], a[156:159], a[152:155], v[208:223]
v_accvgpr_write_b32 a221, v89
v_accvgpr_write_b32 a222, v90
v_accvgpr_write_b32 a223, v91
v_mul_f32 v96, v254, v96
v_mul_f32 v97, v254, v97
v_add_u32 v158, 0x8000, v158
v_add_u32 v159, 0x8000, v159
v_add_u32 v160, 0x8000, v160
v_add_u32 v161, 0x8000, v161
v_add_u32 v162, 0x8000, v162
s_waitcnt vmcnt(3) lgkmcnt(0)
s_cmp_eq_u32 s20, 0
s_cbranch_scc0 KA_rdyK
v_cmp_ne_u32 vcc, 1, v166
s_mov_b32 s37, 0
s_nop 3
s_cbranch_vccz KA_rdyK
KA_pollK:
s_sleep 2
buffer_load_dword v166, v146, s[4:7], 0 offen offset:0 sc1
s_waitcnt vmcnt(0)
v_cmp_ne_u32 vcc, 1, v166
s_add_u32 s37, s37, 1
s_nop 3
s_cbranch_vccz KA_rdyK
s_cmp_lt_u32 s37, 0x40000
s_cbranch_scc1 KA_pollK
KA_rdyK:
s_barrier
v_mfma_f32_32x32x16_bf16 v[176:191], a[160:163], a[172:175], v[176:191]
ds_read_b128 a[140:143], v158
ds_read_b64_tr_b16 a[128:129], v162 offset:0
ds_read_b64_tr_b16 a[130:131], v162 offset:512
ds_read_b64_tr_b16 a[132:133], v162 offset:8192
v_mul_f32 v98, v254, v98
v_mul_f32 v99, v254, v99
v_mfma_f32_32x32x16_bf16 v[192:207], a[164:167], a[172:175], v[192:207]
ds_read_b64_tr_b16 a[134:135], v162 offset:8704
ds_read_b64_tr_b16 a[136:137], v162 offset:16384
ds_read_b64_tr_b16 a[138:139], v162 offset:16896
s_add_u32 m0, s29, 98304
s_add_u32 s30, s25, 0x1000
buffer_load_dwordx4 v252, s[16:19], s25 offen offset:0 sc1 lds
v_mul_f32 v100, v254, v100
v_mul_f32 v101, v254, v101
v_mul_f32 v102, v254, v102
v_mfma_f32_32x32x16_bf16 v[208:223], a[172:175], a[168:171], v[208:223]
buffer_load_dwordx4 v252, s[16:19], s25 offen offset:1024 sc1 lds
v_mul_f32 v103, v254, v103
v_cvt_pk_bf16_f32 v96, v96, v97
v_cvt_pk_bf16_f32 v97, v98, v99
v_cvt_pk_bf16_f32 v98, v100, v101
v_cvt_pk_bf16_f32 v99, v102, v103
s_waitcnt lgkmcnt(7)
v_mfma_f32_32x32x16_bf16 v[176:191], a[176:179], a[188:191], v[176:191]
ds_read_b128 a[156:159], v159
ds_read_b64_tr_b16 a[144:145], v162 offset:2048
ds_read_b64_tr_b16 a[146:147], v162 offset:2560
ds_read_b64_tr_b16 a[148:149], v162 offset:10240
v_accvgpr_write_b32 a112, v96
v_accvgpr_write_b32 a113, v97
v_mfma_f32_32x32x16_bf16 v[192:207], a[180:183], a[188:191], v[192:207]
ds_read_b64_tr_b16 a[150:151], v162 offset:10752
ds_read_b64_tr_b16 a[152:153], v162 offset:18432
ds_read_b64_tr_b16 a[154:155], v162 offset:18944
buffer_load_dwordx4 v252, s[16:19], s25 offen offset:2048 sc1 lds
v_accvgpr_write_b32 a114, v98
v_accvgpr_write_b32 a115, v99
v_accvgpr_write_b32 a224, v96
v_mfma_f32_32x32x16_bf16 v[208:223], a[188:191], a[184:187], v[208:223]
buffer_load_dwordx4 v252, s[16:19], s25 offen offset:3072 sc1 lds
v_accvgpr_write_b32 a225, v97
v_accvgpr_write_b32 a226, v98
v_accvgpr_write_b32 a227, v99
v_mul_f32 v104, v254, v104
v_mul_f32 v105, v254, v105
s_waitcnt lgkmcnt(7)
v_mfma_f32_32x32x16_bf16 v[176:191], a[128:131], a[140:143], v[176:191]
ds_read_b128 a[172:175], v160
ds_read_b64_tr_b16 a[160:161], v162 offset:4096
ds_read_b64_tr_b16 a[162:163], v162 offset:4608
ds_read_b64_tr_b16 a[164:165], v162 offset:12288
v_mul_f32 v106, v254, v106
v_mul_f32 v107, v254, v107
v_mfma_f32_32x32x16_bf16 v[192:207], a[132:135], a[140:143], v[192:207]
ds_read_b64_tr_b16 a[166:167], v162 offset:12800
ds_read_b64_tr_b16 a[168:169], v162 offset:20480
ds_read_b64_tr_b16 a[170:171], v162 offset:20992
s_add_u32 m0, m0, 0x1000
s_add_u32 s25, s25, 0x8000
buffer_load_dwordx4 v252, s[16:19], s30 offen offset:0 sc1 lds
v_mul_f32 v108, v254, v108
v_mul_f32 v109, v254, v109
v_mul_f32 v110, v254, v110
v_mfma_f32_32x32x16_bf16 v[208:223], a[140:143], a[136:139], v[208:223]
buffer_load_dwordx4 v252, s[16:19], s30 offen offset:1024 sc1 lds
v_mul_f32 v111, v254, v111
v_cvt_pk_bf16_f32 v104, v104, v105
v_cvt_pk_bf16_f32 v105, v106, v107
v_cvt_pk_bf16_f32 v106, v108, v109
v_cvt_pk_bf16_f32 v107, v110, v111
s_waitcnt lgkmcnt(7)
v_mfma_f32_32x32x16_bf16 v[176:191], a[144:147], a[156:159], v[176:191]
ds_read_b128 a[188:191], v161
ds_read_b64_tr_b16 a[176:177], v162 offset:6144
ds_read_b64_tr_b16 a[178:179], v162 offset:6656
ds_read_b64_tr_b16 a[180:181], v162 offset:14336
v_accvgpr_write_b32 a116, v104
v_accvgpr_write_b32 a117, v105
v_mfma_f32_32x32x16_bf16 v[192:207], a[148:151], a[156:159], v[192:207]
ds_read_b64_tr_b16 a[182:183], v162 offset:14848
ds_read_b64_tr_b16 a[184:185], v162 offset:22528
ds_read_b64_tr_b16 a[186:187], v162 offset:23040
buffer_load_dwordx4 v252, s[16:19], s30 offen offset:2048 sc1 lds
v_accvgpr_write_b32 a118, v106
v_accvgpr_write_b32 a119, v107
v_accvgpr_write_b32 a228, v104
v_mfma_f32_32x32x16_bf16 v[208:223], a[156:159], a[152:155], v[208:223]
buffer_load_dwordx4 v252, s[16:19], s30 offen offset:3072 sc1 lds
s_sub_u32 s25, s25, s48
v_accvgpr_write_b32 a229, v105
v_accvgpr_write_b32 a230, v106
v_accvgpr_write_b32 a231, v107
v_mul_f32 v112, v254, v112
v_mul_f32 v113, v254, v113
v_add_u32 v158, 0xfffe0000, v158
v_add_u32 v159, 0xfffe0000, v159
v_add_u32 v160, 0xfffe0000, v160
v_add_u32 v161, 0xfffe0000, v161
v_add_u32 v162, 0xfffe0000, v162
s_waitcnt vmcnt(13) lgkmcnt(0)
s_barrier
v_mfma_f32_32x32x16_bf16 v[176:191], a[160:163], a[172:175], v[176:191]
ds_read_b128 a[140:143], v158
ds_read_b64_tr_b16 a[128:129], v162 offset:0
ds_read_b64_tr_b16 a[130:131], v162 offset:512
ds_read_b64_tr_b16 a[132:133], v162 offset:8192
v_mul_f32 v114, v254, v114
v_mul_f32 v115, v254, v115
v_mfma_f32_32x32x16_bf16 v[192:207], a[164:167], a[172:175], v[192:207]
ds_read_b64_tr_b16 a[134:135], v162 offset:8704
ds_read_b64_tr_b16 a[136:137], v162 offset:16384
ds_read_b64_tr_b16 a[138:139], v162 offset:16896
s_add_u32 m0, s29, 131072
s_add_u32 s30, s25, 0x1000
buffer_load_dwordx4 v252, s[16:19], s25 offen offset:0 sc1 lds
v_mul_f32 v116, v254, v116
v_mul_f32 v117, v254, v117
v_mul_f32 v118, v254, v118
v_mfma_f32_32x32x16_bf16 v[208:223], a[172:175], a[168:171], v[208:223]
buffer_load_dwordx4 v252, s[16:19], s25 offen offset:1024 sc1 lds
v_mul_f32 v119, v254, v119
v_cvt_pk_bf16_f32 v112, v112, v113
v_cvt_pk_bf16_f32 v113, v114, v115
v_cvt_pk_bf16_f32 v114, v116, v117
v_cvt_pk_bf16_f32 v115, v118, v119
s_waitcnt lgkmcnt(7)
v_mfma_f32_32x32x16_bf16 v[176:191], a[176:179], a[188:191], v[176:191]
ds_read_b128 a[156:159], v159
ds_read_b64_tr_b16 a[144:145], v162 offset:2048
ds_read_b64_tr_b16 a[146:147], v162 offset:2560
ds_read_b64_tr_b16 a[148:149], v162 offset:10240
v_accvgpr_write_b32 a120, v112
v_accvgpr_write_b32 a121, v113
v_mfma_f32_32x32x16_bf16 v[192:207], a[180:183], a[188:191], v[192:207]
ds_read_b64_tr_b16 a[150:151], v162 offset:10752
ds_read_b64_tr_b16 a[152:153], v162 offset:18432
ds_read_b64_tr_b16 a[154:155], v162 offset:18944
buffer_load_dwordx4 v252, s[16:19], s25 offen offset:2048 sc1 lds
v_accvgpr_write_b32 a122, v114
v_accvgpr_write_b32 a123, v115
v_accvgpr_write_b32 a232, v112
v_mfma_f32_32x32x16_bf16 v[208:223], a[188:191], a[184:187], v[208:223]
buffer_load_dwordx4 v252, s[16:19], s25 offen offset:3072 sc1 lds
v_accvgpr_write_b32 a233, v113
v_accvgpr_write_b32 a234, v114
v_accvgpr_write_b32 a235, v115
v_mul_f32 v120, v254, v120
v_mul_f32 v121, v254, v121
s_waitcnt lgkmcnt(7)
v_mfma_f32_32x32x16_bf16 v[176:191], a[128:131], a[140:143], v[176:191]
ds_read_b128 a[172:175], v160
ds_read_b64_tr_b16 a[160:161], v162 offset:4096
ds_read_b64_tr_b16 a[162:163], v162 offset:4608
ds_read_b64_tr_b16 a[164:165], v162 offset:12288
v_mul_f32 v122, v254, v122
v_mul_f32 v123, v254, v123
v_mfma_f32_32x32x16_bf16 v[192:207], a[132:135], a[140:143], v[192:207]
ds_read_b64_tr_b16 a[166:167], v162 offset:12800
ds_read_b64_tr_b16 a[168:169], v162 offset:20480
ds_read_b64_tr_b16 a[170:171], v162 offset:20992
s_add_u32 m0, m0, 0x1000
s_add_u32 s25, s25, 0x8000
buffer_load_dwordx4 v252, s[16:19], s30 offen offset:0 sc1 lds
v_mul_f32 v124, v254, v124
v_mul_f32 v125, v254, v125
v_mul_f32 v126, v254, v126
v_mfma_f32_32x32x16_bf16 v[208:223], a[140:143], a[136:139], v[208:223]
buffer_load_dwordx4 v252, s[16:19], s30 offen offset:1024 sc1 lds
v_mul_f32 v127, v254, v127
v_cvt_pk_bf16_f32 v120, v120, v121
v_cvt_pk_bf16_f32 v121, v122, v123
v_cvt_pk_bf16_f32 v122, v124, v125
v_cvt_pk_bf16_f32 v123, v126, v127
s_waitcnt lgkmcnt(7)
v_mfma_f32_32x32x16_bf16 v[176:191], a[144:147], a[156:159], v[176:191]
ds_read_b128 a[188:191], v161
ds_read_b64_tr_b16 a[176:177], v162 offset:6144
ds_read_b64_tr_b16 a[178:179], v162 offset:6656
ds_read_b64_tr_b16 a[180:181], v162 offset:14336
v_accvgpr_write_b32 a124, v120
v_accvgpr_write_b32 a125, v121
v_mfma_f32_32x32x16_bf16 v[192:207], a[148:151], a[156:159], v[192:207]
ds_read_b64_tr_b16 a[182:183], v162 offset:14848
ds_read_b64_tr_b16 a[184:185], v162 offset:22528
ds_read_b64_tr_b16 a[186:187], v162 offset:23040
buffer_load_dwordx4 v252, s[16:19], s30 offen offset:2048 sc1 lds
v_accvgpr_write_b32 a126, v122
v_accvgpr_write_b32 a127, v123
v_accvgpr_write_b32 a236, v120
v_mfma_f32_32x32x16_bf16 v[208:223], a[156:159], a[152:155], v[208:223]
buffer_load_dwordx4 v252, s[16:19], s30 offen offset:3072 sc1 lds
s_sub_u32 s25, s25, s48
s_mov_b32 s18, s42
v_accvgpr_write_b32 a237, v121
v_accvgpr_write_b32 a238, v122
v_accvgpr_write_b32 a239, v123
s_waitcnt vmcnt(16) lgkmcnt(0)
s_barrier
v_mfma_f32_32x32x16_bf16 v[176:191], a[160:163], a[172:175], v[176:191]
v_mfma_f32_32x32x16_bf16 v[192:207], a[164:167], a[172:175], v[192:207]
buffer_store_dword v165, v164, s[4:7], 0 offen offset:32 sc1
v_mfma_f32_32x32x16_bf16 v[208:223], a[172:175], a[168:171], v[208:223]
s_waitcnt lgkmcnt(0)
v_mfma_f32_32x32x16_bf16 v[176:191], a[176:179], a[188:191], v[176:191]
v_mfma_f32_32x32x16_bf16 v[192:207], a[180:183], a[188:191], v[192:207]
v_mfma_f32_32x32x16_bf16 v[208:223], a[188:191], a[184:187], v[208:223]
v_accvgpr_write_b32 a255, v255
v_bfe_u32 v240, v253, 4, 1
v_mul_u32_u24 v240, 0x8000, v240
v_lshl_or_b32 v240, v240, 16, v240
v_lshl_or_b32 v168, v225, 16, v224
v_lshl_or_b32 v169, v227, 16, v226
v_lshl_or_b32 v170, v229, 16, v228
v_lshl_or_b32 v171, v231, 16, v230
v_lshl_or_b32 v172, v233, 16, v232
v_lshl_or_b32 v173, v235, 16, v234
v_lshl_or_b32 v174, v237, 16, v236
v_lshl_or_b32 v175, v239, 16, v238
v_xor_b32 v168, v240, v168
v_xor_b32 v169, v240, v169
v_xor_b32 v170, v240, v170
v_xor_b32 v171, v240, v171
v_xor_b32 v172, v240, v172
v_xor_b32 v173, v240, v173
v_xor_b32 v174, v240, v174
v_xor_b32 v175, v240, v175
s_mov_b32 s39, 0x3fb8aa3b
v_mov_b32 v136, 0x3fb8aa3b
s_and_b32 s37, s20, 1
s_lshl_b32 s37, s37, 13
s_lshr_b32 s38, s20, 1
s_lshl_b32 s38, s38, 11
s_add_u32 s37, s37, s38
s_add_u32 s37, s37, 65536
v_and_b32 v242, 31, v253
v_lshlrev_b32 v242, 6, v242
v_lshrrev_b32 v243, 5, v253
v_lshl_add_u32 v242, v243, 3, v242
v_add_u32 v242, s37, v242
s_lshr_b32 s37, s29, 2
s_add_u32 s37, s37, 65536
v_add_u32 v243, s37, v252
v_cvt_pk_bf16_f32 v112, v176, v177
v_cvt_pk_bf16_f32 v120, v192, v193
v_cvt_pk_bf16_f32 v113, v178, v179
v_cvt_pk_bf16_f32 v121, v194, v195
v_cvt_pk_bf16_f32 v114, v180, v181
v_cvt_pk_bf16_f32 v122, v196, v197
v_cvt_pk_bf16_f32 v115, v182, v183
v_cvt_pk_bf16_f32 v123, v198, v199
v_cvt_pk_bf16_f32 v116, v184, v185
v_cvt_pk_bf16_f32 v124, v200, v201
v_cvt_pk_bf16_f32 v117, v186, v187
v_cvt_pk_bf16_f32 v125, v202, v203
v_cvt_pk_bf16_f32 v118, v188, v189
v_cvt_pk_bf16_f32 v126, v204, v205
v_cvt_pk_bf16_f32 v119, v190, v191
v_cvt_pk_bf16_f32 v127, v206, v207
v_cvt_pk_bf16_f32 v148, v208, v209
v_cvt_pk_bf16_f32 v149, v210, v211
v_cvt_pk_bf16_f32 v150, v212, v213
v_cvt_pk_bf16_f32 v151, v214, v215
v_cvt_pk_bf16_f32 v152, v216, v217
v_cvt_pk_bf16_f32 v153, v218, v219
v_cvt_pk_bf16_f32 v154, v220, v221
v_cvt_pk_bf16_f32 v155, v222, v223
ds_write_b128 v243, v[148:151] offset:16384
ds_write_b128 v243, v[152:155] offset:17408
v_mfma_f32_32x32x16_bf16 v[32:47], v[168:171], v[120:123], 0
v_mfma_f32_32x32x16_bf16 v[48:63], v[172:175], v[124:127], 0
v_mfma_f32_32x32x16_bf16 v[64:79], v[168:171], v[112:115], 0
v_mfma_f32_32x32x16_bf16 v[80:95], v[172:175], v[116:119], 0
s_add_u32 s30, s31, 65536
v_bfe_u32 v244, v253, 2, 2
v_lshrrev_b32 v245, 5, v253
v_lshl_add_u32 v244, v245, 2, v244
v_lshlrev_b32 v244, 6, v244
v_bfe_u32 v245, v253, 4, 1
v_lshl_add_u32 v244, v245, 5, v244
v_and_b32 v245, 3, v253
v_lshl_add_u32 v244, v245, 3, v244
v_add_u32 v244, s30, v244
s_lshr_b32 s30, s20, 1
s_lshl_b32 s30, s30, 11
s_and_b32 s43, s20, 1
s_lshl_b32 s43, s43, 8
s_add_u32 s30, s30, s43
s_add_u32 s30, s30, 65536
v_and_b32 v245, 0x2ff, v252
v_add_u32 v245, s30, v245
v_max3_f32 v128, v32, v33, v34
v_max3_f32 v130, v40, v41, v42
v_max3_f32 v128, v128, v35, v36
v_max3_f32 v130, v130, v43, v44
v_max3_f32 v128, v128, v37, v38
v_max3_f32 v130, v130, v45, v46
v_max_f32 v128, v128, v39
v_max_f32 v130, v130, v47
v_mov_b32 v132, v128
v_mov_b32 v134, v130
s_nop 0
v_permlane32_swap_b32 v128, v132
v_permlane32_swap_b32 v130, v134
v_max_f32 v128, v128, v132
v_max_f32 v130, v130, v134
v_mul_f32 v128, s39, v128
v_mul_f32 v130, s39, v130
v_pk_fma_f32 v[32:33], v[32:33], v[136:137], v[128:129] op_sel_hi:[1,0,0] neg_lo:[0,0,1] neg_hi:[0,0,1]
v_pk_fma_f32 v[40:41], v[40:41], v[136:137], v[130:131] op_sel_hi:[1,0,0] neg_lo:[0,0,1] neg_hi:[0,0,1]
v_pk_fma_f32 v[34:35], v[34:35], v[136:137], v[128:129] op_sel_hi:[1,0,0] neg_lo:[0,0,1] neg_hi:[0,0,1]
v_pk_fma_f32 v[42:43], v[42:43], v[136:137], v[130:131] op_sel_hi:[1,0,0] neg_lo:[0,0,1] neg_hi:[0,0,1]
v_pk_fma_f32 v[36:37], v[36:37], v[136:137], v[128:129] op_sel_hi:[1,0,0] neg_lo:[0,0,1] neg_hi:[0,0,1]
v_pk_fma_f32 v[44:45], v[44:45], v[136:137], v[130:131] op_sel_hi:[1,0,0] neg_lo:[0,0,1] neg_hi:[0,0,1]
v_pk_fma_f32 v[38:39], v[38:39], v[136:137], v[128:129] op_sel_hi:[1,0,0] neg_lo:[0,0,1] neg_hi:[0,0,1]
v_pk_fma_f32 v[46:47], v[46:47], v[136:137], v[130:131] op_sel_hi:[1,0,0] neg_lo:[0,0,1] neg_hi:[0,0,1]
v_exp_f32 v32, v32
v_exp_f32 v40, v40
v_exp_f32 v33, v33
v_exp_f32 v41, v41
v_exp_f32 v34, v34
v_exp_f32 v42, v42
v_exp_f32 v35, v35
v_exp_f32 v43, v43
v_exp_f32 v36, v36
v_exp_f32 v44, v44
v_exp_f32 v37, v37
v_exp_f32 v45, v45
v_exp_f32 v38, v38
v_exp_f32 v46, v46
v_exp_f32 v39, v39
v_exp_f32 v47, v47
v_pk_add_f32 v[128:129], v[32:33], v[34:35]
v_pk_add_f32 v[130:131], v[40:41], v[42:43]
v_pk_add_f32 v[132:133], v[36:37], v[38:39]
v_pk_add_f32 v[134:135], v[44:45], v[46:47]
v_pk_add_f32 v[128:129], v[128:129], v[132:133]
v_pk_add_f32 v[130:131], v[130:131], v[134:135]
v_add_f32 v128, v128, v129
v_add_f32 v130, v130, v131
v_mov_b32 v132, v128
v_mov_b32 v134, v130
s_nop 0
v_permlane32_swap_b32 v128, v132
v_permlane32_swap_b32 v130, v134
v_add_f32 v128, v128, v132
v_add_f32 v130, v130, v134
v_rcp_f32 v128, v128
v_rcp_f32 v130, v130
v_pk_mul_f32 v[32:33], v[32:33], v[128:129] op_sel_hi:[1,0]
v_pk_mul_f32 v[40:41], v[40:41], v[130:131] op_sel_hi:[1,0]
v_pk_mul_f32 v[34:35], v[34:35], v[128:129] op_sel_hi:[1,0]
v_pk_mul_f32 v[42:43], v[42:43], v[130:131] op_sel_hi:[1,0]
v_pk_mul_f32 v[36:37], v[36:37], v[128:129] op_sel_hi:[1,0]
v_pk_mul_f32 v[44:45], v[44:45], v[130:131] op_sel_hi:[1,0]
v_pk_mul_f32 v[38:39], v[38:39], v[128:129] op_sel_hi:[1,0]
v_pk_mul_f32 v[46:47], v[46:47], v[130:131] op_sel_hi:[1,0]
v_cvt_pk_bf16_f32 v96, v32, v33
v_cvt_pk_bf16_f32 v97, v34, v35
v_cvt_pk_bf16_f32 v98, v36, v37
v_cvt_pk_bf16_f32 v99, v38, v39
v_cvt_pk_bf16_f32 v100, v40, v41
v_cvt_pk_bf16_f32 v101, v42, v43
v_cvt_pk_bf16_f32 v102, v44, v45
v_cvt_pk_bf16_f32 v103, v46, v47
ds_write_b64 v242, v[96:97] offset:0
ds_write_b64 v242, v[98:99] offset:16
ds_write_b64 v242, v[100:101] offset:32
ds_write_b64 v242, v[102:103] offset:48
v_max3_f32 v128, v48, v49, v50
v_max3_f32 v130, v56, v57, v58
v_max3_f32 v128, v128, v51, v52
v_max3_f32 v130, v130, v59, v60
v_max3_f32 v128, v128, v53, v54
v_max3_f32 v130, v130, v61, v62
v_max_f32 v128, v128, v55
v_max_f32 v130, v130, v63
v_mov_b32 v132, v128
v_mov_b32 v134, v130
s_nop 0
v_permlane32_swap_b32 v128, v132
v_permlane32_swap_b32 v130, v134
v_max_f32 v128, v128, v132
v_max_f32 v130, v130, v134
v_mul_f32 v128, s39, v128
v_mul_f32 v130, s39, v130
v_pk_fma_f32 v[48:49], v[48:49], v[136:137], v[128:129] op_sel_hi:[1,0,0] neg_lo:[0,0,1] neg_hi:[0,0,1]
v_pk_fma_f32 v[56:57], v[56:57], v[136:137], v[130:131] op_sel_hi:[1,0,0] neg_lo:[0,0,1] neg_hi:[0,0,1]
v_pk_fma_f32 v[50:51], v[50:51], v[136:137], v[128:129] op_sel_hi:[1,0,0] neg_lo:[0,0,1] neg_hi:[0,0,1]
v_pk_fma_f32 v[58:59], v[58:59], v[136:137], v[130:131] op_sel_hi:[1,0,0] neg_lo:[0,0,1] neg_hi:[0,0,1]
v_pk_fma_f32 v[52:53], v[52:53], v[136:137], v[128:129] op_sel_hi:[1,0,0] neg_lo:[0,0,1] neg_hi:[0,0,1]
v_pk_fma_f32 v[60:61], v[60:61], v[136:137], v[130:131] op_sel_hi:[1,0,0] neg_lo:[0,0,1] neg_hi:[0,0,1]
v_pk_fma_f32 v[54:55], v[54:55], v[136:137], v[128:129] op_sel_hi:[1,0,0] neg_lo:[0,0,1] neg_hi:[0,0,1]
v_pk_fma_f32 v[62:63], v[62:63], v[136:137], v[130:131] op_sel_hi:[1,0,0] neg_lo:[0,0,1] neg_hi:[0,0,1]
v_exp_f32 v48, v48
v_exp_f32 v56, v56
v_exp_f32 v49, v49
v_exp_f32 v57, v57
v_exp_f32 v50, v50
v_exp_f32 v58, v58
v_exp_f32 v51, v51
v_exp_f32 v59, v59
v_exp_f32 v52, v52
v_exp_f32 v60, v60
v_exp_f32 v53, v53
v_exp_f32 v61, v61
v_exp_f32 v54, v54
v_exp_f32 v62, v62
v_exp_f32 v55, v55
v_exp_f32 v63, v63
v_pk_add_f32 v[128:129], v[48:49], v[50:51]
v_pk_add_f32 v[130:131], v[56:57], v[58:59]
v_pk_add_f32 v[132:133], v[52:53], v[54:55]
v_pk_add_f32 v[134:135], v[60:61], v[62:63]
v_pk_add_f32 v[128:129], v[128:129], v[132:133]
v_pk_add_f32 v[130:131], v[130:131], v[134:135]
v_add_f32 v128, v128, v129
v_add_f32 v130, v130, v131
v_mov_b32 v132, v128
v_mov_b32 v134, v130
s_nop 0
v_permlane32_swap_b32 v128, v132
v_permlane32_swap_b32 v130, v134
v_add_f32 v128, v128, v132
v_add_f32 v130, v130, v134
v_rcp_f32 v128, v128
v_rcp_f32 v130, v130
v_pk_mul_f32 v[48:49], v[48:49], v[128:129] op_sel_hi:[1,0]
v_pk_mul_f32 v[56:57], v[56:57], v[130:131] op_sel_hi:[1,0]
v_pk_mul_f32 v[50:51], v[50:51], v[128:129] op_sel_hi:[1,0]
v_pk_mul_f32 v[58:59], v[58:59], v[130:131] op_sel_hi:[1,0]
v_pk_mul_f32 v[52:53], v[52:53], v[128:129] op_sel_hi:[1,0]
v_pk_mul_f32 v[60:61], v[60:61], v[130:131] op_sel_hi:[1,0]
v_pk_mul_f32 v[54:55], v[54:55], v[128:129] op_sel_hi:[1,0]
v_pk_mul_f32 v[62:63], v[62:63], v[130:131] op_sel_hi:[1,0]
v_cvt_pk_bf16_f32 v96, v48, v49
v_cvt_pk_bf16_f32 v97, v50, v51
v_cvt_pk_bf16_f32 v98, v52, v53
v_cvt_pk_bf16_f32 v99, v54, v55
v_cvt_pk_bf16_f32 v100, v56, v57
v_cvt_pk_bf16_f32 v101, v58, v59
v_cvt_pk_bf16_f32 v102, v60, v61
v_cvt_pk_bf16_f32 v103, v62, v63
ds_write_b64 v242, v[96:97] offset:4096
ds_write_b64 v242, v[98:99] offset:4112
ds_write_b64 v242, v[100:101] offset:4128
ds_write_b64 v242, v[102:103] offset:4144
s_lshl_b32 s37, s22, 2
s_and_b32 s38, s20, 1
s_lshl_b32 s38, s38, 1
s_add_u32 s37, s37, s38
s_lshl_b32 s37, s37, 17
s_lshl_b32 s38, s21, 12
s_add_u32 s37, s37, s38
s_lshr_b32 s38, s20, 1
s_lshl_b32 s38, s38, 11
s_add_u32 s37, s37, s38
s_add_u32 s37, s37, 0x3000000
s_add_u32 s38, s37, 0x20000
s_waitcnt vmcnt(9) lgkmcnt(0)
s_barrier
buffer_load_dword v166, v146, s[4:7], 0 offen offset:32 sc1
ds_read_b64_tr_b16 v[0:1], v244 offset:0
ds_read_b64_tr_b16 v[2:3], v244 offset:512
ds_read_b128 v[16:19], v245 offset:16384
ds_read_b64_tr_b16 v[4:5], v244 offset:1024
ds_read_b64_tr_b16 v[6:7], v244 offset:1536
ds_read_b128 v[20:23], v245 offset:17408
ds_read_b64_tr_b16 v[8:9], v244 offset:2048
ds_read_b64_tr_b16 v[10:11], v244 offset:2560
ds_read_b128 v[24:27], v245 offset:20480
ds_read_b64_tr_b16 v[12:13], v244 offset:3072
ds_read_b64_tr_b16 v[14:15], v244 offset:3584
ds_read_b128 v[28:31], v245 offset:21504
v_add_u32 v250, 98304, v252
ds_read_b128 a[0:3], v250 offset:0
ds_read_b128 a[4:7], v250 offset:1024
ds_read_b128 a[8:11], v250 offset:2048
ds_read_b128 a[12:15], v250 offset:3072
ds_read_b128 a[16:19], v250 offset:4096
ds_read_b128 a[20:23], v250 offset:5120
ds_read_b128 a[24:27], v250 offset:6144
ds_read_b128 a[28:31], v250 offset:7168
v_and_b32 v246, 16, v253
v_cmp_ne_u32 s[50:51], 0, v246
v_mov_b32 v246, 0x3f803f80
v_max3_f32 v128, v64, v65, v66
v_max3_f32 v130, v72, v73, v74
v_max3_f32 v128, v128, v67, v68
v_max3_f32 v130, v130, v75, v76
v_max3_f32 v128, v128, v69, v70
v_max3_f32 v130, v130, v77, v78
v_max_f32 v128, v128, v71
v_max_f32 v130, v130, v79
v_mov_b32 v132, v128
v_mov_b32 v134, v130
s_nop 0
v_permlane32_swap_b32 v128, v132
v_permlane32_swap_b32 v130, v134
v_max_f32 v128, v128, v132
v_max_f32 v130, v130, v134
v_mul_f32 v128, s39, v128
v_mul_f32 v130, s39, v130
v_pk_fma_f32 v[64:65], v[64:65], v[136:137], v[128:129] op_sel_hi:[1,0,0] neg_lo:[0,0,1] neg_hi:[0,0,1]
v_pk_fma_f32 v[72:73], v[72:73], v[136:137], v[130:131] op_sel_hi:[1,0,0] neg_lo:[0,0,1] neg_hi:[0,0,1]
v_pk_fma_f32 v[66:67], v[66:67], v[136:137], v[128:129] op_sel_hi:[1,0,0] neg_lo:[0,0,1] neg_hi:[0,0,1]
v_pk_fma_f32 v[74:75], v[74:75], v[136:137], v[130:131] op_sel_hi:[1,0,0] neg_lo:[0,0,1] neg_hi:[0,0,1]
v_pk_fma_f32 v[68:69], v[68:69], v[136:137], v[128:129] op_sel_hi:[1,0,0] neg_lo:[0,0,1] neg_hi:[0,0,1]
v_pk_fma_f32 v[76:77], v[76:77], v[136:137], v[130:131] op_sel_hi:[1,0,0] neg_lo:[0,0,1] neg_hi:[0,0,1]
v_pk_fma_f32 v[70:71], v[70:71], v[136:137], v[128:129] op_sel_hi:[1,0,0] neg_lo:[0,0,1] neg_hi:[0,0,1]
v_pk_fma_f32 v[78:79], v[78:79], v[136:137], v[130:131] op_sel_hi:[1,0,0] neg_lo:[0,0,1] neg_hi:[0,0,1]
v_exp_f32 v64, v64
v_exp_f32 v72, v72
v_exp_f32 v65, v65
v_exp_f32 v73, v73
v_exp_f32 v66, v66
v_exp_f32 v74, v74
v_exp_f32 v67, v67
v_exp_f32 v75, v75
v_exp_f32 v68, v68
v_exp_f32 v76, v76
v_exp_f32 v69, v69
v_exp_f32 v77, v77
v_exp_f32 v70, v70
v_exp_f32 v78, v78
v_exp_f32 v71, v71
v_exp_f32 v79, v79
v_pk_add_f32 v[128:129], v[64:65], v[66:67]
v_pk_add_f32 v[130:131], v[72:73], v[74:75]
v_pk_add_f32 v[132:133], v[68:69], v[70:71]
v_pk_add_f32 v[134:135], v[76:77], v[78:79]
v_pk_add_f32 v[128:129], v[128:129], v[132:133]
v_pk_add_f32 v[130:131], v[130:131], v[134:135]
v_add_f32 v128, v128, v129
v_add_f32 v130, v130, v131
v_mov_b32 v132, v128
v_mov_b32 v134, v130
s_nop 0
v_permlane32_swap_b32 v128, v132
v_permlane32_swap_b32 v130, v134
v_add_f32 v128, v128, v132
v_add_f32 v130, v130, v134
v_rcp_f32 v128, v128
v_rcp_f32 v130, v130
v_pk_mul_f32 v[64:65], v[64:65], v[128:129] op_sel_hi:[1,0]
v_pk_mul_f32 v[72:73], v[72:73], v[130:131] op_sel_hi:[1,0]
v_pk_mul_f32 v[66:67], v[66:67], v[128:129] op_sel_hi:[1,0]
v_pk_mul_f32 v[74:75], v[74:75], v[130:131] op_sel_hi:[1,0]
v_pk_mul_f32 v[68:69], v[68:69], v[128:129] op_sel_hi:[1,0]
v_pk_mul_f32 v[76:77], v[76:77], v[130:131] op_sel_hi:[1,0]
v_pk_mul_f32 v[70:71], v[70:71], v[128:129] op_sel_hi:[1,0]
v_pk_mul_f32 v[78:79], v[78:79], v[130:131] op_sel_hi:[1,0]
v_cvt_pk_bf16_f32 v96, v64, v65
v_cvt_pk_bf16_f32 v97, v66, v67
v_cvt_pk_bf16_f32 v98, v68, v69
v_cvt_pk_bf16_f32 v99, v70, v71
v_cvt_pk_bf16_f32 v100, v72, v73
v_cvt_pk_bf16_f32 v101, v74, v75
v_cvt_pk_bf16_f32 v102, v76, v77
v_cvt_pk_bf16_f32 v103, v78, v79
buffer_store_dwordx4 v[96:99], v252, s[4:7], s37 offen offset:0 sc1
buffer_store_dwordx4 v[100:103], v252, s[4:7], s37 offen offset:1024 sc1
s_waitcnt vmcnt(2) lgkmcnt(0)
s_cmp_eq_u32 s20, 0
s_cbranch_scc0 KA_rdyV
v_cmp_ne_u32 vcc, 1, v166
s_mov_b32 s30, 0
s_nop 3
s_cbranch_vccz KA_rdyV
KA_pollV:
s_sleep 2
buffer_load_dword v166, v146, s[4:7], 0 offen offset:32 sc1
s_waitcnt vmcnt(0)
v_cmp_ne_u32 vcc, 1, v166
s_add_u32 s30, s30, 1
s_nop 3
s_cbranch_vccz KA_rdyV
s_cmp_lt_u32 s30, 0x40000
s_cbranch_scc1 KA_pollV
KA_rdyV:
s_barrier
s_add_u32 m0, s29, 0
s_add_u32 s30, s25, 0x1000
buffer_load_dwordx4 v252, s[16:19], s25 offen offset:0 sc1 lds
buffer_load_dwordx4 v252, s[16:19], s25 offen offset:1024 sc1 lds
buffer_load_dwordx4 v252, s[16:19], s25 offen offset:2048 sc1 lds
buffer_load_dwordx4 v252, s[16:19], s25 offen offset:3072 sc1 lds
s_add_u32 m0, m0, 0x1000
s_add_u32 s25, s25, 0x8000
buffer_load_dwordx4 v252, s[16:19], s30 offen offset:0 sc1 lds
buffer_load_dwordx4 v252, s[16:19], s30 offen offset:1024 sc1 lds
buffer_load_dwordx4 v252, s[16:19], s30 offen offset:2048 sc1 lds
buffer_load_dwordx4 v252, s[16:19], s30 offen offset:3072 sc1 lds
v_cndmask_b32 v16, v16, v246, s[50:51]
v_cndmask_b32 v17, v17, v246, s[50:51]
v_cndmask_b32 v18, v18, v246, s[50:51]
v_cndmask_b32 v19, v19, v246, s[50:51]
v_cndmask_b32 v20, v20, v246, s[50:51]
v_cndmask_b32 v21, v21, v246, s[50:51]
v_cndmask_b32 v22, v22, v246, s[50:51]
v_cndmask_b32 v23, v23, v246, s[50:51]
v_cndmask_b32 v24, v24, v246, s[50:51]
v_cndmask_b32 v25, v25, v246, s[50:51]
v_cndmask_b32 v26, v26, v246, s[50:51]
v_cndmask_b32 v27, v27, v246, s[50:51]
v_cndmask_b32 v28, v28, v246, s[50:51]
v_cndmask_b32 v29, v29, v246, s[50:51]
v_cndmask_b32 v30, v30, v246, s[50:51]
v_cndmask_b32 v31, v31, v246, s[50:51]
s_add_u32 s43, s29, 0x10000
v_add_u32 v251, s43, v252
v_mfma_f32_32x32x16_bf16 v[32:47], v[0:3], v[16:19], 0
v_mfma_f32_32x32x16_bf16 v[32:47], v[4:7], v[20:23], v[32:47]
v_mfma_f32_32x32x16_bf16 v[32:47], v[8:11], v[24:27], v[32:47]
v_mfma_f32_32x32x16_bf16 v[32:47], v[12:15], v[28:31], v[32:47]
ds_write_b128 v251, a[64:67] offset:0
ds_write_b128 v251, a[68:71] offset:1024
ds_write_b128 v251, a[72:75] offset:2048
ds_write_b128 v251, a[76:79] offset:3072
ds_write_b128 v251, a[80:83] offset:4096
ds_write_b128 v251, a[84:87] offset:5120
ds_write_b128 v251, a[88:91] offset:6144
ds_write_b128 v251, a[92:95] offset:7168
s_add_u32 m0, s29, 32768
s_add_u32 s30, s25, 0x1000
buffer_load_dwordx4 v252, s[16:19], s25 offen offset:0 sc1 lds
buffer_load_dwordx4 v252, s[16:19], s25 offen offset:1024 sc1 lds
buffer_load_dwordx4 v252, s[16:19], s25 offen offset:2048 sc1 lds
buffer_load_dwordx4 v252, s[16:19], s25 offen offset:3072 sc1 lds
s_add_u32 m0, m0, 0x1000
s_add_u32 s25, s25, 0x8000
buffer_load_dwordx4 v252, s[16:19], s30 offen offset:0 sc1 lds
buffer_load_dwordx4 v252, s[16:19], s30 offen offset:1024 sc1 lds
buffer_load_dwordx4 v252, s[16:19], s30 offen offset:2048 sc1 lds
buffer_load_dwordx4 v252, s[16:19], s30 offen offset:3072 sc1 lds
v_max3_f32 v128, v80, v81, v82
v_max3_f32 v130, v88, v89, v90
v_max3_f32 v128, v128, v83, v84
v_max3_f32 v130, v130, v91, v92
v_max3_f32 v128, v128, v85, v86
v_max3_f32 v130, v130, v93, v94
v_max_f32 v128, v128, v87
v_max_f32 v130, v130, v95
v_mov_b32 v132, v128
v_mov_b32 v134, v130
s_nop 0
v_permlane32_swap_b32 v128, v132
v_permlane32_swap_b32 v130, v134
v_max_f32 v128, v128, v132
v_max_f32 v130, v130, v134
v_mul_f32 v128, s39, v128
v_mul_f32 v130, s39, v130
v_pk_fma_f32 v[80:81], v[80:81], v[136:137], v[128:129] op_sel_hi:[1,0,0] neg_lo:[0,0,1] neg_hi:[0,0,1]
v_pk_fma_f32 v[88:89], v[88:89], v[136:137], v[130:131] op_sel_hi:[1,0,0] neg_lo:[0,0,1] neg_hi:[0,0,1]
v_pk_fma_f32 v[82:83], v[82:83], v[136:137], v[128:129] op_sel_hi:[1,0,0] neg_lo:[0,0,1] neg_hi:[0,0,1]
v_pk_fma_f32 v[90:91], v[90:91], v[136:137], v[130:131] op_sel_hi:[1,0,0] neg_lo:[0,0,1] neg_hi:[0,0,1]
v_pk_fma_f32 v[84:85], v[84:85], v[136:137], v[128:129] op_sel_hi:[1,0,0] neg_lo:[0,0,1] neg_hi:[0,0,1]
v_pk_fma_f32 v[92:93], v[92:93], v[136:137], v[130:131] op_sel_hi:[1,0,0] neg_lo:[0,0,1] neg_hi:[0,0,1]
v_pk_fma_f32 v[86:87], v[86:87], v[136:137], v[128:129] op_sel_hi:[1,0,0] neg_lo:[0,0,1] neg_hi:[0,0,1]
v_pk_fma_f32 v[94:95], v[94:95], v[136:137], v[130:131] op_sel_hi:[1,0,0] neg_lo:[0,0,1] neg_hi:[0,0,1]
v_exp_f32 v80, v80
v_exp_f32 v88, v88
v_exp_f32 v81, v81
v_exp_f32 v89, v89
v_exp_f32 v82, v82
v_exp_f32 v90, v90
v_exp_f32 v83, v83
v_exp_f32 v91, v91
v_exp_f32 v84, v84
v_exp_f32 v92, v92
v_exp_f32 v85, v85
v_exp_f32 v93, v93
v_exp_f32 v86, v86
v_exp_f32 v94, v94
v_exp_f32 v87, v87
v_exp_f32 v95, v95
v_pk_add_f32 v[128:129], v[80:81], v[82:83]
v_pk_add_f32 v[130:131], v[88:89], v[90:91]
v_pk_add_f32 v[132:133], v[84:85], v[86:87]
v_pk_add_f32 v[134:135], v[92:93], v[94:95]
v_pk_add_f32 v[128:129], v[128:129], v[132:133]
v_pk_add_f32 v[130:131], v[130:131], v[134:135]
v_add_f32 v128, v128, v129
v_add_f32 v130, v130, v131
v_mov_b32 v132, v128
v_mov_b32 v134, v130
s_nop 0
v_permlane32_swap_b32 v128, v132
v_permlane32_swap_b32 v130, v134
v_add_f32 v128, v128, v132
v_add_f32 v130, v130, v134
v_rcp_f32 v128, v128
v_rcp_f32 v130, v130
v_pk_mul_f32 v[80:81], v[80:81], v[128:129] op_sel_hi:[1,0]
v_pk_mul_f32 v[88:89], v[88:89], v[130:131] op_sel_hi:[1,0]
v_pk_mul_f32 v[82:83], v[82:83], v[128:129] op_sel_hi:[1,0]
v_pk_mul_f32 v[90:91], v[90:91], v[130:131] op_sel_hi:[1,0]
v_pk_mul_f32 v[84:85], v[84:85], v[128:129] op_sel_hi:[1,0]
v_pk_mul_f32 v[92:93], v[92:93], v[130:131] op_sel_hi:[1,0]
v_pk_mul_f32 v[86:87], v[86:87], v[128:129] op_sel_hi:[1,0]
v_pk_mul_f32 v[94:95], v[94:95], v[130:131] op_sel_hi:[1,0]
v_cvt_pk_bf16_f32 v104, v80, v81
v_cvt_pk_bf16_f32 v105, v82, v83
v_cvt_pk_bf16_f32 v106, v84, v85
v_cvt_pk_bf16_f32 v107, v86, v87
v_cvt_pk_bf16_f32 v108, v88, v89
v_cvt_pk_bf16_f32 v109, v90, v91
v_cvt_pk_bf16_f32 v110, v92, v93
v_cvt_pk_bf16_f32 v111, v94, v95
buffer_store_dwordx4 v[104:107], v252, s[4:7], s38 offen offset:0 sc1
buffer_store_dwordx4 v[108:111], v252, s[4:7], s38 offen offset:1024 sc1
s_lshl_b32 s37, s22, 2
s_add_u32 s37, s37, s20
s_lshl_b32 s37, s37, 5
s_add_u32 s37, s37, s21
s_lshl_b32 s38, s37, 7
s_add_u32 s38, s38, 0x3600000
s_lshl_b32 s37, s37, 11
s_add_u32 s37, s37, 0x3400000
v_lshrrev_b32 v240, 5, v253
v_and_b32 v241, 31, v253
v_lshl_add_u32 v242, v240, 4, v241
v_lshl_add_u32 v242, v242, 4, s37
v_lshl_add_u32 v243, v240, 4, s38
v_mov_b32 v244, 0x70000000
v_cmp_eq_u32 vcc, 16, v241
v_mov_b32 v245, 512
s_nop 0
v_cndmask_b32 v243, v244, v243, vcc
v_cmp_gt_u32 vcc, 16, v241
s_nop 1
v_cndmask_b32 v242, v243, v242, vcc
v_cndmask_b32 v245, 32, v245, vcc
buffer_store_dwordx4 v[32:35], v242, s[4:7], 0 offen sc1
v_add_u32 v242, v245, v242
buffer_store_dwordx4 v[36:39], v242, s[4:7], 0 offen sc1
v_add_u32 v242, v245, v242
buffer_store_dwordx4 v[40:43], v242, s[4:7], 0 offen sc1
v_add_u32 v242, v245, v242
buffer_store_dwordx4 v[44:47], v242, s[4:7], 0 offen sc1
s_lshl_b32 s33, s22, 2
s_add_u32 s33, s33, 4
s_mov_b32 s34, 0x42800000
s_mov_b32 s43, 0
s_mov_b32 s49, 0
s_add_u32 s37, s29, 0x10000
s_xor_b32 s38, s37, 0x2000
v_add_u32 v160, s38, v252
v_mov_b32 v254, 0xff800000
v_and_b32 v161, 15, v253
v_lshrrev_b32 v162, 4, v253
v_lshlrev_b32 v162, 2, v162
v_sub_u32 v161, v161, v162
v_cmp_gt_i32 s[64:65], 0, v161
v_cmp_gt_i32 s[66:67], 1, v161
v_cmp_gt_i32 s[68:69], 2, v161
v_cmp_gt_i32 s[70:71], 3, v161
v_mov_b32 v80, 0
v_mov_b32 v81, 0
v_mov_b32 v82, 0
v_mov_b32 v83, 0
v_mov_b32 v84, 0
v_mov_b32 v85, 0
v_mov_b32 v86, 0
v_mov_b32 v87, 0
v_mov_b32 v88, 0
v_mov_b32 v89, 0
v_mov_b32 v90, 0
v_mov_b32 v91, 0
v_mov_b32 v92, 0
v_mov_b32 v93, 0
v_mov_b32 v94, 0
v_mov_b32 v95, 0
v_mov_b32 v96, 0
v_mov_b32 v97, 0
v_mov_b32 v98, 0
v_mov_b32 v99, 0
v_mov_b32 v100, 0
v_mov_b32 v101, 0
v_mov_b32 v102, 0
v_mov_b32 v103, 0
v_mov_b32 v104, 0
v_mov_b32 v105, 0
v_mov_b32 v106, 0
v_mov_b32 v107, 0
v_mov_b32 v108, 0
v_mov_b32 v109, 0
v_mov_b32 v110, 0
v_mov_b32 v111, 0
v_mov_b32 v248, 0x3f803f80
v_accvgpr_write_b32 a176, v248
v_accvgpr_write_b32 a177, v248
v_accvgpr_write_b32 a178, v248
v_accvgpr_write_b32 a179, v248
s_cmp_eq_u32 s22, 0
s_cbranch_scc0 K2_nm0
s_sub_u32 s37, 0, s20
s_cmp_lt_i32 s37, 0
s_cbranch_scc1 Lme_2002
s_cmp_eq_i32 s37, 0
s_cbranch_scc1 Lmd_2001
v_mov_b32 v96, v254
v_mov_b32 v97, v254
v_mov_b32 v98, v254
v_mov_b32 v99, v254
v_mov_b32 v100, v254
v_mov_b32 v101, v254
v_mov_b32 v102, v254
v_mov_b32 v103, v254
v_mov_b32 v104, v254
v_mov_b32 v105, v254
v_mov_b32 v106, v254
v_mov_b32 v107, v254
v_mov_b32 v108, v254
v_mov_b32 v109, v254
v_mov_b32 v110, v254
v_mov_b32 v111, v254
s_branch Lme_2002
Lmd_2001:
v_cndmask_b32 v96, v96, v254, s[64:65]
v_mov_b32 v100, v254
v_cndmask_b32 v108, v108, v254, s[64:65]
v_cndmask_b32 v97, v97, v254, s[66:67]
v_mov_b32 v101, v254
v_cndmask_b32 v109, v109, v254, s[66:67]
v_cndmask_b32 v98, v98, v254, s[68:69]
v_mov_b32 v102, v254
v_cndmask_b32 v110, v110, v254, s[68:69]
v_cndmask_b32 v99, v99, v254, s[70:71]
v_mov_b32 v103, v254
v_cndmask_b32 v111, v111, v254, s[70:71]
Lme_2002:
K2_nm0:
s_waitcnt lgkmcnt(0)
s_barrier
ds_read_b128 a[128:131], v160 offset:0
ds_read_b128 a[132:135], v160 offset:1024
ds_read_b128 a[136:139], v160 offset:2048
ds_read_b128 a[140:143], v160 offset:3072
ds_read_b128 a[144:147], v160 offset:4096
ds_read_b128 a[148:151], v160 offset:5120
ds_read_b128 a[152:155], v160 offset:6144
ds_read_b128 a[156:159], v160 offset:7168
v_add_u32 v250, 106496, v252
s_mov_b32 s26, 0
s_mov_b32 s27, 131072
s_mov_b32 s28, 98304
s_mov_b32 s36, 0x7fc00000
s_mov_b32 s35, s34
v_mfma_f32_16x16x32_bf16 v[0:3], a[0:3], a[64:67], v[80:83]
v_mfma_f32_16x16x32_bf16 v[0:3], a[4:7], a[68:71], v[0:3]
v_mfma_f32_16x16x32_bf16 v[0:3], a[8:11], a[72:75], v[0:3]
v_mfma_f32_16x16x32_bf16 v[0:3], a[12:15], a[76:79], v[0:3]
v_mfma_f32_16x16x32_bf16 v[8:11], a[0:3], a[80:83], v[88:91]
v_mfma_f32_16x16x32_bf16 v[8:11], a[4:7], a[84:87], v[8:11]
v_mfma_f32_16x16x32_bf16 v[8:11], a[8:11], a[88:91], v[8:11]
v_mfma_f32_16x16x32_bf16 v[8:11], a[12:15], a[92:95], v[8:11]
v_mfma_f32_16x16x32_bf16 v[16:19], a[0:3], a[96:99], v[96:99]
v_mfma_f32_16x16x32_bf16 v[16:19], a[4:7], a[100:103], v[16:19]
v_mfma_f32_16x16x32_bf16 v[16:19], a[8:11], a[104:107], v[16:19]
v_mfma_f32_16x16x32_bf16 v[16:19], a[12:15], a[108:111], v[16:19]
v_mfma_f32_16x16x32_bf16 v[24:27], a[0:3], a[112:115], v[104:107]
v_mfma_f32_16x16x32_bf16 v[24:27], a[4:7], a[116:119], v[24:27]
v_mfma_f32_16x16x32_bf16 v[24:27], a[8:11], a[120:123], v[24:27]
v_mfma_f32_16x16x32_bf16 v[24:27], a[12:15], a[124:127], v[24:27]
v_mfma_f32_16x16x32_bf16 v[4:7], a[16:19], a[64:67], v[84:87]
ds_read_b128 a[0:3], v250 offset:0
v_mfma_f32_16x16x32_bf16 v[4:7], a[20:23], a[68:71], v[4:7]
ds_read_b128 a[4:7], v250 offset:1024
v_mfma_f32_16x16x32_bf16 v[4:7], a[24:27], a[72:75], v[4:7]
ds_read_b128 a[8:11], v250 offset:2048
v_mfma_f32_16x16x32_bf16 v[4:7], a[28:31], a[76:79], v[4:7]
ds_read_b128 a[12:15], v250 offset:3072
v_mfma_f32_16x16x32_bf16 v[12:15], a[16:19], a[80:83], v[92:95]
v_mfma_f32_16x16x32_bf16 v[12:15], a[20:23], a[84:87], v[12:15]
v_mfma_f32_16x16x32_bf16 v[12:15], a[24:27], a[88:91], v[12:15]
v_mfma_f32_16x16x32_bf16 v[12:15], a[28:31], a[92:95], v[12:15]
v_mfma_f32_16x16x32_bf16 v[20:23], a[16:19], a[96:99], v[100:103]
v_mfma_f32_16x16x32_bf16 v[20:23], a[20:23], a[100:103], v[20:23]
v_mfma_f32_16x16x32_bf16 v[20:23], a[24:27], a[104:107], v[20:23]
v_mfma_f32_16x16x32_bf16 v[20:23], a[28:31], a[108:111], v[20:23]
v_mfma_f32_16x16x32_bf16 v[28:31], a[16:19], a[112:115], v[108:111]
v_mfma_f32_16x16x32_bf16 v[28:31], a[20:23], a[116:119], v[28:31]
v_mfma_f32_16x16x32_bf16 v[28:31], a[24:27], a[120:123], v[28:31]
v_mfma_f32_16x16x32_bf16 v[28:31], a[28:31], a[124:127], v[28:31]
ds_read_b128 a[16:19], v250 offset:4096
ds_read_b128 a[20:23], v250 offset:5120
ds_read_b128 a[24:27], v250 offset:6144
ds_read_b128 a[28:31], v250 offset:7168
s_nop 7
v_add_u32 v250, s27, v252
v_mov_b32 v251, v252
s_waitcnt vmcnt(0) lgkmcnt(0)
s_barrier
v_accvgpr_read_b32 v248, a255
v_mov_b32 v249, 1
s_nop 0
buffer_store_dword v249, v248, s[4:7], 0 offen sc1
s_add_u32 m0, s29, 65536
s_add_u32 s30, s25, 0x1000
buffer_load_dwordx4 v252, s[16:19], s25 offen offset:0 sc1 lds
buffer_load_dwordx4 v252, s[16:19], s25 offen offset:1024 sc1 lds
buffer_load_dwordx4 v252, s[16:19], s25 offen offset:2048 sc1 lds
buffer_load_dwordx4 v252, s[16:19], s25 offen offset:3072 sc1 lds
s_add_u32 m0, m0, 0x1000
s_add_u32 s25, s25, 0x8000
buffer_load_dwordx4 v252, s[16:19], s30 offen offset:0 sc1 lds
buffer_load_dwordx4 v252, s[16:19], s30 offen offset:1024 sc1 lds
buffer_load_dwordx4 v252, s[16:19], s30 offen offset:2048 sc1 lds
buffer_load_dwordx4 v252, s[16:19], s30 offen offset:3072 sc1 lds
v_max3_f32 v246, v0, v1, v2
v_max3_f32 v246, v246, v3, v4
v_max3_f32 v246, v246, v5, v6
v_max_f32 v246, v246, v7
v_mov_b32 v248, v246
s_nop 1
v_permlane16_swap_b32 v246, v248
v_max_f32 v246, v246, v248
v_mov_b32 v248, v246
s_nop 1
v_permlane32_swap_b32 v246, v248
v_max_f32 v246, v246, v248
v_max_f32 v246, 0xf149f2ca, v246
v_add_f32 v246, 0x42400000, v246
v_ceil_f32 v240, v246
v_sub_f32 v246, 0, v240
v_pk_add_f32 v[0:1], v[0:1], v[246:247] op_sel_hi:[1,0]
v_pk_add_f32 v[2:3], v[2:3], v[246:247] op_sel_hi:[1,0]
v_pk_add_f32 v[4:5], v[4:5], v[246:247] op_sel_hi:[1,0]
v_pk_add_f32 v[6:7], v[6:7], v[246:247] op_sel_hi:[1,0]
v_mov_b32 v80, v246
v_mov_b32 v81, v246
v_mov_b32 v82, v246
v_mov_b32 v83, v246
v_mov_b32 v84, v246
v_mov_b32 v85, v246
v_mov_b32 v86, v246
v_mov_b32 v87, v246
v_max3_f32 v246, v8, v9, v10
v_max3_f32 v246, v246, v11, v12
v_max3_f32 v246, v246, v13, v14
v_max_f32 v246, v246, v15
v_mov_b32 v248, v246
s_nop 1
v_permlane16_swap_b32 v246, v248
v_max_f32 v246, v246, v248
v_mov_b32 v248, v246
s_nop 1
v_permlane32_swap_b32 v246, v248
v_max_f32 v246, v246, v248
v_max_f32 v246, 0xf149f2ca, v246
v_add_f32 v246, 0x42400000, v246
v_ceil_f32 v241, v246
v_sub_f32 v246, 0, v241
v_pk_add_f32 v[8:9], v[8:9], v[246:247] op_sel_hi:[1,0]
v_pk_add_f32 v[10:11], v[10:11], v[246:247] op_sel_hi:[1,0]
v_pk_add_f32 v[12:13], v[12:13], v[246:247] op_sel_hi:[1,0]
v_pk_add_f32 v[14:15], v[14:15], v[246:247] op_sel_hi:[1,0]
v_mov_b32 v88, v246
v_mov_b32 v89, v246
v_mov_b32 v90, v246
v_mov_b32 v91, v246
v_mov_b32 v92, v246
v_mov_b32 v93, v246
v_mov_b32 v94, v246
v_mov_b32 v95, v246
v_max3_f32 v246, v16, v17, v18
v_max3_f32 v246, v246, v19, v20
v_max3_f32 v246, v246, v21, v22
v_max_f32 v246, v246, v23
v_mov_b32 v248, v246
s_nop 1
v_permlane16_swap_b32 v246, v248
v_max_f32 v246, v246, v248
v_mov_b32 v248, v246
s_nop 1
v_permlane32_swap_b32 v246, v248
v_max_f32 v246, v246, v248
v_max_f32 v246, 0xf149f2ca, v246
v_add_f32 v246, 0x42400000, v246
v_ceil_f32 v242, v246
v_sub_f32 v246, 0, v242
v_pk_add_f32 v[16:17], v[16:17], v[246:247] op_sel_hi:[1,0]
v_pk_add_f32 v[18:19], v[18:19], v[246:247] op_sel_hi:[1,0]
v_pk_add_f32 v[20:21], v[20:21], v[246:247] op_sel_hi:[1,0]
v_pk_add_f32 v[22:23], v[22:23], v[246:247] op_sel_hi:[1,0]
v_mov_b32 v96, v246
v_mov_b32 v97, v246
v_mov_b32 v98, v246
v_mov_b32 v99, v246
v_mov_b32 v100, v246
v_mov_b32 v101, v246
v_mov_b32 v102, v246
v_mov_b32 v103, v246
v_max3_f32 v246, v24, v25, v26
v_max3_f32 v246, v246, v27, v28
v_max3_f32 v246, v246, v29, v30
v_max_f32 v246, v246, v31
v_mov_b32 v248, v246
s_nop 1
v_permlane16_swap_b32 v246, v248
v_max_f32 v246, v246, v248
v_mov_b32 v248, v246
s_nop 1
v_permlane32_swap_b32 v246, v248
v_max_f32 v246, v246, v248
v_max_f32 v246, 0xf149f2ca, v246
v_add_f32 v246, 0x42400000, v246
v_ceil_f32 v243, v246
v_sub_f32 v246, 0, v243
v_pk_add_f32 v[24:25], v[24:25], v[246:247] op_sel_hi:[1,0]
v_pk_add_f32 v[26:27], v[26:27], v[246:247] op_sel_hi:[1,0]
v_pk_add_f32 v[28:29], v[28:29], v[246:247] op_sel_hi:[1,0]
v_pk_add_f32 v[30:31], v[30:31], v[246:247] op_sel_hi:[1,0]
v_mov_b32 v104, v246
v_mov_b32 v105, v246
v_mov_b32 v106, v246
v_mov_b32 v107, v246
v_mov_b32 v108, v246
v_mov_b32 v109, v246
v_mov_b32 v110, v246
v_mov_b32 v111, v246
v_mov_b32 v255, 0x5f800000
s_cmp_le_u32 s33, 5
s_cbranch_scc0 K2_f1
s_sub_u32 s37, 1, s20
s_cmp_lt_i32 s37, 0
s_cbranch_scc1 Lme_2004
s_cmp_eq_i32 s37, 0
s_cbranch_scc1 Lmd_2003
v_mov_b32 v96, v254
v_mov_b32 v97, v254
v_mov_b32 v98, v254
v_mov_b32 v99, v254
v_mov_b32 v100, v254
v_mov_b32 v101, v254
v_mov_b32 v102, v254
v_mov_b32 v103, v254
v_mov_b32 v104, v254
v_mov_b32 v105, v254
v_mov_b32 v106, v254
v_mov_b32 v107, v254
v_mov_b32 v108, v254
v_mov_b32 v109, v254
v_mov_b32 v110, v254
v_mov_b32 v111, v254
s_branch Lme_2004
Lmd_2003:
v_cndmask_b32 v96, v96, v254, s[64:65]
v_mov_b32 v100, v254
v_cndmask_b32 v108, v108, v254, s[64:65]
v_cndmask_b32 v97, v97, v254, s[66:67]
v_mov_b32 v101, v254
v_cndmask_b32 v109, v109, v254, s[66:67]
v_cndmask_b32 v98, v98, v254, s[68:69]
v_mov_b32 v102, v254
v_cndmask_b32 v110, v110, v254, s[68:69]
v_cndmask_b32 v99, v99, v254, s[70:71]
v_mov_b32 v103, v254
v_cndmask_b32 v111, v111, v254, s[70:71]
Lme_2004:
K2_f1:
s_waitcnt vmcnt(16) lgkmcnt(0)
s_barrier
v_mfma_f32_16x16x32_bf16 v[32:35], a[0:3], a[64:67], v[80:83]
s_add_u32 m0, s29, s28
v_exp_f32 v0, v0
v_mfma_f32_16x16x32_bf16 v[32:35], a[4:7], a[68:71], v[32:35]
s_add_u32 s30, s25, 0x1000
v_exp_f32 v1, v1
v_mfma_f32_16x16x32_bf16 v[32:35], a[8:11], a[72:75], v[32:35]
ds_read_b128 a[32:35], v251 offset:16384
v_cvt_pk_bf16_f32 v64, v0, v1
v_mfma_f32_16x16x32_bf16 v[32:35], a[12:15], a[76:79], v[32:35]
v_exp_f32 v2, v2
v_mfma_f32_16x16x32_bf16 v[40:43], a[0:3], a[80:83], v[88:91]
s_add_u32 s37, s27, 0x2000
v_exp_f32 v3, v3
v_mfma_f32_16x16x32_bf16 v[40:43], a[4:7], a[84:87], v[40:43]
s_sub_u32 s33, s33, 1
ds_read_b128 a[36:39], v251 offset:17408
v_cvt_pk_bf16_f32 v65, v2, v3
v_mfma_f32_16x16x32_bf16 v[40:43], a[8:11], a[88:91], v[40:43]
buffer_load_dwordx4 v252, s[16:19], s25 offen offset:0 sc1 lds
v_mfma_f32_16x16x32_bf16 v[40:43], a[12:15], a[92:95], v[40:43]
v_exp_f32 v4, v4
v_mfma_f32_16x16x32_bf16 v[48:51], a[0:3], a[96:99], v[96:99]
v_exp_f32 v5, v5
v_mfma_f32_16x16x32_bf16 v[48:51], a[4:7], a[100:103], v[48:51]
ds_read_b128 a[40:43], v251 offset:18432
v_cvt_pk_bf16_f32 v66, v4, v5
v_mfma_f32_16x16x32_bf16 v[48:51], a[8:11], a[104:107], v[48:51]
v_exp_f32 v6, v6
v_mfma_f32_16x16x32_bf16 v[48:51], a[12:15], a[108:111], v[48:51]
v_exp_f32 v7, v7
v_mfma_f32_16x16x32_bf16 v[56:59], a[0:3], a[112:115], v[104:107]
ds_read_b128 a[44:47], v251 offset:19456
v_cvt_pk_bf16_f32 v67, v6, v7
v_mfma_f32_16x16x32_bf16 v[56:59], a[4:7], a[116:119], v[56:59]
v_exp_f32 v8, v8
v_mfma_f32_16x16x32_bf16 v[56:59], a[8:11], a[120:123], v[56:59]
s_cmp_le_u32 s33, 5
s_cselect_b64 vcc, -1, 0
ds_read_b128 a[48:51], v251 offset:20480
v_mfma_f32_16x16x32_bf16 v[56:59], a[12:15], a[124:127], v[56:59]
v_exp_f32 v9, v9
v_mfma_f32_16x16x32_bf16 v[36:39], a[16:19], a[64:67], v[84:87]
ds_read_b128 a[52:55], v251 offset:21504
v_cvt_pk_bf16_f32 v68, v8, v9
v_mfma_f32_16x16x32_bf16 v[36:39], a[20:23], a[68:71], v[36:39]
v_exp_f32 v10, v10
v_mfma_f32_16x16x32_bf16 v[36:39], a[24:27], a[72:75], v[36:39]
v_exp_f32 v11, v11
v_mfma_f32_16x16x32_bf16 v[36:39], a[28:31], a[76:79], v[36:39]
ds_read_b128 a[56:59], v251 offset:22528
v_cvt_pk_bf16_f32 v69, v10, v11
v_mfma_f32_16x16x32_bf16 v[44:47], a[16:19], a[80:83], v[92:95]
buffer_load_dwordx4 v252, s[16:19], s25 offen offset:1024 sc1 lds
v_mfma_f32_16x16x32_bf16 v[44:47], a[20:23], a[84:87], v[44:47]
v_exp_f32 v12, v12
v_mfma_f32_16x16x32_bf16 v[44:47], a[24:27], a[88:91], v[44:47]
v_exp_f32 v13, v13
v_mfma_f32_16x16x32_bf16 v[44:47], a[28:31], a[92:95], v[44:47]
ds_read_b128 a[60:63], v251 offset:23552
v_cvt_pk_bf16_f32 v70, v12, v13
v_mfma_f32_16x16x32_bf16 v[52:55], a[16:19], a[96:99], v[100:103]
v_exp_f32 v14, v14
v_mfma_f32_16x16x32_bf16 v[52:55], a[20:23], a[100:103], v[52:55]
v_exp_f32 v15, v15
v_mfma_f32_16x16x32_bf16 v[52:55], a[24:27], a[104:107], v[52:55]
v_cvt_pk_bf16_f32 v71, v14, v15
v_mfma_f32_16x16x32_bf16 v[52:55], a[28:31], a[108:111], v[52:55]
v_exp_f32 v16, v16
v_mfma_f32_16x16x32_bf16 v[60:63], a[16:19], a[112:115], v[108:111]
v_exp_f32 v17, v17
v_mfma_f32_16x16x32_bf16 v[60:63], a[20:23], a[116:119], v[60:63]
ds_read_b128 a[0:3], v250 offset:0
v_cvt_pk_bf16_f32 v72, v16, v17
v_mfma_f32_16x16x32_bf16 v[60:63], a[24:27], a[120:123], v[60:63]
v_exp_f32 v18, v18
v_mfma_f32_16x16x32_bf16 v[60:63], a[28:31], a[124:127], v[60:63]
s_waitcnt lgkmcnt(1)
v_mfma_f32_16x16x32_bf16 v[112:115], a[32:35], v[64:67], 0
v_exp_f32 v19, v19
v_mfma_f32_16x16x32_bf16 v[116:119], a[36:39], v[64:67], 0
ds_read_b128 a[4:7], v250 offset:1024
v_cvt_pk_bf16_f32 v73, v18, v19
v_mfma_f32_16x16x32_bf16 v[120:123], a[40:43], v[64:67], 0
v_exp_f32 v20, v20
v_mfma_f32_16x16x32_bf16 v[124:127], a[44:47], v[64:67], 0
buffer_load_dwordx4 v252, s[16:19], s25 offen offset:2048 sc1 lds
v_mfma_f32_16x16x32_bf16 v[128:131], a[48:51], v[64:67], 0
v_exp_f32 v21, v21
v_mfma_f32_16x16x32_bf16 v[132:135], a[52:55], v[64:67], 0
ds_read_b128 a[8:11], v250 offset:2048
v_cvt_pk_bf16_f32 v74, v20, v21
v_mfma_f32_16x16x32_bf16 v[136:139], a[56:59], v[64:67], 0
v_exp_f32 v22, v22
v_mfma_f32_16x16x32_bf16 v[140:143], a[60:63], v[64:67], 0
v_exp_f32 v23, v23
v_mfma_f32_16x16x32_bf16 a[160:163], a[176:179], v[64:67], 0
ds_read_b128 a[12:15], v250 offset:3072
v_cvt_pk_bf16_f32 v75, v22, v23
v_mfma_f32_16x16x32_bf16 v[144:147], a[32:35], v[68:71], 0
v_exp_f32 v24, v24
v_mfma_f32_16x16x32_bf16 v[148:151], a[36:39], v[68:71], 0
v_exp_f32 v25, v25
v_mfma_f32_16x16x32_bf16 v[152:155], a[40:43], v[68:71], 0
v_cvt_pk_bf16_f32 v76, v24, v25
v_mfma_f32_16x16x32_bf16 v[156:159], a[44:47], v[68:71], 0
v_exp_f32 v26, v26
v_mfma_f32_16x16x32_bf16 v[160:163], a[48:51], v[68:71], 0
v_exp_f32 v27, v27
v_mfma_f32_16x16x32_bf16 v[164:167], a[52:55], v[68:71], 0
ds_read_b128 a[16:19], v250 offset:4096
v_cvt_pk_bf16_f32 v77, v26, v27
v_mfma_f32_16x16x32_bf16 v[168:171], a[56:59], v[68:71], 0
v_exp_f32 v28, v28
v_mfma_f32_16x16x32_bf16 v[172:175], a[60:63], v[68:71], 0
v_exp_f32 v29, v29
v_mfma_f32_16x16x32_bf16 a[164:167], a[176:179], v[68:71], 0
buffer_load_dwordx4 v252, s[16:19], s25 offen offset:3072 sc1 lds
v_mfma_f32_16x16x32_bf16 v[176:179], a[32:35], v[72:75], 0
ds_read_b128 a[20:23], v250 offset:5120
v_cvt_pk_bf16_f32 v78, v28, v29
v_mfma_f32_16x16x32_bf16 v[180:183], a[36:39], v[72:75], 0
v_exp_f32 v30, v30
v_mfma_f32_16x16x32_bf16 v[184:187], a[40:43], v[72:75], 0
v_exp_f32 v31, v31
v_mfma_f32_16x16x32_bf16 v[188:191], a[44:47], v[72:75], 0
ds_read_b128 a[24:27], v250 offset:6144
v_cvt_pk_bf16_f32 v79, v30, v31
v_mfma_f32_16x16x32_bf16 v[192:195], a[48:51], v[72:75], 0
v_mfma_f32_16x16x32_bf16 v[196:199], a[52:55], v[72:75], 0
v_mfma_f32_16x16x32_bf16 v[200:203], a[56:59], v[72:75], 0
ds_read_b128 a[28:31], v250 offset:7168
v_mfma_f32_16x16x32_bf16 v[204:207], a[60:63], v[72:75], 0
v_mfma_f32_16x16x32_bf16 a[168:171], a[176:179], v[72:75], 0
v_add_u32 v250, s37, v252
v_mfma_f32_16x16x32_bf16 v[208:211], a[32:35], v[76:79], 0
v_mfma_f32_16x16x32_bf16 v[212:215], a[36:39], v[76:79], 0
v_mfma_f32_16x16x32_bf16 v[216:219], a[40:43], v[76:79], 0
v_mfma_f32_16x16x32_bf16 v[220:223], a[44:47], v[76:79], 0
v_mfma_f32_16x16x32_bf16 v[224:227], a[48:51], v[76:79], 0
v_mfma_f32_16x16x32_bf16 v[228:231], a[52:55], v[76:79], 0
v_mfma_f32_16x16x32_bf16 v[232:235], a[56:59], v[76:79], 0
v_mfma_f32_16x16x32_bf16 v[236:239], a[60:63], v[76:79], 0
v_mfma_f32_16x16x32_bf16 a[172:175], a[176:179], v[76:79], 0
s_cbranch_vccnz K2_rare10
s_branch K2_c1a
.p2align 6
K2_loop1:
s_waitcnt vmcnt(16) lgkmcnt(0)
s_barrier
v_mfma_f32_16x16x32_bf16 v[32:35], a[0:3], a[64:67], v[80:83]
s_add_u32 m0, s29, s28
v_exp_f32 v0, v0
v_mfma_f32_16x16x32_bf16 v[32:35], a[4:7], a[68:71], v[32:35]
s_add_u32 s30, s25, 0x1000
v_exp_f32 v1, v1
v_mfma_f32_16x16x32_bf16 v[32:35], a[8:11], a[72:75], v[32:35]
ds_read_b128 a[32:35], v251 offset:16384
v_cvt_pk_bf16_f32 v64, v0, v1
v_mfma_f32_16x16x32_bf16 v[32:35], a[12:15], a[76:79], v[32:35]
v_exp_f32 v2, v2
v_mfma_f32_16x16x32_bf16 v[40:43], a[0:3], a[80:83], v[88:91]
s_add_u32 s37, s27, 0x2000
v_exp_f32 v3, v3
v_mfma_f32_16x16x32_bf16 v[40:43], a[4:7], a[84:87], v[40:43]
s_add_u32 s38, s26, s24
ds_read_b128 a[36:39], v251 offset:17408
v_cvt_pk_bf16_f32 v65, v2, v3
v_mfma_f32_16x16x32_bf16 v[40:43], a[8:11], a[88:91], v[40:43]
buffer_load_dwordx4 v252, s[16:19], s25 offen offset:0 sc1 lds
v_mfma_f32_16x16x32_bf16 v[40:43], a[12:15], a[92:95], v[40:43]
v_exp_f32 v4, v4
v_mfma_f32_16x16x32_bf16 v[48:51], a[0:3], a[96:99], v[96:99]
v_exp_f32 v5, v5
v_mfma_f32_16x16x32_bf16 v[48:51], a[4:7], a[100:103], v[48:51]
ds_read_b128 a[40:43], v251 offset:18432
v_cvt_pk_bf16_f32 v66, v4, v5
v_mfma_f32_16x16x32_bf16 v[48:51], a[8:11], a[104:107], v[48:51]
v_exp_f32 v6, v6
v_mfma_f32_16x16x32_bf16 v[48:51], a[12:15], a[108:111], v[48:51]
v_exp_f32 v7, v7
v_mfma_f32_16x16x32_bf16 v[56:59], a[0:3], a[112:115], v[104:107]
ds_read_b128 a[44:47], v251 offset:19456
v_cvt_pk_bf16_f32 v67, v6, v7
v_mfma_f32_16x16x32_bf16 v[56:59], a[4:7], a[116:119], v[56:59]
v_exp_f32 v8, v8
v_mfma_f32_16x16x32_bf16 v[56:59], a[8:11], a[120:123], v[56:59]
s_cmp_eq_u32 s33, 2
s_cselect_b32 s37, s38, s37
ds_read_b128 a[48:51], v251 offset:20480
v_mfma_f32_16x16x32_bf16 v[56:59], a[12:15], a[124:127], v[56:59]
s_sub_u32 s33, s33, 1
v_exp_f32 v9, v9
v_mfma_f32_16x16x32_bf16 v[36:39], a[16:19], a[64:67], v[84:87]
ds_read_b128 a[52:55], v251 offset:21504
v_cvt_pk_bf16_f32 v68, v8, v9
v_mfma_f32_16x16x32_bf16 v[36:39], a[20:23], a[68:71], v[36:39]
v_exp_f32 v10, v10
v_mfma_f32_16x16x32_bf16 v[36:39], a[24:27], a[72:75], v[36:39]
v_exp_f32 v11, v11
v_mfma_f32_16x16x32_bf16 v[36:39], a[28:31], a[76:79], v[36:39]
ds_read_b128 a[56:59], v251 offset:22528
v_cvt_pk_bf16_f32 v69, v10, v11
v_mfma_f32_16x16x32_bf16 v[44:47], a[16:19], a[80:83], v[92:95]
buffer_load_dwordx4 v252, s[16:19], s25 offen offset:1024 sc1 lds
v_mfma_f32_16x16x32_bf16 v[44:47], a[20:23], a[84:87], v[44:47]
v_exp_f32 v12, v12
v_mfma_f32_16x16x32_bf16 v[44:47], a[24:27], a[88:91], v[44:47]
v_exp_f32 v13, v13
v_mfma_f32_16x16x32_bf16 v[44:47], a[28:31], a[92:95], v[44:47]
ds_read_b128 a[60:63], v251 offset:23552
v_cvt_pk_bf16_f32 v70, v12, v13
v_mfma_f32_16x16x32_bf16 v[52:55], a[16:19], a[96:99], v[100:103]
v_exp_f32 v14, v14
v_mfma_f32_16x16x32_bf16 v[52:55], a[20:23], a[100:103], v[52:55]
v_exp_f32 v15, v15
v_mfma_f32_16x16x32_bf16 v[52:55], a[24:27], a[104:107], v[52:55]
s_cmp_le_u32 s33, 5
s_cselect_b64 vcc, -1, 0
v_cvt_pk_bf16_f32 v71, v14, v15
v_mfma_f32_16x16x32_bf16 v[52:55], a[28:31], a[108:111], v[52:55]
v_exp_f32 v16, v16
v_mfma_f32_16x16x32_bf16 v[60:63], a[16:19], a[112:115], v[108:111]
v_exp_f32 v17, v17
v_mfma_f32_16x16x32_bf16 v[60:63], a[20:23], a[116:119], v[60:63]
ds_read_b128 a[0:3], v250 offset:0
v_cvt_pk_bf16_f32 v72, v16, v17
v_mfma_f32_16x16x32_bf16 v[60:63], a[24:27], a[120:123], v[60:63]
v_exp_f32 v18, v18
v_mfma_f32_16x16x32_bf16 v[60:63], a[28:31], a[124:127], v[60:63]
s_waitcnt lgkmcnt(1)
v_mfma_f32_16x16x32_bf16 v[112:115], a[32:35], v[64:67], v[112:115]
v_exp_f32 v19, v19
v_mfma_f32_16x16x32_bf16 v[116:119], a[36:39], v[64:67], v[116:119]
ds_read_b128 a[4:7], v250 offset:1024
v_cvt_pk_bf16_f32 v73, v18, v19
v_mfma_f32_16x16x32_bf16 v[120:123], a[40:43], v[64:67], v[120:123]
v_exp_f32 v20, v20
v_mfma_f32_16x16x32_bf16 v[124:127], a[44:47], v[64:67], v[124:127]
buffer_load_dwordx4 v252, s[16:19], s25 offen offset:2048 sc1 lds
v_mfma_f32_16x16x32_bf16 v[128:131], a[48:51], v[64:67], v[128:131]
v_exp_f32 v21, v21
v_mfma_f32_16x16x32_bf16 v[132:135], a[52:55], v[64:67], v[132:135]
ds_read_b128 a[8:11], v250 offset:2048
v_cvt_pk_bf16_f32 v74, v20, v21
v_mfma_f32_16x16x32_bf16 v[136:139], a[56:59], v[64:67], v[136:139]
v_exp_f32 v22, v22
v_mfma_f32_16x16x32_bf16 v[140:143], a[60:63], v[64:67], v[140:143]
v_exp_f32 v23, v23
v_mfma_f32_16x16x32_bf16 a[160:163], a[176:179], v[64:67], a[160:163]
ds_read_b128 a[12:15], v250 offset:3072
v_cvt_pk_bf16_f32 v75, v22, v23
v_mfma_f32_16x16x32_bf16 v[144:147], a[32:35], v[68:71], v[144:147]
v_exp_f32 v24, v24
v_mfma_f32_16x16x32_bf16 v[148:151], a[36:39], v[68:71], v[148:151]
v_exp_f32 v25, v25
v_mfma_f32_16x16x32_bf16 v[152:155], a[40:43], v[68:71], v[152:155]
v_cvt_pk_bf16_f32 v76, v24, v25
v_mfma_f32_16x16x32_bf16 v[156:159], a[44:47], v[68:71], v[156:159]
v_exp_f32 v26, v26
v_mfma_f32_16x16x32_bf16 v[160:163], a[48:51], v[68:71], v[160:163]
v_exp_f32 v27, v27
v_mfma_f32_16x16x32_bf16 v[164:167], a[52:55], v[68:71], v[164:167]
ds_read_b128 a[16:19], v250 offset:4096
v_cvt_pk_bf16_f32 v77, v26, v27
v_mfma_f32_16x16x32_bf16 v[168:171], a[56:59], v[68:71], v[168:171]
v_exp_f32 v28, v28
v_mfma_f32_16x16x32_bf16 v[172:175], a[60:63], v[68:71], v[172:175]
v_exp_f32 v29, v29
v_mfma_f32_16x16x32_bf16 a[164:167], a[176:179], v[68:71], a[164:167]
buffer_load_dwordx4 v252, s[16:19], s25 offen offset:3072 sc1 lds
v_mfma_f32_16x16x32_bf16 v[176:179], a[32:35], v[72:75], v[176:179]
ds_read_b128 a[20:23], v250 offset:5120
v_cvt_pk_bf16_f32 v78, v28, v29
v_mfma_f32_16x16x32_bf16 v[180:183], a[36:39], v[72:75], v[180:183]
v_exp_f32 v30, v30
v_mfma_f32_16x16x32_bf16 v[184:187], a[40:43], v[72:75], v[184:187]
v_exp_f32 v31, v31
v_mfma_f32_16x16x32_bf16 v[188:191], a[44:47], v[72:75], v[188:191]
ds_read_b128 a[24:27], v250 offset:6144
v_cvt_pk_bf16_f32 v79, v30, v31
v_mfma_f32_16x16x32_bf16 v[192:195], a[48:51], v[72:75], v[192:195]
v_mfma_f32_16x16x32_bf16 v[196:199], a[52:55], v[72:75], v[196:199]
v_mfma_f32_16x16x32_bf16 v[200:203], a[56:59], v[72:75], v[200:203]
ds_read_b128 a[28:31], v250 offset:7168
v_mfma_f32_16x16x32_bf16 v[204:207], a[60:63], v[72:75], v[204:207]
v_mfma_f32_16x16x32_bf16 a[168:171], a[176:179], v[72:75], a[168:171]
v_add_u32 v250, s37, v252
v_mfma_f32_16x16x32_bf16 v[208:211], a[32:35], v[76:79], v[208:211]
v_mfma_f32_16x16x32_bf16 v[212:215], a[36:39], v[76:79], v[212:215]
v_mfma_f32_16x16x32_bf16 v[216:219], a[40:43], v[76:79], v[216:219]
v_mfma_f32_16x16x32_bf16 v[220:223], a[44:47], v[76:79], v[220:223]
v_mfma_f32_16x16x32_bf16 v[224:227], a[48:51], v[76:79], v[224:227]
v_mfma_f32_16x16x32_bf16 v[228:231], a[52:55], v[76:79], v[228:231]
v_mfma_f32_16x16x32_bf16 v[232:235], a[56:59], v[76:79], v[232:235]
v_mfma_f32_16x16x32_bf16 v[236:239], a[60:63], v[76:79], v[236:239]
v_mfma_f32_16x16x32_bf16 a[172:175], a[176:179], v[76:79], a[172:175]
s_cbranch_vccnz K2_rare10
K2_c1a:
s_waitcnt lgkmcnt(0)
v_mfma_f32_16x16x32_bf16 v[0:3], a[0:3], a[64:67], v[80:83]
s_add_u32 m0, m0, 0x1000
v_exp_f32 v32, v32
v_mfma_f32_16x16x32_bf16 v[0:3], a[4:7], a[68:71], v[0:3]
s_add_u32 s25, s25, 0x8000
v_exp_f32 v33, v33
v_mfma_f32_16x16x32_bf16 v[0:3], a[8:11], a[72:75], v[0:3]
ds_read_b128 a[32:35], v251 offset:24576
v_cvt_pk_bf16_f32 v64, v32, v33
v_mfma_f32_16x16x32_bf16 v[0:3], a[12:15], a[76:79], v[0:3]
v_exp_f32 v34, v34
v_mfma_f32_16x16x32_bf16 v[8:11], a[0:3], a[80:83], v[88:91]
s_mov_b32 s28, s27
v_exp_f32 v35, v35
v_mfma_f32_16x16x32_bf16 v[8:11], a[4:7], a[84:87], v[8:11]
s_mov_b32 s27, s26
ds_read_b128 a[36:39], v251 offset:25600
v_cvt_pk_bf16_f32 v65, v34, v35
v_mfma_f32_16x16x32_bf16 v[8:11], a[8:11], a[88:91], v[8:11]
s_add_u32 s26, s26, 0x8000
buffer_load_dwordx4 v252, s[16:19], s30 offen offset:0 sc1 lds
v_mfma_f32_16x16x32_bf16 v[8:11], a[12:15], a[92:95], v[8:11]
v_exp_f32 v36, v36
v_mfma_f32_16x16x32_bf16 v[16:19], a[0:3], a[96:99], v[96:99]
v_exp_f32 v37, v37
v_mfma_f32_16x16x32_bf16 v[16:19], a[4:7], a[100:103], v[16:19]
ds_read_b128 a[40:43], v251 offset:26624
v_cvt_pk_bf16_f32 v66, v36, v37
v_mfma_f32_16x16x32_bf16 v[16:19], a[8:11], a[104:107], v[16:19]
v_exp_f32 v38, v38
v_mfma_f32_16x16x32_bf16 v[16:19], a[12:15], a[108:111], v[16:19]
v_exp_f32 v39, v39
v_mfma_f32_16x16x32_bf16 v[24:27], a[0:3], a[112:115], v[104:107]
ds_read_b128 a[44:47], v251 offset:27648
v_cvt_pk_bf16_f32 v67, v38, v39
v_mfma_f32_16x16x32_bf16 v[24:27], a[4:7], a[116:119], v[24:27]
v_exp_f32 v40, v40
v_mfma_f32_16x16x32_bf16 v[24:27], a[8:11], a[120:123], v[24:27]
s_cmp_eq_u32 s26, 0x28000
s_cselect_b32 s26, 0, s26
ds_read_b128 a[48:51], v251 offset:28672
v_mfma_f32_16x16x32_bf16 v[24:27], a[12:15], a[124:127], v[24:27]
s_sub_u32 s33, s33, 1
v_exp_f32 v41, v41
v_mfma_f32_16x16x32_bf16 v[4:7], a[16:19], a[64:67], v[84:87]
ds_read_b128 a[52:55], v251 offset:29696
v_cvt_pk_bf16_f32 v68, v40, v41
v_mfma_f32_16x16x32_bf16 v[4:7], a[20:23], a[68:71], v[4:7]
v_exp_f32 v42, v42
v_mfma_f32_16x16x32_bf16 v[4:7], a[24:27], a[72:75], v[4:7]
v_exp_f32 v43, v43
v_mfma_f32_16x16x32_bf16 v[4:7], a[28:31], a[76:79], v[4:7]
ds_read_b128 a[56:59], v251 offset:30720
v_cvt_pk_bf16_f32 v69, v42, v43
v_mfma_f32_16x16x32_bf16 v[12:15], a[16:19], a[80:83], v[92:95]
buffer_load_dwordx4 v252, s[16:19], s30 offen offset:1024 sc1 lds
v_mfma_f32_16x16x32_bf16 v[12:15], a[20:23], a[84:87], v[12:15]
v_exp_f32 v44, v44
v_mfma_f32_16x16x32_bf16 v[12:15], a[24:27], a[88:91], v[12:15]
v_exp_f32 v45, v45
v_mfma_f32_16x16x32_bf16 v[12:15], a[28:31], a[92:95], v[12:15]
ds_read_b128 a[60:63], v251 offset:31744
v_cvt_pk_bf16_f32 v70, v44, v45
v_mfma_f32_16x16x32_bf16 v[20:23], a[16:19], a[96:99], v[100:103]
v_exp_f32 v46, v46
v_mfma_f32_16x16x32_bf16 v[20:23], a[20:23], a[100:103], v[20:23]
v_exp_f32 v47, v47
v_mfma_f32_16x16x32_bf16 v[20:23], a[24:27], a[104:107], v[20:23]
s_cmp_le_u32 s33, 5
s_cselect_b64 vcc, -1, 0
v_cvt_pk_bf16_f32 v71, v46, v47
v_mfma_f32_16x16x32_bf16 v[20:23], a[28:31], a[108:111], v[20:23]
v_exp_f32 v48, v48
v_mfma_f32_16x16x32_bf16 v[28:31], a[16:19], a[112:115], v[108:111]
v_exp_f32 v49, v49
v_mfma_f32_16x16x32_bf16 v[28:31], a[20:23], a[116:119], v[28:31]
ds_read_b128 a[0:3], v250 offset:0
v_cvt_pk_bf16_f32 v72, v48, v49
v_mfma_f32_16x16x32_bf16 v[28:31], a[24:27], a[120:123], v[28:31]
v_exp_f32 v50, v50
v_mfma_f32_16x16x32_bf16 v[28:31], a[28:31], a[124:127], v[28:31]
s_waitcnt lgkmcnt(1)
v_mfma_f32_16x16x32_bf16 v[112:115], a[32:35], v[64:67], v[112:115]
v_exp_f32 v51, v51
v_mfma_f32_16x16x32_bf16 v[116:119], a[36:39], v[64:67], v[116:119]
ds_read_b128 a[4:7], v250 offset:1024
v_cvt_pk_bf16_f32 v73, v50, v51
v_mfma_f32_16x16x32_bf16 v[120:123], a[40:43], v[64:67], v[120:123]
v_exp_f32 v52, v52
v_mfma_f32_16x16x32_bf16 v[124:127], a[44:47], v[64:67], v[124:127]
buffer_load_dwordx4 v252, s[16:19], s30 offen offset:2048 sc1 lds
v_mfma_f32_16x16x32_bf16 v[128:131], a[48:51], v[64:67], v[128:131]
v_exp_f32 v53, v53
v_mfma_f32_16x16x32_bf16 v[132:135], a[52:55], v[64:67], v[132:135]
ds_read_b128 a[8:11], v250 offset:2048
v_cvt_pk_bf16_f32 v74, v52, v53
v_mfma_f32_16x16x32_bf16 v[136:139], a[56:59], v[64:67], v[136:139]
v_exp_f32 v54, v54
v_mfma_f32_16x16x32_bf16 v[140:143], a[60:63], v[64:67], v[140:143]
v_exp_f32 v55, v55
v_mfma_f32_16x16x32_bf16 a[160:163], a[176:179], v[64:67], a[160:163]
ds_read_b128 a[12:15], v250 offset:3072
v_cvt_pk_bf16_f32 v75, v54, v55
v_mfma_f32_16x16x32_bf16 v[144:147], a[32:35], v[68:71], v[144:147]
v_exp_f32 v56, v56
v_mfma_f32_16x16x32_bf16 v[148:151], a[36:39], v[68:71], v[148:151]
v_exp_f32 v57, v57
v_mfma_f32_16x16x32_bf16 v[152:155], a[40:43], v[68:71], v[152:155]
v_cvt_pk_bf16_f32 v76, v56, v57
v_mfma_f32_16x16x32_bf16 v[156:159], a[44:47], v[68:71], v[156:159]
v_exp_f32 v58, v58
v_mfma_f32_16x16x32_bf16 v[160:163], a[48:51], v[68:71], v[160:163]
v_exp_f32 v59, v59
v_mfma_f32_16x16x32_bf16 v[164:167], a[52:55], v[68:71], v[164:167]
ds_read_b128 a[16:19], v250 offset:4096
v_cvt_pk_bf16_f32 v77, v58, v59
v_mfma_f32_16x16x32_bf16 v[168:171], a[56:59], v[68:71], v[168:171]
v_exp_f32 v60, v60
v_mfma_f32_16x16x32_bf16 v[172:175], a[60:63], v[68:71], v[172:175]
v_exp_f32 v61, v61
v_mfma_f32_16x16x32_bf16 a[164:167], a[176:179], v[68:71], a[164:167]
buffer_load_dwordx4 v252, s[16:19], s30 offen offset:3072 sc1 lds
v_mfma_f32_16x16x32_bf16 v[176:179], a[32:35], v[72:75], v[176:179]
ds_read_b128 a[20:23], v250 offset:5120
v_cvt_pk_bf16_f32 v78, v60, v61
v_mfma_f32_16x16x32_bf16 v[180:183], a[36:39], v[72:75], v[180:183]
v_exp_f32 v62, v62
v_mfma_f32_16x16x32_bf16 v[184:187], a[40:43], v[72:75], v[184:187]
v_exp_f32 v63, v63
v_mfma_f32_16x16x32_bf16 v[188:191], a[44:47], v[72:75], v[188:191]
ds_read_b128 a[24:27], v250 offset:6144
v_cvt_pk_bf16_f32 v79, v62, v63
v_mfma_f32_16x16x32_bf16 v[192:195], a[48:51], v[72:75], v[192:195]
v_mfma_f32_16x16x32_bf16 v[196:199], a[52:55], v[72:75], v[196:199]
v_mfma_f32_16x16x32_bf16 v[200:203], a[56:59], v[72:75], v[200:203]
ds_read_b128 a[28:31], v250 offset:7168
v_mfma_f32_16x16x32_bf16 v[204:207], a[60:63], v[72:75], v[204:207]
v_mfma_f32_16x16x32_bf16 a[168:171], a[176:179], v[72:75], a[168:171]
v_add_u32 v250, s27, v252
v_add_u32 v251, s26, v252
v_mfma_f32_16x16x32_bf16 v[208:211], a[32:35], v[76:79], v[208:211]
v_mfma_f32_16x16x32_bf16 v[212:215], a[36:39], v[76:79], v[212:215]
v_mfma_f32_16x16x32_bf16 v[216:219], a[40:43], v[76:79], v[216:219]
v_mfma_f32_16x16x32_bf16 v[220:223], a[44:47], v[76:79], v[220:223]
v_mfma_f32_16x16x32_bf16 v[224:227], a[48:51], v[76:79], v[224:227]
v_mfma_f32_16x16x32_bf16 v[228:231], a[52:55], v[76:79], v[228:231]
v_mfma_f32_16x16x32_bf16 v[232:235], a[56:59], v[76:79], v[232:235]
v_mfma_f32_16x16x32_bf16 v[236:239], a[60:63], v[76:79], v[236:239]
v_mfma_f32_16x16x32_bf16 a[172:175], a[176:179], v[76:79], a[172:175]
s_cbranch_vccz K2_loop1
K2_rare11:
K2_h1b:
s_cmp_eq_u32 s33, 0
s_cbranch_scc1 K2_trans
s_sub_u32 s37, 5, s33
s_sub_u32 s37, s37, s20
s_cmp_lt_i32 s37, 0
s_cbranch_scc1 Lme_2006
s_cmp_eq_i32 s37, 0
s_cbranch_scc1 Lmd_2005
v_mov_b32 v96, v254
v_mov_b32 v97, v254
v_mov_b32 v98, v254
v_mov_b32 v99, v254
v_mov_b32 v100, v254
v_mov_b32 v101, v254
v_mov_b32 v102, v254
v_mov_b32 v103, v254
v_mov_b32 v104, v254
v_mov_b32 v105, v254
v_mov_b32 v106, v254
v_mov_b32 v107, v254
v_mov_b32 v108, v254
v_mov_b32 v109, v254
v_mov_b32 v110, v254
v_mov_b32 v111, v254
s_branch Lme_2006
Lmd_2005:
v_cndmask_b32 v96, v96, v254, s[64:65]
v_mov_b32 v100, v254
v_cndmask_b32 v108, v108, v254, s[64:65]
v_cndmask_b32 v97, v97, v254, s[66:67]
v_mov_b32 v101, v254
v_cndmask_b32 v109, v109, v254, s[66:67]
v_cndmask_b32 v98, v98, v254, s[68:69]
v_mov_b32 v102, v254
v_cndmask_b32 v110, v110, v254, s[68:69]
v_cndmask_b32 v99, v99, v254, s[70:71]
v_mov_b32 v103, v254
v_cndmask_b32 v111, v111, v254, s[70:71]
Lme_2006:
s_cmp_eq_u32 s33, 2
s_cbranch_scc0 K2_loop1
v_add_u32 v250, s24, v250
s_branch K2_loop1
K2_rare10:
s_cmp_eq_u32 s33, 1
s_cbranch_scc1 K2_swap
s_sub_u32 s37, 5, s33
s_sub_u32 s37, s37, s20
s_cmp_lt_i32 s37, 0
s_cbranch_scc1 Lme_2008
s_cmp_eq_i32 s37, 0
s_cbranch_scc1 Lmd_2007
v_mov_b32 v96, v254
v_mov_b32 v97, v254
v_mov_b32 v98, v254
v_mov_b32 v99, v254
v_mov_b32 v100, v254
v_mov_b32 v101, v254
v_mov_b32 v102, v254
v_mov_b32 v103, v254
v_mov_b32 v104, v254
v_mov_b32 v105, v254
v_mov_b32 v106, v254
v_mov_b32 v107, v254
v_mov_b32 v108, v254
v_mov_b32 v109, v254
v_mov_b32 v110, v254
v_mov_b32 v111, v254
s_branch Lme_2008
Lmd_2007:
v_cndmask_b32 v96, v96, v254, s[64:65]
v_mov_b32 v100, v254
v_cndmask_b32 v108, v108, v254, s[64:65]
v_cndmask_b32 v97, v97, v254, s[66:67]
v_mov_b32 v101, v254
v_cndmask_b32 v109, v109, v254, s[66:67]
v_cndmask_b32 v98, v98, v254, s[68:69]
v_mov_b32 v102, v254
v_cndmask_b32 v110, v110, v254, s[68:69]
v_cndmask_b32 v99, v99, v254, s[70:71]
v_mov_b32 v103, v254
v_cndmask_b32 v111, v111, v254, s[70:71]
Lme_2008:
s_branch K2_c1a
K2_swap:
v_accvgpr_mov_b32 a96, a128
v_accvgpr_mov_b32 a97, a129
v_accvgpr_mov_b32 a98, a130
v_accvgpr_mov_b32 a99, a131
v_accvgpr_mov_b32 a100, a132
v_accvgpr_mov_b32 a101, a133
v_accvgpr_mov_b32 a102, a134
v_accvgpr_mov_b32 a103, a135
v_accvgpr_mov_b32 a104, a136
v_accvgpr_mov_b32 a105, a137
v_accvgpr_mov_b32 a106, a138
v_accvgpr_mov_b32 a107, a139
v_accvgpr_mov_b32 a108, a140
v_accvgpr_mov_b32 a109, a141
v_accvgpr_mov_b32 a110, a142
v_accvgpr_mov_b32 a111, a143
v_accvgpr_mov_b32 a112, a144
v_accvgpr_mov_b32 a113, a145
v_accvgpr_mov_b32 a114, a146
v_accvgpr_mov_b32 a115, a147
v_accvgpr_mov_b32 a116, a148
v_accvgpr_mov_b32 a117, a149
v_accvgpr_mov_b32 a118, a150
v_accvgpr_mov_b32 a119, a151
v_accvgpr_mov_b32 a120, a152
v_accvgpr_mov_b32 a121, a153
v_accvgpr_mov_b32 a122, a154
v_accvgpr_mov_b32 a123, a155
v_accvgpr_mov_b32 a124, a156
v_accvgpr_mov_b32 a125, a157
v_accvgpr_mov_b32 a126, a158
v_accvgpr_mov_b32 a127, a159
v_mov_b32 v96, 0
v_mov_b32 v97, 0
v_mov_b32 v98, 0
v_mov_b32 v99, 0
v_mov_b32 v100, 0
v_mov_b32 v101, 0
v_mov_b32 v102, 0
v_mov_b32 v103, 0
v_mov_b32 v104, 0
v_mov_b32 v105, 0
v_mov_b32 v106, 0
v_mov_b32 v107, 0
v_mov_b32 v108, 0
v_mov_b32 v109, 0
v_mov_b32 v110, 0
v_mov_b32 v111, 0
s_mov_b32 s34, 0x7f800000
s_lshl_b32 s39, s2, 2
s_add_u32 s39, s39, s20
s_mov_b32 s75, 0x00020000
v_lshlrev_b32 v248, 3, v253
s_mov_b32 s72, s86
s_and_b32 s73, s87, 0xffff
s_mov_b32 s74, 4194304
s_lshl_b32 s37, s39, 12
buffer_load_dword a254, v252, s[72:75], s37 offen offset:0
buffer_load_dword a254, v252, s[72:75], s37 offen offset:1024
buffer_load_dword a254, v252, s[72:75], s37 offen offset:2048
buffer_load_dword a254, v252, s[72:75], s37 offen offset:3072
s_mov_b32 s72, s94
s_and_b32 s73, s95, 0xffff
s_mov_b32 s74, 524288
s_lshl_b32 s37, s39, 9
buffer_load_dword a254, v248, s[72:75], s37 offen
s_cmp_eq_u32 s22, 7
s_cbranch_scc0 K2_c1a
s_and_b32 s39, s20, 1
s_add_u32 s39, s39, 0
s_sub_u32 s37, s39, s20
s_cmp_lt_i32 s37, 0
s_cbranch_scc1 Lme_2010
s_cmp_eq_i32 s37, 0
s_cbranch_scc1 Lmd_2009
v_mov_b32 v80, v254
v_mov_b32 v81, v254
v_mov_b32 v82, v254
v_mov_b32 v83, v254
v_mov_b32 v84, v254
v_mov_b32 v85, v254
v_mov_b32 v86, v254
v_mov_b32 v87, v254
v_mov_b32 v88, v254
v_mov_b32 v89, v254
v_mov_b32 v90, v254
v_mov_b32 v91, v254
v_mov_b32 v92, v254
v_mov_b32 v93, v254
v_mov_b32 v94, v254
v_mov_b32 v95, v254
s_branch Lme_2010
Lmd_2009:
v_cndmask_b32 v80, v80, v254, s[64:65]
v_mov_b32 v84, v254
v_cndmask_b32 v92, v92, v254, s[64:65]
v_cndmask_b32 v81, v81, v254, s[66:67]
v_mov_b32 v85, v254
v_cndmask_b32 v93, v93, v254, s[66:67]
v_cndmask_b32 v82, v82, v254, s[68:69]
v_mov_b32 v86, v254
v_cndmask_b32 v94, v94, v254, s[68:69]
v_cndmask_b32 v83, v83, v254, s[70:71]
v_mov_b32 v87, v254
v_cndmask_b32 v95, v95, v254, s[70:71]
Lme_2010:
s_xor_b32 s37, s20, 1
s_sub_u32 s37, s39, s37
s_cmp_lt_i32 s37, 0
s_cbranch_scc1 Lme_2012
s_cmp_eq_i32 s37, 0
s_cbranch_scc1 Lmd_2011
v_mov_b32 v96, v254
v_mov_b32 v97, v254
v_mov_b32 v98, v254
v_mov_b32 v99, v254
v_mov_b32 v100, v254
v_mov_b32 v101, v254
v_mov_b32 v102, v254
v_mov_b32 v103, v254
v_mov_b32 v104, v254
v_mov_b32 v105, v254
v_mov_b32 v106, v254
v_mov_b32 v107, v254
v_mov_b32 v108, v254
v_mov_b32 v109, v254
v_mov_b32 v110, v254
v_mov_b32 v111, v254
s_branch Lme_2012
Lmd_2011:
v_cndmask_b32 v96, v96, v254, s[64:65]
v_mov_b32 v100, v254
v_cndmask_b32 v108, v108, v254, s[64:65]
v_cndmask_b32 v97, v97, v254, s[66:67]
v_mov_b32 v101, v254
v_cndmask_b32 v109, v109, v254, s[66:67]
v_cndmask_b32 v98, v98, v254, s[68:69]
v_mov_b32 v102, v254
v_cndmask_b32 v110, v110, v254, s[68:69]
v_cndmask_b32 v99, v99, v254, s[70:71]
v_mov_b32 v103, v254
v_cndmask_b32 v111, v111, v254, s[70:71]
Lme_2012:
s_branch K2_c1a
K2_trans:
s_lshl_b32 s37, s22, 2
s_add_u32 s37, s37, s20
s_lshl_b32 s37, s37, 18
s_lshl_b32 s38, s21, 12
s_add_u32 s37, s37, s38
s_add_u32 s37, s37, 0x2000000
s_add_u32 s38, s37, 0x20000
s_nop 3
v_accvgpr_read_b32 v248, a168
s_nop 0
v_cmp_nlt_f32 vcc, v248, v255
s_or_b32 s43, s43, vcc_lo
s_or_b32 s43, s43, vcc_hi
v_rcp_f32 v248, v248
s_nop 0
v_pk_mul_f32 v[176:177], v[176:177], v[248:249] op_sel_hi:[1,0]
v_pk_mul_f32 v[178:179], v[178:179], v[248:249] op_sel_hi:[1,0]
v_pk_mul_f32 v[180:181], v[180:181], v[248:249] op_sel_hi:[1,0]
v_pk_mul_f32 v[182:183], v[182:183], v[248:249] op_sel_hi:[1,0]
v_cvt_pk_bf16_f32 v32, v176, v177
v_cvt_pk_bf16_f32 v33, v178, v179
v_cvt_pk_bf16_f32 v34, v180, v181
v_cvt_pk_bf16_f32 v35, v182, v183
buffer_store_dwordx4 v[32:35], v252, s[4:7], s37 offen offset:0 sc1
v_pk_mul_f32 v[184:185], v[184:185], v[248:249] op_sel_hi:[1,0]
v_pk_mul_f32 v[186:187], v[186:187], v[248:249] op_sel_hi:[1,0]
v_pk_mul_f32 v[188:189], v[188:189], v[248:249] op_sel_hi:[1,0]
v_pk_mul_f32 v[190:191], v[190:191], v[248:249] op_sel_hi:[1,0]
v_cvt_pk_bf16_f32 v36, v184, v185
v_cvt_pk_bf16_f32 v37, v186, v187
v_cvt_pk_bf16_f32 v38, v188, v189
v_cvt_pk_bf16_f32 v39, v190, v191
buffer_store_dwordx4 v[36:39], v252, s[4:7], s37 offen offset:1024 sc1
v_pk_mul_f32 v[192:193], v[192:193], v[248:249] op_sel_hi:[1,0]
v_pk_mul_f32 v[194:195], v[194:195], v[248:249] op_sel_hi:[1,0]
v_pk_mul_f32 v[196:197], v[196:197], v[248:249] op_sel_hi:[1,0]
v_pk_mul_f32 v[198:199], v[198:199], v[248:249] op_sel_hi:[1,0]
v_cvt_pk_bf16_f32 v40, v192, v193
v_cvt_pk_bf16_f32 v41, v194, v195
v_cvt_pk_bf16_f32 v42, v196, v197
v_cvt_pk_bf16_f32 v43, v198, v199
buffer_store_dwordx4 v[40:43], v252, s[4:7], s37 offen offset:2048 sc1
v_pk_mul_f32 v[200:201], v[200:201], v[248:249] op_sel_hi:[1,0]
v_pk_mul_f32 v[202:203], v[202:203], v[248:249] op_sel_hi:[1,0]
v_pk_mul_f32 v[204:205], v[204:205], v[248:249] op_sel_hi:[1,0]
v_pk_mul_f32 v[206:207], v[206:207], v[248:249] op_sel_hi:[1,0]
v_cvt_pk_bf16_f32 v44, v200, v201
v_cvt_pk_bf16_f32 v45, v202, v203
v_cvt_pk_bf16_f32 v46, v204, v205
v_cvt_pk_bf16_f32 v47, v206, v207
buffer_store_dwordx4 v[44:47], v252, s[4:7], s37 offen offset:3072 sc1
v_accvgpr_read_b32 v248, a172
s_nop 0
v_cmp_nlt_f32 vcc, v248, v255
s_or_b32 s43, s43, vcc_lo
s_or_b32 s43, s43, vcc_hi
v_rcp_f32 v248, v248
s_nop 0
v_pk_mul_f32 v[208:209], v[208:209], v[248:249] op_sel_hi:[1,0]
v_pk_mul_f32 v[210:211], v[210:211], v[248:249] op_sel_hi:[1,0]
v_pk_mul_f32 v[212:213], v[212:213], v[248:249] op_sel_hi:[1,0]
v_pk_mul_f32 v[214:215], v[214:215], v[248:249] op_sel_hi:[1,0]
v_cvt_pk_bf16_f32 v48, v208, v209
v_cvt_pk_bf16_f32 v49, v210, v211
v_cvt_pk_bf16_f32 v50, v212, v213
v_cvt_pk_bf16_f32 v51, v214, v215
buffer_store_dwordx4 v[48:51], v252, s[4:7], s38 offen offset:0 sc1
v_pk_mul_f32 v[216:217], v[216:217], v[248:249] op_sel_hi:[1,0]
v_pk_mul_f32 v[218:219], v[218:219], v[248:249] op_sel_hi:[1,0]
v_pk_mul_f32 v[220:221], v[220:221], v[248:249] op_sel_hi:[1,0]
v_pk_mul_f32 v[222:223], v[222:223], v[248:249] op_sel_hi:[1,0]
v_cvt_pk_bf16_f32 v52, v216, v217
v_cvt_pk_bf16_f32 v53, v218, v219
v_cvt_pk_bf16_f32 v54, v220, v221
v_cvt_pk_bf16_f32 v55, v222, v223
buffer_store_dwordx4 v[52:55], v252, s[4:7], s38 offen offset:1024 sc1
v_pk_mul_f32 v[224:225], v[224:225], v[248:249] op_sel_hi:[1,0]
v_pk_mul_f32 v[226:227], v[226:227], v[248:249] op_sel_hi:[1,0]
v_pk_mul_f32 v[228:229], v[228:229], v[248:249] op_sel_hi:[1,0]
v_pk_mul_f32 v[230:231], v[230:231], v[248:249] op_sel_hi:[1,0]
v_cvt_pk_bf16_f32 v56, v224, v225
v_cvt_pk_bf16_f32 v57, v226, v227
v_cvt_pk_bf16_f32 v58, v228, v229
v_cvt_pk_bf16_f32 v59, v230, v231
buffer_store_dwordx4 v[56:59], v252, s[4:7], s38 offen offset:2048 sc1
v_pk_mul_f32 v[232:233], v[232:233], v[248:249] op_sel_hi:[1,0]
v_pk_mul_f32 v[234:235], v[234:235], v[248:249] op_sel_hi:[1,0]
v_pk_mul_f32 v[236:237], v[236:237], v[248:249] op_sel_hi:[1,0]
v_pk_mul_f32 v[238:239], v[238:239], v[248:249] op_sel_hi:[1,0]
v_cvt_pk_bf16_f32 v60, v232, v233
v_cvt_pk_bf16_f32 v61, v234, v235
v_cvt_pk_bf16_f32 v62, v236, v237
v_cvt_pk_bf16_f32 v63, v238, v239
buffer_store_dwordx4 v[60:63], v252, s[4:7], s38 offen offset:3072 sc1
v_max3_f32 v246, v16, v17, v18
v_max3_f32 v246, v246, v19, v20
v_max3_f32 v246, v246, v21, v22
v_max_f32 v246, v246, v23
v_mov_b32 v248, v246
s_nop 1
v_permlane16_swap_b32 v246, v248
v_max_f32 v246, v246, v248
v_mov_b32 v248, v246
s_nop 1
v_permlane32_swap_b32 v246, v248
v_max_f32 v246, v246, v248
v_max_f32 v246, 0xf149f2ca, v246
v_add_f32 v246, 0x42400000, v246
v_ceil_f32 v242, v246
v_sub_f32 v246, 0, v242
v_pk_add_f32 v[16:17], v[16:17], v[246:247] op_sel_hi:[1,0]
v_pk_add_f32 v[18:19], v[18:19], v[246:247] op_sel_hi:[1,0]
v_pk_add_f32 v[20:21], v[20:21], v[246:247] op_sel_hi:[1,0]
v_pk_add_f32 v[22:23], v[22:23], v[246:247] op_sel_hi:[1,0]
v_mov_b32 v96, v246
v_mov_b32 v97, v246
v_mov_b32 v98, v246
v_mov_b32 v99, v246
v_mov_b32 v100, v246
v_mov_b32 v101, v246
v_mov_b32 v102, v246
v_mov_b32 v103, v246
v_max3_f32 v246, v24, v25, v26
v_max3_f32 v246, v246, v27, v28
v_max3_f32 v246, v246, v29, v30
v_max_f32 v246, v246, v31
v_mov_b32 v248, v246
s_nop 1
v_permlane16_swap_b32 v246, v248
v_max_f32 v246, v246, v248
v_mov_b32 v248, v246
s_nop 1
v_permlane32_swap_b32 v246, v248
v_max_f32 v246, v246, v248
v_max_f32 v246, 0xf149f2ca, v246
v_add_f32 v246, 0x42400000, v246
v_ceil_f32 v243, v246
v_sub_f32 v246, 0, v243
v_pk_add_f32 v[24:25], v[24:25], v[246:247] op_sel_hi:[1,0]
v_pk_add_f32 v[26:27], v[26:27], v[246:247] op_sel_hi:[1,0]
v_pk_add_f32 v[28:29], v[28:29], v[246:247] op_sel_hi:[1,0]
v_pk_add_f32 v[30:31], v[30:31], v[246:247] op_sel_hi:[1,0]
v_mov_b32 v104, v246
v_mov_b32 v105, v246
v_mov_b32 v106, v246
v_mov_b32 v107, v246
v_mov_b32 v108, v246
v_mov_b32 v109, v246
v_mov_b32 v110, v246
v_mov_b32 v111, v246
s_mov_b32 s34, 0x42800000
s_add_u32 s37, s26, s24
v_add_u32 v250, s37, v252
v_mov_b32 v251, v250
s_lshl_b32 s33, s22, 2
s_sub_u32 s33, 30, s33
K2_t1:
s_cmp_eq_u32 s33, 2
s_cbranch_scc0 K2_f2
s_and_b32 s39, s20, 1
s_add_u32 s39, s39, 2
s_sub_u32 s37, s39, s20
s_cmp_lt_i32 s37, 0
s_cbranch_scc1 Lme_2014
s_cmp_eq_i32 s37, 0
s_cbranch_scc1 Lmd_2013
v_mov_b32 v80, v254
v_mov_b32 v81, v254
v_mov_b32 v82, v254
v_mov_b32 v83, v254
v_mov_b32 v84, v254
v_mov_b32 v85, v254
v_mov_b32 v86, v254
v_mov_b32 v87, v254
v_mov_b32 v88, v254
v_mov_b32 v89, v254
v_mov_b32 v90, v254
v_mov_b32 v91, v254
v_mov_b32 v92, v254
v_mov_b32 v93, v254
v_mov_b32 v94, v254
v_mov_b32 v95, v254
s_branch Lme_2014
Lmd_2013:
v_cndmask_b32 v80, v80, v254, s[64:65]
v_mov_b32 v84, v254
v_cndmask_b32 v92, v92, v254, s[64:65]
v_cndmask_b32 v81, v81, v254, s[66:67]
v_mov_b32 v85, v254
v_cndmask_b32 v93, v93, v254, s[66:67]
v_cndmask_b32 v82, v82, v254, s[68:69]
v_mov_b32 v86, v254
v_cndmask_b32 v94, v94, v254, s[68:69]
v_cndmask_b32 v83, v83, v254, s[70:71]
v_mov_b32 v87, v254
v_cndmask_b32 v95, v95, v254, s[70:71]
Lme_2014:
s_xor_b32 s37, s20, 1
s_sub_u32 s37, s39, s37
s_cmp_lt_i32 s37, 0
s_cbranch_scc1 Lme_2016
s_cmp_eq_i32 s37, 0
s_cbranch_scc1 Lmd_2015
v_mov_b32 v96, v254
v_mov_b32 v97, v254
v_mov_b32 v98, v254
v_mov_b32 v99, v254
v_mov_b32 v100, v254
v_mov_b32 v101, v254
v_mov_b32 v102, v254
v_mov_b32 v103, v254
v_mov_b32 v104, v254
v_mov_b32 v105, v254
v_mov_b32 v106, v254
v_mov_b32 v107, v254
v_mov_b32 v108, v254
v_mov_b32 v109, v254
v_mov_b32 v110, v254
v_mov_b32 v111, v254
s_branch Lme_2016
Lmd_2015:
v_cndmask_b32 v96, v96, v254, s[64:65]
v_mov_b32 v100, v254
v_cndmask_b32 v108, v108, v254, s[64:65]
v_cndmask_b32 v97, v97, v254, s[66:67]
v_mov_b32 v101, v254
v_cndmask_b32 v109, v109, v254, s[66:67]
v_cndmask_b32 v98, v98, v254, s[68:69]
v_mov_b32 v102, v254
v_cndmask_b32 v110, v110, v254, s[68:69]
v_cndmask_b32 v99, v99, v254, s[70:71]
v_mov_b32 v103, v254
v_cndmask_b32 v111, v111, v254, s[70:71]
Lme_2016:
s_lshr_b32 s37, s21, 2
s_lshl_b32 s37, s37, 7
s_add_u32 s37, s37, 0x3c03000
v_and_b32 v248, 31, v253
v_lshlrev_b32 v248, 2, v248
buffer_load_dword a253, v248, s[4:7], s37 offen sc1
K2_f2:
s_waitcnt vmcnt(16) lgkmcnt(0)
s_barrier
v_mfma_f32_16x16x32_bf16 v[32:35], a[0:3], a[64:67], v[80:83]
s_add_u32 m0, s29, s28
v_exp_f32 v0, v0
v_mfma_f32_16x16x32_bf16 v[32:35], a[4:7], a[68:71], v[32:35]
s_add_u32 s30, s25, 0x1000
v_exp_f32 v1, v1
v_mfma_f32_16x16x32_bf16 v[32:35], a[8:11], a[72:75], v[32:35]
ds_read_b128 a[32:35], v251 offset:16384
v_cvt_pk_bf16_f32 v64, v0, v1
v_mfma_f32_16x16x32_bf16 v[32:35], a[12:15], a[76:79], v[32:35]
v_exp_f32 v2, v2
v_mfma_f32_16x16x32_bf16 v[40:43], a[0:3], a[80:83], v[88:91]
s_mov_b32 s28, s27
v_exp_f32 v3, v3
v_mfma_f32_16x16x32_bf16 v[40:43], a[4:7], a[84:87], v[40:43]
s_mov_b32 s27, s26
ds_read_b128 a[36:39], v251 offset:17408
v_cvt_pk_bf16_f32 v65, v2, v3
v_mfma_f32_16x16x32_bf16 v[40:43], a[8:11], a[88:91], v[40:43]
s_add_u32 s26, s26, 0x8000
buffer_load_dwordx4 v252, s[16:19], s25 offen offset:0 sc1 lds
v_mfma_f32_16x16x32_bf16 v[40:43], a[12:15], a[92:95], v[40:43]
v_exp_f32 v4, v4
v_mfma_f32_16x16x32_bf16 v[48:51], a[0:3], a[96:99], v[96:99]
v_exp_f32 v5, v5
v_mfma_f32_16x16x32_bf16 v[48:51], a[4:7], a[100:103], v[48:51]
ds_read_b128 a[40:43], v251 offset:18432
v_cvt_pk_bf16_f32 v66, v4, v5
v_mfma_f32_16x16x32_bf16 v[48:51], a[8:11], a[104:107], v[48:51]
v_exp_f32 v6, v6
v_mfma_f32_16x16x32_bf16 v[48:51], a[12:15], a[108:111], v[48:51]
v_exp_f32 v7, v7
v_mfma_f32_16x16x32_bf16 v[56:59], a[0:3], a[112:115], v[104:107]
ds_read_b128 a[44:47], v251 offset:19456
v_cvt_pk_bf16_f32 v67, v6, v7
v_mfma_f32_16x16x32_bf16 v[56:59], a[4:7], a[116:119], v[56:59]
buffer_load_dwordx4 v252, s[16:19], s25 offen offset:1024 sc1 lds
v_mfma_f32_16x16x32_bf16 v[56:59], a[8:11], a[120:123], v[56:59]
v_exp_f32 v8, v8
v_mfma_f32_16x16x32_bf16 v[56:59], a[12:15], a[124:127], v[56:59]
ds_read_b128 a[48:51], v251 offset:20480
ds_read_b128 a[52:55], v251 offset:21504
v_mfma_f32_16x16x32_bf16 v[36:39], a[16:19], a[64:67], v[84:87]
v_exp_f32 v9, v9
v_mfma_f32_16x16x32_bf16 v[36:39], a[20:23], a[68:71], v[36:39]
s_cmp_eq_u32 s26, 0x28000
s_cselect_b32 s26, 0, s26
v_cvt_pk_bf16_f32 v68, v8, v9
v_mfma_f32_16x16x32_bf16 v[36:39], a[24:27], a[72:75], v[36:39]
s_add_u32 s37, s26, s24
v_exp_f32 v10, v10
v_mfma_f32_16x16x32_bf16 v[36:39], a[28:31], a[76:79], v[36:39]
s_sub_u32 s33, s33, 1
v_exp_f32 v11, v11
v_mfma_f32_16x16x32_bf16 v[44:47], a[16:19], a[80:83], v[92:95]
ds_read_b128 a[56:59], v251 offset:22528
v_cvt_pk_bf16_f32 v69, v10, v11
v_mfma_f32_16x16x32_bf16 v[44:47], a[20:23], a[84:87], v[44:47]
buffer_load_dwordx4 v252, s[16:19], s25 offen offset:2048 sc1 lds
v_mfma_f32_16x16x32_bf16 v[44:47], a[24:27], a[88:91], v[44:47]
v_exp_f32 v12, v12
v_mfma_f32_16x16x32_bf16 v[44:47], a[28:31], a[92:95], v[44:47]
v_exp_f32 v13, v13
v_mfma_f32_16x16x32_bf16 v[52:55], a[16:19], a[96:99], v[100:103]
ds_read_b128 a[60:63], v251 offset:23552
v_cvt_pk_bf16_f32 v70, v12, v13
v_mfma_f32_16x16x32_bf16 v[52:55], a[20:23], a[100:103], v[52:55]
v_exp_f32 v14, v14
v_mfma_f32_16x16x32_bf16 v[52:55], a[24:27], a[104:107], v[52:55]
v_exp_f32 v15, v15
v_mfma_f32_16x16x32_bf16 v[52:55], a[28:31], a[108:111], v[52:55]
s_cmp_le_u32 s33, 3
s_cselect_b64 vcc, -1, 0
v_cvt_pk_bf16_f32 v71, v14, v15
v_mfma_f32_16x16x32_bf16 v[60:63], a[16:19], a[112:115], v[108:111]
buffer_load_dwordx4 v252, s[16:19], s25 offen offset:3072 sc1 lds
v_mfma_f32_16x16x32_bf16 v[60:63], a[20:23], a[116:119], v[60:63]
s_add_u32 m0, m0, 0x1000
v_exp_f32 v16, v16
v_mfma_f32_16x16x32_bf16 v[60:63], a[24:27], a[120:123], v[60:63]
s_add_u32 s25, s25, 0x8000
v_exp_f32 v17, v17
v_mfma_f32_16x16x32_bf16 v[60:63], a[28:31], a[124:127], v[60:63]
v_cvt_pk_bf16_f32 v72, v16, v17
s_waitcnt lgkmcnt(0)
v_mfma_f32_16x16x32_bf16 v[112:115], a[32:35], v[64:67], v[112:115]
v_exp_f32 v18, v18
v_mfma_f32_16x16x32_bf16 v[116:119], a[36:39], v[64:67], v[116:119]
ds_read_b128 a[0:3], v250 offset:0
ds_read_b128 a[4:7], v250 offset:1024
v_mfma_f32_16x16x32_bf16 v[120:123], a[40:43], v[64:67], v[120:123]
v_exp_f32 v19, v19
v_mfma_f32_16x16x32_bf16 v[124:127], a[44:47], v[64:67], v[124:127]
v_cvt_pk_bf16_f32 v73, v18, v19
v_mfma_f32_16x16x32_bf16 v[128:131], a[48:51], v[64:67], v[128:131]
v_exp_f32 v20, v20
v_mfma_f32_16x16x32_bf16 v[132:135], a[52:55], v[64:67], v[132:135]
buffer_load_dwordx4 v252, s[16:19], s30 offen offset:0 sc1 lds
v_mfma_f32_16x16x32_bf16 v[136:139], a[56:59], v[64:67], v[136:139]
v_exp_f32 v21, v21
v_mfma_f32_16x16x32_bf16 v[140:143], a[60:63], v[64:67], v[140:143]
ds_read_b128 a[8:11], v250 offset:2048
v_cvt_pk_bf16_f32 v74, v20, v21
v_mfma_f32_16x16x32_bf16 a[160:163], a[176:179], v[64:67], a[160:163]
v_exp_f32 v22, v22
v_mfma_f32_16x16x32_bf16 v[144:147], a[32:35], v[68:71], v[144:147]
v_exp_f32 v23, v23
v_mfma_f32_16x16x32_bf16 v[148:151], a[36:39], v[68:71], v[148:151]
ds_read_b128 a[12:15], v250 offset:3072
v_cvt_pk_bf16_f32 v75, v22, v23
v_mfma_f32_16x16x32_bf16 v[152:155], a[40:43], v[68:71], v[152:155]
v_exp_f32 v24, v24
v_mfma_f32_16x16x32_bf16 v[156:159], a[44:47], v[68:71], v[156:159]
buffer_load_dwordx4 v252, s[16:19], s30 offen offset:1024 sc1 lds
v_mfma_f32_16x16x32_bf16 v[160:163], a[48:51], v[68:71], v[160:163]
v_exp_f32 v25, v25
v_mfma_f32_16x16x32_bf16 v[164:167], a[52:55], v[68:71], v[164:167]
ds_read_b128 a[16:19], v250 offset:4096
v_cvt_pk_bf16_f32 v76, v24, v25
v_mfma_f32_16x16x32_bf16 v[168:171], a[56:59], v[68:71], v[168:171]
v_exp_f32 v26, v26
v_mfma_f32_16x16x32_bf16 v[172:175], a[60:63], v[68:71], v[172:175]
v_exp_f32 v27, v27
v_mfma_f32_16x16x32_bf16 a[164:167], a[176:179], v[68:71], a[164:167]
ds_read_b128 a[20:23], v250 offset:5120
v_cvt_pk_bf16_f32 v77, v26, v27
v_mfma_f32_16x16x32_bf16 v[176:179], a[32:35], v[72:75], 0
v_exp_f32 v28, v28
v_mfma_f32_16x16x32_bf16 v[180:183], a[36:39], v[72:75], 0
v_exp_f32 v29, v29
v_mfma_f32_16x16x32_bf16 v[184:187], a[40:43], v[72:75], 0
buffer_load_dwordx4 v252, s[16:19], s30 offen offset:2048 sc1 lds
v_mfma_f32_16x16x32_bf16 v[188:191], a[44:47], v[72:75], 0
ds_read_b128 a[24:27], v250 offset:6144
v_cvt_pk_bf16_f32 v78, v28, v29
v_mfma_f32_16x16x32_bf16 v[192:195], a[48:51], v[72:75], 0
v_exp_f32 v30, v30
v_mfma_f32_16x16x32_bf16 v[196:199], a[52:55], v[72:75], 0
v_exp_f32 v31, v31
v_mfma_f32_16x16x32_bf16 v[200:203], a[56:59], v[72:75], 0
ds_read_b128 a[28:31], v250 offset:7168
v_cvt_pk_bf16_f32 v79, v30, v31
v_mfma_f32_16x16x32_bf16 v[204:207], a[60:63], v[72:75], 0
buffer_load_dwordx4 v252, s[16:19], s30 offen offset:3072 sc1 lds
v_mfma_f32_16x16x32_bf16 a[168:171], a[176:179], v[72:75], 0
v_add_u32 v250, s37, v252
v_add_u32 v251, s37, v252
v_mfma_f32_16x16x32_bf16 v[208:211], a[32:35], v[76:79], 0
v_mfma_f32_16x16x32_bf16 v[212:215], a[36:39], v[76:79], 0
v_mfma_f32_16x16x32_bf16 v[216:219], a[40:43], v[76:79], 0
v_mfma_f32_16x16x32_bf16 v[220:223], a[44:47], v[76:79], 0
v_mfma_f32_16x16x32_bf16 v[224:227], a[48:51], v[76:79], 0
v_mfma_f32_16x16x32_bf16 v[228:231], a[52:55], v[76:79], 0
v_mfma_f32_16x16x32_bf16 v[232:235], a[56:59], v[76:79], 0
v_mfma_f32_16x16x32_bf16 v[236:239], a[60:63], v[76:79], 0
v_mfma_f32_16x16x32_bf16 a[172:175], a[176:179], v[76:79], 0
s_cbranch_vccnz K2_rare20
s_branch K2_c2a
.p2align 6
K2_loop2:
s_waitcnt vmcnt(8) lgkmcnt(0)
s_barrier
v_mfma_f32_16x16x32_bf16 v[32:35], a[0:3], a[64:67], v[80:83]
s_add_u32 m0, s29, s28
v_exp_f32 v0, v0
v_mfma_f32_16x16x32_bf16 v[32:35], a[4:7], a[68:71], v[32:35]
s_add_u32 s30, s25, 0x1000
v_exp_f32 v1, v1
v_mfma_f32_16x16x32_bf16 v[32:35], a[8:11], a[72:75], v[32:35]
ds_read_b128 a[32:35], v251 offset:16384
v_cvt_pk_bf16_f32 v64, v0, v1
v_mfma_f32_16x16x32_bf16 v[32:35], a[12:15], a[76:79], v[32:35]
v_exp_f32 v2, v2
v_mfma_f32_16x16x32_bf16 v[40:43], a[0:3], a[80:83], v[88:91]
s_mov_b32 s28, s27
v_exp_f32 v3, v3
v_mfma_f32_16x16x32_bf16 v[40:43], a[4:7], a[84:87], v[40:43]
s_mov_b32 s27, s26
ds_read_b128 a[36:39], v251 offset:17408
v_cvt_pk_bf16_f32 v65, v2, v3
v_mfma_f32_16x16x32_bf16 v[40:43], a[8:11], a[88:91], v[40:43]
s_add_u32 s26, s26, 0x8000
buffer_load_dwordx4 v252, s[16:19], s25 offen offset:0 sc1 lds
v_mfma_f32_16x16x32_bf16 v[40:43], a[12:15], a[92:95], v[40:43]
v_exp_f32 v4, v4
v_mfma_f32_16x16x32_bf16 v[48:51], a[0:3], a[96:99], v[96:99]
v_exp_f32 v5, v5
v_mfma_f32_16x16x32_bf16 v[48:51], a[4:7], a[100:103], v[48:51]
ds_read_b128 a[40:43], v251 offset:18432
v_cvt_pk_bf16_f32 v66, v4, v5
v_mfma_f32_16x16x32_bf16 v[48:51], a[8:11], a[104:107], v[48:51]
v_exp_f32 v6, v6
v_mfma_f32_16x16x32_bf16 v[48:51], a[12:15], a[108:111], v[48:51]
v_exp_f32 v7, v7
v_mfma_f32_16x16x32_bf16 v[56:59], a[0:3], a[112:115], v[104:107]
ds_read_b128 a[44:47], v251 offset:19456
v_cvt_pk_bf16_f32 v67, v6, v7
v_mfma_f32_16x16x32_bf16 v[56:59], a[4:7], a[116:119], v[56:59]
buffer_load_dwordx4 v252, s[16:19], s25 offen offset:1024 sc1 lds
v_mfma_f32_16x16x32_bf16 v[56:59], a[8:11], a[120:123], v[56:59]
v_exp_f32 v8, v8
v_mfma_f32_16x16x32_bf16 v[56:59], a[12:15], a[124:127], v[56:59]
ds_read_b128 a[48:51], v251 offset:20480
ds_read_b128 a[52:55], v251 offset:21504
v_mfma_f32_16x16x32_bf16 v[36:39], a[16:19], a[64:67], v[84:87]
v_exp_f32 v9, v9
v_mfma_f32_16x16x32_bf16 v[36:39], a[20:23], a[68:71], v[36:39]
s_cmp_eq_u32 s26, 0x28000
s_cselect_b32 s26, 0, s26
v_cvt_pk_bf16_f32 v68, v8, v9
v_mfma_f32_16x16x32_bf16 v[36:39], a[24:27], a[72:75], v[36:39]
s_add_u32 s37, s26, s24
v_exp_f32 v10, v10
v_mfma_f32_16x16x32_bf16 v[36:39], a[28:31], a[76:79], v[36:39]
s_sub_u32 s33, s33, 1
v_exp_f32 v11, v11
v_mfma_f32_16x16x32_bf16 v[44:47], a[16:19], a[80:83], v[92:95]
ds_read_b128 a[56:59], v251 offset:22528
v_cvt_pk_bf16_f32 v69, v10, v11
v_mfma_f32_16x16x32_bf16 v[44:47], a[20:23], a[84:87], v[44:47]
buffer_load_dwordx4 v252, s[16:19], s25 offen offset:2048 sc1 lds
v_mfma_f32_16x16x32_bf16 v[44:47], a[24:27], a[88:91], v[44:47]
v_exp_f32 v12, v12
v_mfma_f32_16x16x32_bf16 v[44:47], a[28:31], a[92:95], v[44:47]
v_exp_f32 v13, v13
v_mfma_f32_16x16x32_bf16 v[52:55], a[16:19], a[96:99], v[100:103]
ds_read_b128 a[60:63], v251 offset:23552
v_cvt_pk_bf16_f32 v70, v12, v13
v_mfma_f32_16x16x32_bf16 v[52:55], a[20:23], a[100:103], v[52:55]
v_exp_f32 v14, v14
v_mfma_f32_16x16x32_bf16 v[52:55], a[24:27], a[104:107], v[52:55]
v_exp_f32 v15, v15
v_mfma_f32_16x16x32_bf16 v[52:55], a[28:31], a[108:111], v[52:55]
s_cmp_le_u32 s33, 3
s_cselect_b64 vcc, -1, 0
v_cvt_pk_bf16_f32 v71, v14, v15
v_mfma_f32_16x16x32_bf16 v[60:63], a[16:19], a[112:115], v[108:111]
buffer_load_dwordx4 v252, s[16:19], s25 offen offset:3072 sc1 lds
v_mfma_f32_16x16x32_bf16 v[60:63], a[20:23], a[116:119], v[60:63]
s_add_u32 m0, m0, 0x1000
v_exp_f32 v16, v16
v_mfma_f32_16x16x32_bf16 v[60:63], a[24:27], a[120:123], v[60:63]
s_add_u32 s25, s25, 0x8000
v_exp_f32 v17, v17
v_mfma_f32_16x16x32_bf16 v[60:63], a[28:31], a[124:127], v[60:63]
v_cvt_pk_bf16_f32 v72, v16, v17
s_waitcnt lgkmcnt(0)
v_mfma_f32_16x16x32_bf16 v[112:115], a[32:35], v[64:67], v[112:115]
v_exp_f32 v18, v18
v_mfma_f32_16x16x32_bf16 v[116:119], a[36:39], v[64:67], v[116:119]
ds_read_b128 a[0:3], v250 offset:0
ds_read_b128 a[4:7], v250 offset:1024
v_mfma_f32_16x16x32_bf16 v[120:123], a[40:43], v[64:67], v[120:123]
v_exp_f32 v19, v19
v_mfma_f32_16x16x32_bf16 v[124:127], a[44:47], v[64:67], v[124:127]
v_cvt_pk_bf16_f32 v73, v18, v19
v_mfma_f32_16x16x32_bf16 v[128:131], a[48:51], v[64:67], v[128:131]
v_exp_f32 v20, v20
v_mfma_f32_16x16x32_bf16 v[132:135], a[52:55], v[64:67], v[132:135]
buffer_load_dwordx4 v252, s[16:19], s30 offen offset:0 sc1 lds
v_mfma_f32_16x16x32_bf16 v[136:139], a[56:59], v[64:67], v[136:139]
v_exp_f32 v21, v21
v_mfma_f32_16x16x32_bf16 v[140:143], a[60:63], v[64:67], v[140:143]
ds_read_b128 a[8:11], v250 offset:2048
v_cvt_pk_bf16_f32 v74, v20, v21
v_mfma_f32_16x16x32_bf16 a[160:163], a[176:179], v[64:67], a[160:163]
v_exp_f32 v22, v22
v_mfma_f32_16x16x32_bf16 v[144:147], a[32:35], v[68:71], v[144:147]
v_exp_f32 v23, v23
v_mfma_f32_16x16x32_bf16 v[148:151], a[36:39], v[68:71], v[148:151]
ds_read_b128 a[12:15], v250 offset:3072
v_cvt_pk_bf16_f32 v75, v22, v23
v_mfma_f32_16x16x32_bf16 v[152:155], a[40:43], v[68:71], v[152:155]
v_exp_f32 v24, v24
v_mfma_f32_16x16x32_bf16 v[156:159], a[44:47], v[68:71], v[156:159]
buffer_load_dwordx4 v252, s[16:19], s30 offen offset:1024 sc1 lds
v_mfma_f32_16x16x32_bf16 v[160:163], a[48:51], v[68:71], v[160:163]
v_exp_f32 v25, v25
v_mfma_f32_16x16x32_bf16 v[164:167], a[52:55], v[68:71], v[164:167]
ds_read_b128 a[16:19], v250 offset:4096
v_cvt_pk_bf16_f32 v76, v24, v25
v_mfma_f32_16x16x32_bf16 v[168:171], a[56:59], v[68:71], v[168:171]
v_exp_f32 v26, v26
v_mfma_f32_16x16x32_bf16 v[172:175], a[60:63], v[68:71], v[172:175]
v_exp_f32 v27, v27
v_mfma_f32_16x16x32_bf16 a[164:167], a[176:179], v[68:71], a[164:167]
ds_read_b128 a[20:23], v250 offset:5120
v_cvt_pk_bf16_f32 v77, v26, v27
v_mfma_f32_16x16x32_bf16 v[176:179], a[32:35], v[72:75], v[176:179]
v_exp_f32 v28, v28
v_mfma_f32_16x16x32_bf16 v[180:183], a[36:39], v[72:75], v[180:183]
v_exp_f32 v29, v29
v_mfma_f32_16x16x32_bf16 v[184:187], a[40:43], v[72:75], v[184:187]
buffer_load_dwordx4 v252, s[16:19], s30 offen offset:2048 sc1 lds
v_mfma_f32_16x16x32_bf16 v[188:191], a[44:47], v[72:75], v[188:191]
ds_read_b128 a[24:27], v250 offset:6144
v_cvt_pk_bf16_f32 v78, v28, v29
v_mfma_f32_16x16x32_bf16 v[192:195], a[48:51], v[72:75], v[192:195]
v_exp_f32 v30, v30
v_mfma_f32_16x16x32_bf16 v[196:199], a[52:55], v[72:75], v[196:199]
v_exp_f32 v31, v31
v_mfma_f32_16x16x32_bf16 v[200:203], a[56:59], v[72:75], v[200:203]
ds_read_b128 a[28:31], v250 offset:7168
v_cvt_pk_bf16_f32 v79, v30, v31
v_mfma_f32_16x16x32_bf16 v[204:207], a[60:63], v[72:75], v[204:207]
buffer_load_dwordx4 v252, s[16:19], s30 offen offset:3072 sc1 lds
v_mfma_f32_16x16x32_bf16 a[168:171], a[176:179], v[72:75], a[168:171]
v_add_u32 v250, s37, v252
v_add_u32 v251, s37, v252
v_mfma_f32_16x16x32_bf16 v[208:211], a[32:35], v[76:79], v[208:211]
v_mfma_f32_16x16x32_bf16 v[212:215], a[36:39], v[76:79], v[212:215]
v_mfma_f32_16x16x32_bf16 v[216:219], a[40:43], v[76:79], v[216:219]
v_mfma_f32_16x16x32_bf16 v[220:223], a[44:47], v[76:79], v[220:223]
v_mfma_f32_16x16x32_bf16 v[224:227], a[48:51], v[76:79], v[224:227]
v_mfma_f32_16x16x32_bf16 v[228:231], a[52:55], v[76:79], v[228:231]
v_mfma_f32_16x16x32_bf16 v[232:235], a[56:59], v[76:79], v[232:235]
v_mfma_f32_16x16x32_bf16 v[236:239], a[60:63], v[76:79], v[236:239]
v_mfma_f32_16x16x32_bf16 a[172:175], a[176:179], v[76:79], a[172:175]
s_cbranch_vccnz K2_rare20
K2_c2a:
s_waitcnt lgkmcnt(0)
v_mfma_f32_16x16x32_bf16 v[0:3], a[0:3], a[64:67], v[80:83]
s_add_u32 m0, s29, s28
v_exp_f32 v32, v32
v_mfma_f32_16x16x32_bf16 v[0:3], a[4:7], a[68:71], v[0:3]
s_add_u32 s30, s25, 0x1000
v_exp_f32 v33, v33
v_mfma_f32_16x16x32_bf16 v[0:3], a[8:11], a[72:75], v[0:3]
ds_read_b128 a[32:35], v251 offset:16384
v_cvt_pk_bf16_f32 v64, v32, v33
v_mfma_f32_16x16x32_bf16 v[0:3], a[12:15], a[76:79], v[0:3]
v_exp_f32 v34, v34
v_mfma_f32_16x16x32_bf16 v[8:11], a[0:3], a[80:83], v[88:91]
s_mov_b32 s28, s27
v_exp_f32 v35, v35
v_mfma_f32_16x16x32_bf16 v[8:11], a[4:7], a[84:87], v[8:11]
s_mov_b32 s27, s26
ds_read_b128 a[36:39], v251 offset:17408
v_cvt_pk_bf16_f32 v65, v34, v35
v_mfma_f32_16x16x32_bf16 v[8:11], a[8:11], a[88:91], v[8:11]
s_add_u32 s26, s26, 0x8000
buffer_load_dwordx4 v252, s[16:19], s25 offen offset:0 sc1 lds
v_mfma_f32_16x16x32_bf16 v[8:11], a[12:15], a[92:95], v[8:11]
v_exp_f32 v36, v36
v_mfma_f32_16x16x32_bf16 v[16:19], a[0:3], a[96:99], v[96:99]
v_exp_f32 v37, v37
v_mfma_f32_16x16x32_bf16 v[16:19], a[4:7], a[100:103], v[16:19]
ds_read_b128 a[40:43], v251 offset:18432
v_cvt_pk_bf16_f32 v66, v36, v37
v_mfma_f32_16x16x32_bf16 v[16:19], a[8:11], a[104:107], v[16:19]
v_exp_f32 v38, v38
v_mfma_f32_16x16x32_bf16 v[16:19], a[12:15], a[108:111], v[16:19]
v_exp_f32 v39, v39
v_mfma_f32_16x16x32_bf16 v[24:27], a[0:3], a[112:115], v[104:107]
ds_read_b128 a[44:47], v251 offset:19456
v_cvt_pk_bf16_f32 v67, v38, v39
v_mfma_f32_16x16x32_bf16 v[24:27], a[4:7], a[116:119], v[24:27]
buffer_load_dwordx4 v252, s[16:19], s25 offen offset:1024 sc1 lds
v_mfma_f32_16x16x32_bf16 v[24:27], a[8:11], a[120:123], v[24:27]
v_exp_f32 v40, v40
v_mfma_f32_16x16x32_bf16 v[24:27], a[12:15], a[124:127], v[24:27]
ds_read_b128 a[48:51], v251 offset:20480
ds_read_b128 a[52:55], v251 offset:21504
v_mfma_f32_16x16x32_bf16 v[4:7], a[16:19], a[64:67], v[84:87]
v_exp_f32 v41, v41
v_mfma_f32_16x16x32_bf16 v[4:7], a[20:23], a[68:71], v[4:7]
s_cmp_eq_u32 s26, 0x28000
s_cselect_b32 s26, 0, s26
v_cvt_pk_bf16_f32 v68, v40, v41
v_mfma_f32_16x16x32_bf16 v[4:7], a[24:27], a[72:75], v[4:7]
s_add_u32 s37, s26, s24
v_exp_f32 v42, v42
v_mfma_f32_16x16x32_bf16 v[4:7], a[28:31], a[76:79], v[4:7]
s_sub_u32 s33, s33, 1
v_exp_f32 v43, v43
v_mfma_f32_16x16x32_bf16 v[12:15], a[16:19], a[80:83], v[92:95]
ds_read_b128 a[56:59], v251 offset:22528
v_cvt_pk_bf16_f32 v69, v42, v43
v_mfma_f32_16x16x32_bf16 v[12:15], a[20:23], a[84:87], v[12:15]
buffer_load_dwordx4 v252, s[16:19], s25 offen offset:2048 sc1 lds
v_mfma_f32_16x16x32_bf16 v[12:15], a[24:27], a[88:91], v[12:15]
v_exp_f32 v44, v44
v_mfma_f32_16x16x32_bf16 v[12:15], a[28:31], a[92:95], v[12:15]
v_exp_f32 v45, v45
v_mfma_f32_16x16x32_bf16 v[20:23], a[16:19], a[96:99], v[100:103]
ds_read_b128 a[60:63], v251 offset:23552
v_cvt_pk_bf16_f32 v70, v44, v45
v_mfma_f32_16x16x32_bf16 v[20:23], a[20:23], a[100:103], v[20:23]
v_exp_f32 v46, v46
v_mfma_f32_16x16x32_bf16 v[20:23], a[24:27], a[104:107], v[20:23]
v_exp_f32 v47, v47
v_mfma_f32_16x16x32_bf16 v[20:23], a[28:31], a[108:111], v[20:23]
s_cmp_le_u32 s33, 3
s_cselect_b64 vcc, -1, 0
v_cvt_pk_bf16_f32 v71, v46, v47
v_mfma_f32_16x16x32_bf16 v[28:31], a[16:19], a[112:115], v[108:111]
buffer_load_dwordx4 v252, s[16:19], s25 offen offset:3072 sc1 lds
v_mfma_f32_16x16x32_bf16 v[28:31], a[20:23], a[116:119], v[28:31]
s_add_u32 m0, m0, 0x1000
v_exp_f32 v48, v48
v_mfma_f32_16x16x32_bf16 v[28:31], a[24:27], a[120:123], v[28:31]
s_add_u32 s25, s25, 0x8000
v_exp_f32 v49, v49
v_mfma_f32_16x16x32_bf16 v[28:31], a[28:31], a[124:127], v[28:31]
v_cvt_pk_bf16_f32 v72, v48, v49
s_waitcnt lgkmcnt(0)
v_mfma_f32_16x16x32_bf16 v[112:115], a[32:35], v[64:67], v[112:115]
v_exp_f32 v50, v50
v_mfma_f32_16x16x32_bf16 v[116:119], a[36:39], v[64:67], v[116:119]
ds_read_b128 a[0:3], v250 offset:0
ds_read_b128 a[4:7], v250 offset:1024
v_mfma_f32_16x16x32_bf16 v[120:123], a[40:43], v[64:67], v[120:123]
v_exp_f32 v51, v51
v_mfma_f32_16x16x32_bf16 v[124:127], a[44:47], v[64:67], v[124:127]
v_cvt_pk_bf16_f32 v73, v50, v51
v_mfma_f32_16x16x32_bf16 v[128:131], a[48:51], v[64:67], v[128:131]
v_exp_f32 v52, v52
v_mfma_f32_16x16x32_bf16 v[132:135], a[52:55], v[64:67], v[132:135]
buffer_load_dwordx4 v252, s[16:19], s30 offen offset:0 sc1 lds
v_mfma_f32_16x16x32_bf16 v[136:139], a[56:59], v[64:67], v[136:139]
v_exp_f32 v53, v53
v_mfma_f32_16x16x32_bf16 v[140:143], a[60:63], v[64:67], v[140:143]
ds_read_b128 a[8:11], v250 offset:2048
v_cvt_pk_bf16_f32 v74, v52, v53
v_mfma_f32_16x16x32_bf16 a[160:163], a[176:179], v[64:67], a[160:163]
v_exp_f32 v54, v54
v_mfma_f32_16x16x32_bf16 v[144:147], a[32:35], v[68:71], v[144:147]
v_exp_f32 v55, v55
v_mfma_f32_16x16x32_bf16 v[148:151], a[36:39], v[68:71], v[148:151]
ds_read_b128 a[12:15], v250 offset:3072
v_cvt_pk_bf16_f32 v75, v54, v55
v_mfma_f32_16x16x32_bf16 v[152:155], a[40:43], v[68:71], v[152:155]
v_exp_f32 v56, v56
v_mfma_f32_16x16x32_bf16 v[156:159], a[44:47], v[68:71], v[156:159]
buffer_load_dwordx4 v252, s[16:19], s30 offen offset:1024 sc1 lds
v_mfma_f32_16x16x32_bf16 v[160:163], a[48:51], v[68:71], v[160:163]
v_exp_f32 v57, v57
v_mfma_f32_16x16x32_bf16 v[164:167], a[52:55], v[68:71], v[164:167]
ds_read_b128 a[16:19], v250 offset:4096
v_cvt_pk_bf16_f32 v76, v56, v57
v_mfma_f32_16x16x32_bf16 v[168:171], a[56:59], v[68:71], v[168:171]
v_exp_f32 v58, v58
v_mfma_f32_16x16x32_bf16 v[172:175], a[60:63], v[68:71], v[172:175]
v_exp_f32 v59, v59
v_mfma_f32_16x16x32_bf16 a[164:167], a[176:179], v[68:71], a[164:167]
ds_read_b128 a[20:23], v250 offset:5120
v_cvt_pk_bf16_f32 v77, v58, v59
v_mfma_f32_16x16x32_bf16 v[176:179], a[32:35], v[72:75], v[176:179]
v_exp_f32 v60, v60
v_mfma_f32_16x16x32_bf16 v[180:183], a[36:39], v[72:75], v[180:183]
v_exp_f32 v61, v61
v_mfma_f32_16x16x32_bf16 v[184:187], a[40:43], v[72:75], v[184:187]
buffer_load_dwordx4 v252, s[16:19], s30 offen offset:2048 sc1 lds
v_mfma_f32_16x16x32_bf16 v[188:191], a[44:47], v[72:75], v[188:191]
ds_read_b128 a[24:27], v250 offset:6144
v_cvt_pk_bf16_f32 v78, v60, v61
v_mfma_f32_16x16x32_bf16 v[192:195], a[48:51], v[72:75], v[192:195]
v_exp_f32 v62, v62
v_mfma_f32_16x16x32_bf16 v[196:199], a[52:55], v[72:75], v[196:199]
v_exp_f32 v63, v63
v_mfma_f32_16x16x32_bf16 v[200:203], a[56:59], v[72:75], v[200:203]
ds_read_b128 a[28:31], v250 offset:7168
v_cvt_pk_bf16_f32 v79, v62, v63
v_mfma_f32_16x16x32_bf16 v[204:207], a[60:63], v[72:75], v[204:207]
buffer_load_dwordx4 v252, s[16:19], s30 offen offset:3072 sc1 lds
v_mfma_f32_16x16x32_bf16 a[168:171], a[176:179], v[72:75], a[168:171]
v_add_u32 v250, s37, v252
v_add_u32 v251, s37, v252
v_mfma_f32_16x16x32_bf16 v[208:211], a[32:35], v[76:79], v[208:211]
v_mfma_f32_16x16x32_bf16 v[212:215], a[36:39], v[76:79], v[212:215]
v_mfma_f32_16x16x32_bf16 v[216:219], a[40:43], v[76:79], v[216:219]
v_mfma_f32_16x16x32_bf16 v[220:223], a[44:47], v[76:79], v[220:223]
v_mfma_f32_16x16x32_bf16 v[224:227], a[48:51], v[76:79], v[224:227]
v_mfma_f32_16x16x32_bf16 v[228:231], a[52:55], v[76:79], v[228:231]
v_mfma_f32_16x16x32_bf16 v[232:235], a[56:59], v[76:79], v[232:235]
v_mfma_f32_16x16x32_bf16 v[236:239], a[60:63], v[76:79], v[236:239]
v_mfma_f32_16x16x32_bf16 a[172:175], a[176:179], v[76:79], a[172:175]
s_cbranch_vccz K2_loop2
K2_rare21:
K2_h2b:
s_and_b32 s39, s20, 1
s_add_u32 s39, s39, 2
s_sub_u32 s37, s39, s20
s_cmp_lt_i32 s37, 0
s_cbranch_scc1 Lme_2018
s_cmp_eq_i32 s37, 0
s_cbranch_scc1 Lmd_2017
v_mov_b32 v80, v254
v_mov_b32 v81, v254
v_mov_b32 v82, v254
v_mov_b32 v83, v254
v_mov_b32 v84, v254
v_mov_b32 v85, v254
v_mov_b32 v86, v254
v_mov_b32 v87, v254
v_mov_b32 v88, v254
v_mov_b32 v89, v254
v_mov_b32 v90, v254
v_mov_b32 v91, v254
v_mov_b32 v92, v254
v_mov_b32 v93, v254
v_mov_b32 v94, v254
v_mov_b32 v95, v254
s_branch Lme_2018
Lmd_2017:
v_cndmask_b32 v80, v80, v254, s[64:65]
v_mov_b32 v84, v254
v_cndmask_b32 v92, v92, v254, s[64:65]
v_cndmask_b32 v81, v81, v254, s[66:67]
v_mov_b32 v85, v254
v_cndmask_b32 v93, v93, v254, s[66:67]
v_cndmask_b32 v82, v82, v254, s[68:69]
v_mov_b32 v86, v254
v_cndmask_b32 v94, v94, v254, s[68:69]
v_cndmask_b32 v83, v83, v254, s[70:71]
v_mov_b32 v87, v254
v_cndmask_b32 v95, v95, v254, s[70:71]
Lme_2018:
s_xor_b32 s37, s20, 1
s_sub_u32 s37, s39, s37
s_cmp_lt_i32 s37, 0
s_cbranch_scc1 Lme_2020
s_cmp_eq_i32 s37, 0
s_cbranch_scc1 Lmd_2019
v_mov_b32 v96, v254
v_mov_b32 v97, v254
v_mov_b32 v98, v254
v_mov_b32 v99, v254
v_mov_b32 v100, v254
v_mov_b32 v101, v254
v_mov_b32 v102, v254
v_mov_b32 v103, v254
v_mov_b32 v104, v254
v_mov_b32 v105, v254
v_mov_b32 v106, v254
v_mov_b32 v107, v254
v_mov_b32 v108, v254
v_mov_b32 v109, v254
v_mov_b32 v110, v254
v_mov_b32 v111, v254
s_branch Lme_2020
Lmd_2019:
v_cndmask_b32 v96, v96, v254, s[64:65]
v_mov_b32 v100, v254
v_cndmask_b32 v108, v108, v254, s[64:65]
v_cndmask_b32 v97, v97, v254, s[66:67]
v_mov_b32 v101, v254
v_cndmask_b32 v109, v109, v254, s[66:67]
v_cndmask_b32 v98, v98, v254, s[68:69]
v_mov_b32 v102, v254
v_cndmask_b32 v110, v110, v254, s[68:69]
v_cndmask_b32 v99, v99, v254, s[70:71]
v_mov_b32 v103, v254
v_cndmask_b32 v111, v111, v254, s[70:71]
Lme_2020:
s_lshr_b32 s37, s21, 2
s_lshl_b32 s37, s37, 7
s_add_u32 s37, s37, 0x3c03000
v_and_b32 v248, 31, v253
v_lshlrev_b32 v248, 2, v248
buffer_load_dword a253, v248, s[4:7], s37 offen sc1
s_branch K2_loop2
K2_rare20:
s_cmp_eq_u32 s33, 1
s_cbranch_scc1 K2_tail
s_and_b32 s39, s20, 1
s_add_u32 s39, s39, 0
s_sub_u32 s37, s39, s20
s_cmp_lt_i32 s37, 0
s_cbranch_scc1 Lme_2022
s_cmp_eq_i32 s37, 0
s_cbranch_scc1 Lmd_2021
v_mov_b32 v80, v254
v_mov_b32 v81, v254
v_mov_b32 v82, v254
v_mov_b32 v83, v254
v_mov_b32 v84, v254
v_mov_b32 v85, v254
v_mov_b32 v86, v254
v_mov_b32 v87, v254
v_mov_b32 v88, v254
v_mov_b32 v89, v254
v_mov_b32 v90, v254
v_mov_b32 v91, v254
v_mov_b32 v92, v254
v_mov_b32 v93, v254
v_mov_b32 v94, v254
v_mov_b32 v95, v254
s_branch Lme_2022
Lmd_2021:
v_cndmask_b32 v80, v80, v254, s[64:65]
v_mov_b32 v84, v254
v_cndmask_b32 v92, v92, v254, s[64:65]
v_cndmask_b32 v81, v81, v254, s[66:67]
v_mov_b32 v85, v254
v_cndmask_b32 v93, v93, v254, s[66:67]
v_cndmask_b32 v82, v82, v254, s[68:69]
v_mov_b32 v86, v254
v_cndmask_b32 v94, v94, v254, s[68:69]
v_cndmask_b32 v83, v83, v254, s[70:71]
v_mov_b32 v87, v254
v_cndmask_b32 v95, v95, v254, s[70:71]
Lme_2022:
s_xor_b32 s37, s20, 1
s_sub_u32 s37, s39, s37
s_cmp_lt_i32 s37, 0
s_cbranch_scc1 Lme_2024
s_cmp_eq_i32 s37, 0
s_cbranch_scc1 Lmd_2023
v_mov_b32 v96, v254
v_mov_b32 v97, v254
v_mov_b32 v98, v254
v_mov_b32 v99, v254
v_mov_b32 v100, v254
v_mov_b32 v101, v254
v_mov_b32 v102, v254
v_mov_b32 v103, v254
v_mov_b32 v104, v254
v_mov_b32 v105, v254
v_mov_b32 v106, v254
v_mov_b32 v107, v254
v_mov_b32 v108, v254
v_mov_b32 v109, v254
v_mov_b32 v110, v254
v_mov_b32 v111, v254
s_branch Lme_2024
Lmd_2023:
v_cndmask_b32 v96, v96, v254, s[64:65]
v_mov_b32 v100, v254
v_cndmask_b32 v108, v108, v254, s[64:65]
v_cndmask_b32 v97, v97, v254, s[66:67]
v_mov_b32 v101, v254
v_cndmask_b32 v109, v109, v254, s[66:67]
v_cndmask_b32 v98, v98, v254, s[68:69]
v_mov_b32 v102, v254
v_cndmask_b32 v110, v110, v254, s[68:69]
v_cndmask_b32 v99, v99, v254, s[70:71]
v_mov_b32 v103, v254
v_cndmask_b32 v111, v111, v254, s[70:71]
Lme_2024:
s_branch K2_c2a
K2_tail:
s_lshr_b32 s37, s21, 2
s_lshl_b32 s37, s37, 7
s_add_u32 s37, s37, 0x3c03000
v_and_b32 v0, 31, v253
v_lshlrev_b32 v0, 2, v0
s_mov_b32 s38, 0
s_waitcnt vmcnt(8)
v_accvgpr_read_b32 v1, a253
B2_poll:
v_cmp_ne_u32 vcc, 1, v1
s_add_u32 s38, s38, 1
s_nop 3
s_cbranch_vccz B2_go
s_sleep 2
buffer_load_dword v1, v0, s[4:7], s37 offen sc1
s_waitcnt vmcnt(0)
s_cmp_lt_u32 s38, 0x40000
s_cbranch_scc1 B2_poll
B2_go:
BACK_entry:
s_load_dwordx2 s[40:41], s[0:1], 80
s_waitcnt vmcnt(0) lgkmcnt(0)
s_barrier
ds_read_b128 a[32:35], v251 offset:16384
ds_read_b128 a[36:39], v251 offset:17408
ds_read_b128 a[40:43], v251 offset:18432
ds_read_b128 a[44:47], v251 offset:19456
ds_read_b128 a[48:51], v251 offset:20480
ds_read_b128 a[52:55], v251 offset:21504
ds_read_b128 a[56:59], v251 offset:22528
ds_read_b128 a[60:63], v251 offset:23552
s_lshl_b32 s37, s20, 15
s_xor_b32 s38, s37, 0x8000
v_add_u32 v250, s37, v252
v_add_u32 v251, s38, v252
s_lshl_b32 s37, s20, 10
s_add_u32 s37, s37, 0x20000
s_xor_b32 s38, s37, 0x400
v_add_u32 v94, s37, v252
v_add_u32 v95, s38, v252
v_mov_b32 v96, v242
v_mov_b32 v97, v243
s_lshr_b32 s37, s21, 3
s_lshl_b32 s37, s37, 11
s_and_b32 s38, s21, 7
s_lshl_b32 s38, s38, 2
s_add_u32 s37, s37, s38
s_add_u32 s37, s37, 0x3c04000
s_cmp_eq_u32 s20, 0
s_cselect_b32 s37, s37, 0x7ffefff0
v_mov_b32 v110, 0x7ffefff0
v_writelane_b32 v110, s37, 0
v_mov_b32 v111, 1
s_lshl_b32 s64, s22, 7
s_lshl_b32 s65, s23, 7
s_lshl_b32 s37, s20, 2
s_add_u32 s37, s37, 0x21000
v_mov_b32 v109, s37
v_mov_b32 v107, 0x21000
v_mov_b32 v255, 0x5f800000
s_lshl_b32 s37, s23, 2
s_add_u32 s37, s37, s20
s_lshl_b32 s37, s37, 18
s_lshl_b32 s38, s21, 12
s_add_u32 s37, s37, s38
s_add_u32 s37, s37, 0x2000000
s_add_u32 s38, s37, 0x20000
s_nop 0
v_exp_f32 v48, v48
v_exp_f32 v49, v49
s_nop 0
v_cvt_pk_bf16_f32 v72, v48, v49
v_exp_f32 v50, v50
s_nop 0
v_exp_f32 v51, v51
v_exp_f32 v52, v52
s_nop 0
v_cvt_pk_bf16_f32 v73, v50, v51
v_exp_f32 v53, v53
s_nop 0
v_cvt_pk_bf16_f32 v74, v52, v53
v_exp_f32 v54, v54
s_nop 0
v_exp_f32 v55, v55
v_exp_f32 v56, v56
s_nop 0
v_cvt_pk_bf16_f32 v75, v54, v55
v_exp_f32 v57, v57
s_nop 0
v_cvt_pk_bf16_f32 v76, v56, v57
v_exp_f32 v58, v58
s_waitcnt lgkmcnt(0)
v_mfma_f32_16x16x32_bf16 v[176:179], a[32:35], v[72:75], v[176:179]
v_exp_f32 v59, v59
v_exp_f32 v60, v60
v_mfma_f32_16x16x32_bf16 v[180:183], a[36:39], v[72:75], v[180:183]
v_cvt_pk_bf16_f32 v77, v58, v59
v_exp_f32 v61, v61
v_mfma_f32_16x16x32_bf16 v[184:187], a[40:43], v[72:75], v[184:187]
v_cvt_pk_bf16_f32 v78, v60, v61
v_exp_f32 v62, v62
v_mfma_f32_16x16x32_bf16 v[188:191], a[44:47], v[72:75], v[188:191]
v_exp_f32 v63, v63
v_exp_f32 v32, v32
v_mfma_f32_16x16x32_bf16 v[192:195], a[48:51], v[72:75], v[192:195]
v_cvt_pk_bf16_f32 v79, v62, v63
v_exp_f32 v33, v33
v_mfma_f32_16x16x32_bf16 v[196:199], a[52:55], v[72:75], v[196:199]
v_cvt_pk_bf16_f32 v64, v32, v33
v_exp_f32 v34, v34
v_mfma_f32_16x16x32_bf16 v[200:203], a[56:59], v[72:75], v[200:203]
v_exp_f32 v35, v35
v_exp_f32 v36, v36
v_mfma_f32_16x16x32_bf16 v[204:207], a[60:63], v[72:75], v[204:207]
v_cvt_pk_bf16_f32 v65, v34, v35
v_exp_f32 v37, v37
v_mfma_f32_16x16x32_bf16 a[168:171], a[176:179], v[72:75], a[168:171]
ds_write_b128 v250, v[176:179] offset:0
v_cvt_pk_bf16_f32 v66, v36, v37
v_exp_f32 v38, v38
v_mfma_f32_16x16x32_bf16 v[208:211], a[32:35], v[76:79], v[208:211]
v_exp_f32 v39, v39
v_exp_f32 v40, v40
v_mfma_f32_16x16x32_bf16 v[212:215], a[36:39], v[76:79], v[212:215]
ds_write_b128 v250, v[180:183] offset:1024
v_cvt_pk_bf16_f32 v67, v38, v39
v_exp_f32 v41, v41
v_mfma_f32_16x16x32_bf16 v[216:219], a[40:43], v[76:79], v[216:219]
ds_write_b128 v250, v[184:187] offset:2048
v_cvt_pk_bf16_f32 v68, v40, v41
v_exp_f32 v42, v42
v_mfma_f32_16x16x32_bf16 v[220:223], a[44:47], v[76:79], v[220:223]
v_exp_f32 v43, v43
v_exp_f32 v44, v44
v_mfma_f32_16x16x32_bf16 v[224:227], a[48:51], v[76:79], v[224:227]
ds_write_b128 v250, v[188:191] offset:3072
v_cvt_pk_bf16_f32 v69, v42, v43
v_exp_f32 v45, v45
v_mfma_f32_16x16x32_bf16 v[228:231], a[52:55], v[76:79], v[228:231]
ds_write_b128 v250, v[192:195] offset:4096
v_cvt_pk_bf16_f32 v70, v44, v45
v_exp_f32 v46, v46
v_mfma_f32_16x16x32_bf16 v[232:235], a[56:59], v[76:79], v[232:235]
ds_write_b128 v250, v[196:199] offset:5120
ds_write_b128 v250, v[200:203] offset:6144
v_exp_f32 v47, v47
v_mfma_f32_16x16x32_bf16 v[236:239], a[60:63], v[76:79], v[236:239]
ds_write_b128 v250, v[204:207] offset:7168
v_cvt_pk_bf16_f32 v71, v46, v47
v_mfma_f32_16x16x32_bf16 a[172:175], a[176:179], v[76:79], a[172:175]
ds_write_b128 v250, v[208:211] offset:8192
v_mfma_f32_16x16x32_bf16 v[112:115], a[32:35], v[64:67], v[112:115]
ds_write_b128 v250, v[212:215] offset:9216
v_mfma_f32_16x16x32_bf16 v[116:119], a[36:39], v[64:67], v[116:119]
ds_write_b128 v250, v[216:219] offset:10240
v_mfma_f32_16x16x32_bf16 v[120:123], a[40:43], v[64:67], v[120:123]
ds_write_b128 v250, v[220:223] offset:11264
v_mfma_f32_16x16x32_bf16 v[124:127], a[44:47], v[64:67], v[124:127]
ds_write_b128 v250, v[224:227] offset:12288
v_mfma_f32_16x16x32_bf16 v[128:131], a[48:51], v[64:67], v[128:131]
ds_write_b128 v250, v[228:231] offset:13312
v_mfma_f32_16x16x32_bf16 v[132:135], a[52:55], v[64:67], v[132:135]
ds_write_b128 v250, v[232:235] offset:14336
v_mfma_f32_16x16x32_bf16 v[136:139], a[56:59], v[64:67], v[136:139]
ds_write_b128 v250, v[236:239] offset:15360
v_mfma_f32_16x16x32_bf16 v[140:143], a[60:63], v[64:67], v[140:143]
v_mfma_f32_16x16x32_bf16 a[160:163], a[176:179], v[64:67], a[160:163]
v_mfma_f32_16x16x32_bf16 v[144:147], a[32:35], v[68:71], v[144:147]
v_accvgpr_read_b32 v98, a168
v_accvgpr_read_b32 v99, a172
v_mfma_f32_16x16x32_bf16 v[148:151], a[36:39], v[68:71], v[148:151]
ds_write_b128 v94, v[96:99]
v_mfma_f32_16x16x32_bf16 v[152:155], a[40:43], v[68:71], v[152:155]
v_mfma_f32_16x16x32_bf16 v[156:159], a[44:47], v[68:71], v[156:159]
v_mfma_f32_16x16x32_bf16 v[160:163], a[48:51], v[68:71], v[160:163]
v_mfma_f32_16x16x32_bf16 v[164:167], a[52:55], v[68:71], v[164:167]
v_mfma_f32_16x16x32_bf16 v[168:171], a[56:59], v[68:71], v[168:171]
v_mfma_f32_16x16x32_bf16 v[172:175], a[60:63], v[68:71], v[172:175]
v_mfma_f32_16x16x32_bf16 a[164:167], a[176:179], v[68:71], a[164:167]
v_cmp_nlt_f32 vcc, v98, v255
s_or_b32 s43, s43, vcc_lo
s_or_b32 s43, s43, vcc_hi
v_cmp_nlt_f32 vcc, v99, v255
s_or_b32 s43, s43, vcc_lo
s_or_b32 s43, s43, vcc_hi
s_nop 2
v_accvgpr_read_b32 v100, a160
v_accvgpr_read_b32 v101, a164
v_cmp_nlt_f32 vcc, v100, v255
s_or_b32 s43, s43, vcc_lo
s_or_b32 s43, s43, vcc_hi
v_cmp_nlt_f32 vcc, v101, v255
s_or_b32 s43, s43, vcc_lo
s_or_b32 s43, s43, vcc_hi
s_cmp_eq_u32 s49, 1
s_cselect_b32 s43, 0, s43
v_mov_b32 v108, s43
ds_write_b32 v109, v108
s_waitcnt lgkmcnt(0)
s_barrier
ds_read_b128 v[104:107], v107
ds_read_b128 v[96:99], v95
ds_read_b128 v[0:3], v251 offset:0
ds_read_b128 v[4:7], v251 offset:1024
ds_read_b128 v[8:11], v251 offset:2048
ds_read_b128 v[12:15], v251 offset:3072
ds_read_b128 v[16:19], v251 offset:4096
ds_read_b128 v[20:23], v251 offset:5120
ds_read_b128 v[24:27], v251 offset:6144
ds_read_b128 v[28:31], v251 offset:7168
ds_read_b128 v[32:35], v251 offset:8192
ds_read_b128 v[36:39], v251 offset:9216
ds_read_b128 v[40:43], v251 offset:10240
ds_read_b128 v[44:47], v251 offset:11264
ds_read_b128 v[48:51], v251 offset:12288
s_waitcnt lgkmcnt(14)
v_or3_b32 v104, v104, v105, v106
v_or_b32 v104, v104, v107
v_cmp_ne_u32 vcc, 0, v104
s_nop 4
s_cbranch_vccnz SAFE_entry
ds_read_b128 v[52:55], v251 offset:13312
ds_read_b128 v[56:59], v251 offset:14336
ds_read_b128 v[60:63], v251 offset:15360
buffer_store_dword v111, v110, s[4:7], s64 offen sc1
s_lshl_b32 s66, s21, 16
s_lshl_b32 s67, s20, 14
s_add_u32 s66, s66, s67
s_add_u32 s66, s66, 0x3400000
buffer_load_dwordx4 v[176:179], v252, s[4:7], s66 offen offset:0 sc1
buffer_load_dwordx4 v[180:183], v252, s[4:7], s66 offen offset:1024 sc1
buffer_load_dwordx4 v[184:187], v252, s[4:7], s66 offen offset:2048 sc1
buffer_load_dwordx4 v[188:191], v252, s[4:7], s66 offen offset:3072 sc1
s_add_u32 s66, s66, 0x1000
buffer_load_dwordx4 v[192:195], v252, s[4:7], s66 offen offset:0 sc1
buffer_load_dwordx4 v[196:199], v252, s[4:7], s66 offen offset:1024 sc1
buffer_load_dwordx4 v[200:203], v252, s[4:7], s66 offen offset:2048 sc1
buffer_load_dwordx4 v[204:207], v252, s[4:7], s66 offen offset:3072 sc1
s_add_u32 s66, s66, 0x1000
s_waitcnt lgkmcnt(15)
v_max_f32 v255, v240, v96
v_sub_f32 v102, v240, v255
v_sub_f32 v104, v96, v255
v_exp_f32 v102, v102
v_exp_f32 v104, v104
s_nop 0
v_mul_f32 v100, v100, v102
v_fma_f32 v100, v98, v104, v100
v_rcp_f32 v100, v100
s_nop 0
v_mul_f32 v102, v102, v100
v_mul_f32 v104, v104, v100
v_max_f32 v255, v241, v97
v_sub_f32 v106, v241, v255
v_sub_f32 v108, v97, v255
v_exp_f32 v106, v106
v_exp_f32 v108, v108
s_nop 0
v_mul_f32 v101, v101, v106
v_fma_f32 v101, v99, v108, v101
v_rcp_f32 v101, v101
s_nop 0
v_mul_f32 v106, v106, v101
v_mul_f32 v108, v108, v101
v_pk_mul_f32 v[112:113], v[112:113], v[102:103] op_sel_hi:[1,0]
v_pk_mul_f32 v[114:115], v[114:115], v[102:103] op_sel_hi:[1,0]
v_pk_mul_f32 v[116:117], v[116:117], v[102:103] op_sel_hi:[1,0]
v_pk_mul_f32 v[118:119], v[118:119], v[102:103] op_sel_hi:[1,0]
s_waitcnt lgkmcnt(14)
v_pk_fma_f32 v[112:113], v[0:1], v[104:105], v[112:113] op_sel_hi:[1,0,1]
v_pk_fma_f32 v[114:115], v[2:3], v[104:105], v[114:115] op_sel_hi:[1,0,1]
v_pk_fma_f32 v[116:117], v[4:5], v[104:105], v[116:117] op_sel_hi:[1,0,1]
v_pk_fma_f32 v[118:119], v[6:7], v[104:105], v[118:119] op_sel_hi:[1,0,1]
v_cvt_pk_bf16_f32 v64, v112, v113
v_cvt_pk_bf16_f32 v65, v114, v115
v_cvt_pk_bf16_f32 v66, v116, v117
v_cvt_pk_bf16_f32 v67, v118, v119
buffer_store_dwordx4 v[64:67], v252, s[4:7], s37 offen offset:0 sc1
v_pk_mul_f32 v[120:121], v[120:121], v[102:103] op_sel_hi:[1,0]
v_pk_mul_f32 v[122:123], v[122:123], v[102:103] op_sel_hi:[1,0]
v_pk_mul_f32 v[124:125], v[124:125], v[102:103] op_sel_hi:[1,0]
v_pk_mul_f32 v[126:127], v[126:127], v[102:103] op_sel_hi:[1,0]
s_waitcnt lgkmcnt(12)
v_pk_fma_f32 v[120:121], v[8:9], v[104:105], v[120:121] op_sel_hi:[1,0,1]
v_pk_fma_f32 v[122:123], v[10:11], v[104:105], v[122:123] op_sel_hi:[1,0,1]
v_pk_fma_f32 v[124:125], v[12:13], v[104:105], v[124:125] op_sel_hi:[1,0,1]
v_pk_fma_f32 v[126:127], v[14:15], v[104:105], v[126:127] op_sel_hi:[1,0,1]
v_cvt_pk_bf16_f32 v68, v120, v121
v_cvt_pk_bf16_f32 v69, v122, v123
v_cvt_pk_bf16_f32 v70, v124, v125
v_cvt_pk_bf16_f32 v71, v126, v127
buffer_store_dwordx4 v[68:71], v252, s[4:7], s37 offen offset:1024 sc1
v_pk_mul_f32 v[128:129], v[128:129], v[102:103] op_sel_hi:[1,0]
v_pk_mul_f32 v[130:131], v[130:131], v[102:103] op_sel_hi:[1,0]
v_pk_mul_f32 v[132:133], v[132:133], v[102:103] op_sel_hi:[1,0]
v_pk_mul_f32 v[134:135], v[134:135], v[102:103] op_sel_hi:[1,0]
s_waitcnt lgkmcnt(10)
v_pk_fma_f32 v[128:129], v[16:17], v[104:105], v[128:129] op_sel_hi:[1,0,1]
v_pk_fma_f32 v[130:131], v[18:19], v[104:105], v[130:131] op_sel_hi:[1,0,1]
v_pk_fma_f32 v[132:133], v[20:21], v[104:105], v[132:133] op_sel_hi:[1,0,1]
v_pk_fma_f32 v[134:135], v[22:23], v[104:105], v[134:135] op_sel_hi:[1,0,1]
v_cvt_pk_bf16_f32 v72, v128, v129
v_cvt_pk_bf16_f32 v73, v130, v131
v_cvt_pk_bf16_f32 v74, v132, v133
v_cvt_pk_bf16_f32 v75, v134, v135
buffer_store_dwordx4 v[72:75], v252, s[4:7], s37 offen offset:2048 sc1
v_pk_mul_f32 v[136:137], v[136:137], v[102:103] op_sel_hi:[1,0]
v_pk_mul_f32 v[138:139], v[138:139], v[102:103] op_sel_hi:[1,0]
v_pk_mul_f32 v[140:141], v[140:141], v[102:103] op_sel_hi:[1,0]
v_pk_mul_f32 v[142:143], v[142:143], v[102:103] op_sel_hi:[1,0]
s_waitcnt lgkmcnt(8)
v_pk_fma_f32 v[136:137], v[24:25], v[104:105], v[136:137] op_sel_hi:[1,0,1]
v_pk_fma_f32 v[138:139], v[26:27], v[104:105], v[138:139] op_sel_hi:[1,0,1]
v_pk_fma_f32 v[140:141], v[28:29], v[104:105], v[140:141] op_sel_hi:[1,0,1]
v_pk_fma_f32 v[142:143], v[30:31], v[104:105], v[142:143] op_sel_hi:[1,0,1]
v_cvt_pk_bf16_f32 v76, v136, v137
v_cvt_pk_bf16_f32 v77, v138, v139
v_cvt_pk_bf16_f32 v78, v140, v141
v_cvt_pk_bf16_f32 v79, v142, v143
buffer_store_dwordx4 v[76:79], v252, s[4:7], s37 offen offset:3072 sc1
v_pk_mul_f32 v[144:145], v[144:145], v[106:107] op_sel_hi:[1,0]
v_pk_mul_f32 v[146:147], v[146:147], v[106:107] op_sel_hi:[1,0]
v_pk_mul_f32 v[148:149], v[148:149], v[106:107] op_sel_hi:[1,0]
v_pk_mul_f32 v[150:151], v[150:151], v[106:107] op_sel_hi:[1,0]
s_waitcnt lgkmcnt(6)
v_pk_fma_f32 v[144:145], v[32:33], v[108:109], v[144:145] op_sel_hi:[1,0,1]
v_pk_fma_f32 v[146:147], v[34:35], v[108:109], v[146:147] op_sel_hi:[1,0,1]
v_pk_fma_f32 v[148:149], v[36:37], v[108:109], v[148:149] op_sel_hi:[1,0,1]
v_pk_fma_f32 v[150:151], v[38:39], v[108:109], v[150:151] op_sel_hi:[1,0,1]
v_cvt_pk_bf16_f32 v80, v144, v145
v_cvt_pk_bf16_f32 v81, v146, v147
v_cvt_pk_bf16_f32 v82, v148, v149
v_cvt_pk_bf16_f32 v83, v150, v151
buffer_store_dwordx4 v[80:83], v252, s[4:7], s38 offen offset:0 sc1
v_pk_mul_f32 v[152:153], v[152:153], v[106:107] op_sel_hi:[1,0]
v_pk_mul_f32 v[154:155], v[154:155], v[106:107] op_sel_hi:[1,0]
v_pk_mul_f32 v[156:157], v[156:157], v[106:107] op_sel_hi:[1,0]
v_pk_mul_f32 v[158:159], v[158:159], v[106:107] op_sel_hi:[1,0]
s_waitcnt lgkmcnt(4)
v_pk_fma_f32 v[152:153], v[40:41], v[108:109], v[152:153] op_sel_hi:[1,0,1]
v_pk_fma_f32 v[154:155], v[42:43], v[108:109], v[154:155] op_sel_hi:[1,0,1]
v_pk_fma_f32 v[156:157], v[44:45], v[108:109], v[156:157] op_sel_hi:[1,0,1]
v_pk_fma_f32 v[158:159], v[46:47], v[108:109], v[158:159] op_sel_hi:[1,0,1]
v_cvt_pk_bf16_f32 v84, v152, v153
v_cvt_pk_bf16_f32 v85, v154, v155
v_cvt_pk_bf16_f32 v86, v156, v157
v_cvt_pk_bf16_f32 v87, v158, v159
buffer_store_dwordx4 v[84:87], v252, s[4:7], s38 offen offset:1024 sc1
v_pk_mul_f32 v[160:161], v[160:161], v[106:107] op_sel_hi:[1,0]
v_pk_mul_f32 v[162:163], v[162:163], v[106:107] op_sel_hi:[1,0]
v_pk_mul_f32 v[164:165], v[164:165], v[106:107] op_sel_hi:[1,0]
v_pk_mul_f32 v[166:167], v[166:167], v[106:107] op_sel_hi:[1,0]
s_waitcnt lgkmcnt(2)
v_pk_fma_f32 v[160:161], v[48:49], v[108:109], v[160:161] op_sel_hi:[1,0,1]
v_pk_fma_f32 v[162:163], v[50:51], v[108:109], v[162:163] op_sel_hi:[1,0,1]
v_pk_fma_f32 v[164:165], v[52:53], v[108:109], v[164:165] op_sel_hi:[1,0,1]
v_pk_fma_f32 v[166:167], v[54:55], v[108:109], v[166:167] op_sel_hi:[1,0,1]
v_cvt_pk_bf16_f32 v88, v160, v161
v_cvt_pk_bf16_f32 v89, v162, v163
v_cvt_pk_bf16_f32 v90, v164, v165
v_cvt_pk_bf16_f32 v91, v166, v167
buffer_store_dwordx4 v[88:91], v252, s[4:7], s38 offen offset:2048 sc1
v_pk_mul_f32 v[168:169], v[168:169], v[106:107] op_sel_hi:[1,0]
v_pk_mul_f32 v[170:171], v[170:171], v[106:107] op_sel_hi:[1,0]
v_pk_mul_f32 v[172:173], v[172:173], v[106:107] op_sel_hi:[1,0]
v_pk_mul_f32 v[174:175], v[174:175], v[106:107] op_sel_hi:[1,0]
s_waitcnt lgkmcnt(0)
v_pk_fma_f32 v[168:169], v[56:57], v[108:109], v[168:169] op_sel_hi:[1,0,1]
v_pk_fma_f32 v[170:171], v[58:59], v[108:109], v[170:171] op_sel_hi:[1,0,1]
v_pk_fma_f32 v[172:173], v[60:61], v[108:109], v[172:173] op_sel_hi:[1,0,1]
v_pk_fma_f32 v[174:175], v[62:63], v[108:109], v[174:175] op_sel_hi:[1,0,1]
v_cvt_pk_bf16_f32 v92, v168, v169
v_cvt_pk_bf16_f32 v93, v170, v171
v_cvt_pk_bf16_f32 v94, v172, v173
v_cvt_pk_bf16_f32 v95, v174, v175
buffer_store_dwordx4 v[92:95], v252, s[4:7], s38 offen offset:3072 sc1
v_add_u32 v240, s65, v110
v_mov_b32 v151, 1
buffer_load_dwordx4 v[208:211], v252, s[4:7], s66 offen offset:0 sc1
buffer_load_dwordx4 v[212:215], v252, s[4:7], s66 offen offset:1024 sc1
buffer_load_dwordx4 v[216:219], v252, s[4:7], s66 offen offset:2048 sc1
buffer_load_dwordx4 v[220:223], v252, s[4:7], s66 offen offset:3072 sc1
s_add_u32 s66, s66, 0x1000
buffer_load_dwordx4 v[224:227], v252, s[4:7], s66 offen offset:0 sc1
buffer_load_dwordx4 v[228:231], v252, s[4:7], s66 offen offset:1024 sc1
buffer_load_dwordx4 v[232:235], v252, s[4:7], s66 offen offset:2048 sc1
buffer_load_dwordx4 v[236:239], v252, s[4:7], s66 offen offset:3072 sc1
s_add_u32 s66, s66, 0x1000
s_lshl_b32 s66, s21, 12
s_lshl_b32 s67, s20, 10
s_add_u32 s66, s66, s67
s_add_u32 s66, s66, 0x3600000
buffer_load_dwordx4 a[244:247], v252, s[4:7], s66 offen sc1
s_lshl_b32 s66, s21, 17
s_lshl_b32 s67, s22, 14
s_add_u32 s66, s66, s67
s_add_u32 s66, s66, s31
s_add_u32 s66, s66, 0x3000000
buffer_load_dwordx4 a[128:131], v252, s[4:7], s66 offen offset:0 sc1
buffer_load_dwordx4 a[132:135], v252, s[4:7], s66 offen offset:1024 sc1
buffer_load_dwordx4 a[136:139], v252, s[4:7], s66 offen offset:2048 sc1
buffer_load_dwordx4 a[140:143], v252, s[4:7], s66 offen offset:3072 sc1
s_bfe_u32 s64, s2, 0x20001
s_and_b32 s65, s2, 1
s_lshl_b32 s65, s65, 3
s_add_u32 s65, s65, s22
s_bfe_u32 s66, s2, 0x20003
s_mov_b32 s71, s21
s_mov_b32 s72, s22
s_lshl_b32 s67, s65, 20
s_lshl_b32 s37, s20, 18
s_add_u32 s67, s67, s37
s_lshl_b32 s37, s64, 15
s_add_u32 s67, s67, s37
s_add_u32 s67, s67, 0x2000000
s_lshl_b32 s68, s64, 20
s_lshl_b32 s37, s20, 14
s_add_u32 s68, s68, s37
s_lshl_b32 s37, s66, 8
s_add_u32 s68, s68, s37
s_lshl_b32 s69, s71, 16
s_lshl_b32 s37, s20, 14
s_add_u32 s69, s69, s37
s_add_u32 s69, s69, 0x3800000
s_lshl_b32 s70, s20, 15
s_lshl_b32 s37, s72, 7
s_add_u32 s70, s70, s37
v_lshrrev_b32 v152, 4, v253
v_lshlrev_b32 v153, 1, v152
v_and_b32 v154, 15, v253
v_xor_b32 v153, v153, v154
v_lshlrev_b32 v153, 4, v153
v_lshl_add_u32 v128, v152, 10, v153
v_xor_b32 v152, 128, v128
v_add_u32 v129, 3072, v152
v_add_u32 v130, 6144, v128
v_add_u32 v131, 9216, v152
s_mov_b32 s8, s86
s_and_b32 s9, s87, 0xffff
s_mov_b32 s10, 0x400000
s_mov_b32 s11, 0x00020000
s_mov_b32 s12, s94
s_and_b32 s13, s95, 0xffff
s_mov_b32 s14, 0x80000
s_mov_b32 s15, 0x00020000
s_mov_b32 s16, s40
s_and_b32 s17, s41, 0xffff
s_mov_b32 s18, 0x400000
s_mov_b32 s19, 0x00020000
s_add_u32 m0, s31, 16384
s_add_u32 s30, s68, 0
buffer_load_dwordx4 v128, s[8:11], s30 offen offset:0 lds
buffer_load_dwordx4 v129, s[8:11], s30 offen offset:1024 lds
buffer_load_dwordx4 v130, s[8:11], s30 offen offset:2048 lds
buffer_load_dwordx4 v131, s[8:11], s30 offen offset:3072 lds
s_add_u32 m0, s31, 49152
s_add_u32 s30, s68, 65536
buffer_load_dwordx4 v128, s[8:11], s30 offen offset:0 lds
buffer_load_dwordx4 v129, s[8:11], s30 offen offset:1024 lds
buffer_load_dwordx4 v130, s[8:11], s30 offen offset:2048 lds
buffer_load_dwordx4 v131, s[8:11], s30 offen offset:3072 lds
s_lshl_b32 s37, s64, 4
s_add_u32 s37, s37, s65
s_lshl_b32 s37, s37, 7
s_add_u32 s37, s37, 0x3c04000
v_and_b32 v152, 7, v253
v_lshl_add_u32 v149, v152, 2, s37
s_and_b32 s37, s2, 7
s_lshl_b32 s37, s37, 7
s_add_u32 s37, s37, 0x3c03400
v_and_b32 v152, 31, v253
v_lshl_add_u32 v242, v152, 2, s37
s_lshl_b32 s37, s22, 7
s_lshl_b32 s38, s21, 2
s_add_u32 s37, s37, s38
s_add_u32 s37, s37, 0x3c03400
s_cmp_eq_u32 s20, 0
s_cselect_b32 s37, s37, 0x7ffffff0
v_mov_b32 v241, 0x7ffffff0
v_writelane_b32 v241, s37, 0
v_lshrrev_b32 v152, 4, v253
v_lshlrev_b32 v152, 1, v152
v_and_b32 v153, 7, v253
v_xor_b32 v152, v152, v153
v_lshlrev_b32 v152, 4, v152
v_lshrrev_b32 v153, 3, v253
v_lshl_add_u32 v132, v153, 10, v152
v_add_u32 v133, 7168, v132
v_add_u32 v134, 14336, v132
v_add_u32 v135, 21504, v132
s_lshr_b32 s37, s20, 1
s_lshl_b32 s37, s37, 7
v_lshrrev_b32 v152, 2, v253
v_lshlrev_b32 v152, 8, v152
v_bfe_u32 v153, v253, 2, 3
v_lshl_add_u32 v152, v153, 5, v152
v_and_b32 v153, 3, v253
v_lshl_add_u32 v152, v153, 3, v152
v_xor_b32 v152, s37, v152
v_add_u32 v136, 0x4000, v152
v_xor_b32 v137, 32, v136
v_xor_b32 v138, 64, v136
v_xor_b32 v139, 96, v136
s_and_b32 s37, s20, 1
s_lshl_b32 s37, s37, 13
v_add_u32 v142, s37, v252
s_lshr_b32 s37, s20, 1
s_lshl_b32 s37, s37, 6
v_bfe_u32 v152, v253, 2, 3
v_lshlrev_b32 v152, 7, v152
v_lshrrev_b32 v153, 5, v253
v_lshl_add_u32 v152, v153, 11, v152
v_bfe_u32 v153, v253, 3, 2
v_lshl_add_u32 v152, v153, 5, v152
v_and_b32 v153, 3, v253
v_lshl_add_u32 v152, v153, 3, v152
v_xor_b32 v152, s37, v152
v_add_u32 v140, 0x4000, v152
v_xor_b32 v141, 32, v140
s_lshl_b32 s37, s65, 2
s_add_u32 s37, s37, s66
s_lshl_b32 s74, s37, 7
s_add_u32 s74, s74, 0x3c00000
s_lshl_b32 s73, s37, 17
s_add_u32 s73, s73, 0x4000000
s_waitcnt vmcnt(21)
s_barrier
buffer_store_dword v151, v240, s[4:7], 0 offen sc1
s_add_u32 m0, s31, 81920
s_add_u32 s30, s68, 131072
buffer_load_dwordx4 v128, s[8:11], s30 offen offset:0 lds
buffer_load_dwordx4 v129, s[8:11], s30 offen offset:1024 lds
buffer_load_dwordx4 v130, s[8:11], s30 offen offset:2048 lds
buffer_load_dwordx4 v131, s[8:11], s30 offen offset:3072 lds
s_add_u32 m0, s31, 114688
s_add_u32 s30, s68, 196608
buffer_load_dwordx4 v128, s[8:11], s30 offen offset:0 lds
buffer_load_dwordx4 v129, s[8:11], s30 offen offset:1024 lds
buffer_load_dwordx4 v130, s[8:11], s30 offen offset:2048 lds
buffer_load_dwordx4 v131, s[8:11], s30 offen offset:3072 lds
s_add_u32 s37, s31, 147456
v_add_u32 v64, s37, v252
v_and_b32 v65, 0x70, v252
v_add_u32 v65, s37, v65
v_lshrrev_b32 v66, 5, v253
v_and_b32 v67, 31, v253
v_lshl_add_u32 v68, v66, 4, v67
v_lshlrev_b32 v68, 4, v68
v_lshlrev_b32 v69, 4, v66
v_add_u32 v69, 0x800, v69
v_cmp_gt_u32 vcc, 16, v67
v_mov_b32 v72, 512
s_nop 0
v_cndmask_b32 v68, v69, v68, vcc
v_cndmask_b32 v72, 32, v72, vcc
v_add_u32 v68, 147456, v68
v_add_u32 v69, v72, v68
v_add_u32 v70, v72, v69
v_add_u32 v71, v72, v70
v_bfe_u32 v73, v253, 4, 1
v_lshlrev_b32 v73, 14, v73
v_and_b32 v74, 15, v253
v_lshl_add_u32 v73, v74, 4, v73
v_lshl_add_u32 v73, v66, 8, v73
s_lshl_b32 s37, s22, 18
s_lshl_b32 s38, s20, 16
s_add_u32 s37, s37, s38
s_lshl_b32 s38, s21, 9
s_add_u32 s37, s37, s38
s_add_u32 s37, s37, 0x3800000
s_add_u32 s38, s37, 0x8000
s_waitcnt vmcnt(17)
v_accvgpr_read_b32 v0, a244
v_accvgpr_read_b32 v1, a245
v_accvgpr_read_b32 v2, a246
v_accvgpr_read_b32 v3, a247
v_pk_add_f32 v[176:177], v[176:177], v[208:209]
v_pk_add_f32 v[178:179], v[178:179], v[210:211]
v_pk_add_f32 v[180:181], v[180:181], v[212:213]
v_pk_add_f32 v[182:183], v[182:183], v[214:215]
v_pk_add_f32 v[184:185], v[184:185], v[216:217]
v_pk_add_f32 v[186:187], v[186:187], v[218:219]
v_pk_add_f32 v[188:189], v[188:189], v[220:221]
v_pk_add_f32 v[190:191], v[190:191], v[222:223]
v_pk_add_f32 v[192:193], v[192:193], v[224:225]
v_pk_add_f32 v[194:195], v[194:195], v[226:227]
v_pk_add_f32 v[196:197], v[196:197], v[228:229]
v_pk_add_f32 v[198:199], v[198:199], v[230:231]
v_pk_add_f32 v[200:201], v[200:201], v[232:233]
v_pk_add_f32 v[202:203], v[202:203], v[234:235]
v_pk_add_f32 v[204:205], v[204:205], v[236:237]
v_pk_add_f32 v[206:207], v[206:207], v[238:239]
v_pk_add_f32 v[176:177], v[176:177], v[192:193]
v_pk_add_f32 v[178:179], v[178:179], v[194:195]
v_pk_add_f32 v[180:181], v[180:181], v[196:197]
v_pk_add_f32 v[182:183], v[182:183], v[198:199]
v_pk_add_f32 v[184:185], v[184:185], v[200:201]
v_pk_add_f32 v[186:187], v[186:187], v[202:203]
v_pk_add_f32 v[188:189], v[188:189], v[204:205]
v_pk_add_f32 v[190:191], v[190:191], v[206:207]
v_pk_add_f32 v[176:177], v[176:177], v[184:185]
v_pk_add_f32 v[178:179], v[178:179], v[186:187]
v_pk_add_f32 v[180:181], v[180:181], v[188:189]
v_pk_add_f32 v[182:183], v[182:183], v[190:191]
v_add_f32_dpp v0, v0, v0 row_ror:8 row_mask:0xf bank_mask:0xf
v_add_f32_dpp v1, v1, v1 row_ror:8 row_mask:0xf bank_mask:0xf
v_add_f32_dpp v2, v2, v2 row_ror:8 row_mask:0xf bank_mask:0xf
v_add_f32_dpp v3, v3, v3 row_ror:8 row_mask:0xf bank_mask:0xf
ds_write_b128 v64, v[176:179]
ds_write_b128 v64, v[180:183] offset:1024
v_mov_b32 v4, v0
v_mov_b32 v5, v1
v_mov_b32 v6, v2
v_mov_b32 v7, v3
s_nop 0
v_permlane16_swap_b32 v0, v4
v_permlane16_swap_b32 v1, v5
v_permlane16_swap_b32 v2, v6
v_permlane16_swap_b32 v3, v7
v_add_f32 v0, v0, v4
v_add_f32 v1, v1, v5
v_add_f32 v2, v2, v6
v_add_f32 v3, v3, v7
v_mov_b32 v4, v0
v_mov_b32 v5, v1
v_mov_b32 v6, v2
v_mov_b32 v7, v3
s_nop 0
v_permlane32_swap_b32 v0, v4
v_permlane32_swap_b32 v1, v5
v_permlane32_swap_b32 v2, v6
v_permlane32_swap_b32 v3, v7
v_add_f32 v0, v0, v4
v_add_f32 v1, v1, v5
v_add_f32 v2, v2, v6
v_add_f32 v3, v3, v7
ds_write_b128 v65, v[0:3] offset:2048
buffer_load_dword v150, v149, s[4:7], 0 offen sc1
s_waitcnt lgkmcnt(0)
s_barrier
ds_read_b128 v[176:179], v68 offset:0
ds_read_b128 v[180:183], v69 offset:0
ds_read_b128 v[184:187], v70 offset:0
ds_read_b128 v[188:191], v71 offset:0
ds_read_b128 v[192:195], v68 offset:4096
ds_read_b128 v[196:199], v69 offset:4096
ds_read_b128 v[200:203], v70 offset:4096
ds_read_b128 v[204:207], v71 offset:4096
ds_read_b128 v[208:211], v68 offset:8192
ds_read_b128 v[212:215], v69 offset:8192
ds_read_b128 v[216:219], v70 offset:8192
ds_read_b128 v[220:223], v71 offset:8192
ds_read_b128 v[224:227], v68 offset:12288
ds_read_b128 v[228:231], v69 offset:12288
ds_read_b128 v[232:235], v70 offset:12288
ds_read_b128 v[236:239], v71 offset:12288
s_waitcnt lgkmcnt(8)
v_pk_add_f32 v[176:177], v[176:177], v[192:193]
v_pk_add_f32 v[178:179], v[178:179], v[194:195]
v_pk_add_f32 v[180:181], v[180:181], v[196:197]
v_pk_add_f32 v[182:183], v[182:183], v[198:199]
v_pk_add_f32 v[184:185], v[184:185], v[200:201]
v_pk_add_f32 v[186:187], v[186:187], v[202:203]
v_pk_add_f32 v[188:189], v[188:189], v[204:205]
v_pk_add_f32 v[190:191], v[190:191], v[206:207]
s_waitcnt lgkmcnt(0)
v_pk_add_f32 v[208:209], v[208:209], v[224:225]
v_pk_add_f32 v[210:211], v[210:211], v[226:227]
v_pk_add_f32 v[212:213], v[212:213], v[228:229]
v_pk_add_f32 v[214:215], v[214:215], v[230:231]
v_pk_add_f32 v[216:217], v[216:217], v[232:233]
v_pk_add_f32 v[218:219], v[218:219], v[234:235]
v_pk_add_f32 v[220:221], v[220:221], v[236:237]
v_pk_add_f32 v[222:223], v[222:223], v[238:239]
v_pk_add_f32 v[176:177], v[176:177], v[208:209]
v_pk_add_f32 v[178:179], v[178:179], v[210:211]
v_pk_add_f32 v[180:181], v[180:181], v[212:213]
v_pk_add_f32 v[182:183], v[182:183], v[214:215]
v_pk_add_f32 v[184:185], v[184:185], v[216:217]
v_pk_add_f32 v[186:187], v[186:187], v[218:219]
v_pk_add_f32 v[188:189], v[188:189], v[220:221]
v_pk_add_f32 v[190:191], v[190:191], v[222:223]
v_cvt_pk_bf16_f32 v192, v176, v177
v_cvt_pk_bf16_f32 v193, v178, v179
v_cvt_pk_bf16_f32 v194, v180, v181
v_cvt_pk_bf16_f32 v195, v182, v183
v_cvt_pk_bf16_f32 v196, v184, v185
v_cvt_pk_bf16_f32 v197, v186, v187
v_cvt_pk_bf16_f32 v198, v188, v189
v_cvt_pk_bf16_f32 v199, v190, v191
s_nop 1
v_mfma_f32_32x32x16_bf16 v[208:223], v[192:195], a[128:131], 0
v_mfma_f32_32x32x16_bf16 v[224:239], v[192:195], a[136:139], 0
v_mfma_f32_32x32x16_bf16 v[208:223], v[196:199], a[132:135], v[208:223]
v_mfma_f32_32x32x16_bf16 v[224:239], v[196:199], a[140:143], v[224:239]
s_waitcnt vmcnt(0)
v_cmp_ne_u32 vcc, 1, v150
s_mov_b32 s39, 0
s_nop 3
s_cbranch_vccz BK_rdyA
BK_pollA:
s_sleep 1
buffer_load_dword v150, v149, s[4:7], 0 offen sc1
s_waitcnt vmcnt(0)
v_cmp_ne_u32 vcc, 1, v150
s_add_u32 s39, s39, 1
s_nop 3
s_cbranch_vccz BK_rdyA
s_cmp_lt_u32 s39, 0x40000
s_cbranch_scc1 BK_pollA
BK_rdyA:
s_add_u32 m0, s31, 0
s_add_u32 s30, s67, 0
buffer_load_dwordx4 v252, s[4:7], s30 offen offset:0 sc1 lds
buffer_load_dwordx4 v252, s[4:7], s30 offen offset:1024 sc1 lds
s_add_u32 s30, s67, 129024
buffer_load_dwordx4 v252, s[4:7], s30 offen offset:2048 sc1 lds
buffer_load_dwordx4 v252, s[4:7], s30 offen offset:3072 sc1 lds
s_add_u32 m0, s31, 32768
s_add_u32 s30, s67, 2048
buffer_load_dwordx4 v252, s[4:7], s30 offen offset:0 sc1 lds
buffer_load_dwordx4 v252, s[4:7], s30 offen offset:1024 sc1 lds
s_add_u32 s30, s67, 131072
buffer_load_dwordx4 v252, s[4:7], s30 offen offset:2048 sc1 lds
buffer_load_dwordx4 v252, s[4:7], s30 offen offset:3072 sc1 lds
s_add_u32 m0, s31, 65536
s_add_u32 s30, s67, 4096
buffer_load_dwordx4 v252, s[4:7], s30 offen offset:0 sc1 lds
buffer_load_dwordx4 v252, s[4:7], s30 offen offset:1024 sc1 lds
s_add_u32 s30, s67, 133120
buffer_load_dwordx4 v252, s[4:7], s30 offen offset:2048 sc1 lds
buffer_load_dwordx4 v252, s[4:7], s30 offen offset:3072 sc1 lds
s_add_u32 m0, s31, 98304
s_add_u32 s30, s67, 6144
buffer_load_dwordx4 v252, s[4:7], s30 offen offset:0 sc1 lds
buffer_load_dwordx4 v252, s[4:7], s30 offen offset:1024 sc1 lds
s_add_u32 s30, s67, 135168
buffer_load_dwordx4 v252, s[4:7], s30 offen offset:2048 sc1 lds
buffer_load_dwordx4 v252, s[4:7], s30 offen offset:3072 sc1 lds
v_add_f32 v216, 0x358637bd, v216
v_rcp_f32 v216, v216
s_nop 0
v_pk_mul_f32 v[208:209], v[208:209], v[216:217] op_sel_hi:[1,0]
v_pk_mul_f32 v[210:211], v[210:211], v[216:217] op_sel_hi:[1,0]
v_pk_mul_f32 v[212:213], v[212:213], v[216:217] op_sel_hi:[1,0]
v_pk_mul_f32 v[214:215], v[214:215], v[216:217] op_sel_hi:[1,0]
v_cvt_pk_bf16_f32 v220, v208, v209
v_cvt_pk_bf16_f32 v221, v210, v211
v_cvt_pk_bf16_f32 v222, v212, v213
v_cvt_pk_bf16_f32 v223, v214, v215
buffer_store_dwordx4 v[220:223], v73, s[4:7], s37 offen sc1
v_add_f32 v232, 0x358637bd, v232
v_rcp_f32 v232, v232
s_nop 0
v_pk_mul_f32 v[224:225], v[224:225], v[232:233] op_sel_hi:[1,0]
v_pk_mul_f32 v[226:227], v[226:227], v[232:233] op_sel_hi:[1,0]
v_pk_mul_f32 v[228:229], v[228:229], v[232:233] op_sel_hi:[1,0]
v_pk_mul_f32 v[230:231], v[230:231], v[232:233] op_sel_hi:[1,0]
v_cvt_pk_bf16_f32 v236, v224, v225
v_cvt_pk_bf16_f32 v237, v226, v227
v_cvt_pk_bf16_f32 v238, v228, v229
v_cvt_pk_bf16_f32 v239, v230, v231
buffer_store_dwordx4 v[236:239], v73, s[4:7], s38 offen sc1
v_add_u32 v144, 0, v136
v_add_u32 v145, 0, v137
v_add_u32 v146, 0, v138
v_add_u32 v147, 0, v139
v_add_u32 v148, 0, v142
s_waitcnt vmcnt(14)
s_barrier
ds_read_b128 v[16:19], v148 offset:0
ds_read_b64_tr_b16 v[0:1], v144 offset:0
ds_read_b64_tr_b16 v[2:3], v144 offset:4096
ds_read_b128 v[20:23], v148 offset:2048
ds_read_b64_tr_b16 v[4:5], v145 offset:0
ds_read_b64_tr_b16 v[6:7], v145 offset:4096
ds_read_b128 v[24:27], v148 offset:4096
ds_read_b64_tr_b16 v[8:9], v146 offset:0
ds_read_b64_tr_b16 v[10:11], v146 offset:4096
ds_read_b128 v[28:31], v148 offset:6144
ds_read_b64_tr_b16 v[12:13], v147 offset:0
ds_read_b64_tr_b16 v[14:15], v147 offset:4096
s_waitcnt lgkmcnt(0)
v_mfma_f32_16x16x32_bf16 v[64:67], v[0:3], v[16:19], 0
ds_read_b128 v[48:51], v148 offset:1024
v_mfma_f32_16x16x32_bf16 v[80:83], v[0:3], v[20:23], 0
ds_read_b64_tr_b16 v[32:33], v144 offset:8192
ds_read_b64_tr_b16 v[34:35], v144 offset:12288
v_mfma_f32_16x16x32_bf16 v[96:99], v[0:3], v[24:27], 0
ds_read_b128 v[52:55], v148 offset:3072
v_mfma_f32_16x16x32_bf16 v[112:115], v[0:3], v[28:31], 0
ds_read_b64_tr_b16 v[36:37], v145 offset:8192
ds_read_b64_tr_b16 v[38:39], v145 offset:12288
v_mfma_f32_16x16x32_bf16 v[68:71], v[4:7], v[16:19], 0
ds_read_b128 v[56:59], v148 offset:5120
v_mfma_f32_16x16x32_bf16 v[84:87], v[4:7], v[20:23], 0
ds_read_b64_tr_b16 v[40:41], v146 offset:8192
ds_read_b64_tr_b16 v[42:43], v146 offset:12288
v_mfma_f32_16x16x32_bf16 v[100:103], v[4:7], v[24:27], 0
ds_read_b128 v[60:63], v148 offset:7168
v_mfma_f32_16x16x32_bf16 v[116:119], v[4:7], v[28:31], 0
ds_read_b64_tr_b16 v[44:45], v147 offset:8192
ds_read_b64_tr_b16 v[46:47], v147 offset:12288
v_mfma_f32_16x16x32_bf16 v[72:75], v[8:11], v[16:19], 0
v_add_u32 v144, 32768, v136
v_add_u32 v145, 32768, v137
v_mfma_f32_16x16x32_bf16 v[88:91], v[8:11], v[20:23], 0
v_add_u32 v146, 32768, v138
v_add_u32 v147, 32768, v139
v_mfma_f32_16x16x32_bf16 v[104:107], v[8:11], v[24:27], 0
v_add_u32 v148, 32768, v142
v_mfma_f32_16x16x32_bf16 v[120:123], v[8:11], v[28:31], 0
v_mfma_f32_16x16x32_bf16 v[76:79], v[12:15], v[16:19], 0
v_mfma_f32_16x16x32_bf16 v[92:95], v[12:15], v[20:23], 0
v_mfma_f32_16x16x32_bf16 v[108:111], v[12:15], v[24:27], 0
v_mfma_f32_16x16x32_bf16 v[124:127], v[12:15], v[28:31], 0
s_waitcnt vmcnt(10) lgkmcnt(0)
s_barrier
v_mfma_f32_16x16x32_bf16 v[64:67], v[32:35], v[48:51], v[64:67]
s_add_u32 m0, s31, 0
ds_read_b128 v[16:19], v148 offset:0
v_mfma_f32_16x16x32_bf16 v[80:83], v[32:35], v[52:55], v[80:83]
s_add_u32 s30, s67, 8192
ds_read_b64_tr_b16 v[0:1], v144 offset:0
ds_read_b64_tr_b16 v[2:3], v144 offset:4096
v_mfma_f32_16x16x32_bf16 v[96:99], v[32:35], v[56:59], v[96:99]
buffer_load_dwordx4 v252, s[4:7], s30 offen offset:0 sc1 lds
v_mfma_f32_16x16x32_bf16 v[112:115], v[32:35], v[60:63], v[112:115]
ds_read_b128 v[20:23], v148 offset:2048
v_mfma_f32_16x16x32_bf16 v[68:71], v[36:39], v[48:51], v[68:71]
ds_read_b64_tr_b16 v[4:5], v145 offset:0
ds_read_b64_tr_b16 v[6:7], v145 offset:4096
v_mfma_f32_16x16x32_bf16 v[84:87], v[36:39], v[52:55], v[84:87]
buffer_load_dwordx4 v252, s[4:7], s30 offen offset:1024 sc1 lds
v_mfma_f32_16x16x32_bf16 v[100:103], v[36:39], v[56:59], v[100:103]
ds_read_b128 v[24:27], v148 offset:4096
v_mfma_f32_16x16x32_bf16 v[116:119], v[36:39], v[60:63], v[116:119]
s_add_u32 s30, s67, 137216
ds_read_b64_tr_b16 v[8:9], v146 offset:0
ds_read_b64_tr_b16 v[10:11], v146 offset:4096
v_mfma_f32_16x16x32_bf16 v[72:75], v[40:43], v[48:51], v[72:75]
buffer_load_dwordx4 v252, s[4:7], s30 offen offset:2048 sc1 lds
v_mfma_f32_16x16x32_bf16 v[88:91], v[40:43], v[52:55], v[88:91]
ds_read_b128 v[28:31], v148 offset:6144
v_mfma_f32_16x16x32_bf16 v[104:107], v[40:43], v[56:59], v[104:107]
ds_read_b64_tr_b16 v[12:13], v147 offset:0
ds_read_b64_tr_b16 v[14:15], v147 offset:4096
v_mfma_f32_16x16x32_bf16 v[120:123], v[40:43], v[60:63], v[120:123]
buffer_load_dwordx4 v252, s[4:7], s30 offen offset:3072 sc1 lds
v_mfma_f32_16x16x32_bf16 v[76:79], v[44:47], v[48:51], v[76:79]
v_mfma_f32_16x16x32_bf16 v[92:95], v[44:47], v[52:55], v[92:95]
v_mfma_f32_16x16x32_bf16 v[108:111], v[44:47], v[56:59], v[108:111]
v_mfma_f32_16x16x32_bf16 v[124:127], v[44:47], v[60:63], v[124:127]
s_waitcnt lgkmcnt(0)
v_mfma_f32_16x16x32_bf16 v[64:67], v[0:3], v[16:19], v[64:67]
s_add_u32 m0, s31, 16384
ds_read_b128 v[48:51], v148 offset:1024
v_mfma_f32_16x16x32_bf16 v[80:83], v[0:3], v[20:23], v[80:83]
s_add_u32 s30, s68, 262144
ds_read_b64_tr_b16 v[32:33], v144 offset:8192
ds_read_b64_tr_b16 v[34:35], v144 offset:12288
v_mfma_f32_16x16x32_bf16 v[96:99], v[0:3], v[24:27], v[96:99]
buffer_load_dwordx4 v128, s[8:11], s30 offen offset:0 lds
v_mfma_f32_16x16x32_bf16 v[112:115], v[0:3], v[28:31], v[112:115]
ds_read_b128 v[52:55], v148 offset:3072
v_mfma_f32_16x16x32_bf16 v[68:71], v[4:7], v[16:19], v[68:71]
ds_read_b64_tr_b16 v[36:37], v145 offset:8192
ds_read_b64_tr_b16 v[38:39], v145 offset:12288
v_mfma_f32_16x16x32_bf16 v[84:87], v[4:7], v[20:23], v[84:87]
buffer_load_dwordx4 v129, s[8:11], s30 offen offset:1024 lds
v_mfma_f32_16x16x32_bf16 v[100:103], v[4:7], v[24:27], v[100:103]
ds_read_b128 v[56:59], v148 offset:5120
v_mfma_f32_16x16x32_bf16 v[116:119], v[4:7], v[28:31], v[116:119]
ds_read_b64_tr_b16 v[40:41], v146 offset:8192
ds_read_b64_tr_b16 v[42:43], v146 offset:12288
v_mfma_f32_16x16x32_bf16 v[72:75], v[8:11], v[16:19], v[72:75]
buffer_load_dwordx4 v130, s[8:11], s30 offen offset:2048 lds
v_mfma_f32_16x16x32_bf16 v[88:91], v[8:11], v[20:23], v[88:91]
ds_read_b128 v[60:63], v148 offset:7168
v_mfma_f32_16x16x32_bf16 v[104:107], v[8:11], v[24:27], v[104:107]
ds_read_b64_tr_b16 v[44:45], v147 offset:8192
ds_read_b64_tr_b16 v[46:47], v147 offset:12288
v_mfma_f32_16x16x32_bf16 v[120:123], v[8:11], v[28:31], v[120:123]
buffer_load_dwordx4 v131, s[8:11], s30 offen offset:3072 lds
v_mfma_f32_16x16x32_bf16 v[76:79], v[12:15], v[16:19], v[76:79]
v_add_u32 v144, 65536, v136
v_add_u32 v145, 65536, v137
v_mfma_f32_16x16x32_bf16 v[92:95], v[12:15], v[20:23], v[92:95]
v_add_u32 v146, 65536, v138
v_add_u32 v147, 65536, v139
v_mfma_f32_16x16x32_bf16 v[108:111], v[12:15], v[24:27], v[108:111]
v_add_u32 v148, 65536, v142
v_mfma_f32_16x16x32_bf16 v[124:127], v[12:15], v[28:31], v[124:127]
s_waitcnt vmcnt(14) lgkmcnt(0)
s_barrier
v_mfma_f32_16x16x32_bf16 v[64:67], v[32:35], v[48:51], v[64:67]
s_add_u32 m0, s31, 32768
ds_read_b128 v[16:19], v148 offset:0
v_mfma_f32_16x16x32_bf16 v[80:83], v[32:35], v[52:55], v[80:83]
s_add_u32 s30, s67, 10240
ds_read_b64_tr_b16 v[0:1], v144 offset:0
ds_read_b64_tr_b16 v[2:3], v144 offset:4096
v_mfma_f32_16x16x32_bf16 v[96:99], v[32:35], v[56:59], v[96:99]
buffer_load_dwordx4 v252, s[4:7], s30 offen offset:0 sc1 lds
v_mfma_f32_16x16x32_bf16 v[112:115], v[32:35], v[60:63], v[112:115]
ds_read_b128 v[20:23], v148 offset:2048
v_mfma_f32_16x16x32_bf16 v[68:71], v[36:39], v[48:51], v[68:71]
ds_read_b64_tr_b16 v[4:5], v145 offset:0
ds_read_b64_tr_b16 v[6:7], v145 offset:4096
v_mfma_f32_16x16x32_bf16 v[84:87], v[36:39], v[52:55], v[84:87]
buffer_load_dwordx4 v252, s[4:7], s30 offen offset:1024 sc1 lds
v_mfma_f32_16x16x32_bf16 v[100:103], v[36:39], v[56:59], v[100:103]
ds_read_b128 v[24:27], v148 offset:4096
v_mfma_f32_16x16x32_bf16 v[116:119], v[36:39], v[60:63], v[116:119]
s_add_u32 s30, s67, 139264
ds_read_b64_tr_b16 v[8:9], v146 offset:0
ds_read_b64_tr_b16 v[10:11], v146 offset:4096
v_mfma_f32_16x16x32_bf16 v[72:75], v[40:43], v[48:51], v[72:75]
buffer_load_dwordx4 v252, s[4:7], s30 offen offset:2048 sc1 lds
v_mfma_f32_16x16x32_bf16 v[88:91], v[40:43], v[52:55], v[88:91]
ds_read_b128 v[28:31], v148 offset:6144
v_mfma_f32_16x16x32_bf16 v[104:107], v[40:43], v[56:59], v[104:107]
ds_read_b64_tr_b16 v[12:13], v147 offset:0
ds_read_b64_tr_b16 v[14:15], v147 offset:4096
v_mfma_f32_16x16x32_bf16 v[120:123], v[40:43], v[60:63], v[120:123]
buffer_load_dwordx4 v252, s[4:7], s30 offen offset:3072 sc1 lds
v_mfma_f32_16x16x32_bf16 v[76:79], v[44:47], v[48:51], v[76:79]
v_mfma_f32_16x16x32_bf16 v[92:95], v[44:47], v[52:55], v[92:95]
v_mfma_f32_16x16x32_bf16 v[108:111], v[44:47], v[56:59], v[108:111]
v_mfma_f32_16x16x32_bf16 v[124:127], v[44:47], v[60:63], v[124:127]
s_waitcnt lgkmcnt(0)
v_mfma_f32_16x16x32_bf16 v[64:67], v[0:3], v[16:19], v[64:67]
s_add_u32 m0, s31, 49152
ds_read_b128 v[48:51], v148 offset:1024
v_mfma_f32_16x16x32_bf16 v[80:83], v[0:3], v[20:23], v[80:83]
s_add_u32 s30, s68, 327680
ds_read_b64_tr_b16 v[32:33], v144 offset:8192
ds_read_b64_tr_b16 v[34:35], v144 offset:12288
v_mfma_f32_16x16x32_bf16 v[96:99], v[0:3], v[24:27], v[96:99]
buffer_load_dwordx4 v128, s[8:11], s30 offen offset:0 lds
v_mfma_f32_16x16x32_bf16 v[112:115], v[0:3], v[28:31], v[112:115]
ds_read_b128 v[52:55], v148 offset:3072
v_mfma_f32_16x16x32_bf16 v[68:71], v[4:7], v[16:19], v[68:71]
ds_read_b64_tr_b16 v[36:37], v145 offset:8192
ds_read_b64_tr_b16 v[38:39], v145 offset:12288
v_mfma_f32_16x16x32_bf16 v[84:87], v[4:7], v[20:23], v[84:87]
buffer_load_dwordx4 v129, s[8:11], s30 offen offset:1024 lds
v_mfma_f32_16x16x32_bf16 v[100:103], v[4:7], v[24:27], v[100:103]
ds_read_b128 v[56:59], v148 offset:5120
v_mfma_f32_16x16x32_bf16 v[116:119], v[4:7], v[28:31], v[116:119]
ds_read_b64_tr_b16 v[40:41], v146 offset:8192
ds_read_b64_tr_b16 v[42:43], v146 offset:12288
v_mfma_f32_16x16x32_bf16 v[72:75], v[8:11], v[16:19], v[72:75]
buffer_load_dwordx4 v130, s[8:11], s30 offen offset:2048 lds
v_mfma_f32_16x16x32_bf16 v[88:91], v[8:11], v[20:23], v[88:91]
ds_read_b128 v[60:63], v148 offset:7168
v_mfma_f32_16x16x32_bf16 v[104:107], v[8:11], v[24:27], v[104:107]
ds_read_b64_tr_b16 v[44:45], v147 offset:8192
ds_read_b64_tr_b16 v[46:47], v147 offset:12288
v_mfma_f32_16x16x32_bf16 v[120:123], v[8:11], v[28:31], v[120:123]
buffer_load_dwordx4 v131, s[8:11], s30 offen offset:3072 lds
v_mfma_f32_16x16x32_bf16 v[76:79], v[12:15], v[16:19], v[76:79]
v_add_u32 v144, 98304, v136
v_add_u32 v145, 98304, v137
v_mfma_f32_16x16x32_bf16 v[92:95], v[12:15], v[20:23], v[92:95]
v_add_u32 v146, 98304, v138
v_add_u32 v147, 98304, v139
v_mfma_f32_16x16x32_bf16 v[108:111], v[12:15], v[24:27], v[108:111]
v_add_u32 v148, 98304, v142
v_mfma_f32_16x16x32_bf16 v[124:127], v[12:15], v[28:31], v[124:127]
s_waitcnt vmcnt(18) lgkmcnt(0)
s_barrier
v_mfma_f32_16x16x32_bf16 v[64:67], v[32:35], v[48:51], v[64:67]
s_add_u32 m0, s31, 65536
ds_read_b128 v[16:19], v148 offset:0
v_mfma_f32_16x16x32_bf16 v[80:83], v[32:35], v[52:55], v[80:83]
s_add_u32 s30, s67, 12288
ds_read_b64_tr_b16 v[0:1], v144 offset:0
ds_read_b64_tr_b16 v[2:3], v144 offset:4096
v_mfma_f32_16x16x32_bf16 v[96:99], v[32:35], v[56:59], v[96:99]
buffer_load_dwordx4 v252, s[4:7], s30 offen offset:0 sc1 lds
v_mfma_f32_16x16x32_bf16 v[112:115], v[32:35], v[60:63], v[112:115]
ds_read_b128 v[20:23], v148 offset:2048
v_mfma_f32_16x16x32_bf16 v[68:71], v[36:39], v[48:51], v[68:71]
ds_read_b64_tr_b16 v[4:5], v145 offset:0
ds_read_b64_tr_b16 v[6:7], v145 offset:4096
v_mfma_f32_16x16x32_bf16 v[84:87], v[36:39], v[52:55], v[84:87]
buffer_load_dwordx4 v252, s[4:7], s30 offen offset:1024 sc1 lds
v_mfma_f32_16x16x32_bf16 v[100:103], v[36:39], v[56:59], v[100:103]
ds_read_b128 v[24:27], v148 offset:4096
v_mfma_f32_16x16x32_bf16 v[116:119], v[36:39], v[60:63], v[116:119]
s_add_u32 s30, s67, 141312
ds_read_b64_tr_b16 v[8:9], v146 offset:0
ds_read_b64_tr_b16 v[10:11], v146 offset:4096
v_mfma_f32_16x16x32_bf16 v[72:75], v[40:43], v[48:51], v[72:75]
buffer_load_dwordx4 v252, s[4:7], s30 offen offset:2048 sc1 lds
v_mfma_f32_16x16x32_bf16 v[88:91], v[40:43], v[52:55], v[88:91]
ds_read_b128 v[28:31], v148 offset:6144
v_mfma_f32_16x16x32_bf16 v[104:107], v[40:43], v[56:59], v[104:107]
ds_read_b64_tr_b16 v[12:13], v147 offset:0
ds_read_b64_tr_b16 v[14:15], v147 offset:4096
v_mfma_f32_16x16x32_bf16 v[120:123], v[40:43], v[60:63], v[120:123]
buffer_load_dwordx4 v252, s[4:7], s30 offen offset:3072 sc1 lds
v_mfma_f32_16x16x32_bf16 v[76:79], v[44:47], v[48:51], v[76:79]
v_mfma_f32_16x16x32_bf16 v[92:95], v[44:47], v[52:55], v[92:95]
v_mfma_f32_16x16x32_bf16 v[108:111], v[44:47], v[56:59], v[108:111]
v_mfma_f32_16x16x32_bf16 v[124:127], v[44:47], v[60:63], v[124:127]
s_waitcnt lgkmcnt(0)
v_mfma_f32_16x16x32_bf16 v[64:67], v[0:3], v[16:19], v[64:67]
s_add_u32 m0, s31, 81920
ds_read_b128 v[48:51], v148 offset:1024
v_mfma_f32_16x16x32_bf16 v[80:83], v[0:3], v[20:23], v[80:83]
s_add_u32 s30, s68, 393216
ds_read_b64_tr_b16 v[32:33], v144 offset:8192
ds_read_b64_tr_b16 v[34:35], v144 offset:12288
v_mfma_f32_16x16x32_bf16 v[96:99], v[0:3], v[24:27], v[96:99]
buffer_load_dwordx4 v128, s[8:11], s30 offen offset:0 lds
v_mfma_f32_16x16x32_bf16 v[112:115], v[0:3], v[28:31], v[112:115]
ds_read_b128 v[52:55], v148 offset:3072
v_mfma_f32_16x16x32_bf16 v[68:71], v[4:7], v[16:19], v[68:71]
ds_read_b64_tr_b16 v[36:37], v145 offset:8192
ds_read_b64_tr_b16 v[38:39], v145 offset:12288
v_mfma_f32_16x16x32_bf16 v[84:87], v[4:7], v[20:23], v[84:87]
buffer_load_dwordx4 v129, s[8:11], s30 offen offset:1024 lds
v_mfma_f32_16x16x32_bf16 v[100:103], v[4:7], v[24:27], v[100:103]
ds_read_b128 v[56:59], v148 offset:5120
v_mfma_f32_16x16x32_bf16 v[116:119], v[4:7], v[28:31], v[116:119]
ds_read_b64_tr_b16 v[40:41], v146 offset:8192
ds_read_b64_tr_b16 v[42:43], v146 offset:12288
v_mfma_f32_16x16x32_bf16 v[72:75], v[8:11], v[16:19], v[72:75]
buffer_load_dwordx4 v130, s[8:11], s30 offen offset:2048 lds
v_mfma_f32_16x16x32_bf16 v[88:91], v[8:11], v[20:23], v[88:91]
ds_read_b128 v[60:63], v148 offset:7168
v_mfma_f32_16x16x32_bf16 v[104:107], v[8:11], v[24:27], v[104:107]
ds_read_b64_tr_b16 v[44:45], v147 offset:8192
ds_read_b64_tr_b16 v[46:47], v147 offset:12288
v_mfma_f32_16x16x32_bf16 v[120:123], v[8:11], v[28:31], v[120:123]
buffer_load_dwordx4 v131, s[8:11], s30 offen offset:3072 lds
v_mfma_f32_16x16x32_bf16 v[76:79], v[12:15], v[16:19], v[76:79]
v_add_u32 v144, 0, v136
v_add_u32 v145, 0, v137
v_mfma_f32_16x16x32_bf16 v[92:95], v[12:15], v[20:23], v[92:95]
v_add_u32 v146, 0, v138
v_add_u32 v147, 0, v139
v_mfma_f32_16x16x32_bf16 v[108:111], v[12:15], v[24:27], v[108:111]
v_add_u32 v148, 0, v142
v_mfma_f32_16x16x32_bf16 v[124:127], v[12:15], v[28:31], v[124:127]
s_waitcnt vmcnt(16) lgkmcnt(0)
s_barrier
v_mfma_f32_16x16x32_bf16 v[64:67], v[32:35], v[48:51], v[64:67]
ds_read_b128 v[16:19], v148 offset:0
v_mfma_f32_16x16x32_bf16 v[80:83], v[32:35], v[52:55], v[80:83]
ds_read_b64_tr_b16 v[0:1], v144 offset:0
ds_read_b64_tr_b16 v[2:3], v144 offset:4096
v_mfma_f32_16x16x32_bf16 v[96:99], v[32:35], v[56:59], v[96:99]
buffer_store_dword v151, v241, s[4:7], 0 offen sc1
v_mfma_f32_16x16x32_bf16 v[112:115], v[32:35], v[60:63], v[112:115]
s_add_u32 m0, s31, 98304
s_add_u32 s30, s67, 14336
v_mfma_f32_16x16x32_bf16 v[68:71], v[36:39], v[48:51], v[68:71]
buffer_load_dwordx4 v252, s[4:7], s30 offen offset:0 sc1 lds
v_mfma_f32_16x16x32_bf16 v[84:87], v[36:39], v[52:55], v[84:87]
ds_read_b128 v[20:23], v148 offset:2048
v_mfma_f32_16x16x32_bf16 v[100:103], v[36:39], v[56:59], v[100:103]
ds_read_b64_tr_b16 v[4:5], v145 offset:0
ds_read_b64_tr_b16 v[6:7], v145 offset:4096
v_mfma_f32_16x16x32_bf16 v[116:119], v[36:39], v[60:63], v[116:119]
buffer_load_dwordx4 v252, s[4:7], s30 offen offset:1024 sc1 lds
v_mfma_f32_16x16x32_bf16 v[72:75], v[40:43], v[48:51], v[72:75]
s_add_u32 s30, s67, 143360
ds_read_b128 v[24:27], v148 offset:4096
v_mfma_f32_16x16x32_bf16 v[88:91], v[40:43], v[52:55], v[88:91]
buffer_load_dwordx4 v252, s[4:7], s30 offen offset:2048 sc1 lds
v_mfma_f32_16x16x32_bf16 v[104:107], v[40:43], v[56:59], v[104:107]
ds_read_b64_tr_b16 v[8:9], v146 offset:0
ds_read_b64_tr_b16 v[10:11], v146 offset:4096
v_mfma_f32_16x16x32_bf16 v[120:123], v[40:43], v[60:63], v[120:123]
ds_read_b128 v[28:31], v148 offset:6144
v_mfma_f32_16x16x32_bf16 v[76:79], v[44:47], v[48:51], v[76:79]
buffer_load_dwordx4 v252, s[4:7], s30 offen offset:3072 sc1 lds
v_mfma_f32_16x16x32_bf16 v[92:95], v[44:47], v[52:55], v[92:95]
ds_read_b64_tr_b16 v[12:13], v147 offset:0
ds_read_b64_tr_b16 v[14:15], v147 offset:4096
v_mfma_f32_16x16x32_bf16 v[108:111], v[44:47], v[56:59], v[108:111]
v_mfma_f32_16x16x32_bf16 v[124:127], v[44:47], v[60:63], v[124:127]
s_waitcnt lgkmcnt(0)
v_mfma_f32_16x16x32_bf16 v[64:67], v[0:3], v[16:19], v[64:67]
s_add_u32 m0, s31, 114688
ds_read_b128 v[48:51], v148 offset:1024
v_mfma_f32_16x16x32_bf16 v[80:83], v[0:3], v[20:23], v[80:83]
s_add_u32 s30, s68, 458752
ds_read_b64_tr_b16 v[32:33], v144 offset:8192
ds_read_b64_tr_b16 v[34:35], v144 offset:12288
v_mfma_f32_16x16x32_bf16 v[96:99], v[0:3], v[24:27], v[96:99]
buffer_load_dwordx4 v128, s[8:11], s30 offen offset:0 lds
v_mfma_f32_16x16x32_bf16 v[112:115], v[0:3], v[28:31], v[112:115]
ds_read_b128 v[52:55], v148 offset:3072
v_mfma_f32_16x16x32_bf16 v[68:71], v[4:7], v[16:19], v[68:71]
ds_read_b64_tr_b16 v[36:37], v145 offset:8192
ds_read_b64_tr_b16 v[38:39], v145 offset:12288
v_mfma_f32_16x16x32_bf16 v[84:87], v[4:7], v[20:23], v[84:87]
buffer_load_dwordx4 v129, s[8:11], s30 offen offset:1024 lds
v_mfma_f32_16x16x32_bf16 v[100:103], v[4:7], v[24:27], v[100:103]
ds_read_b128 v[56:59], v148 offset:5120
v_mfma_f32_16x16x32_bf16 v[116:119], v[4:7], v[28:31], v[116:119]
ds_read_b64_tr_b16 v[40:41], v146 offset:8192
ds_read_b64_tr_b16 v[42:43], v146 offset:12288
v_mfma_f32_16x16x32_bf16 v[72:75], v[8:11], v[16:19], v[72:75]
buffer_load_dwordx4 v130, s[8:11], s30 offen offset:2048 lds
v_mfma_f32_16x16x32_bf16 v[88:91], v[8:11], v[20:23], v[88:91]
ds_read_b128 v[60:63], v148 offset:7168
v_mfma_f32_16x16x32_bf16 v[104:107], v[8:11], v[24:27], v[104:107]
ds_read_b64_tr_b16 v[44:45], v147 offset:8192
ds_read_b64_tr_b16 v[46:47], v147 offset:12288
v_mfma_f32_16x16x32_bf16 v[120:123], v[8:11], v[28:31], v[120:123]
buffer_load_dwordx4 v131, s[8:11], s30 offen offset:3072 lds
v_mfma_f32_16x16x32_bf16 v[76:79], v[12:15], v[16:19], v[76:79]
v_add_u32 v144, 32768, v136
v_add_u32 v145, 32768, v137
v_mfma_f32_16x16x32_bf16 v[92:95], v[12:15], v[20:23], v[92:95]
v_add_u32 v146, 32768, v138
v_add_u32 v147, 32768, v139
v_mfma_f32_16x16x32_bf16 v[108:111], v[12:15], v[24:27], v[108:111]
v_add_u32 v148, 32768, v142
v_mfma_f32_16x16x32_bf16 v[124:127], v[12:15], v[28:31], v[124:127]
s_waitcnt vmcnt(17) lgkmcnt(0)
s_barrier
v_mfma_f32_16x16x32_bf16 v[64:67], v[32:35], v[48:51], v[64:67]
s_add_u32 m0, s31, 0
ds_read_b128 v[16:19], v148 offset:0
v_mfma_f32_16x16x32_bf16 v[80:83], v[32:35], v[52:55], v[80:83]
s_add_u32 s30, s67, 16384
ds_read_b64_tr_b16 v[0:1], v144 offset:0
ds_read_b64_tr_b16 v[2:3], v144 offset:4096
v_mfma_f32_16x16x32_bf16 v[96:99], v[32:35], v[56:59], v[96:99]
buffer_load_dwordx4 v252, s[4:7], s30 offen offset:0 sc1 lds
v_mfma_f32_16x16x32_bf16 v[112:115], v[32:35], v[60:63], v[112:115]
ds_read_b128 v[20:23], v148 offset:2048
v_mfma_f32_16x16x32_bf16 v[68:71], v[36:39], v[48:51], v[68:71]
ds_read_b64_tr_b16 v[4:5], v145 offset:0
ds_read_b64_tr_b16 v[6:7], v145 offset:4096
v_mfma_f32_16x16x32_bf16 v[84:87], v[36:39], v[52:55], v[84:87]
buffer_load_dwordx4 v252, s[4:7], s30 offen offset:1024 sc1 lds
v_mfma_f32_16x16x32_bf16 v[100:103], v[36:39], v[56:59], v[100:103]
ds_read_b128 v[24:27], v148 offset:4096
v_mfma_f32_16x16x32_bf16 v[116:119], v[36:39], v[60:63], v[116:119]
s_add_u32 s30, s67, 145408
ds_read_b64_tr_b16 v[8:9], v146 offset:0
ds_read_b64_tr_b16 v[10:11], v146 offset:4096
v_mfma_f32_16x16x32_bf16 v[72:75], v[40:43], v[48:51], v[72:75]
buffer_load_dwordx4 v252, s[4:7], s30 offen offset:2048 sc1 lds
v_mfma_f32_16x16x32_bf16 v[88:91], v[40:43], v[52:55], v[88:91]
ds_read_b128 v[28:31], v148 offset:6144
v_mfma_f32_16x16x32_bf16 v[104:107], v[40:43], v[56:59], v[104:107]
ds_read_b64_tr_b16 v[12:13], v147 offset:0
ds_read_b64_tr_b16 v[14:15], v147 offset:4096
v_mfma_f32_16x16x32_bf16 v[120:123], v[40:43], v[60:63], v[120:123]
buffer_load_dwordx4 v252, s[4:7], s30 offen offset:3072 sc1 lds
v_mfma_f32_16x16x32_bf16 v[76:79], v[44:47], v[48:51], v[76:79]
v_mfma_f32_16x16x32_bf16 v[92:95], v[44:47], v[52:55], v[92:95]
v_mfma_f32_16x16x32_bf16 v[108:111], v[44:47], v[56:59], v[108:111]
v_mfma_f32_16x16x32_bf16 v[124:127], v[44:47], v[60:63], v[124:127]
s_waitcnt lgkmcnt(0)
v_mfma_f32_16x16x32_bf16 v[64:67], v[0:3], v[16:19], v[64:67]
s_add_u32 m0, s31, 16384
ds_read_b128 v[48:51], v148 offset:1024
v_mfma_f32_16x16x32_bf16 v[80:83], v[0:3], v[20:23], v[80:83]
s_add_u32 s30, s68, 524288
ds_read_b64_tr_b16 v[32:33], v144 offset:8192
ds_read_b64_tr_b16 v[34:35], v144 offset:12288
v_mfma_f32_16x16x32_bf16 v[96:99], v[0:3], v[24:27], v[96:99]
buffer_load_dwordx4 v128, s[8:11], s30 offen offset:0 lds
v_mfma_f32_16x16x32_bf16 v[112:115], v[0:3], v[28:31], v[112:115]
ds_read_b128 v[52:55], v148 offset:3072
v_mfma_f32_16x16x32_bf16 v[68:71], v[4:7], v[16:19], v[68:71]
ds_read_b64_tr_b16 v[36:37], v145 offset:8192
ds_read_b64_tr_b16 v[38:39], v145 offset:12288
v_mfma_f32_16x16x32_bf16 v[84:87], v[4:7], v[20:23], v[84:87]
buffer_load_dwordx4 v129, s[8:11], s30 offen offset:1024 lds
v_mfma_f32_16x16x32_bf16 v[100:103], v[4:7], v[24:27], v[100:103]
ds_read_b128 v[56:59], v148 offset:5120
v_mfma_f32_16x16x32_bf16 v[116:119], v[4:7], v[28:31], v[116:119]
ds_read_b64_tr_b16 v[40:41], v146 offset:8192
ds_read_b64_tr_b16 v[42:43], v146 offset:12288
v_mfma_f32_16x16x32_bf16 v[72:75], v[8:11], v[16:19], v[72:75]
buffer_load_dwordx4 v130, s[8:11], s30 offen offset:2048 lds
v_mfma_f32_16x16x32_bf16 v[88:91], v[8:11], v[20:23], v[88:91]
ds_read_b128 v[60:63], v148 offset:7168
v_mfma_f32_16x16x32_bf16 v[104:107], v[8:11], v[24:27], v[104:107]
ds_read_b64_tr_b16 v[44:45], v147 offset:8192
ds_read_b64_tr_b16 v[46:47], v147 offset:12288
v_mfma_f32_16x16x32_bf16 v[120:123], v[8:11], v[28:31], v[120:123]
buffer_load_dwordx4 v131, s[8:11], s30 offen offset:3072 lds
v_mfma_f32_16x16x32_bf16 v[76:79], v[12:15], v[16:19], v[76:79]
v_add_u32 v144, 65536, v136
v_add_u32 v145, 65536, v137
v_mfma_f32_16x16x32_bf16 v[92:95], v[12:15], v[20:23], v[92:95]
v_add_u32 v146, 65536, v138
v_add_u32 v147, 65536, v139
v_mfma_f32_16x16x32_bf16 v[108:111], v[12:15], v[24:27], v[108:111]
v_add_u32 v148, 65536, v142
v_mfma_f32_16x16x32_bf16 v[124:127], v[12:15], v[28:31], v[124:127]
s_waitcnt vmcnt(17) lgkmcnt(0)
s_barrier
v_mfma_f32_16x16x32_bf16 v[64:67], v[32:35], v[48:51], v[64:67]
s_add_u32 m0, s31, 32768
ds_read_b128 v[16:19], v148 offset:0
v_mfma_f32_16x16x32_bf16 v[80:83], v[32:35], v[52:55], v[80:83]
s_add_u32 s30, s67, 18432
ds_read_b64_tr_b16 v[0:1], v144 offset:0
ds_read_b64_tr_b16 v[2:3], v144 offset:4096
v_mfma_f32_16x16x32_bf16 v[96:99], v[32:35], v[56:59], v[96:99]
buffer_load_dwordx4 v252, s[4:7], s30 offen offset:0 sc1 lds
v_mfma_f32_16x16x32_bf16 v[112:115], v[32:35], v[60:63], v[112:115]
ds_read_b128 v[20:23], v148 offset:2048
v_mfma_f32_16x16x32_bf16 v[68:71], v[36:39], v[48:51], v[68:71]
ds_read_b64_tr_b16 v[4:5], v145 offset:0
ds_read_b64_tr_b16 v[6:7], v145 offset:4096
v_mfma_f32_16x16x32_bf16 v[84:87], v[36:39], v[52:55], v[84:87]
buffer_load_dwordx4 v252, s[4:7], s30 offen offset:1024 sc1 lds
v_mfma_f32_16x16x32_bf16 v[100:103], v[36:39], v[56:59], v[100:103]
ds_read_b128 v[24:27], v148 offset:4096
v_mfma_f32_16x16x32_bf16 v[116:119], v[36:39], v[60:63], v[116:119]
s_add_u32 s30, s67, 147456
ds_read_b64_tr_b16 v[8:9], v146 offset:0
ds_read_b64_tr_b16 v[10:11], v146 offset:4096
v_mfma_f32_16x16x32_bf16 v[72:75], v[40:43], v[48:51], v[72:75]
buffer_load_dwordx4 v252, s[4:7], s30 offen offset:2048 sc1 lds
v_mfma_f32_16x16x32_bf16 v[88:91], v[40:43], v[52:55], v[88:91]
ds_read_b128 v[28:31], v148 offset:6144
v_mfma_f32_16x16x32_bf16 v[104:107], v[40:43], v[56:59], v[104:107]
ds_read_b64_tr_b16 v[12:13], v147 offset:0
ds_read_b64_tr_b16 v[14:15], v147 offset:4096
v_mfma_f32_16x16x32_bf16 v[120:123], v[40:43], v[60:63], v[120:123]
buffer_load_dwordx4 v252, s[4:7], s30 offen offset:3072 sc1 lds
v_mfma_f32_16x16x32_bf16 v[76:79], v[44:47], v[48:51], v[76:79]
v_mfma_f32_16x16x32_bf16 v[92:95], v[44:47], v[52:55], v[92:95]
v_mfma_f32_16x16x32_bf16 v[108:111], v[44:47], v[56:59], v[108:111]
v_mfma_f32_16x16x32_bf16 v[124:127], v[44:47], v[60:63], v[124:127]
s_waitcnt lgkmcnt(0)
v_mfma_f32_16x16x32_bf16 v[64:67], v[0:3], v[16:19], v[64:67]
s_add_u32 m0, s31, 49152
ds_read_b128 v[48:51], v148 offset:1024
v_mfma_f32_16x16x32_bf16 v[80:83], v[0:3], v[20:23], v[80:83]
s_add_u32 s30, s68, 589824
ds_read_b64_tr_b16 v[32:33], v144 offset:8192
ds_read_b64_tr_b16 v[34:35], v144 offset:12288
v_mfma_f32_16x16x32_bf16 v[96:99], v[0:3], v[24:27], v[96:99]
buffer_load_dwordx4 v128, s[8:11], s30 offen offset:0 lds
v_mfma_f32_16x16x32_bf16 v[112:115], v[0:3], v[28:31], v[112:115]
ds_read_b128 v[52:55], v148 offset:3072
v_mfma_f32_16x16x32_bf16 v[68:71], v[4:7], v[16:19], v[68:71]
ds_read_b64_tr_b16 v[36:37], v145 offset:8192
ds_read_b64_tr_b16 v[38:39], v145 offset:12288
v_mfma_f32_16x16x32_bf16 v[84:87], v[4:7], v[20:23], v[84:87]
buffer_load_dwordx4 v129, s[8:11], s30 offen offset:1024 lds
v_mfma_f32_16x16x32_bf16 v[100:103], v[4:7], v[24:27], v[100:103]
ds_read_b128 v[56:59], v148 offset:5120
v_mfma_f32_16x16x32_bf16 v[116:119], v[4:7], v[28:31], v[116:119]
ds_read_b64_tr_b16 v[40:41], v146 offset:8192
ds_read_b64_tr_b16 v[42:43], v146 offset:12288
v_mfma_f32_16x16x32_bf16 v[72:75], v[8:11], v[16:19], v[72:75]
buffer_load_dwordx4 v130, s[8:11], s30 offen offset:2048 lds
v_mfma_f32_16x16x32_bf16 v[88:91], v[8:11], v[20:23], v[88:91]
ds_read_b128 v[60:63], v148 offset:7168
v_mfma_f32_16x16x32_bf16 v[104:107], v[8:11], v[24:27], v[104:107]
ds_read_b64_tr_b16 v[44:45], v147 offset:8192
ds_read_b64_tr_b16 v[46:47], v147 offset:12288
v_mfma_f32_16x16x32_bf16 v[120:123], v[8:11], v[28:31], v[120:123]
buffer_load_dwordx4 v131, s[8:11], s30 offen offset:3072 lds
v_mfma_f32_16x16x32_bf16 v[76:79], v[12:15], v[16:19], v[76:79]
v_add_u32 v144, 98304, v136
v_add_u32 v145, 98304, v137
v_mfma_f32_16x16x32_bf16 v[92:95], v[12:15], v[20:23], v[92:95]
v_add_u32 v146, 98304, v138
v_add_u32 v147, 98304, v139
v_mfma_f32_16x16x32_bf16 v[108:111], v[12:15], v[24:27], v[108:111]
v_add_u32 v148, 98304, v142
v_mfma_f32_16x16x32_bf16 v[124:127], v[12:15], v[28:31], v[124:127]
s_waitcnt vmcnt(16) lgkmcnt(0)
s_barrier
v_mfma_f32_16x16x32_bf16 v[64:67], v[32:35], v[48:51], v[64:67]
s_add_u32 m0, s31, 65536
ds_read_b128 v[16:19], v148 offset:0
v_mfma_f32_16x16x32_bf16 v[80:83], v[32:35], v[52:55], v[80:83]
s_add_u32 s30, s67, 20480
ds_read_b64_tr_b16 v[0:1], v144 offset:0
ds_read_b64_tr_b16 v[2:3], v144 offset:4096
v_mfma_f32_16x16x32_bf16 v[96:99], v[32:35], v[56:59], v[96:99]
buffer_load_dwordx4 v252, s[4:7], s30 offen offset:0 sc1 lds
v_mfma_f32_16x16x32_bf16 v[112:115], v[32:35], v[60:63], v[112:115]
ds_read_b128 v[20:23], v148 offset:2048
v_mfma_f32_16x16x32_bf16 v[68:71], v[36:39], v[48:51], v[68:71]
ds_read_b64_tr_b16 v[4:5], v145 offset:0
ds_read_b64_tr_b16 v[6:7], v145 offset:4096
v_mfma_f32_16x16x32_bf16 v[84:87], v[36:39], v[52:55], v[84:87]
buffer_load_dwordx4 v252, s[4:7], s30 offen offset:1024 sc1 lds
v_mfma_f32_16x16x32_bf16 v[100:103], v[36:39], v[56:59], v[100:103]
ds_read_b128 v[24:27], v148 offset:4096
v_mfma_f32_16x16x32_bf16 v[116:119], v[36:39], v[60:63], v[116:119]
s_add_u32 s30, s67, 149504
ds_read_b64_tr_b16 v[8:9], v146 offset:0
ds_read_b64_tr_b16 v[10:11], v146 offset:4096
v_mfma_f32_16x16x32_bf16 v[72:75], v[40:43], v[48:51], v[72:75]
buffer_load_dwordx4 v252, s[4:7], s30 offen offset:2048 sc1 lds
v_mfma_f32_16x16x32_bf16 v[88:91], v[40:43], v[52:55], v[88:91]
ds_read_b128 v[28:31], v148 offset:6144
v_mfma_f32_16x16x32_bf16 v[104:107], v[40:43], v[56:59], v[104:107]
ds_read_b64_tr_b16 v[12:13], v147 offset:0
ds_read_b64_tr_b16 v[14:15], v147 offset:4096
v_mfma_f32_16x16x32_bf16 v[120:123], v[40:43], v[60:63], v[120:123]
buffer_load_dwordx4 v252, s[4:7], s30 offen offset:3072 sc1 lds
v_mfma_f32_16x16x32_bf16 v[76:79], v[44:47], v[48:51], v[76:79]
v_mfma_f32_16x16x32_bf16 v[92:95], v[44:47], v[52:55], v[92:95]
v_mfma_f32_16x16x32_bf16 v[108:111], v[44:47], v[56:59], v[108:111]
v_mfma_f32_16x16x32_bf16 v[124:127], v[44:47], v[60:63], v[124:127]
s_waitcnt lgkmcnt(0)
v_mfma_f32_16x16x32_bf16 v[64:67], v[0:3], v[16:19], v[64:67]
s_add_u32 m0, s31, 81920
ds_read_b128 v[48:51], v148 offset:1024
v_mfma_f32_16x16x32_bf16 v[80:83], v[0:3], v[20:23], v[80:83]
s_add_u32 s30, s68, 655360
ds_read_b64_tr_b16 v[32:33], v144 offset:8192
ds_read_b64_tr_b16 v[34:35], v144 offset:12288
v_mfma_f32_16x16x32_bf16 v[96:99], v[0:3], v[24:27], v[96:99]
buffer_load_dwordx4 v128, s[8:11], s30 offen offset:0 lds
v_mfma_f32_16x16x32_bf16 v[112:115], v[0:3], v[28:31], v[112:115]
ds_read_b128 v[52:55], v148 offset:3072
v_mfma_f32_16x16x32_bf16 v[68:71], v[4:7], v[16:19], v[68:71]
ds_read_b64_tr_b16 v[36:37], v145 offset:8192
ds_read_b64_tr_b16 v[38:39], v145 offset:12288
v_mfma_f32_16x16x32_bf16 v[84:87], v[4:7], v[20:23], v[84:87]
buffer_load_dwordx4 v129, s[8:11], s30 offen offset:1024 lds
v_mfma_f32_16x16x32_bf16 v[100:103], v[4:7], v[24:27], v[100:103]
ds_read_b128 v[56:59], v148 offset:5120
v_mfma_f32_16x16x32_bf16 v[116:119], v[4:7], v[28:31], v[116:119]
ds_read_b64_tr_b16 v[40:41], v146 offset:8192
ds_read_b64_tr_b16 v[42:43], v146 offset:12288
v_mfma_f32_16x16x32_bf16 v[72:75], v[8:11], v[16:19], v[72:75]
buffer_load_dwordx4 v130, s[8:11], s30 offen offset:2048 lds
v_mfma_f32_16x16x32_bf16 v[88:91], v[8:11], v[20:23], v[88:91]
ds_read_b128 v[60:63], v148 offset:7168
v_mfma_f32_16x16x32_bf16 v[104:107], v[8:11], v[24:27], v[104:107]
ds_read_b64_tr_b16 v[44:45], v147 offset:8192
ds_read_b64_tr_b16 v[46:47], v147 offset:12288
v_mfma_f32_16x16x32_bf16 v[120:123], v[8:11], v[28:31], v[120:123]
buffer_load_dwordx4 v131, s[8:11], s30 offen offset:3072 lds
v_mfma_f32_16x16x32_bf16 v[76:79], v[12:15], v[16:19], v[76:79]
v_add_u32 v144, 0, v136
v_add_u32 v145, 0, v137
v_mfma_f32_16x16x32_bf16 v[92:95], v[12:15], v[20:23], v[92:95]
v_add_u32 v146, 0, v138
v_add_u32 v147, 0, v139
v_mfma_f32_16x16x32_bf16 v[108:111], v[12:15], v[24:27], v[108:111]
v_add_u32 v148, 0, v142
v_mfma_f32_16x16x32_bf16 v[124:127], v[12:15], v[28:31], v[124:127]
s_waitcnt vmcnt(16) lgkmcnt(0)
s_barrier
v_mfma_f32_16x16x32_bf16 v[64:67], v[32:35], v[48:51], v[64:67]
s_add_u32 m0, s31, 98304
ds_read_b128 v[16:19], v148 offset:0
v_mfma_f32_16x16x32_bf16 v[80:83], v[32:35], v[52:55], v[80:83]
s_add_u32 s30, s67, 22528
ds_read_b64_tr_b16 v[0:1], v144 offset:0
ds_read_b64_tr_b16 v[2:3], v144 offset:4096
v_mfma_f32_16x16x32_bf16 v[96:99], v[32:35], v[56:59], v[96:99]
buffer_load_dwordx4 v252, s[4:7], s30 offen offset:0 sc1 lds
v_mfma_f32_16x16x32_bf16 v[112:115], v[32:35], v[60:63], v[112:115]
ds_read_b128 v[20:23], v148 offset:2048
v_mfma_f32_16x16x32_bf16 v[68:71], v[36:39], v[48:51], v[68:71]
ds_read_b64_tr_b16 v[4:5], v145 offset:0
ds_read_b64_tr_b16 v[6:7], v145 offset:4096
v_mfma_f32_16x16x32_bf16 v[84:87], v[36:39], v[52:55], v[84:87]
buffer_load_dwordx4 v252, s[4:7], s30 offen offset:1024 sc1 lds
v_mfma_f32_16x16x32_bf16 v[100:103], v[36:39], v[56:59], v[100:103]
ds_read_b128 v[24:27], v148 offset:4096
v_mfma_f32_16x16x32_bf16 v[116:119], v[36:39], v[60:63], v[116:119]
s_add_u32 s30, s67, 151552
ds_read_b64_tr_b16 v[8:9], v146 offset:0
ds_read_b64_tr_b16 v[10:11], v146 offset:4096
v_mfma_f32_16x16x32_bf16 v[72:75], v[40:43], v[48:51], v[72:75]
buffer_load_dwordx4 v252, s[4:7], s30 offen offset:2048 sc1 lds
v_mfma_f32_16x16x32_bf16 v[88:91], v[40:43], v[52:55], v[88:91]
ds_read_b128 v[28:31], v148 offset:6144
v_mfma_f32_16x16x32_bf16 v[104:107], v[40:43], v[56:59], v[104:107]
ds_read_b64_tr_b16 v[12:13], v147 offset:0
ds_read_b64_tr_b16 v[14:15], v147 offset:4096
v_mfma_f32_16x16x32_bf16 v[120:123], v[40:43], v[60:63], v[120:123]
buffer_load_dwordx4 v252, s[4:7], s30 offen offset:3072 sc1 lds
v_mfma_f32_16x16x32_bf16 v[76:79], v[44:47], v[48:51], v[76:79]
v_mfma_f32_16x16x32_bf16 v[92:95], v[44:47], v[52:55], v[92:95]
v_mfma_f32_16x16x32_bf16 v[108:111], v[44:47], v[56:59], v[108:111]
v_mfma_f32_16x16x32_bf16 v[124:127], v[44:47], v[60:63], v[124:127]
s_waitcnt lgkmcnt(0)
v_mfma_f32_16x16x32_bf16 v[64:67], v[0:3], v[16:19], v[64:67]
s_add_u32 m0, s31, 114688
ds_read_b128 v[48:51], v148 offset:1024
v_mfma_f32_16x16x32_bf16 v[80:83], v[0:3], v[20:23], v[80:83]
s_add_u32 s30, s68, 720896
ds_read_b64_tr_b16 v[32:33], v144 offset:8192
ds_read_b64_tr_b16 v[34:35], v144 offset:12288
v_mfma_f32_16x16x32_bf16 v[96:99], v[0:3], v[24:27], v[96:99]
buffer_load_dwordx4 v128, s[8:11], s30 offen offset:0 lds
v_mfma_f32_16x16x32_bf16 v[112:115], v[0:3], v[28:31], v[112:115]
ds_read_b128 v[52:55], v148 offset:3072
v_mfma_f32_16x16x32_bf16 v[68:71], v[4:7], v[16:19], v[68:71]
ds_read_b64_tr_b16 v[36:37], v145 offset:8192
ds_read_b64_tr_b16 v[38:39], v145 offset:12288
v_mfma_f32_16x16x32_bf16 v[84:87], v[4:7], v[20:23], v[84:87]
buffer_load_dwordx4 v129, s[8:11], s30 offen offset:1024 lds
v_mfma_f32_16x16x32_bf16 v[100:103], v[4:7], v[24:27], v[100:103]
ds_read_b128 v[56:59], v148 offset:5120
v_mfma_f32_16x16x32_bf16 v[116:119], v[4:7], v[28:31], v[116:119]
ds_read_b64_tr_b16 v[40:41], v146 offset:8192
ds_read_b64_tr_b16 v[42:43], v146 offset:12288
v_mfma_f32_16x16x32_bf16 v[72:75], v[8:11], v[16:19], v[72:75]
buffer_load_dwordx4 v130, s[8:11], s30 offen offset:2048 lds
v_mfma_f32_16x16x32_bf16 v[88:91], v[8:11], v[20:23], v[88:91]
ds_read_b128 v[60:63], v148 offset:7168
v_mfma_f32_16x16x32_bf16 v[104:107], v[8:11], v[24:27], v[104:107]
ds_read_b64_tr_b16 v[44:45], v147 offset:8192
ds_read_b64_tr_b16 v[46:47], v147 offset:12288
v_mfma_f32_16x16x32_bf16 v[120:123], v[8:11], v[28:31], v[120:123]
buffer_load_dwordx4 v131, s[8:11], s30 offen offset:3072 lds
v_mfma_f32_16x16x32_bf16 v[76:79], v[12:15], v[16:19], v[76:79]
v_add_u32 v144, 32768, v136
v_add_u32 v145, 32768, v137
v_mfma_f32_16x16x32_bf16 v[92:95], v[12:15], v[20:23], v[92:95]
v_add_u32 v146, 32768, v138
v_add_u32 v147, 32768, v139
v_mfma_f32_16x16x32_bf16 v[108:111], v[12:15], v[24:27], v[108:111]
v_add_u32 v148, 32768, v142
v_mfma_f32_16x16x32_bf16 v[124:127], v[12:15], v[28:31], v[124:127]
s_waitcnt vmcnt(16) lgkmcnt(0)
s_barrier
v_mfma_f32_16x16x32_bf16 v[64:67], v[32:35], v[48:51], v[64:67]
s_add_u32 m0, s31, 0
ds_read_b128 v[16:19], v148 offset:0
v_mfma_f32_16x16x32_bf16 v[80:83], v[32:35], v[52:55], v[80:83]
s_add_u32 s30, s67, 24576
ds_read_b64_tr_b16 v[0:1], v144 offset:0
ds_read_b64_tr_b16 v[2:3], v144 offset:4096
v_mfma_f32_16x16x32_bf16 v[96:99], v[32:35], v[56:59], v[96:99]
buffer_load_dwordx4 v252, s[4:7], s30 offen offset:0 sc1 lds
v_mfma_f32_16x16x32_bf16 v[112:115], v[32:35], v[60:63], v[112:115]
ds_read_b128 v[20:23], v148 offset:2048
v_mfma_f32_16x16x32_bf16 v[68:71], v[36:39], v[48:51], v[68:71]
ds_read_b64_tr_b16 v[4:5], v145 offset:0
ds_read_b64_tr_b16 v[6:7], v145 offset:4096
v_mfma_f32_16x16x32_bf16 v[84:87], v[36:39], v[52:55], v[84:87]
buffer_load_dwordx4 v252, s[4:7], s30 offen offset:1024 sc1 lds
v_mfma_f32_16x16x32_bf16 v[100:103], v[36:39], v[56:59], v[100:103]
ds_read_b128 v[24:27], v148 offset:4096
v_mfma_f32_16x16x32_bf16 v[116:119], v[36:39], v[60:63], v[116:119]
s_add_u32 s30, s67, 153600
ds_read_b64_tr_b16 v[8:9], v146 offset:0
ds_read_b64_tr_b16 v[10:11], v146 offset:4096
v_mfma_f32_16x16x32_bf16 v[72:75], v[40:43], v[48:51], v[72:75]
buffer_load_dwordx4 v252, s[4:7], s30 offen offset:2048 sc1 lds
v_mfma_f32_16x16x32_bf16 v[88:91], v[40:43], v[52:55], v[88:91]
ds_read_b128 v[28:31], v148 offset:6144
v_mfma_f32_16x16x32_bf16 v[104:107], v[40:43], v[56:59], v[104:107]
ds_read_b64_tr_b16 v[12:13], v147 offset:0
ds_read_b64_tr_b16 v[14:15], v147 offset:4096
v_mfma_f32_16x16x32_bf16 v[120:123], v[40:43], v[60:63], v[120:123]
buffer_load_dwordx4 v252, s[4:7], s30 offen offset:3072 sc1 lds
v_mfma_f32_16x16x32_bf16 v[76:79], v[44:47], v[48:51], v[76:79]
v_mfma_f32_16x16x32_bf16 v[92:95], v[44:47], v[52:55], v[92:95]
v_mfma_f32_16x16x32_bf16 v[108:111], v[44:47], v[56:59], v[108:111]
v_mfma_f32_16x16x32_bf16 v[124:127], v[44:47], v[60:63], v[124:127]
s_waitcnt lgkmcnt(0)
v_mfma_f32_16x16x32_bf16 v[64:67], v[0:3], v[16:19], v[64:67]
s_add_u32 m0, s31, 16384
ds_read_b128 v[48:51], v148 offset:1024
v_mfma_f32_16x16x32_bf16 v[80:83], v[0:3], v[20:23], v[80:83]
s_add_u32 s30, s68, 786432
ds_read_b64_tr_b16 v[32:33], v144 offset:8192
ds_read_b64_tr_b16 v[34:35], v144 offset:12288
v_mfma_f32_16x16x32_bf16 v[96:99], v[0:3], v[24:27], v[96:99]
buffer_load_dwordx4 v128, s[8:11], s30 offen offset:0 lds
v_mfma_f32_16x16x32_bf16 v[112:115], v[0:3], v[28:31], v[112:115]
ds_read_b128 v[52:55], v148 offset:3072
v_mfma_f32_16x16x32_bf16 v[68:71], v[4:7], v[16:19], v[68:71]
ds_read_b64_tr_b16 v[36:37], v145 offset:8192
ds_read_b64_tr_b16 v[38:39], v145 offset:12288
v_mfma_f32_16x16x32_bf16 v[84:87], v[4:7], v[20:23], v[84:87]
buffer_load_dwordx4 v129, s[8:11], s30 offen offset:1024 lds
v_mfma_f32_16x16x32_bf16 v[100:103], v[4:7], v[24:27], v[100:103]
ds_read_b128 v[56:59], v148 offset:5120
v_mfma_f32_16x16x32_bf16 v[116:119], v[4:7], v[28:31], v[116:119]
ds_read_b64_tr_b16 v[40:41], v146 offset:8192
ds_read_b64_tr_b16 v[42:43], v146 offset:12288
v_mfma_f32_16x16x32_bf16 v[72:75], v[8:11], v[16:19], v[72:75]
buffer_load_dwordx4 v130, s[8:11], s30 offen offset:2048 lds
v_mfma_f32_16x16x32_bf16 v[88:91], v[8:11], v[20:23], v[88:91]
ds_read_b128 v[60:63], v148 offset:7168
v_mfma_f32_16x16x32_bf16 v[104:107], v[8:11], v[24:27], v[104:107]
ds_read_b64_tr_b16 v[44:45], v147 offset:8192
ds_read_b64_tr_b16 v[46:47], v147 offset:12288
v_mfma_f32_16x16x32_bf16 v[120:123], v[8:11], v[28:31], v[120:123]
buffer_load_dwordx4 v131, s[8:11], s30 offen offset:3072 lds
v_mfma_f32_16x16x32_bf16 v[76:79], v[12:15], v[16:19], v[76:79]
v_add_u32 v144, 65536, v136
v_add_u32 v145, 65536, v137
v_mfma_f32_16x16x32_bf16 v[92:95], v[12:15], v[20:23], v[92:95]
v_add_u32 v146, 65536, v138
v_add_u32 v147, 65536, v139
v_mfma_f32_16x16x32_bf16 v[108:111], v[12:15], v[24:27], v[108:111]
v_add_u32 v148, 65536, v142
v_mfma_f32_16x16x32_bf16 v[124:127], v[12:15], v[28:31], v[124:127]
s_waitcnt vmcnt(16) lgkmcnt(0)
s_barrier
v_mfma_f32_16x16x32_bf16 v[64:67], v[32:35], v[48:51], v[64:67]
s_add_u32 m0, s31, 32768
ds_read_b128 v[16:19], v148 offset:0
v_mfma_f32_16x16x32_bf16 v[80:83], v[32:35], v[52:55], v[80:83]
s_add_u32 s30, s67, 26624
ds_read_b64_tr_b16 v[0:1], v144 offset:0
ds_read_b64_tr_b16 v[2:3], v144 offset:4096
v_mfma_f32_16x16x32_bf16 v[96:99], v[32:35], v[56:59], v[96:99]
buffer_load_dwordx4 v252, s[4:7], s30 offen offset:0 sc1 lds
v_mfma_f32_16x16x32_bf16 v[112:115], v[32:35], v[60:63], v[112:115]
ds_read_b128 v[20:23], v148 offset:2048
v_mfma_f32_16x16x32_bf16 v[68:71], v[36:39], v[48:51], v[68:71]
ds_read_b64_tr_b16 v[4:5], v145 offset:0
ds_read_b64_tr_b16 v[6:7], v145 offset:4096
v_mfma_f32_16x16x32_bf16 v[84:87], v[36:39], v[52:55], v[84:87]
buffer_load_dwordx4 v252, s[4:7], s30 offen offset:1024 sc1 lds
v_mfma_f32_16x16x32_bf16 v[100:103], v[36:39], v[56:59], v[100:103]
ds_read_b128 v[24:27], v148 offset:4096
v_mfma_f32_16x16x32_bf16 v[116:119], v[36:39], v[60:63], v[116:119]
s_add_u32 s30, s67, 155648
ds_read_b64_tr_b16 v[8:9], v146 offset:0
ds_read_b64_tr_b16 v[10:11], v146 offset:4096
v_mfma_f32_16x16x32_bf16 v[72:75], v[40:43], v[48:51], v[72:75]
buffer_load_dwordx4 v252, s[4:7], s30 offen offset:2048 sc1 lds
v_mfma_f32_16x16x32_bf16 v[88:91], v[40:43], v[52:55], v[88:91]
ds_read_b128 v[28:31], v148 offset:6144
v_mfma_f32_16x16x32_bf16 v[104:107], v[40:43], v[56:59], v[104:107]
ds_read_b64_tr_b16 v[12:13], v147 offset:0
ds_read_b64_tr_b16 v[14:15], v147 offset:4096
v_mfma_f32_16x16x32_bf16 v[120:123], v[40:43], v[60:63], v[120:123]
buffer_load_dwordx4 v252, s[4:7], s30 offen offset:3072 sc1 lds
v_mfma_f32_16x16x32_bf16 v[76:79], v[44:47], v[48:51], v[76:79]
v_mfma_f32_16x16x32_bf16 v[92:95], v[44:47], v[52:55], v[92:95]
v_mfma_f32_16x16x32_bf16 v[108:111], v[44:47], v[56:59], v[108:111]
v_mfma_f32_16x16x32_bf16 v[124:127], v[44:47], v[60:63], v[124:127]
s_waitcnt lgkmcnt(0)
v_mfma_f32_16x16x32_bf16 v[64:67], v[0:3], v[16:19], v[64:67]
s_add_u32 m0, s31, 49152
ds_read_b128 v[48:51], v148 offset:1024
v_mfma_f32_16x16x32_bf16 v[80:83], v[0:3], v[20:23], v[80:83]
s_add_u32 s30, s68, 851968
ds_read_b64_tr_b16 v[32:33], v144 offset:8192
ds_read_b64_tr_b16 v[34:35], v144 offset:12288
v_mfma_f32_16x16x32_bf16 v[96:99], v[0:3], v[24:27], v[96:99]
buffer_load_dwordx4 v128, s[8:11], s30 offen offset:0 lds
v_mfma_f32_16x16x32_bf16 v[112:115], v[0:3], v[28:31], v[112:115]
ds_read_b128 v[52:55], v148 offset:3072
v_mfma_f32_16x16x32_bf16 v[68:71], v[4:7], v[16:19], v[68:71]
buffer_load_dwordx4 v129, s[8:11], s30 offen offset:1024 lds
v_mfma_f32_16x16x32_bf16 v[84:87], v[4:7], v[20:23], v[84:87]
ds_read_b64_tr_b16 v[36:37], v145 offset:8192
ds_read_b64_tr_b16 v[38:39], v145 offset:12288
v_mfma_f32_16x16x32_bf16 v[100:103], v[4:7], v[24:27], v[100:103]
ds_read_b128 v[56:59], v148 offset:5120
v_mfma_f32_16x16x32_bf16 v[116:119], v[4:7], v[28:31], v[116:119]
buffer_load_dwordx4 v130, s[8:11], s30 offen offset:2048 lds
v_mfma_f32_16x16x32_bf16 v[72:75], v[8:11], v[16:19], v[72:75]
ds_read_b64_tr_b16 v[40:41], v146 offset:8192
ds_read_b64_tr_b16 v[42:43], v146 offset:12288
v_mfma_f32_16x16x32_bf16 v[88:91], v[8:11], v[20:23], v[88:91]
buffer_load_dwordx4 v131, s[8:11], s30 offen offset:3072 lds
v_mfma_f32_16x16x32_bf16 v[104:107], v[8:11], v[24:27], v[104:107]
ds_read_b128 v[60:63], v148 offset:7168
v_mfma_f32_16x16x32_bf16 v[120:123], v[8:11], v[28:31], v[120:123]
ds_read_b64_tr_b16 v[44:45], v147 offset:8192
ds_read_b64_tr_b16 v[46:47], v147 offset:12288
v_mfma_f32_16x16x32_bf16 v[76:79], v[12:15], v[16:19], v[76:79]
buffer_load_dword v150, v242, s[4:7], 0 offen sc1
v_mfma_f32_16x16x32_bf16 v[92:95], v[12:15], v[20:23], v[92:95]
v_add_u32 v144, 98304, v136
v_add_u32 v145, 98304, v137
v_mfma_f32_16x16x32_bf16 v[108:111], v[12:15], v[24:27], v[108:111]
v_add_u32 v146, 98304, v138
v_add_u32 v147, 98304, v139
v_mfma_f32_16x16x32_bf16 v[124:127], v[12:15], v[28:31], v[124:127]
v_add_u32 v148, 98304, v142
s_waitcnt vmcnt(17) lgkmcnt(0)
s_barrier
v_mfma_f32_16x16x32_bf16 v[64:67], v[32:35], v[48:51], v[64:67]
s_add_u32 m0, s31, 65536
ds_read_b128 v[16:19], v148 offset:0
v_mfma_f32_16x16x32_bf16 v[80:83], v[32:35], v[52:55], v[80:83]
s_add_u32 s30, s67, 28672
ds_read_b64_tr_b16 v[0:1], v144 offset:0
ds_read_b64_tr_b16 v[2:3], v144 offset:4096
v_mfma_f32_16x16x32_bf16 v[96:99], v[32:35], v[56:59], v[96:99]
buffer_load_dwordx4 v252, s[4:7], s30 offen offset:0 sc1 lds
v_mfma_f32_16x16x32_bf16 v[112:115], v[32:35], v[60:63], v[112:115]
ds_read_b128 v[20:23], v148 offset:2048
v_mfma_f32_16x16x32_bf16 v[68:71], v[36:39], v[48:51], v[68:71]
ds_read_b64_tr_b16 v[4:5], v145 offset:0
ds_read_b64_tr_b16 v[6:7], v145 offset:4096
v_mfma_f32_16x16x32_bf16 v[84:87], v[36:39], v[52:55], v[84:87]
buffer_load_dwordx4 v252, s[4:7], s30 offen offset:1024 sc1 lds
v_mfma_f32_16x16x32_bf16 v[100:103], v[36:39], v[56:59], v[100:103]
ds_read_b128 v[24:27], v148 offset:4096
v_mfma_f32_16x16x32_bf16 v[116:119], v[36:39], v[60:63], v[116:119]
s_add_u32 s30, s67, 157696
ds_read_b64_tr_b16 v[8:9], v146 offset:0
ds_read_b64_tr_b16 v[10:11], v146 offset:4096
v_mfma_f32_16x16x32_bf16 v[72:75], v[40:43], v[48:51], v[72:75]
buffer_load_dwordx4 v252, s[4:7], s30 offen offset:2048 sc1 lds
v_mfma_f32_16x16x32_bf16 v[88:91], v[40:43], v[52:55], v[88:91]
ds_read_b128 v[28:31], v148 offset:6144
v_mfma_f32_16x16x32_bf16 v[104:107], v[40:43], v[56:59], v[104:107]
ds_read_b64_tr_b16 v[12:13], v147 offset:0
ds_read_b64_tr_b16 v[14:15], v147 offset:4096
v_mfma_f32_16x16x32_bf16 v[120:123], v[40:43], v[60:63], v[120:123]
buffer_load_dwordx4 v252, s[4:7], s30 offen offset:3072 sc1 lds
v_mfma_f32_16x16x32_bf16 v[76:79], v[44:47], v[48:51], v[76:79]
v_mfma_f32_16x16x32_bf16 v[92:95], v[44:47], v[52:55], v[92:95]
v_mfma_f32_16x16x32_bf16 v[108:111], v[44:47], v[56:59], v[108:111]
v_mfma_f32_16x16x32_bf16 v[124:127], v[44:47], v[60:63], v[124:127]
s_waitcnt lgkmcnt(0)
v_mfma_f32_16x16x32_bf16 v[64:67], v[0:3], v[16:19], v[64:67]
s_add_u32 m0, s31, 81920
ds_read_b128 v[48:51], v148 offset:1024
v_mfma_f32_16x16x32_bf16 v[80:83], v[0:3], v[20:23], v[80:83]
s_add_u32 s30, s68, 917504
ds_read_b64_tr_b16 v[32:33], v144 offset:8192
ds_read_b64_tr_b16 v[34:35], v144 offset:12288
v_mfma_f32_16x16x32_bf16 v[96:99], v[0:3], v[24:27], v[96:99]
buffer_load_dwordx4 v128, s[8:11], s30 offen offset:0 lds
v_mfma_f32_16x16x32_bf16 v[112:115], v[0:3], v[28:31], v[112:115]
ds_read_b128 v[52:55], v148 offset:3072
v_mfma_f32_16x16x32_bf16 v[68:71], v[4:7], v[16:19], v[68:71]
ds_read_b64_tr_b16 v[36:37], v145 offset:8192
ds_read_b64_tr_b16 v[38:39], v145 offset:12288
v_mfma_f32_16x16x32_bf16 v[84:87], v[4:7], v[20:23], v[84:87]
buffer_load_dwordx4 v129, s[8:11], s30 offen offset:1024 lds
v_mfma_f32_16x16x32_bf16 v[100:103], v[4:7], v[24:27], v[100:103]
ds_read_b128 v[56:59], v148 offset:5120
v_mfma_f32_16x16x32_bf16 v[116:119], v[4:7], v[28:31], v[116:119]
ds_read_b64_tr_b16 v[40:41], v146 offset:8192
ds_read_b64_tr_b16 v[42:43], v146 offset:12288
v_mfma_f32_16x16x32_bf16 v[72:75], v[8:11], v[16:19], v[72:75]
buffer_load_dwordx4 v130, s[8:11], s30 offen offset:2048 lds
v_mfma_f32_16x16x32_bf16 v[88:91], v[8:11], v[20:23], v[88:91]
ds_read_b128 v[60:63], v148 offset:7168
v_mfma_f32_16x16x32_bf16 v[104:107], v[8:11], v[24:27], v[104:107]
ds_read_b64_tr_b16 v[44:45], v147 offset:8192
ds_read_b64_tr_b16 v[46:47], v147 offset:12288
v_mfma_f32_16x16x32_bf16 v[120:123], v[8:11], v[28:31], v[120:123]
buffer_load_dwordx4 v131, s[8:11], s30 offen offset:3072 lds
v_mfma_f32_16x16x32_bf16 v[76:79], v[12:15], v[16:19], v[76:79]
v_add_u32 v144, 0, v136
v_add_u32 v145, 0, v137
v_mfma_f32_16x16x32_bf16 v[92:95], v[12:15], v[20:23], v[92:95]
v_add_u32 v146, 0, v138
v_add_u32 v147, 0, v139
v_mfma_f32_16x16x32_bf16 v[108:111], v[12:15], v[24:27], v[108:111]
v_add_u32 v148, 0, v142
v_mfma_f32_16x16x32_bf16 v[124:127], v[12:15], v[28:31], v[124:127]
s_waitcnt vmcnt(17) lgkmcnt(0)
s_barrier
v_mfma_f32_16x16x32_bf16 v[64:67], v[32:35], v[48:51], v[64:67]
s_add_u32 m0, s31, 98304
ds_read_b128 v[16:19], v148 offset:0
v_mfma_f32_16x16x32_bf16 v[80:83], v[32:35], v[52:55], v[80:83]
s_add_u32 s30, s67, 30720
ds_read_b64_tr_b16 v[0:1], v144 offset:0
ds_read_b64_tr_b16 v[2:3], v144 offset:4096
v_mfma_f32_16x16x32_bf16 v[96:99], v[32:35], v[56:59], v[96:99]
buffer_load_dwordx4 v252, s[4:7], s30 offen offset:0 sc1 lds
v_mfma_f32_16x16x32_bf16 v[112:115], v[32:35], v[60:63], v[112:115]
ds_read_b128 v[20:23], v148 offset:2048
v_mfma_f32_16x16x32_bf16 v[68:71], v[36:39], v[48:51], v[68:71]
ds_read_b64_tr_b16 v[4:5], v145 offset:0
ds_read_b64_tr_b16 v[6:7], v145 offset:4096
v_mfma_f32_16x16x32_bf16 v[84:87], v[36:39], v[52:55], v[84:87]
buffer_load_dwordx4 v252, s[4:7], s30 offen offset:1024 sc1 lds
v_mfma_f32_16x16x32_bf16 v[100:103], v[36:39], v[56:59], v[100:103]
ds_read_b128 v[24:27], v148 offset:4096
v_mfma_f32_16x16x32_bf16 v[116:119], v[36:39], v[60:63], v[116:119]
s_add_u32 s30, s67, 159744
ds_read_b64_tr_b16 v[8:9], v146 offset:0
ds_read_b64_tr_b16 v[10:11], v146 offset:4096
v_mfma_f32_16x16x32_bf16 v[72:75], v[40:43], v[48:51], v[72:75]
buffer_load_dwordx4 v252, s[4:7], s30 offen offset:2048 sc1 lds
v_mfma_f32_16x16x32_bf16 v[88:91], v[40:43], v[52:55], v[88:91]
ds_read_b128 v[28:31], v148 offset:6144
v_mfma_f32_16x16x32_bf16 v[104:107], v[40:43], v[56:59], v[104:107]
ds_read_b64_tr_b16 v[12:13], v147 offset:0
ds_read_b64_tr_b16 v[14:15], v147 offset:4096
v_mfma_f32_16x16x32_bf16 v[120:123], v[40:43], v[60:63], v[120:123]
buffer_load_dwordx4 v252, s[4:7], s30 offen offset:3072 sc1 lds
v_mfma_f32_16x16x32_bf16 v[76:79], v[44:47], v[48:51], v[76:79]
v_mfma_f32_16x16x32_bf16 v[92:95], v[44:47], v[52:55], v[92:95]
v_mfma_f32_16x16x32_bf16 v[108:111], v[44:47], v[56:59], v[108:111]
v_mfma_f32_16x16x32_bf16 v[124:127], v[44:47], v[60:63], v[124:127]
s_waitcnt lgkmcnt(0)
v_mfma_f32_16x16x32_bf16 v[64:67], v[0:3], v[16:19], v[64:67]
s_add_u32 m0, s31, 114688
ds_read_b128 v[48:51], v148 offset:1024
v_mfma_f32_16x16x32_bf16 v[80:83], v[0:3], v[20:23], v[80:83]
s_add_u32 s30, s68, 983040
ds_read_b64_tr_b16 v[32:33], v144 offset:8192
ds_read_b64_tr_b16 v[34:35], v144 offset:12288
v_mfma_f32_16x16x32_bf16 v[96:99], v[0:3], v[24:27], v[96:99]
buffer_load_dwordx4 v128, s[8:11], s30 offen offset:0 lds
v_mfma_f32_16x16x32_bf16 v[112:115], v[0:3], v[28:31], v[112:115]
ds_read_b128 v[52:55], v148 offset:3072
v_mfma_f32_16x16x32_bf16 v[68:71], v[4:7], v[16:19], v[68:71]
ds_read_b64_tr_b16 v[36:37], v145 offset:8192
ds_read_b64_tr_b16 v[38:39], v145 offset:12288
v_mfma_f32_16x16x32_bf16 v[84:87], v[4:7], v[20:23], v[84:87]
buffer_load_dwordx4 v129, s[8:11], s30 offen offset:1024 lds
v_mfma_f32_16x16x32_bf16 v[100:103], v[4:7], v[24:27], v[100:103]
ds_read_b128 v[56:59], v148 offset:5120
v_mfma_f32_16x16x32_bf16 v[116:119], v[4:7], v[28:31], v[116:119]
ds_read_b64_tr_b16 v[40:41], v146 offset:8192
ds_read_b64_tr_b16 v[42:43], v146 offset:12288
v_mfma_f32_16x16x32_bf16 v[72:75], v[8:11], v[16:19], v[72:75]
buffer_load_dwordx4 v130, s[8:11], s30 offen offset:2048 lds
v_mfma_f32_16x16x32_bf16 v[88:91], v[8:11], v[20:23], v[88:91]
ds_read_b128 v[60:63], v148 offset:7168
v_mfma_f32_16x16x32_bf16 v[104:107], v[8:11], v[24:27], v[104:107]
ds_read_b64_tr_b16 v[44:45], v147 offset:8192
ds_read_b64_tr_b16 v[46:47], v147 offset:12288
v_mfma_f32_16x16x32_bf16 v[120:123], v[8:11], v[28:31], v[120:123]
buffer_load_dwordx4 v131, s[8:11], s30 offen offset:3072 lds
v_mfma_f32_16x16x32_bf16 v[76:79], v[12:15], v[16:19], v[76:79]
v_add_u32 v144, 32768, v136
v_add_u32 v145, 32768, v137
v_mfma_f32_16x16x32_bf16 v[92:95], v[12:15], v[20:23], v[92:95]
v_add_u32 v146, 32768, v138
v_add_u32 v147, 32768, v139
v_mfma_f32_16x16x32_bf16 v[108:111], v[12:15], v[24:27], v[108:111]
v_add_u32 v148, 32768, v142
v_mfma_f32_16x16x32_bf16 v[124:127], v[12:15], v[28:31], v[124:127]
s_waitcnt vmcnt(16) lgkmcnt(0)
v_cmp_ne_u32 vcc, 1, v150
s_mov_b32 s37, 0
s_nop 3
s_cbranch_vccz BK_rdyB
BK_pollB:
s_sleep 1
buffer_load_dword v150, v242, s[4:7], 0 offen sc1
s_waitcnt vmcnt(0)
v_cmp_ne_u32 vcc, 1, v150
s_add_u32 s37, s37, 1
s_nop 3
s_cbranch_vccz BK_rdyB
s_cmp_lt_u32 s37, 0x40000
s_cbranch_scc1 BK_pollB
BK_rdyB:
s_barrier
v_mfma_f32_16x16x32_bf16 v[64:67], v[32:35], v[48:51], v[64:67]
s_add_u32 m0, s31, 0
ds_read_b128 v[16:19], v148 offset:0
v_mfma_f32_16x16x32_bf16 v[80:83], v[32:35], v[52:55], v[80:83]
s_add_u32 s30, s69, 0
ds_read_b64_tr_b16 v[0:1], v144 offset:0
ds_read_b64_tr_b16 v[2:3], v144 offset:4096
v_mfma_f32_16x16x32_bf16 v[96:99], v[32:35], v[56:59], v[96:99]
buffer_load_dwordx4 v252, s[4:7], s30 offen offset:0 sc1 lds
v_mfma_f32_16x16x32_bf16 v[112:115], v[32:35], v[60:63], v[112:115]
ds_read_b128 v[20:23], v148 offset:2048
v_mfma_f32_16x16x32_bf16 v[68:71], v[36:39], v[48:51], v[68:71]
ds_read_b64_tr_b16 v[4:5], v145 offset:0
ds_read_b64_tr_b16 v[6:7], v145 offset:4096
v_mfma_f32_16x16x32_bf16 v[84:87], v[36:39], v[52:55], v[84:87]
buffer_load_dwordx4 v252, s[4:7], s30 offen offset:1024 sc1 lds
v_mfma_f32_16x16x32_bf16 v[100:103], v[36:39], v[56:59], v[100:103]
ds_read_b128 v[24:27], v148 offset:4096
v_mfma_f32_16x16x32_bf16 v[116:119], v[36:39], v[60:63], v[116:119]
ds_read_b64_tr_b16 v[8:9], v146 offset:0
ds_read_b64_tr_b16 v[10:11], v146 offset:4096
v_mfma_f32_16x16x32_bf16 v[72:75], v[40:43], v[48:51], v[72:75]
buffer_load_dwordx4 v252, s[4:7], s30 offen offset:2048 sc1 lds
v_mfma_f32_16x16x32_bf16 v[88:91], v[40:43], v[52:55], v[88:91]
ds_read_b128 v[28:31], v148 offset:6144
v_mfma_f32_16x16x32_bf16 v[104:107], v[40:43], v[56:59], v[104:107]
ds_read_b64_tr_b16 v[12:13], v147 offset:0
ds_read_b64_tr_b16 v[14:15], v147 offset:4096
v_mfma_f32_16x16x32_bf16 v[120:123], v[40:43], v[60:63], v[120:123]
buffer_load_dwordx4 v252, s[4:7], s30 offen offset:3072 sc1 lds
v_mfma_f32_16x16x32_bf16 v[76:79], v[44:47], v[48:51], v[76:79]
v_mfma_f32_16x16x32_bf16 v[92:95], v[44:47], v[52:55], v[92:95]
v_mfma_f32_16x16x32_bf16 v[108:111], v[44:47], v[56:59], v[108:111]
v_mfma_f32_16x16x32_bf16 v[124:127], v[44:47], v[60:63], v[124:127]
s_waitcnt lgkmcnt(0)
v_mfma_f32_16x16x32_bf16 v[64:67], v[0:3], v[16:19], v[64:67]
s_add_u32 m0, s31, 16384
ds_read_b128 v[48:51], v148 offset:1024
v_mfma_f32_16x16x32_bf16 v[80:83], v[0:3], v[20:23], v[80:83]
s_add_u32 s30, s70, 0
ds_read_b64_tr_b16 v[32:33], v144 offset:8192
ds_read_b64_tr_b16 v[34:35], v144 offset:12288
v_mfma_f32_16x16x32_bf16 v[96:99], v[0:3], v[24:27], v[96:99]
buffer_load_dwordx4 v132, s[12:15], s30 offen offset:0 lds
v_mfma_f32_16x16x32_bf16 v[112:115], v[0:3], v[28:31], v[112:115]
ds_read_b128 v[52:55], v148 offset:3072
v_mfma_f32_16x16x32_bf16 v[68:71], v[4:7], v[16:19], v[68:71]
ds_read_b64_tr_b16 v[36:37], v145 offset:8192
ds_read_b64_tr_b16 v[38:39], v145 offset:12288
v_mfma_f32_16x16x32_bf16 v[84:87], v[4:7], v[20:23], v[84:87]
buffer_load_dwordx4 v133, s[12:15], s30 offen offset:1024 lds
v_mfma_f32_16x16x32_bf16 v[100:103], v[4:7], v[24:27], v[100:103]
ds_read_b128 v[56:59], v148 offset:5120
v_mfma_f32_16x16x32_bf16 v[116:119], v[4:7], v[28:31], v[116:119]
ds_read_b64_tr_b16 v[40:41], v146 offset:8192
ds_read_b64_tr_b16 v[42:43], v146 offset:12288
v_mfma_f32_16x16x32_bf16 v[72:75], v[8:11], v[16:19], v[72:75]
buffer_load_dwordx4 v134, s[12:15], s30 offen offset:2048 lds
v_mfma_f32_16x16x32_bf16 v[88:91], v[8:11], v[20:23], v[88:91]
ds_read_b128 v[60:63], v148 offset:7168
v_mfma_f32_16x16x32_bf16 v[104:107], v[8:11], v[24:27], v[104:107]
ds_read_b64_tr_b16 v[44:45], v147 offset:8192
ds_read_b64_tr_b16 v[46:47], v147 offset:12288
v_mfma_f32_16x16x32_bf16 v[120:123], v[8:11], v[28:31], v[120:123]
buffer_load_dwordx4 v135, s[12:15], s30 offen offset:3072 lds
v_mfma_f32_16x16x32_bf16 v[76:79], v[12:15], v[16:19], v[76:79]
v_add_u32 v144, 65536, v136
v_add_u32 v145, 65536, v137
v_mfma_f32_16x16x32_bf16 v[92:95], v[12:15], v[20:23], v[92:95]
v_add_u32 v146, 65536, v138
v_add_u32 v147, 65536, v139
v_mfma_f32_16x16x32_bf16 v[108:111], v[12:15], v[24:27], v[108:111]
v_add_u32 v148, 65536, v142
v_mfma_f32_16x16x32_bf16 v[124:127], v[12:15], v[28:31], v[124:127]
s_waitcnt vmcnt(16) lgkmcnt(0)
s_barrier
v_mfma_f32_16x16x32_bf16 v[64:67], v[32:35], v[48:51], v[64:67]
s_add_u32 m0, s31, 32768
ds_read_b128 v[16:19], v148 offset:0
v_mfma_f32_16x16x32_bf16 v[80:83], v[32:35], v[52:55], v[80:83]
s_add_u32 s30, s69, 4096
ds_read_b64_tr_b16 v[0:1], v144 offset:0
ds_read_b64_tr_b16 v[2:3], v144 offset:4096
v_mfma_f32_16x16x32_bf16 v[96:99], v[32:35], v[56:59], v[96:99]
buffer_load_dwordx4 v252, s[4:7], s30 offen offset:0 sc1 lds
v_mfma_f32_16x16x32_bf16 v[112:115], v[32:35], v[60:63], v[112:115]
ds_read_b128 v[20:23], v148 offset:2048
v_mfma_f32_16x16x32_bf16 v[68:71], v[36:39], v[48:51], v[68:71]
ds_read_b64_tr_b16 v[4:5], v145 offset:0
ds_read_b64_tr_b16 v[6:7], v145 offset:4096
v_mfma_f32_16x16x32_bf16 v[84:87], v[36:39], v[52:55], v[84:87]
buffer_load_dwordx4 v252, s[4:7], s30 offen offset:1024 sc1 lds
v_mfma_f32_16x16x32_bf16 v[100:103], v[36:39], v[56:59], v[100:103]
ds_read_b128 v[24:27], v148 offset:4096
v_mfma_f32_16x16x32_bf16 v[116:119], v[36:39], v[60:63], v[116:119]
ds_read_b64_tr_b16 v[8:9], v146 offset:0
ds_read_b64_tr_b16 v[10:11], v146 offset:4096
v_mfma_f32_16x16x32_bf16 v[72:75], v[40:43], v[48:51], v[72:75]
buffer_load_dwordx4 v252, s[4:7], s30 offen offset:2048 sc1 lds
v_mfma_f32_16x16x32_bf16 v[88:91], v[40:43], v[52:55], v[88:91]
ds_read_b128 v[28:31], v148 offset:6144
v_mfma_f32_16x16x32_bf16 v[104:107], v[40:43], v[56:59], v[104:107]
ds_read_b64_tr_b16 v[12:13], v147 offset:0
ds_read_b64_tr_b16 v[14:15], v147 offset:4096
v_mfma_f32_16x16x32_bf16 v[120:123], v[40:43], v[60:63], v[120:123]
buffer_load_dwordx4 v252, s[4:7], s30 offen offset:3072 sc1 lds
v_mfma_f32_16x16x32_bf16 v[76:79], v[44:47], v[48:51], v[76:79]
v_mfma_f32_16x16x32_bf16 v[92:95], v[44:47], v[52:55], v[92:95]
v_mfma_f32_16x16x32_bf16 v[108:111], v[44:47], v[56:59], v[108:111]
v_mfma_f32_16x16x32_bf16 v[124:127], v[44:47], v[60:63], v[124:127]
s_waitcnt lgkmcnt(0)
v_mfma_f32_16x16x32_bf16 v[64:67], v[0:3], v[16:19], v[64:67]
s_add_u32 m0, s31, 49152
ds_read_b128 v[48:51], v148 offset:1024
v_mfma_f32_16x16x32_bf16 v[80:83], v[0:3], v[20:23], v[80:83]
s_add_u32 s30, s70, 131072
ds_read_b64_tr_b16 v[32:33], v144 offset:8192
ds_read_b64_tr_b16 v[34:35], v144 offset:12288
v_mfma_f32_16x16x32_bf16 v[96:99], v[0:3], v[24:27], v[96:99]
buffer_load_dwordx4 v132, s[12:15], s30 offen offset:0 lds
v_mfma_f32_16x16x32_bf16 v[112:115], v[0:3], v[28:31], v[112:115]
ds_read_b128 v[52:55], v148 offset:3072
v_mfma_f32_16x16x32_bf16 v[68:71], v[4:7], v[16:19], v[68:71]
ds_read_b64_tr_b16 v[36:37], v145 offset:8192
ds_read_b64_tr_b16 v[38:39], v145 offset:12288
v_mfma_f32_16x16x32_bf16 v[84:87], v[4:7], v[20:23], v[84:87]
buffer_load_dwordx4 v133, s[12:15], s30 offen offset:1024 lds
v_mfma_f32_16x16x32_bf16 v[100:103], v[4:7], v[24:27], v[100:103]
ds_read_b128 v[56:59], v148 offset:5120
v_mfma_f32_16x16x32_bf16 v[116:119], v[4:7], v[28:31], v[116:119]
ds_read_b64_tr_b16 v[40:41], v146 offset:8192
ds_read_b64_tr_b16 v[42:43], v146 offset:12288
v_mfma_f32_16x16x32_bf16 v[72:75], v[8:11], v[16:19], v[72:75]
buffer_load_dwordx4 v134, s[12:15], s30 offen offset:2048 lds
v_mfma_f32_16x16x32_bf16 v[88:91], v[8:11], v[20:23], v[88:91]
ds_read_b128 v[60:63], v148 offset:7168
v_mfma_f32_16x16x32_bf16 v[104:107], v[8:11], v[24:27], v[104:107]
ds_read_b64_tr_b16 v[44:45], v147 offset:8192
ds_read_b64_tr_b16 v[46:47], v147 offset:12288
v_mfma_f32_16x16x32_bf16 v[120:123], v[8:11], v[28:31], v[120:123]
buffer_load_dwordx4 v135, s[12:15], s30 offen offset:3072 lds
v_mfma_f32_16x16x32_bf16 v[76:79], v[12:15], v[16:19], v[76:79]
v_add_u32 v144, 98304, v136
v_add_u32 v145, 98304, v137
v_mfma_f32_16x16x32_bf16 v[92:95], v[12:15], v[20:23], v[92:95]
v_add_u32 v146, 98304, v138
v_add_u32 v147, 98304, v139
v_mfma_f32_16x16x32_bf16 v[108:111], v[12:15], v[24:27], v[108:111]
v_add_u32 v148, 98304, v142
v_mfma_f32_16x16x32_bf16 v[124:127], v[12:15], v[28:31], v[124:127]
s_waitcnt vmcnt(16) lgkmcnt(0)
s_barrier
v_mfma_f32_16x16x32_bf16 v[64:67], v[32:35], v[48:51], v[64:67]
s_add_u32 m0, s31, 65536
ds_read_b128 v[16:19], v148 offset:0
v_mfma_f32_16x16x32_bf16 v[80:83], v[32:35], v[52:55], v[80:83]
s_add_u32 s30, s69, 8192
ds_read_b64_tr_b16 v[0:1], v144 offset:0
ds_read_b64_tr_b16 v[2:3], v144 offset:4096
v_mfma_f32_16x16x32_bf16 v[96:99], v[32:35], v[56:59], v[96:99]
buffer_load_dwordx4 v252, s[4:7], s30 offen offset:0 sc1 lds
v_mfma_f32_16x16x32_bf16 v[112:115], v[32:35], v[60:63], v[112:115]
ds_read_b128 v[20:23], v148 offset:2048
v_mfma_f32_16x16x32_bf16 v[68:71], v[36:39], v[48:51], v[68:71]
ds_read_b64_tr_b16 v[4:5], v145 offset:0
ds_read_b64_tr_b16 v[6:7], v145 offset:4096
v_mfma_f32_16x16x32_bf16 v[84:87], v[36:39], v[52:55], v[84:87]
buffer_load_dwordx4 v252, s[4:7], s30 offen offset:1024 sc1 lds
v_mfma_f32_16x16x32_bf16 v[100:103], v[36:39], v[56:59], v[100:103]
ds_read_b128 v[24:27], v148 offset:4096
v_mfma_f32_16x16x32_bf16 v[116:119], v[36:39], v[60:63], v[116:119]
ds_read_b64_tr_b16 v[8:9], v146 offset:0
ds_read_b64_tr_b16 v[10:11], v146 offset:4096
v_mfma_f32_16x16x32_bf16 v[72:75], v[40:43], v[48:51], v[72:75]
buffer_load_dwordx4 v252, s[4:7], s30 offen offset:2048 sc1 lds
v_mfma_f32_16x16x32_bf16 v[88:91], v[40:43], v[52:55], v[88:91]
ds_read_b128 v[28:31], v148 offset:6144
v_mfma_f32_16x16x32_bf16 v[104:107], v[40:43], v[56:59], v[104:107]
ds_read_b64_tr_b16 v[12:13], v147 offset:0
ds_read_b64_tr_b16 v[14:15], v147 offset:4096
v_mfma_f32_16x16x32_bf16 v[120:123], v[40:43], v[60:63], v[120:123]
buffer_load_dwordx4 v252, s[4:7], s30 offen offset:3072 sc1 lds
v_mfma_f32_16x16x32_bf16 v[76:79], v[44:47], v[48:51], v[76:79]
v_mfma_f32_16x16x32_bf16 v[92:95], v[44:47], v[52:55], v[92:95]
v_mfma_f32_16x16x32_bf16 v[108:111], v[44:47], v[56:59], v[108:111]
v_mfma_f32_16x16x32_bf16 v[124:127], v[44:47], v[60:63], v[124:127]
s_waitcnt lgkmcnt(0)
v_mfma_f32_16x16x32_bf16 v[64:67], v[0:3], v[16:19], v[64:67]
s_add_u32 m0, s31, 81920
ds_read_b128 v[48:51], v148 offset:1024
v_mfma_f32_16x16x32_bf16 v[80:83], v[0:3], v[20:23], v[80:83]
s_add_u32 s30, s70, 262144
ds_read_b64_tr_b16 v[32:33], v144 offset:8192
ds_read_b64_tr_b16 v[34:35], v144 offset:12288
v_mfma_f32_16x16x32_bf16 v[96:99], v[0:3], v[24:27], v[96:99]
buffer_load_dwordx4 v132, s[12:15], s30 offen offset:0 lds
v_mfma_f32_16x16x32_bf16 v[112:115], v[0:3], v[28:31], v[112:115]
ds_read_b128 v[52:55], v148 offset:3072
v_mfma_f32_16x16x32_bf16 v[68:71], v[4:7], v[16:19], v[68:71]
ds_read_b64_tr_b16 v[36:37], v145 offset:8192
ds_read_b64_tr_b16 v[38:39], v145 offset:12288
v_mfma_f32_16x16x32_bf16 v[84:87], v[4:7], v[20:23], v[84:87]
buffer_load_dwordx4 v133, s[12:15], s30 offen offset:1024 lds
v_mfma_f32_16x16x32_bf16 v[100:103], v[4:7], v[24:27], v[100:103]
ds_read_b128 v[56:59], v148 offset:5120
v_mfma_f32_16x16x32_bf16 v[116:119], v[4:7], v[28:31], v[116:119]
ds_read_b64_tr_b16 v[40:41], v146 offset:8192
ds_read_b64_tr_b16 v[42:43], v146 offset:12288
v_mfma_f32_16x16x32_bf16 v[72:75], v[8:11], v[16:19], v[72:75]
buffer_load_dwordx4 v134, s[12:15], s30 offen offset:2048 lds
v_mfma_f32_16x16x32_bf16 v[88:91], v[8:11], v[20:23], v[88:91]
ds_read_b128 v[60:63], v148 offset:7168
v_mfma_f32_16x16x32_bf16 v[104:107], v[8:11], v[24:27], v[104:107]
ds_read_b64_tr_b16 v[44:45], v147 offset:8192
ds_read_b64_tr_b16 v[46:47], v147 offset:12288
v_mfma_f32_16x16x32_bf16 v[120:123], v[8:11], v[28:31], v[120:123]
buffer_load_dwordx4 v135, s[12:15], s30 offen offset:3072 lds
v_mfma_f32_16x16x32_bf16 v[76:79], v[12:15], v[16:19], v[76:79]
v_mfma_f32_16x16x32_bf16 v[92:95], v[12:15], v[20:23], v[92:95]
v_mfma_f32_16x16x32_bf16 v[108:111], v[12:15], v[24:27], v[108:111]
v_mfma_f32_16x16x32_bf16 v[124:127], v[12:15], v[28:31], v[124:127]
s_waitcnt lgkmcnt(0)
s_barrier
v_mfma_f32_16x16x32_bf16 v[64:67], v[32:35], v[48:51], v[64:67]
s_add_u32 m0, s31, 98304
v_mfma_f32_16x16x32_bf16 v[80:83], v[32:35], v[52:55], v[80:83]
s_add_u32 s30, s69, 12288
v_mfma_f32_16x16x32_bf16 v[96:99], v[32:35], v[56:59], v[96:99]
buffer_load_dwordx4 v252, s[4:7], s30 offen offset:0 sc1 lds
v_mfma_f32_16x16x32_bf16 v[112:115], v[32:35], v[60:63], v[112:115]
buffer_load_dwordx4 v252, s[4:7], s30 offen offset:1024 sc1 lds
v_mfma_f32_16x16x32_bf16 v[68:71], v[36:39], v[48:51], v[68:71]
v_mfma_f32_16x16x32_bf16 v[84:87], v[36:39], v[52:55], v[84:87]
buffer_load_dwordx4 v252, s[4:7], s30 offen offset:2048 sc1 lds
v_mfma_f32_16x16x32_bf16 v[100:103], v[36:39], v[56:59], v[100:103]
buffer_load_dwordx4 v252, s[4:7], s30 offen offset:3072 sc1 lds
v_mfma_f32_16x16x32_bf16 v[116:119], v[36:39], v[60:63], v[116:119]
s_add_u32 m0, s31, 114688
s_add_u32 s30, s70, 393216
v_mfma_f32_16x16x32_bf16 v[72:75], v[40:43], v[48:51], v[72:75]
buffer_load_dwordx4 v132, s[12:15], s30 offen offset:0 lds
v_mfma_f32_16x16x32_bf16 v[88:91], v[40:43], v[52:55], v[88:91]
v_mfma_f32_16x16x32_bf16 v[104:107], v[40:43], v[56:59], v[104:107]
buffer_load_dwordx4 v133, s[12:15], s30 offen offset:1024 lds
v_mfma_f32_16x16x32_bf16 v[120:123], v[40:43], v[60:63], v[120:123]
buffer_load_dwordx4 v134, s[12:15], s30 offen offset:2048 lds
v_mfma_f32_16x16x32_bf16 v[76:79], v[44:47], v[48:51], v[76:79]
v_mfma_f32_16x16x32_bf16 v[92:95], v[44:47], v[52:55], v[92:95]
buffer_load_dwordx4 v135, s[12:15], s30 offen offset:3072 lds
v_mfma_f32_16x16x32_bf16 v[108:111], v[44:47], v[56:59], v[108:111]
v_mfma_f32_16x16x32_bf16 v[124:127], v[44:47], v[60:63], v[124:127]
s_lshl_b32 s37, s20, 15
s_lshl_b32 s38, s64, 13
s_add_u32 s37, s37, s38
s_add_u32 s37, s37, s73
s_add_u32 s38, s37, 0x1000
v_add_u32 v144, 0, v140
v_add_u32 v145, 0, v141
v_add_u32 v148, 0, v142
v_add_u32 v152, 0x20000, v252
s_cmp_eq_u32 s20, s64
s_cbranch_scc1 K3_own
v_cvt_pk_bf16_f32 v64, v64, v65
v_cvt_pk_bf16_f32 v65, v66, v67
v_cvt_pk_bf16_f32 v66, v68, v69
v_cvt_pk_bf16_f32 v67, v70, v71
buffer_store_dwordx4 v[64:67], v252, s[4:7], s37 offen offset:0 sc1
v_cvt_pk_bf16_f32 v72, v72, v73
v_cvt_pk_bf16_f32 v73, v74, v75
v_cvt_pk_bf16_f32 v74, v76, v77
v_cvt_pk_bf16_f32 v75, v78, v79
buffer_store_dwordx4 v[72:75], v252, s[4:7], s37 offen offset:1024 sc1
v_cvt_pk_bf16_f32 v80, v80, v81
v_cvt_pk_bf16_f32 v81, v82, v83
v_cvt_pk_bf16_f32 v82, v84, v85
v_cvt_pk_bf16_f32 v83, v86, v87
buffer_store_dwordx4 v[80:83], v252, s[4:7], s37 offen offset:2048 sc1
v_cvt_pk_bf16_f32 v88, v88, v89
v_cvt_pk_bf16_f32 v89, v90, v91
v_cvt_pk_bf16_f32 v90, v92, v93
v_cvt_pk_bf16_f32 v91, v94, v95
buffer_store_dwordx4 v[88:91], v252, s[4:7], s37 offen offset:3072 sc1
v_cvt_pk_bf16_f32 v96, v96, v97
v_cvt_pk_bf16_f32 v97, v98, v99
v_cvt_pk_bf16_f32 v98, v100, v101
v_cvt_pk_bf16_f32 v99, v102, v103
buffer_store_dwordx4 v[96:99], v252, s[4:7], s38 offen offset:0 sc1
v_cvt_pk_bf16_f32 v104, v104, v105
v_cvt_pk_bf16_f32 v105, v106, v107
v_cvt_pk_bf16_f32 v106, v108, v109
v_cvt_pk_bf16_f32 v107, v110, v111
buffer_store_dwordx4 v[104:107], v252, s[4:7], s38 offen offset:1024 sc1
v_cvt_pk_bf16_f32 v112, v112, v113
v_cvt_pk_bf16_f32 v113, v114, v115
v_cvt_pk_bf16_f32 v114, v116, v117
v_cvt_pk_bf16_f32 v115, v118, v119
buffer_store_dwordx4 v[112:115], v252, s[4:7], s38 offen offset:2048 sc1
v_cvt_pk_bf16_f32 v120, v120, v121
v_cvt_pk_bf16_f32 v121, v122, v123
v_cvt_pk_bf16_f32 v122, v124, v125
v_cvt_pk_bf16_f32 v123, v126, v127
buffer_store_dwordx4 v[120:123], v252, s[4:7], s38 offen offset:3072 sc1
s_waitcnt vmcnt(8)
s_branch K3_pub
K3_own:
ds_write_b128 v152, v[64:67] offset:0
ds_write_b128 v152, v[68:71] offset:1024
ds_write_b128 v152, v[72:75] offset:2048
ds_write_b128 v152, v[76:79] offset:3072
ds_write_b128 v152, v[80:83] offset:4096
ds_write_b128 v152, v[84:87] offset:5120
ds_write_b128 v152, v[88:91] offset:6144
ds_write_b128 v152, v[92:95] offset:7168
ds_write_b128 v152, v[96:99] offset:8192
ds_write_b128 v152, v[100:103] offset:9216
ds_write_b128 v152, v[104:107] offset:10240
ds_write_b128 v152, v[108:111] offset:11264
ds_write_b128 v152, v[112:115] offset:12288
ds_write_b128 v152, v[116:119] offset:13312
ds_write_b128 v152, v[120:123] offset:14336
ds_write_b128 v152, v[124:127] offset:15360
s_waitcnt vmcnt(0)
K3_pub:
s_barrier
s_waitcnt lgkmcnt(0)
ds_read_b128 v[8:11], v148 offset:0
ds_read_b64_tr_b16 v[0:1], v144 offset:0
ds_read_b64_tr_b16 v[2:3], v144 offset:1024
ds_read_b128 v[12:15], v148 offset:4096
ds_read_b64_tr_b16 v[4:5], v145 offset:0
ds_read_b64_tr_b16 v[6:7], v145 offset:1024
ds_read_b128 v[24:27], v148 offset:1024
ds_read_b64_tr_b16 v[16:17], v144 offset:4096
ds_read_b64_tr_b16 v[18:19], v144 offset:5120
ds_read_b128 v[28:31], v148 offset:5120
ds_read_b64_tr_b16 v[20:21], v145 offset:4096
ds_read_b64_tr_b16 v[22:23], v145 offset:5120
ds_read_b128 v[40:43], v148 offset:2048
ds_read_b64_tr_b16 v[32:33], v144 offset:8192
ds_read_b64_tr_b16 v[34:35], v144 offset:9216
ds_read_b128 v[44:47], v148 offset:6144
ds_read_b64_tr_b16 v[36:37], v145 offset:8192
ds_read_b64_tr_b16 v[38:39], v145 offset:9216
s_waitcnt lgkmcnt(12)
v_mfma_f32_16x16x32_bf16 a[64:67], v[0:3], v[8:11], 0
v_mfma_f32_16x16x32_bf16 a[72:75], v[0:3], v[12:15], 0
v_mfma_f32_16x16x32_bf16 a[68:71], v[4:7], v[8:11], 0
v_mfma_f32_16x16x32_bf16 a[76:79], v[4:7], v[12:15], 0
ds_read_b128 v[56:59], v148 offset:3072
ds_read_b64_tr_b16 v[48:49], v144 offset:12288
ds_read_b64_tr_b16 v[50:51], v144 offset:13312
ds_read_b128 v[60:63], v148 offset:7168
ds_read_b64_tr_b16 v[52:53], v145 offset:12288
ds_read_b64_tr_b16 v[54:55], v145 offset:13312
s_waitcnt lgkmcnt(12)
v_mfma_f32_16x16x32_bf16 a[64:67], v[16:19], v[24:27], a[64:67]
v_mfma_f32_16x16x32_bf16 a[72:75], v[16:19], v[28:31], a[72:75]
v_mfma_f32_16x16x32_bf16 a[68:71], v[20:23], v[24:27], a[68:71]
v_mfma_f32_16x16x32_bf16 a[76:79], v[20:23], v[28:31], a[76:79]
v_add_u32 v144, 32768, v140
v_add_u32 v145, 32768, v141
v_add_u32 v148, 32768, v142
ds_read_b128 v[8:11], v148 offset:0
ds_read_b64_tr_b16 v[0:1], v144 offset:0
ds_read_b64_tr_b16 v[2:3], v144 offset:1024
ds_read_b128 v[12:15], v148 offset:4096
ds_read_b64_tr_b16 v[4:5], v145 offset:0
ds_read_b64_tr_b16 v[6:7], v145 offset:1024
s_waitcnt lgkmcnt(12)
v_mfma_f32_16x16x32_bf16 a[64:67], v[32:35], v[40:43], a[64:67]
v_mfma_f32_16x16x32_bf16 a[72:75], v[32:35], v[44:47], a[72:75]
v_mfma_f32_16x16x32_bf16 a[68:71], v[36:39], v[40:43], a[68:71]
v_mfma_f32_16x16x32_bf16 a[76:79], v[36:39], v[44:47], a[76:79]
ds_read_b128 v[24:27], v148 offset:1024
ds_read_b64_tr_b16 v[16:17], v144 offset:4096
ds_read_b64_tr_b16 v[18:19], v144 offset:5120
ds_read_b128 v[28:31], v148 offset:5120
ds_read_b64_tr_b16 v[20:21], v145 offset:4096
ds_read_b64_tr_b16 v[22:23], v145 offset:5120
s_waitcnt lgkmcnt(12)
v_mfma_f32_16x16x32_bf16 a[64:67], v[48:51], v[56:59], a[64:67]
v_mfma_f32_16x16x32_bf16 a[72:75], v[48:51], v[60:63], a[72:75]
v_mfma_f32_16x16x32_bf16 a[68:71], v[52:55], v[56:59], a[68:71]
v_mfma_f32_16x16x32_bf16 a[76:79], v[52:55], v[60:63], a[76:79]
s_lshl_b32 s37, s64, 2
s_add_u32 s37, s37, s74
s_cmp_eq_u32 s20, 0
s_cselect_b32 s37, s37, 0x7ffffff0
v_mov_b32 v153, 0x7ffffff0
v_writelane_b32 v153, s37, 0
s_waitcnt vmcnt(0)
s_barrier
buffer_store_dword v151, v153, s[4:7], 0 offen sc1
ds_read_b128 v[40:43], v148 offset:2048
ds_read_b64_tr_b16 v[32:33], v144 offset:8192
ds_read_b64_tr_b16 v[34:35], v144 offset:9216
ds_read_b128 v[44:47], v148 offset:6144
ds_read_b64_tr_b16 v[36:37], v145 offset:8192
ds_read_b64_tr_b16 v[38:39], v145 offset:9216
s_waitcnt lgkmcnt(12)
v_mfma_f32_16x16x32_bf16 a[64:67], v[0:3], v[8:11], a[64:67]
v_mfma_f32_16x16x32_bf16 a[72:75], v[0:3], v[12:15], a[72:75]
v_mfma_f32_16x16x32_bf16 a[68:71], v[4:7], v[8:11], a[68:71]
v_mfma_f32_16x16x32_bf16 a[76:79], v[4:7], v[12:15], a[76:79]
ds_read_b128 v[56:59], v148 offset:3072
ds_read_b64_tr_b16 v[48:49], v144 offset:12288
ds_read_b64_tr_b16 v[50:51], v144 offset:13312
ds_read_b128 v[60:63], v148 offset:7168
ds_read_b64_tr_b16 v[52:53], v145 offset:12288
ds_read_b64_tr_b16 v[54:55], v145 offset:13312
s_waitcnt lgkmcnt(12)
v_mfma_f32_16x16x32_bf16 a[64:67], v[16:19], v[24:27], a[64:67]
v_mfma_f32_16x16x32_bf16 a[72:75], v[16:19], v[28:31], a[72:75]
v_mfma_f32_16x16x32_bf16 a[68:71], v[20:23], v[24:27], a[68:71]
v_mfma_f32_16x16x32_bf16 a[76:79], v[20:23], v[28:31], a[76:79]
v_add_u32 v144, 65536, v140
v_add_u32 v145, 65536, v141
v_add_u32 v148, 65536, v142
ds_read_b128 v[8:11], v148 offset:0
ds_read_b64_tr_b16 v[0:1], v144 offset:0
ds_read_b64_tr_b16 v[2:3], v144 offset:1024
ds_read_b128 v[12:15], v148 offset:4096
ds_read_b64_tr_b16 v[4:5], v145 offset:0
ds_read_b64_tr_b16 v[6:7], v145 offset:1024
s_waitcnt lgkmcnt(12)
v_mfma_f32_16x16x32_bf16 a[64:67], v[32:35], v[40:43], a[64:67]
v_mfma_f32_16x16x32_bf16 a[72:75], v[32:35], v[44:47], a[72:75]
v_mfma_f32_16x16x32_bf16 a[68:71], v[36:39], v[40:43], a[68:71]
v_mfma_f32_16x16x32_bf16 a[76:79], v[36:39], v[44:47], a[76:79]
ds_read_b128 v[24:27], v148 offset:1024
ds_read_b64_tr_b16 v[16:17], v144 offset:4096
ds_read_b64_tr_b16 v[18:19], v144 offset:5120
ds_read_b128 v[28:31], v148 offset:5120
ds_read_b64_tr_b16 v[20:21], v145 offset:4096
ds_read_b64_tr_b16 v[22:23], v145 offset:5120
s_waitcnt lgkmcnt(12)
v_mfma_f32_16x16x32_bf16 a[64:67], v[48:51], v[56:59], a[64:67]
v_mfma_f32_16x16x32_bf16 a[72:75], v[48:51], v[60:63], a[72:75]
v_mfma_f32_16x16x32_bf16 a[68:71], v[52:55], v[56:59], a[68:71]
v_mfma_f32_16x16x32_bf16 a[76:79], v[52:55], v[60:63], a[76:79]
ds_read_b128 v[40:43], v148 offset:2048
ds_read_b64_tr_b16 v[32:33], v144 offset:8192
ds_read_b64_tr_b16 v[34:35], v144 offset:9216
ds_read_b128 v[44:47], v148 offset:6144
ds_read_b64_tr_b16 v[36:37], v145 offset:8192
ds_read_b64_tr_b16 v[38:39], v145 offset:9216
s_waitcnt lgkmcnt(12)
v_mfma_f32_16x16x32_bf16 a[64:67], v[0:3], v[8:11], a[64:67]
v_mfma_f32_16x16x32_bf16 a[72:75], v[0:3], v[12:15], a[72:75]
v_mfma_f32_16x16x32_bf16 a[68:71], v[4:7], v[8:11], a[68:71]
v_mfma_f32_16x16x32_bf16 a[76:79], v[4:7], v[12:15], a[76:79]
ds_read_b128 v[56:59], v148 offset:3072
ds_read_b64_tr_b16 v[48:49], v144 offset:12288
ds_read_b64_tr_b16 v[50:51], v144 offset:13312
ds_read_b128 v[60:63], v148 offset:7168
ds_read_b64_tr_b16 v[52:53], v145 offset:12288
ds_read_b64_tr_b16 v[54:55], v145 offset:13312
s_waitcnt lgkmcnt(12)
v_mfma_f32_16x16x32_bf16 a[64:67], v[16:19], v[24:27], a[64:67]
v_mfma_f32_16x16x32_bf16 a[72:75], v[16:19], v[28:31], a[72:75]
v_mfma_f32_16x16x32_bf16 a[68:71], v[20:23], v[24:27], a[68:71]
v_mfma_f32_16x16x32_bf16 a[76:79], v[20:23], v[28:31], a[76:79]
v_add_u32 v144, 98304, v140
v_add_u32 v145, 98304, v141
v_add_u32 v148, 98304, v142
ds_read_b128 v[8:11], v148 offset:0
ds_read_b64_tr_b16 v[0:1], v144 offset:0
ds_read_b64_tr_b16 v[2:3], v144 offset:1024
ds_read_b128 v[12:15], v148 offset:4096
ds_read_b64_tr_b16 v[4:5], v145 offset:0
ds_read_b64_tr_b16 v[6:7], v145 offset:1024
s_waitcnt lgkmcnt(12)
v_mfma_f32_16x16x32_bf16 a[64:67], v[32:35], v[40:43], a[64:67]
v_mfma_f32_16x16x32_bf16 a[72:75], v[32:35], v[44:47], a[72:75]
v_mfma_f32_16x16x32_bf16 a[68:71], v[36:39], v[40:43], a[68:71]
v_mfma_f32_16x16x32_bf16 a[76:79], v[36:39], v[44:47], a[76:79]
ds_read_b128 v[24:27], v148 offset:1024
ds_read_b64_tr_b16 v[16:17], v144 offset:4096
ds_read_b64_tr_b16 v[18:19], v144 offset:5120
ds_read_b128 v[28:31], v148 offset:5120
ds_read_b64_tr_b16 v[20:21], v145 offset:4096
ds_read_b64_tr_b16 v[22:23], v145 offset:5120
s_waitcnt lgkmcnt(12)
v_mfma_f32_16x16x32_bf16 a[64:67], v[48:51], v[56:59], a[64:67]
v_mfma_f32_16x16x32_bf16 a[72:75], v[48:51], v[60:63], a[72:75]
v_mfma_f32_16x16x32_bf16 a[68:71], v[52:55], v[56:59], a[68:71]
v_mfma_f32_16x16x32_bf16 a[76:79], v[52:55], v[60:63], a[76:79]
ds_read_b128 v[40:43], v148 offset:2048
ds_read_b64_tr_b16 v[32:33], v144 offset:8192
ds_read_b64_tr_b16 v[34:35], v144 offset:9216
ds_read_b128 v[44:47], v148 offset:6144
ds_read_b64_tr_b16 v[36:37], v145 offset:8192
ds_read_b64_tr_b16 v[38:39], v145 offset:9216
s_waitcnt lgkmcnt(12)
v_mfma_f32_16x16x32_bf16 a[64:67], v[0:3], v[8:11], a[64:67]
v_mfma_f32_16x16x32_bf16 a[72:75], v[0:3], v[12:15], a[72:75]
v_mfma_f32_16x16x32_bf16 a[68:71], v[4:7], v[8:11], a[68:71]
v_mfma_f32_16x16x32_bf16 a[76:79], v[4:7], v[12:15], a[76:79]
ds_read_b128 v[56:59], v148 offset:3072
ds_read_b64_tr_b16 v[48:49], v144 offset:12288
ds_read_b64_tr_b16 v[50:51], v144 offset:13312
ds_read_b128 v[60:63], v148 offset:7168
ds_read_b64_tr_b16 v[52:53], v145 offset:12288
ds_read_b64_tr_b16 v[54:55], v145 offset:13312
s_waitcnt lgkmcnt(12)
v_mfma_f32_16x16x32_bf16 a[64:67], v[16:19], v[24:27], a[64:67]
v_mfma_f32_16x16x32_bf16 a[72:75], v[16:19], v[28:31], a[72:75]
v_mfma_f32_16x16x32_bf16 a[68:71], v[20:23], v[24:27], a[68:71]
v_mfma_f32_16x16x32_bf16 a[76:79], v[20:23], v[28:31], a[76:79]
s_waitcnt lgkmcnt(6)
v_mfma_f32_16x16x32_bf16 a[64:67], v[32:35], v[40:43], a[64:67]
v_mfma_f32_16x16x32_bf16 a[72:75], v[32:35], v[44:47], a[72:75]
v_mfma_f32_16x16x32_bf16 a[68:71], v[36:39], v[40:43], a[68:71]
v_mfma_f32_16x16x32_bf16 a[76:79], v[36:39], v[44:47], a[76:79]
s_waitcnt lgkmcnt(0)
v_mfma_f32_16x16x32_bf16 a[64:67], v[48:51], v[56:59], a[64:67]
v_mfma_f32_16x16x32_bf16 a[72:75], v[48:51], v[60:63], a[72:75]
v_mfma_f32_16x16x32_bf16 a[68:71], v[52:55], v[56:59], a[68:71]
v_mfma_f32_16x16x32_bf16 a[76:79], v[52:55], v[60:63], a[76:79]
v_and_b32 v152, 15, v253
v_lshlrev_b32 v152, 11, v152
v_lshrrev_b32 v155, 4, v253
v_lshl_add_u32 v154, v155, 3, v152
s_lshl_b32 s37, s71, 17
s_and_b32 s38, s20, 1
s_lshl_b32 s38, s38, 16
s_add_u32 s37, s37, s38
s_lshl_b32 s38, s72, 7
s_add_u32 s37, s37, s38
s_lshr_b32 s38, s20, 1
s_lshl_b32 s38, s38, 6
s_add_u32 s37, s37, s38
s_add_u32 s38, s37, 0x8000
v_and_b32 v149, 3, v253
v_lshl_add_u32 v149, v149, 2, s74
buffer_load_dword v150, v149, s[4:7], 0 offen sc1
v_accvgpr_read_b32 v0, a64
v_accvgpr_read_b32 v1, a65
v_accvgpr_read_b32 v2, a66
v_accvgpr_read_b32 v3, a67
v_accvgpr_read_b32 v4, a68
v_accvgpr_read_b32 v5, a69
v_accvgpr_read_b32 v6, a70
v_accvgpr_read_b32 v7, a71
v_accvgpr_read_b32 v8, a72
v_accvgpr_read_b32 v9, a73
v_accvgpr_read_b32 v10, a74
v_accvgpr_read_b32 v11, a75
v_accvgpr_read_b32 v12, a76
v_accvgpr_read_b32 v13, a77
v_accvgpr_read_b32 v14, a78
v_accvgpr_read_b32 v15, a79
v_cvt_pk_bf16_f32 v16, v0, v1
v_cvt_pk_bf16_f32 v17, v2, v3
v_cvt_pk_bf16_f32 v18, v4, v5
v_cvt_pk_bf16_f32 v19, v6, v7
v_cvt_pk_bf16_f32 v20, v8, v9
v_cvt_pk_bf16_f32 v21, v10, v11
v_cvt_pk_bf16_f32 v22, v12, v13
v_cvt_pk_bf16_f32 v23, v14, v15
buffer_store_dwordx2 v[16:17], v154, s[16:19], s37 offen offset:1024 nt
buffer_store_dwordx2 v[18:19], v154, s[16:19], s37 offen offset:1056 nt
buffer_store_dwordx2 v[20:21], v154, s[16:19], s38 offen offset:1024 nt
buffer_store_dwordx2 v[22:23], v154, s[16:19], s38 offen offset:1056 nt
s_add_u32 s38, s31, 0x20000
v_add_u32 v152, s38, v252
ds_read_b128 v[48:51], v152 offset:0
ds_read_b128 v[52:55], v152 offset:1024
ds_read_b128 v[56:59], v152 offset:2048
ds_read_b128 v[60:63], v152 offset:3072
s_waitcnt vmcnt(4)
v_cmp_ne_u32 vcc, 1, v150
s_mov_b32 s38, 0
s_nop 3
s_cbranch_vccz BK_rdyP
BK_pollP:
s_sleep 1
buffer_load_dword v150, v149, s[4:7], 0 offen sc1
s_waitcnt vmcnt(0)
v_cmp_ne_u32 vcc, 1, v150
s_add_u32 s38, s38, 1
s_nop 3
s_cbranch_vccz BK_rdyP
s_cmp_lt_u32 s38, 0x40000
s_cbranch_scc1 BK_pollP
BK_rdyP:
s_lshl_b32 s37, s64, 15
s_add_u32 s37, s37, s73
s_lshl_b32 s38, s20, 11
s_add_u32 s37, s37, s38
s_add_u32 s38, s64, 1
s_and_b32 s38, s38, 3
s_lshl_b32 s38, s38, 13
s_add_u32 s38, s38, s37
buffer_load_dwordx4 v[64:67], v252, s[4:7], s38 offen offset:0 sc1
buffer_load_dwordx4 v[68:71], v252, s[4:7], s38 offen offset:1024 sc1
s_add_u32 s38, s64, 2
s_and_b32 s38, s38, 3
s_lshl_b32 s38, s38, 13
s_add_u32 s38, s38, s37
buffer_load_dwordx4 v[72:75], v252, s[4:7], s38 offen offset:0 sc1
buffer_load_dwordx4 v[76:79], v252, s[4:7], s38 offen offset:1024 sc1
s_add_u32 s38, s64, 3
s_and_b32 s38, s38, 3
s_lshl_b32 s38, s38, 13
s_add_u32 s38, s38, s37
buffer_load_dwordx4 v[80:83], v252, s[4:7], s38 offen offset:0 sc1
buffer_load_dwordx4 v[84:87], v252, s[4:7], s38 offen offset:1024 sc1
s_lshl_b32 s37, s65, 18
s_and_b32 s38, s64, 1
s_lshl_b32 s38, s38, 17
s_add_u32 s37, s37, s38
s_lshl_b32 s38, s20, 15
s_add_u32 s37, s37, s38
s_lshl_b32 s38, s66, 8
s_add_u32 s37, s37, s38
s_lshr_b32 s38, s64, 1
s_lshl_b32 s38, s38, 7
s_add_u32 s37, s37, s38
s_waitcnt lgkmcnt(0)
s_waitcnt vmcnt(4)
v_lshlrev_b32 v40, 16, v64
v_and_b32 v41, 0xffff0000, v64
v_pk_add_f32 v[48:49], v[48:49], v[40:41]
v_lshlrev_b32 v40, 16, v65
v_and_b32 v41, 0xffff0000, v65
v_pk_add_f32 v[50:51], v[50:51], v[40:41]
v_lshlrev_b32 v40, 16, v66
v_and_b32 v41, 0xffff0000, v66
v_pk_add_f32 v[52:53], v[52:53], v[40:41]
v_lshlrev_b32 v40, 16, v67
v_and_b32 v41, 0xffff0000, v67
v_pk_add_f32 v[54:55], v[54:55], v[40:41]
v_lshlrev_b32 v40, 16, v68
v_and_b32 v41, 0xffff0000, v68
v_pk_add_f32 v[56:57], v[56:57], v[40:41]
v_lshlrev_b32 v40, 16, v69
v_and_b32 v41, 0xffff0000, v69
v_pk_add_f32 v[58:59], v[58:59], v[40:41]
v_lshlrev_b32 v40, 16, v70
v_and_b32 v41, 0xffff0000, v70
v_pk_add_f32 v[60:61], v[60:61], v[40:41]
v_lshlrev_b32 v40, 16, v71
v_and_b32 v41, 0xffff0000, v71
v_pk_add_f32 v[62:63], v[62:63], v[40:41]
s_waitcnt vmcnt(2)
v_lshlrev_b32 v40, 16, v72
v_and_b32 v41, 0xffff0000, v72
v_pk_add_f32 v[48:49], v[48:49], v[40:41]
v_lshlrev_b32 v40, 16, v73
v_and_b32 v41, 0xffff0000, v73
v_pk_add_f32 v[50:51], v[50:51], v[40:41]
v_lshlrev_b32 v40, 16, v74
v_and_b32 v41, 0xffff0000, v74
v_pk_add_f32 v[52:53], v[52:53], v[40:41]
v_lshlrev_b32 v40, 16, v75
v_and_b32 v41, 0xffff0000, v75
v_pk_add_f32 v[54:55], v[54:55], v[40:41]
v_lshlrev_b32 v40, 16, v76
v_and_b32 v41, 0xffff0000, v76
v_pk_add_f32 v[56:57], v[56:57], v[40:41]
v_lshlrev_b32 v40, 16, v77
v_and_b32 v41, 0xffff0000, v77
v_pk_add_f32 v[58:59], v[58:59], v[40:41]
v_lshlrev_b32 v40, 16, v78
v_and_b32 v41, 0xffff0000, v78
v_pk_add_f32 v[60:61], v[60:61], v[40:41]
v_lshlrev_b32 v40, 16, v79
v_and_b32 v41, 0xffff0000, v79
v_pk_add_f32 v[62:63], v[62:63], v[40:41]
s_waitcnt vmcnt(0)
v_lshlrev_b32 v40, 16, v80
v_and_b32 v41, 0xffff0000, v80
v_pk_add_f32 v[48:49], v[48:49], v[40:41]
v_lshlrev_b32 v40, 16, v81
v_and_b32 v41, 0xffff0000, v81
v_pk_add_f32 v[50:51], v[50:51], v[40:41]
v_lshlrev_b32 v40, 16, v82
v_and_b32 v41, 0xffff0000, v82
v_pk_add_f32 v[52:53], v[52:53], v[40:41]
v_lshlrev_b32 v40, 16, v83
v_and_b32 v41, 0xffff0000, v83
v_pk_add_f32 v[54:55], v[54:55], v[40:41]
v_lshlrev_b32 v40, 16, v84
v_and_b32 v41, 0xffff0000, v84
v_pk_add_f32 v[56:57], v[56:57], v[40:41]
v_lshlrev_b32 v40, 16, v85
v_and_b32 v41, 0xffff0000, v85
v_pk_add_f32 v[58:59], v[58:59], v[40:41]
v_lshlrev_b32 v40, 16, v86
v_and_b32 v41, 0xffff0000, v86
v_pk_add_f32 v[60:61], v[60:61], v[40:41]
v_lshlrev_b32 v40, 16, v87
v_and_b32 v41, 0xffff0000, v87
v_pk_add_f32 v[62:63], v[62:63], v[40:41]
v_cvt_pk_bf16_f32 v24, v48, v49
v_cvt_pk_bf16_f32 v25, v50, v51
v_cvt_pk_bf16_f32 v26, v52, v53
v_cvt_pk_bf16_f32 v27, v54, v55
v_cvt_pk_bf16_f32 v28, v56, v57
v_cvt_pk_bf16_f32 v29, v58, v59
v_cvt_pk_bf16_f32 v30, v60, v61
v_cvt_pk_bf16_f32 v31, v62, v63
buffer_store_dwordx2 v[24:25], v154, s[16:19], s37 offen offset:0 nt
buffer_store_dwordx2 v[26:27], v154, s[16:19], s37 offen offset:32 nt
buffer_store_dwordx2 v[28:29], v154, s[16:19], s37 offen offset:64 nt
buffer_store_dwordx2 v[30:31], v154, s[16:19], s37 offen offset:96 nt
KA_end:
s_endpgm
SAFE_entry:
s_waitcnt lgkmcnt(0)
s_barrier
s_and_b32 s24, s20, 1
s_lshl_b32 s37, s24, 14
s_lshr_b32 s48, s20, 1
s_lshl_b32 s39, s48, 13
s_lshl_b32 s25, s21, 20
s_add_u32 s25, s25, s37
s_add_u32 s25, s25, s39
s_cmp_eq_u32 s48, 1
s_cselect_b32 s18, 0, s42
s_lshl_b32 s48, s48, 15
s_lshl_b32 s24, s24, 13
s_add_u32 m0, s29, 98304
s_add_u32 s30, s25, 0x1000
buffer_load_dwordx4 v252, s[16:19], s25 offen offset:0 sc1 lds
buffer_load_dwordx4 v252, s[16:19], s25 offen offset:1024 sc1 lds
buffer_load_dwordx4 v252, s[16:19], s25 offen offset:2048 sc1 lds
buffer_load_dwordx4 v252, s[16:19], s25 offen offset:3072 sc1 lds
s_add_u32 m0, m0, 0x1000
s_add_u32 s25, s25, 0x8000
buffer_load_dwordx4 v252, s[16:19], s30 offen offset:0 sc1 lds
buffer_load_dwordx4 v252, s[16:19], s30 offen offset:1024 sc1 lds
buffer_load_dwordx4 v252, s[16:19], s30 offen offset:2048 sc1 lds
buffer_load_dwordx4 v252, s[16:19], s30 offen offset:3072 sc1 lds
s_sub_u32 s25, s25, s48
s_add_u32 m0, s29, 131072
s_add_u32 s30, s25, 0x1000
buffer_load_dwordx4 v252, s[16:19], s25 offen offset:0 sc1 lds
buffer_load_dwordx4 v252, s[16:19], s25 offen offset:1024 sc1 lds
buffer_load_dwordx4 v252, s[16:19], s25 offen offset:2048 sc1 lds
buffer_load_dwordx4 v252, s[16:19], s25 offen offset:3072 sc1 lds
s_add_u32 m0, m0, 0x1000
s_add_u32 s25, s25, 0x8000
buffer_load_dwordx4 v252, s[16:19], s30 offen offset:0 sc1 lds
buffer_load_dwordx4 v252, s[16:19], s30 offen offset:1024 sc1 lds
buffer_load_dwordx4 v252, s[16:19], s30 offen offset:2048 sc1 lds
buffer_load_dwordx4 v252, s[16:19], s30 offen offset:3072 sc1 lds
s_sub_u32 s25, s25, s48
s_mov_b32 s18, s42
s_add_u32 m0, s29, 0
s_add_u32 s30, s25, 0x1000
buffer_load_dwordx4 v252, s[16:19], s25 offen offset:0 sc1 lds
buffer_load_dwordx4 v252, s[16:19], s25 offen offset:1024 sc1 lds
buffer_load_dwordx4 v252, s[16:19], s25 offen offset:2048 sc1 lds
buffer_load_dwordx4 v252, s[16:19], s25 offen offset:3072 sc1 lds
s_add_u32 m0, m0, 0x1000
s_add_u32 s25, s25, 0x8000
buffer_load_dwordx4 v252, s[16:19], s30 offen offset:0 sc1 lds
buffer_load_dwordx4 v252, s[16:19], s30 offen offset:1024 sc1 lds
buffer_load_dwordx4 v252, s[16:19], s30 offen offset:2048 sc1 lds
buffer_load_dwordx4 v252, s[16:19], s30 offen offset:3072 sc1 lds
s_add_u32 m0, s29, 32768
s_add_u32 s30, s25, 0x1000
buffer_load_dwordx4 v252, s[16:19], s25 offen offset:0 sc1 lds
buffer_load_dwordx4 v252, s[16:19], s25 offen offset:1024 sc1 lds
buffer_load_dwordx4 v252, s[16:19], s25 offen offset:2048 sc1 lds
buffer_load_dwordx4 v252, s[16:19], s25 offen offset:3072 sc1 lds
s_add_u32 m0, m0, 0x1000
s_add_u32 s25, s25, 0x8000
buffer_load_dwordx4 v252, s[16:19], s30 offen offset:0 sc1 lds
buffer_load_dwordx4 v252, s[16:19], s30 offen offset:1024 sc1 lds
buffer_load_dwordx4 v252, s[16:19], s30 offen offset:2048 sc1 lds
buffer_load_dwordx4 v252, s[16:19], s30 offen offset:3072 sc1 lds
v_accvgpr_mov_b32 a96, a208
v_accvgpr_mov_b32 a97, a209
v_accvgpr_mov_b32 a98, a210
v_accvgpr_mov_b32 a99, a211
v_accvgpr_mov_b32 a100, a212
v_accvgpr_mov_b32 a101, a213
v_accvgpr_mov_b32 a102, a214
v_accvgpr_mov_b32 a103, a215
v_accvgpr_mov_b32 a104, a216
v_accvgpr_mov_b32 a105, a217
v_accvgpr_mov_b32 a106, a218
v_accvgpr_mov_b32 a107, a219
v_accvgpr_mov_b32 a108, a220
v_accvgpr_mov_b32 a109, a221
v_accvgpr_mov_b32 a110, a222
v_accvgpr_mov_b32 a111, a223
v_accvgpr_mov_b32 a112, a224
v_accvgpr_mov_b32 a113, a225
v_accvgpr_mov_b32 a114, a226
v_accvgpr_mov_b32 a115, a227
v_accvgpr_mov_b32 a116, a228
v_accvgpr_mov_b32 a117, a229
v_accvgpr_mov_b32 a118, a230
v_accvgpr_mov_b32 a119, a231
v_accvgpr_mov_b32 a120, a232
v_accvgpr_mov_b32 a121, a233
v_accvgpr_mov_b32 a122, a234
v_accvgpr_mov_b32 a123, a235
v_accvgpr_mov_b32 a124, a236
v_accvgpr_mov_b32 a125, a237
v_accvgpr_mov_b32 a126, a238
v_accvgpr_mov_b32 a127, a239
s_add_u32 s37, s29, 0x10000
v_add_u32 v251, s37, v252
v_add_u32 v250, 98304, v252
ds_write_b128 v251, a[64:67] offset:0
ds_write_b128 v251, a[68:71] offset:1024
ds_write_b128 v251, a[72:75] offset:2048
ds_write_b128 v251, a[76:79] offset:3072
ds_write_b128 v251, a[80:83] offset:4096
ds_write_b128 v251, a[84:87] offset:5120
ds_write_b128 v251, a[88:91] offset:6144
ds_write_b128 v251, a[92:95] offset:7168
s_waitcnt vmcnt(0)
s_barrier
ds_read_b128 a[0:3], v250 offset:0
ds_read_b128 a[4:7], v250 offset:1024
ds_read_b128 a[8:11], v250 offset:2048
ds_read_b128 a[12:15], v250 offset:3072
ds_read_b128 a[16:19], v250 offset:4096
ds_read_b128 a[20:23], v250 offset:5120
ds_read_b128 a[24:27], v250 offset:6144
ds_read_b128 a[28:31], v250 offset:7168
s_lshl_b32 s33, s22, 2
s_add_u32 s33, s33, 4
s_mov_b32 s34, 0x42800000
s_mov_b32 s43, 0
s_mov_b32 s49, 1
s_add_u32 s37, s29, 0x10000
s_xor_b32 s38, s37, 0x2000
v_add_u32 v160, s38, v252
v_mov_b32 v254, 0xff800000
v_and_b32 v161, 15, v253
v_lshrrev_b32 v162, 4, v253
v_lshlrev_b32 v162, 2, v162
v_sub_u32 v161, v161, v162
v_cmp_gt_i32 s[64:65], 0, v161
v_cmp_gt_i32 s[66:67], 1, v161
v_cmp_gt_i32 s[68:69], 2, v161
v_cmp_gt_i32 s[70:71], 3, v161
v_mov_b32 v80, 0
v_mov_b32 v81, 0
v_mov_b32 v82, 0
v_mov_b32 v83, 0
v_mov_b32 v84, 0
v_mov_b32 v85, 0
v_mov_b32 v86, 0
v_mov_b32 v87, 0
v_mov_b32 v88, 0
v_mov_b32 v89, 0
v_mov_b32 v90, 0
v_mov_b32 v91, 0
v_mov_b32 v92, 0
v_mov_b32 v93, 0
v_mov_b32 v94, 0
v_mov_b32 v95, 0
v_mov_b32 v96, 0
v_mov_b32 v97, 0
v_mov_b32 v98, 0
v_mov_b32 v99, 0
v_mov_b32 v100, 0
v_mov_b32 v101, 0
v_mov_b32 v102, 0
v_mov_b32 v103, 0
v_mov_b32 v104, 0
v_mov_b32 v105, 0
v_mov_b32 v106, 0
v_mov_b32 v107, 0
v_mov_b32 v108, 0
v_mov_b32 v109, 0
v_mov_b32 v110, 0
v_mov_b32 v111, 0
v_mov_b32 v248, 0x3f803f80
v_accvgpr_write_b32 a176, v248
v_accvgpr_write_b32 a177, v248
v_accvgpr_write_b32 a178, v248
v_accvgpr_write_b32 a179, v248
s_cmp_eq_u32 s22, 0
s_cbranch_scc0 S2_nm0
s_sub_u32 s37, 0, s20
s_cmp_lt_i32 s37, 0
s_cbranch_scc1 Lme_7002
s_cmp_eq_i32 s37, 0
s_cbranch_scc1 Lmd_7001
v_mov_b32 v96, v254
v_mov_b32 v97, v254
v_mov_b32 v98, v254
v_mov_b32 v99, v254
v_mov_b32 v100, v254
v_mov_b32 v101, v254
v_mov_b32 v102, v254
v_mov_b32 v103, v254
v_mov_b32 v104, v254
v_mov_b32 v105, v254
v_mov_b32 v106, v254
v_mov_b32 v107, v254
v_mov_b32 v108, v254
v_mov_b32 v109, v254
v_mov_b32 v110, v254
v_mov_b32 v111, v254
s_branch Lme_7002
Lmd_7001:
v_cndmask_b32 v96, v96, v254, s[64:65]
v_mov_b32 v100, v254
v_cndmask_b32 v108, v108, v254, s[64:65]
v_cndmask_b32 v97, v97, v254, s[66:67]
v_mov_b32 v101, v254
v_cndmask_b32 v109, v109, v254, s[66:67]
v_cndmask_b32 v98, v98, v254, s[68:69]
v_mov_b32 v102, v254
v_cndmask_b32 v110, v110, v254, s[68:69]
v_cndmask_b32 v99, v99, v254, s[70:71]
v_mov_b32 v103, v254
v_cndmask_b32 v111, v111, v254, s[70:71]
Lme_7002:
S2_nm0:
s_waitcnt lgkmcnt(0)
s_barrier
ds_read_b128 a[128:131], v160 offset:0
ds_read_b128 a[132:135], v160 offset:1024
ds_read_b128 a[136:139], v160 offset:2048
ds_read_b128 a[140:143], v160 offset:3072
ds_read_b128 a[144:147], v160 offset:4096
ds_read_b128 a[148:151], v160 offset:5120
ds_read_b128 a[152:155], v160 offset:6144
ds_read_b128 a[156:159], v160 offset:7168
v_add_u32 v250, 106496, v252
s_mov_b32 s26, 0
s_mov_b32 s27, 131072
s_mov_b32 s28, 98304
s_mov_b32 s36, 0x7fc00000
s_mov_b32 s35, s34
v_mfma_f32_16x16x32_bf16 v[0:3], a[0:3], a[64:67], v[80:83]
v_mfma_f32_16x16x32_bf16 v[0:3], a[4:7], a[68:71], v[0:3]
v_mfma_f32_16x16x32_bf16 v[0:3], a[8:11], a[72:75], v[0:3]
v_mfma_f32_16x16x32_bf16 v[0:3], a[12:15], a[76:79], v[0:3]
v_mfma_f32_16x16x32_bf16 v[8:11], a[0:3], a[80:83], v[88:91]
v_mfma_f32_16x16x32_bf16 v[8:11], a[4:7], a[84:87], v[8:11]
v_mfma_f32_16x16x32_bf16 v[8:11], a[8:11], a[88:91], v[8:11]
v_mfma_f32_16x16x32_bf16 v[8:11], a[12:15], a[92:95], v[8:11]
v_mfma_f32_16x16x32_bf16 v[16:19], a[0:3], a[96:99], v[96:99]
v_mfma_f32_16x16x32_bf16 v[16:19], a[4:7], a[100:103], v[16:19]
v_mfma_f32_16x16x32_bf16 v[16:19], a[8:11], a[104:107], v[16:19]
v_mfma_f32_16x16x32_bf16 v[16:19], a[12:15], a[108:111], v[16:19]
v_mfma_f32_16x16x32_bf16 v[24:27], a[0:3], a[112:115], v[104:107]
v_mfma_f32_16x16x32_bf16 v[24:27], a[4:7], a[116:119], v[24:27]
v_mfma_f32_16x16x32_bf16 v[24:27], a[8:11], a[120:123], v[24:27]
v_mfma_f32_16x16x32_bf16 v[24:27], a[12:15], a[124:127], v[24:27]
v_mfma_f32_16x16x32_bf16 v[4:7], a[16:19], a[64:67], v[84:87]
ds_read_b128 a[0:3], v250 offset:0
v_mfma_f32_16x16x32_bf16 v[4:7], a[20:23], a[68:71], v[4:7]
ds_read_b128 a[4:7], v250 offset:1024
v_mfma_f32_16x16x32_bf16 v[4:7], a[24:27], a[72:75], v[4:7]
ds_read_b128 a[8:11], v250 offset:2048
v_mfma_f32_16x16x32_bf16 v[4:7], a[28:31], a[76:79], v[4:7]
ds_read_b128 a[12:15], v250 offset:3072
v_mfma_f32_16x16x32_bf16 v[12:15], a[16:19], a[80:83], v[92:95]
v_mfma_f32_16x16x32_bf16 v[12:15], a[20:23], a[84:87], v[12:15]
v_mfma_f32_16x16x32_bf16 v[12:15], a[24:27], a[88:91], v[12:15]
v_mfma_f32_16x16x32_bf16 v[12:15], a[28:31], a[92:95], v[12:15]
v_mfma_f32_16x16x32_bf16 v[20:23], a[16:19], a[96:99], v[100:103]
v_mfma_f32_16x16x32_bf16 v[20:23], a[20:23], a[100:103], v[20:23]
v_mfma_f32_16x16x32_bf16 v[20:23], a[24:27], a[104:107], v[20:23]
v_mfma_f32_16x16x32_bf16 v[20:23], a[28:31], a[108:111], v[20:23]
v_mfma_f32_16x16x32_bf16 v[28:31], a[16:19], a[112:115], v[108:111]
v_mfma_f32_16x16x32_bf16 v[28:31], a[20:23], a[116:119], v[28:31]
v_mfma_f32_16x16x32_bf16 v[28:31], a[24:27], a[120:123], v[28:31]
v_mfma_f32_16x16x32_bf16 v[28:31], a[28:31], a[124:127], v[28:31]
ds_read_b128 a[16:19], v250 offset:4096
ds_read_b128 a[20:23], v250 offset:5120
ds_read_b128 a[24:27], v250 offset:6144
ds_read_b128 a[28:31], v250 offset:7168
s_nop 7
v_add_u32 v250, s27, v252
v_mov_b32 v251, v252
s_waitcnt vmcnt(0) lgkmcnt(0)
s_barrier
v_accvgpr_read_b32 v248, a255
v_mov_b32 v249, 1
s_nop 0
buffer_store_dword v249, v248, s[4:7], 0 offen sc1
s_add_u32 m0, s29, 65536
s_add_u32 s30, s25, 0x1000
buffer_load_dwordx4 v252, s[16:19], s25 offen offset:0 sc1 lds
buffer_load_dwordx4 v252, s[16:19], s25 offen offset:1024 sc1 lds
buffer_load_dwordx4 v252, s[16:19], s25 offen offset:2048 sc1 lds
buffer_load_dwordx4 v252, s[16:19], s25 offen offset:3072 sc1 lds
s_add_u32 m0, m0, 0x1000
s_add_u32 s25, s25, 0x8000
buffer_load_dwordx4 v252, s[16:19], s30 offen offset:0 sc1 lds
buffer_load_dwordx4 v252, s[16:19], s30 offen offset:1024 sc1 lds
buffer_load_dwordx4 v252, s[16:19], s30 offen offset:2048 sc1 lds
buffer_load_dwordx4 v252, s[16:19], s30 offen offset:3072 sc1 lds
v_max3_f32 v246, v0, v1, v2
v_max3_f32 v246, v246, v3, v4
v_max3_f32 v246, v246, v5, v6
v_max_f32 v246, v246, v7
v_mov_b32 v248, v246
s_nop 1
v_permlane16_swap_b32 v246, v248
v_max_f32 v246, v246, v248
v_mov_b32 v248, v246
s_nop 1
v_permlane32_swap_b32 v246, v248
v_max_f32 v246, v246, v248
v_max_f32 v246, 0xf149f2ca, v246
v_ceil_f32 v240, v246
v_sub_f32 v246, 0, v240
v_pk_add_f32 v[0:1], v[0:1], v[246:247] op_sel_hi:[1,0]
v_pk_add_f32 v[2:3], v[2:3], v[246:247] op_sel_hi:[1,0]
v_pk_add_f32 v[4:5], v[4:5], v[246:247] op_sel_hi:[1,0]
v_pk_add_f32 v[6:7], v[6:7], v[246:247] op_sel_hi:[1,0]
v_mov_b32 v80, v246
v_mov_b32 v81, v246
v_mov_b32 v82, v246
v_mov_b32 v83, v246
v_mov_b32 v84, v246
v_mov_b32 v85, v246
v_mov_b32 v86, v246
v_mov_b32 v87, v246
v_max3_f32 v246, v8, v9, v10
v_max3_f32 v246, v246, v11, v12
v_max3_f32 v246, v246, v13, v14
v_max_f32 v246, v246, v15
v_mov_b32 v248, v246
s_nop 1
v_permlane16_swap_b32 v246, v248
v_max_f32 v246, v246, v248
v_mov_b32 v248, v246
s_nop 1
v_permlane32_swap_b32 v246, v248
v_max_f32 v246, v246, v248
v_max_f32 v246, 0xf149f2ca, v246
v_ceil_f32 v241, v246
v_sub_f32 v246, 0, v241
v_pk_add_f32 v[8:9], v[8:9], v[246:247] op_sel_hi:[1,0]
v_pk_add_f32 v[10:11], v[10:11], v[246:247] op_sel_hi:[1,0]
v_pk_add_f32 v[12:13], v[12:13], v[246:247] op_sel_hi:[1,0]
v_pk_add_f32 v[14:15], v[14:15], v[246:247] op_sel_hi:[1,0]
v_mov_b32 v88, v246
v_mov_b32 v89, v246
v_mov_b32 v90, v246
v_mov_b32 v91, v246
v_mov_b32 v92, v246
v_mov_b32 v93, v246
v_mov_b32 v94, v246
v_mov_b32 v95, v246
v_max3_f32 v246, v16, v17, v18
v_max3_f32 v246, v246, v19, v20
v_max3_f32 v246, v246, v21, v22
v_max_f32 v246, v246, v23
v_mov_b32 v248, v246
s_nop 1
v_permlane16_swap_b32 v246, v248
v_max_f32 v246, v246, v248
v_mov_b32 v248, v246
s_nop 1
v_permlane32_swap_b32 v246, v248
v_max_f32 v246, v246, v248
v_max_f32 v246, 0xf149f2ca, v246
v_ceil_f32 v242, v246
v_sub_f32 v246, 0, v242
v_pk_add_f32 v[16:17], v[16:17], v[246:247] op_sel_hi:[1,0]
v_pk_add_f32 v[18:19], v[18:19], v[246:247] op_sel_hi:[1,0]
v_pk_add_f32 v[20:21], v[20:21], v[246:247] op_sel_hi:[1,0]
v_pk_add_f32 v[22:23], v[22:23], v[246:247] op_sel_hi:[1,0]
v_mov_b32 v96, v246
v_mov_b32 v97, v246
v_mov_b32 v98, v246
v_mov_b32 v99, v246
v_mov_b32 v100, v246
v_mov_b32 v101, v246
v_mov_b32 v102, v246
v_mov_b32 v103, v246
v_max3_f32 v246, v24, v25, v26
v_max3_f32 v246, v246, v27, v28
v_max3_f32 v246, v246, v29, v30
v_max_f32 v246, v246, v31
v_mov_b32 v248, v246
s_nop 1
v_permlane16_swap_b32 v246, v248
v_max_f32 v246, v246, v248
v_mov_b32 v248, v246
s_nop 1
v_permlane32_swap_b32 v246, v248
v_max_f32 v246, v246, v248
v_max_f32 v246, 0xf149f2ca, v246
v_ceil_f32 v243, v246
v_sub_f32 v246, 0, v243
v_pk_add_f32 v[24:25], v[24:25], v[246:247] op_sel_hi:[1,0]
v_pk_add_f32 v[26:27], v[26:27], v[246:247] op_sel_hi:[1,0]
v_pk_add_f32 v[28:29], v[28:29], v[246:247] op_sel_hi:[1,0]
v_pk_add_f32 v[30:31], v[30:31], v[246:247] op_sel_hi:[1,0]
v_mov_b32 v104, v246
v_mov_b32 v105, v246
v_mov_b32 v106, v246
v_mov_b32 v107, v246
v_mov_b32 v108, v246
v_mov_b32 v109, v246
v_mov_b32 v110, v246
v_mov_b32 v111, v246
s_cmp_le_u32 s33, 5
s_cbranch_scc0 S2_f1
s_sub_u32 s37, 1, s20
s_cmp_lt_i32 s37, 0
s_cbranch_scc1 Lme_7004
s_cmp_eq_i32 s37, 0
s_cbranch_scc1 Lmd_7003
v_mov_b32 v96, v254
v_mov_b32 v97, v254
v_mov_b32 v98, v254
v_mov_b32 v99, v254
v_mov_b32 v100, v254
v_mov_b32 v101, v254
v_mov_b32 v102, v254
v_mov_b32 v103, v254
v_mov_b32 v104, v254
v_mov_b32 v105, v254
v_mov_b32 v106, v254
v_mov_b32 v107, v254
v_mov_b32 v108, v254
v_mov_b32 v109, v254
v_mov_b32 v110, v254
v_mov_b32 v111, v254
s_branch Lme_7004
Lmd_7003:
v_cndmask_b32 v96, v96, v254, s[64:65]
v_mov_b32 v100, v254
v_cndmask_b32 v108, v108, v254, s[64:65]
v_cndmask_b32 v97, v97, v254, s[66:67]
v_mov_b32 v101, v254
v_cndmask_b32 v109, v109, v254, s[66:67]
v_cndmask_b32 v98, v98, v254, s[68:69]
v_mov_b32 v102, v254
v_cndmask_b32 v110, v110, v254, s[68:69]
v_cndmask_b32 v99, v99, v254, s[70:71]
v_mov_b32 v103, v254
v_cndmask_b32 v111, v111, v254, s[70:71]
Lme_7004:
S2_f1:
s_waitcnt vmcnt(16) lgkmcnt(0)
s_barrier
v_mfma_f32_16x16x32_bf16 v[32:35], a[0:3], a[64:67], v[80:83]
s_add_u32 m0, s29, s28
v_exp_f32 v0, v0
v_mfma_f32_16x16x32_bf16 v[32:35], a[4:7], a[68:71], v[32:35]
s_add_u32 s30, s25, 0x1000
v_exp_f32 v1, v1
v_mfma_f32_16x16x32_bf16 v[32:35], a[8:11], a[72:75], v[32:35]
ds_read_b128 a[32:35], v251 offset:16384
v_cvt_pk_bf16_f32 v64, v0, v1
v_mfma_f32_16x16x32_bf16 v[32:35], a[12:15], a[76:79], v[32:35]
v_exp_f32 v2, v2
v_mfma_f32_16x16x32_bf16 v[40:43], a[0:3], a[80:83], v[88:91]
s_add_u32 s37, s27, 0x2000
v_exp_f32 v3, v3
v_mfma_f32_16x16x32_bf16 v[40:43], a[4:7], a[84:87], v[40:43]
s_sub_u32 s33, s33, 1
ds_read_b128 a[36:39], v251 offset:17408
v_cvt_pk_bf16_f32 v65, v2, v3
v_mfma_f32_16x16x32_bf16 v[40:43], a[8:11], a[88:91], v[40:43]
buffer_load_dwordx4 v252, s[16:19], s25 offen offset:0 sc1 lds
v_mfma_f32_16x16x32_bf16 v[40:43], a[12:15], a[92:95], v[40:43]
v_exp_f32 v4, v4
v_mfma_f32_16x16x32_bf16 v[48:51], a[0:3], a[96:99], v[96:99]
v_exp_f32 v5, v5
v_mfma_f32_16x16x32_bf16 v[48:51], a[4:7], a[100:103], v[48:51]
ds_read_b128 a[40:43], v251 offset:18432
v_cvt_pk_bf16_f32 v66, v4, v5
v_mfma_f32_16x16x32_bf16 v[48:51], a[8:11], a[104:107], v[48:51]
v_exp_f32 v6, v6
v_mfma_f32_16x16x32_bf16 v[48:51], a[12:15], a[108:111], v[48:51]
v_exp_f32 v7, v7
v_mfma_f32_16x16x32_bf16 v[56:59], a[0:3], a[112:115], v[104:107]
ds_read_b128 a[44:47], v251 offset:19456
v_cvt_pk_bf16_f32 v67, v6, v7
v_mfma_f32_16x16x32_bf16 v[56:59], a[4:7], a[116:119], v[56:59]
v_exp_f32 v8, v8
v_mfma_f32_16x16x32_bf16 v[56:59], a[8:11], a[120:123], v[56:59]
s_cmp_le_u32 s33, 5
s_cselect_b32 s35, s36, s34
ds_read_b128 a[48:51], v251 offset:20480
v_mfma_f32_16x16x32_bf16 v[56:59], a[12:15], a[124:127], v[56:59]
v_exp_f32 v9, v9
v_mfma_f32_16x16x32_bf16 v[36:39], a[16:19], a[64:67], v[84:87]
ds_read_b128 a[52:55], v251 offset:21504
v_cvt_pk_bf16_f32 v68, v8, v9
v_mfma_f32_16x16x32_bf16 v[36:39], a[20:23], a[68:71], v[36:39]
v_exp_f32 v10, v10
v_mfma_f32_16x16x32_bf16 v[36:39], a[24:27], a[72:75], v[36:39]
v_exp_f32 v11, v11
v_mfma_f32_16x16x32_bf16 v[36:39], a[28:31], a[76:79], v[36:39]
ds_read_b128 a[56:59], v251 offset:22528
v_cvt_pk_bf16_f32 v69, v10, v11
v_mfma_f32_16x16x32_bf16 v[44:47], a[16:19], a[80:83], v[92:95]
buffer_load_dwordx4 v252, s[16:19], s25 offen offset:1024 sc1 lds
v_mfma_f32_16x16x32_bf16 v[44:47], a[20:23], a[84:87], v[44:47]
v_exp_f32 v12, v12
v_mfma_f32_16x16x32_bf16 v[44:47], a[24:27], a[88:91], v[44:47]
v_exp_f32 v13, v13
v_mfma_f32_16x16x32_bf16 v[44:47], a[28:31], a[92:95], v[44:47]
ds_read_b128 a[60:63], v251 offset:23552
v_cvt_pk_bf16_f32 v70, v12, v13
v_mfma_f32_16x16x32_bf16 v[52:55], a[16:19], a[96:99], v[100:103]
v_exp_f32 v14, v14
v_mfma_f32_16x16x32_bf16 v[52:55], a[20:23], a[100:103], v[52:55]
v_exp_f32 v15, v15
v_mfma_f32_16x16x32_bf16 v[52:55], a[24:27], a[104:107], v[52:55]
v_cvt_pk_bf16_f32 v71, v14, v15
v_max_f32 v244, v32, v33
v_mfma_f32_16x16x32_bf16 v[52:55], a[28:31], a[108:111], v[52:55]
v_exp_f32 v16, v16
v_mfma_f32_16x16x32_bf16 v[60:63], a[16:19], a[112:115], v[108:111]
v_exp_f32 v17, v17
v_mfma_f32_16x16x32_bf16 v[60:63], a[20:23], a[116:119], v[60:63]
ds_read_b128 a[0:3], v250 offset:0
v_cvt_pk_bf16_f32 v72, v16, v17
v_mfma_f32_16x16x32_bf16 v[60:63], a[24:27], a[120:123], v[60:63]
v_exp_f32 v18, v18
v_mfma_f32_16x16x32_bf16 v[60:63], a[28:31], a[124:127], v[60:63]
v_max3_f32 v244, v244, v34, v35
s_waitcnt lgkmcnt(1)
v_mfma_f32_16x16x32_bf16 v[112:115], a[32:35], v[64:67], 0
v_exp_f32 v19, v19
v_mfma_f32_16x16x32_bf16 v[116:119], a[36:39], v[64:67], 0
ds_read_b128 a[4:7], v250 offset:1024
v_cvt_pk_bf16_f32 v73, v18, v19
v_mfma_f32_16x16x32_bf16 v[120:123], a[40:43], v[64:67], 0
v_exp_f32 v20, v20
v_mfma_f32_16x16x32_bf16 v[124:127], a[44:47], v[64:67], 0
buffer_load_dwordx4 v252, s[16:19], s25 offen offset:2048 sc1 lds
v_mfma_f32_16x16x32_bf16 v[128:131], a[48:51], v[64:67], 0
v_exp_f32 v21, v21
v_mfma_f32_16x16x32_bf16 v[132:135], a[52:55], v[64:67], 0
ds_read_b128 a[8:11], v250 offset:2048
v_cvt_pk_bf16_f32 v74, v20, v21
v_mfma_f32_16x16x32_bf16 v[136:139], a[56:59], v[64:67], 0
v_exp_f32 v22, v22
v_mfma_f32_16x16x32_bf16 v[140:143], a[60:63], v[64:67], 0
v_exp_f32 v23, v23
v_mfma_f32_16x16x32_bf16 a[160:163], a[176:179], v[64:67], 0
ds_read_b128 a[12:15], v250 offset:3072
v_cvt_pk_bf16_f32 v75, v22, v23
v_mfma_f32_16x16x32_bf16 v[144:147], a[32:35], v[68:71], 0
v_exp_f32 v24, v24
v_mfma_f32_16x16x32_bf16 v[148:151], a[36:39], v[68:71], 0
v_exp_f32 v25, v25
v_mfma_f32_16x16x32_bf16 v[152:155], a[40:43], v[68:71], 0
v_cvt_pk_bf16_f32 v76, v24, v25
v_max3_f32 v244, v244, v40, v41
v_mfma_f32_16x16x32_bf16 v[156:159], a[44:47], v[68:71], 0
v_exp_f32 v26, v26
v_mfma_f32_16x16x32_bf16 v[160:163], a[48:51], v[68:71], 0
v_exp_f32 v27, v27
v_mfma_f32_16x16x32_bf16 v[164:167], a[52:55], v[68:71], 0
ds_read_b128 a[16:19], v250 offset:4096
v_cvt_pk_bf16_f32 v77, v26, v27
v_mfma_f32_16x16x32_bf16 v[168:171], a[56:59], v[68:71], 0
v_exp_f32 v28, v28
v_mfma_f32_16x16x32_bf16 v[172:175], a[60:63], v[68:71], 0
v_exp_f32 v29, v29
v_mfma_f32_16x16x32_bf16 a[164:167], a[176:179], v[68:71], 0
buffer_load_dwordx4 v252, s[16:19], s25 offen offset:3072 sc1 lds
v_mfma_f32_16x16x32_bf16 v[176:179], a[32:35], v[72:75], 0
ds_read_b128 a[20:23], v250 offset:5120
v_cvt_pk_bf16_f32 v78, v28, v29
v_mfma_f32_16x16x32_bf16 v[180:183], a[36:39], v[72:75], 0
v_exp_f32 v30, v30
v_mfma_f32_16x16x32_bf16 v[184:187], a[40:43], v[72:75], 0
v_exp_f32 v31, v31
v_mfma_f32_16x16x32_bf16 v[188:191], a[44:47], v[72:75], 0
v_max3_f32 v244, v244, v42, v43
v_max_f32 v246, v48, v49
v_mfma_f32_16x16x32_bf16 v[192:195], a[48:51], v[72:75], 0
ds_read_b128 a[24:27], v250 offset:6144
v_cvt_pk_bf16_f32 v79, v30, v31
v_mfma_f32_16x16x32_bf16 v[196:199], a[52:55], v[72:75], 0
v_max3_f32 v246, v246, v50, v51
v_max3_f32 v246, v246, v56, v57
v_mfma_f32_16x16x32_bf16 v[200:203], a[56:59], v[72:75], 0
v_max3_f32 v246, v246, v58, v59
v_max3_f32 v244, v244, v36, v37
v_mfma_f32_16x16x32_bf16 v[204:207], a[60:63], v[72:75], 0
ds_read_b128 a[28:31], v250 offset:7168
v_max3_f32 v244, v244, v38, v39
v_mfma_f32_16x16x32_bf16 a[168:171], a[176:179], v[72:75], 0
v_max3_f32 v244, v244, v44, v45
v_max3_f32 v244, v244, v46, v47
v_mfma_f32_16x16x32_bf16 v[208:211], a[32:35], v[76:79], 0
v_max3_f32 v246, v246, v52, v53
v_max3_f32 v246, v246, v54, v55
v_mfma_f32_16x16x32_bf16 v[212:215], a[36:39], v[76:79], 0
v_max3_f32 v246, v246, v60, v61
v_max3_f32 v246, v246, v62, v63
v_mfma_f32_16x16x32_bf16 v[216:219], a[40:43], v[76:79], 0
v_add_u32 v250, s37, v252
v_max_f32 v255, v244, v246
v_mfma_f32_16x16x32_bf16 v[220:223], a[44:47], v[76:79], 0
v_cmp_nge_f32 vcc, s35, v255
v_mfma_f32_16x16x32_bf16 v[224:227], a[48:51], v[76:79], 0
v_mfma_f32_16x16x32_bf16 v[228:231], a[52:55], v[76:79], 0
v_mfma_f32_16x16x32_bf16 v[232:235], a[56:59], v[76:79], 0
v_mfma_f32_16x16x32_bf16 v[236:239], a[60:63], v[76:79], 0
v_mfma_f32_16x16x32_bf16 a[172:175], a[176:179], v[76:79], 0
s_cbranch_vccnz S2_rare10
s_branch S2_c1a
.p2align 6
S2_loop1:
s_waitcnt vmcnt(16) lgkmcnt(0)
s_barrier
v_mfma_f32_16x16x32_bf16 v[32:35], a[0:3], a[64:67], v[80:83]
s_add_u32 m0, s29, s28
v_exp_f32 v0, v0
v_mfma_f32_16x16x32_bf16 v[32:35], a[4:7], a[68:71], v[32:35]
s_add_u32 s30, s25, 0x1000
v_exp_f32 v1, v1
v_mfma_f32_16x16x32_bf16 v[32:35], a[8:11], a[72:75], v[32:35]
ds_read_b128 a[32:35], v251 offset:16384
v_cvt_pk_bf16_f32 v64, v0, v1
v_mfma_f32_16x16x32_bf16 v[32:35], a[12:15], a[76:79], v[32:35]
v_exp_f32 v2, v2
v_mfma_f32_16x16x32_bf16 v[40:43], a[0:3], a[80:83], v[88:91]
s_add_u32 s37, s27, 0x2000
v_exp_f32 v3, v3
v_mfma_f32_16x16x32_bf16 v[40:43], a[4:7], a[84:87], v[40:43]
s_add_u32 s38, s26, s24
ds_read_b128 a[36:39], v251 offset:17408
v_cvt_pk_bf16_f32 v65, v2, v3
v_mfma_f32_16x16x32_bf16 v[40:43], a[8:11], a[88:91], v[40:43]
buffer_load_dwordx4 v252, s[16:19], s25 offen offset:0 sc1 lds
v_mfma_f32_16x16x32_bf16 v[40:43], a[12:15], a[92:95], v[40:43]
v_exp_f32 v4, v4
v_mfma_f32_16x16x32_bf16 v[48:51], a[0:3], a[96:99], v[96:99]
v_exp_f32 v5, v5
v_mfma_f32_16x16x32_bf16 v[48:51], a[4:7], a[100:103], v[48:51]
ds_read_b128 a[40:43], v251 offset:18432
v_cvt_pk_bf16_f32 v66, v4, v5
v_mfma_f32_16x16x32_bf16 v[48:51], a[8:11], a[104:107], v[48:51]
v_exp_f32 v6, v6
v_mfma_f32_16x16x32_bf16 v[48:51], a[12:15], a[108:111], v[48:51]
v_exp_f32 v7, v7
v_mfma_f32_16x16x32_bf16 v[56:59], a[0:3], a[112:115], v[104:107]
ds_read_b128 a[44:47], v251 offset:19456
v_cvt_pk_bf16_f32 v67, v6, v7
v_mfma_f32_16x16x32_bf16 v[56:59], a[4:7], a[116:119], v[56:59]
v_exp_f32 v8, v8
v_mfma_f32_16x16x32_bf16 v[56:59], a[8:11], a[120:123], v[56:59]
s_cmp_eq_u32 s33, 2
s_cselect_b32 s37, s38, s37
ds_read_b128 a[48:51], v251 offset:20480
v_mfma_f32_16x16x32_bf16 v[56:59], a[12:15], a[124:127], v[56:59]
s_sub_u32 s33, s33, 1
v_exp_f32 v9, v9
v_mfma_f32_16x16x32_bf16 v[36:39], a[16:19], a[64:67], v[84:87]
ds_read_b128 a[52:55], v251 offset:21504
v_cvt_pk_bf16_f32 v68, v8, v9
v_mfma_f32_16x16x32_bf16 v[36:39], a[20:23], a[68:71], v[36:39]
v_exp_f32 v10, v10
v_mfma_f32_16x16x32_bf16 v[36:39], a[24:27], a[72:75], v[36:39]
v_exp_f32 v11, v11
v_mfma_f32_16x16x32_bf16 v[36:39], a[28:31], a[76:79], v[36:39]
ds_read_b128 a[56:59], v251 offset:22528
v_cvt_pk_bf16_f32 v69, v10, v11
v_mfma_f32_16x16x32_bf16 v[44:47], a[16:19], a[80:83], v[92:95]
buffer_load_dwordx4 v252, s[16:19], s25 offen offset:1024 sc1 lds
v_mfma_f32_16x16x32_bf16 v[44:47], a[20:23], a[84:87], v[44:47]
v_exp_f32 v12, v12
v_mfma_f32_16x16x32_bf16 v[44:47], a[24:27], a[88:91], v[44:47]
v_exp_f32 v13, v13
v_mfma_f32_16x16x32_bf16 v[44:47], a[28:31], a[92:95], v[44:47]
ds_read_b128 a[60:63], v251 offset:23552
v_cvt_pk_bf16_f32 v70, v12, v13
v_mfma_f32_16x16x32_bf16 v[52:55], a[16:19], a[96:99], v[100:103]
v_exp_f32 v14, v14
v_mfma_f32_16x16x32_bf16 v[52:55], a[20:23], a[100:103], v[52:55]
v_exp_f32 v15, v15
v_mfma_f32_16x16x32_bf16 v[52:55], a[24:27], a[104:107], v[52:55]
s_cmp_le_u32 s33, 5
s_cselect_b32 s35, s36, s34
v_cvt_pk_bf16_f32 v71, v14, v15
v_mfma_f32_16x16x32_bf16 v[52:55], a[28:31], a[108:111], v[52:55]
v_exp_f32 v16, v16
v_mfma_f32_16x16x32_bf16 v[60:63], a[16:19], a[112:115], v[108:111]
v_exp_f32 v17, v17
v_mfma_f32_16x16x32_bf16 v[60:63], a[20:23], a[116:119], v[60:63]
ds_read_b128 a[0:3], v250 offset:0
v_cvt_pk_bf16_f32 v72, v16, v17
v_mfma_f32_16x16x32_bf16 v[60:63], a[24:27], a[120:123], v[60:63]
v_exp_f32 v18, v18
v_mfma_f32_16x16x32_bf16 v[60:63], a[28:31], a[124:127], v[60:63]
v_max_f32 v244, v32, v33
s_waitcnt lgkmcnt(1)
v_mfma_f32_16x16x32_bf16 v[112:115], a[32:35], v[64:67], v[112:115]
v_exp_f32 v19, v19
v_mfma_f32_16x16x32_bf16 v[116:119], a[36:39], v[64:67], v[116:119]
ds_read_b128 a[4:7], v250 offset:1024
v_cvt_pk_bf16_f32 v73, v18, v19
v_mfma_f32_16x16x32_bf16 v[120:123], a[40:43], v[64:67], v[120:123]
v_exp_f32 v20, v20
v_mfma_f32_16x16x32_bf16 v[124:127], a[44:47], v[64:67], v[124:127]
buffer_load_dwordx4 v252, s[16:19], s25 offen offset:2048 sc1 lds
v_mfma_f32_16x16x32_bf16 v[128:131], a[48:51], v[64:67], v[128:131]
v_exp_f32 v21, v21
v_mfma_f32_16x16x32_bf16 v[132:135], a[52:55], v[64:67], v[132:135]
ds_read_b128 a[8:11], v250 offset:2048
v_cvt_pk_bf16_f32 v74, v20, v21
v_mfma_f32_16x16x32_bf16 v[136:139], a[56:59], v[64:67], v[136:139]
v_exp_f32 v22, v22
v_mfma_f32_16x16x32_bf16 v[140:143], a[60:63], v[64:67], v[140:143]
v_exp_f32 v23, v23
v_mfma_f32_16x16x32_bf16 a[160:163], a[176:179], v[64:67], a[160:163]
ds_read_b128 a[12:15], v250 offset:3072
v_cvt_pk_bf16_f32 v75, v22, v23
v_mfma_f32_16x16x32_bf16 v[144:147], a[32:35], v[68:71], v[144:147]
v_exp_f32 v24, v24
v_mfma_f32_16x16x32_bf16 v[148:151], a[36:39], v[68:71], v[148:151]
v_exp_f32 v25, v25
v_mfma_f32_16x16x32_bf16 v[152:155], a[40:43], v[68:71], v[152:155]
v_cvt_pk_bf16_f32 v76, v24, v25
v_max3_f32 v244, v244, v34, v35
v_mfma_f32_16x16x32_bf16 v[156:159], a[44:47], v[68:71], v[156:159]
v_exp_f32 v26, v26
v_mfma_f32_16x16x32_bf16 v[160:163], a[48:51], v[68:71], v[160:163]
v_exp_f32 v27, v27
v_mfma_f32_16x16x32_bf16 v[164:167], a[52:55], v[68:71], v[164:167]
ds_read_b128 a[16:19], v250 offset:4096
v_cvt_pk_bf16_f32 v77, v26, v27
v_mfma_f32_16x16x32_bf16 v[168:171], a[56:59], v[68:71], v[168:171]
v_exp_f32 v28, v28
v_mfma_f32_16x16x32_bf16 v[172:175], a[60:63], v[68:71], v[172:175]
v_exp_f32 v29, v29
v_mfma_f32_16x16x32_bf16 a[164:167], a[176:179], v[68:71], a[164:167]
buffer_load_dwordx4 v252, s[16:19], s25 offen offset:3072 sc1 lds
v_mfma_f32_16x16x32_bf16 v[176:179], a[32:35], v[72:75], v[176:179]
ds_read_b128 a[20:23], v250 offset:5120
v_cvt_pk_bf16_f32 v78, v28, v29
v_mfma_f32_16x16x32_bf16 v[180:183], a[36:39], v[72:75], v[180:183]
v_exp_f32 v30, v30
v_mfma_f32_16x16x32_bf16 v[184:187], a[40:43], v[72:75], v[184:187]
v_max3_f32 v244, v244, v40, v41
v_max3_f32 v244, v244, v42, v43
v_mfma_f32_16x16x32_bf16 v[188:191], a[44:47], v[72:75], v[188:191]
v_exp_f32 v31, v31
v_mfma_f32_16x16x32_bf16 v[192:195], a[48:51], v[72:75], v[192:195]
v_max_f32 v246, v48, v49
v_cvt_pk_bf16_f32 v79, v30, v31
v_mfma_f32_16x16x32_bf16 v[196:199], a[52:55], v[72:75], v[196:199]
ds_read_b128 a[24:27], v250 offset:6144
v_max3_f32 v246, v246, v50, v51
v_mfma_f32_16x16x32_bf16 v[200:203], a[56:59], v[72:75], v[200:203]
v_max3_f32 v246, v246, v56, v57
v_max3_f32 v246, v246, v58, v59
v_mfma_f32_16x16x32_bf16 v[204:207], a[60:63], v[72:75], v[204:207]
ds_read_b128 a[28:31], v250 offset:7168
v_max3_f32 v244, v244, v36, v37
v_mfma_f32_16x16x32_bf16 a[168:171], a[176:179], v[72:75], a[168:171]
v_max3_f32 v244, v244, v38, v39
v_max3_f32 v244, v244, v44, v45
v_mfma_f32_16x16x32_bf16 v[208:211], a[32:35], v[76:79], v[208:211]
v_max3_f32 v244, v244, v46, v47
v_max3_f32 v246, v246, v52, v53
v_mfma_f32_16x16x32_bf16 v[212:215], a[36:39], v[76:79], v[212:215]
v_max3_f32 v246, v246, v54, v55
v_max3_f32 v246, v246, v60, v61
v_mfma_f32_16x16x32_bf16 v[216:219], a[40:43], v[76:79], v[216:219]
v_max3_f32 v246, v246, v62, v63
v_add_u32 v250, s37, v252
v_mfma_f32_16x16x32_bf16 v[220:223], a[44:47], v[76:79], v[220:223]
v_max_f32 v255, v244, v246
v_cmp_nge_f32 vcc, s35, v255
v_mfma_f32_16x16x32_bf16 v[224:227], a[48:51], v[76:79], v[224:227]
v_mfma_f32_16x16x32_bf16 v[228:231], a[52:55], v[76:79], v[228:231]
v_mfma_f32_16x16x32_bf16 v[232:235], a[56:59], v[76:79], v[232:235]
v_mfma_f32_16x16x32_bf16 v[236:239], a[60:63], v[76:79], v[236:239]
v_mfma_f32_16x16x32_bf16 a[172:175], a[176:179], v[76:79], a[172:175]
s_cbranch_vccnz S2_rare10
S2_c1a:
s_waitcnt lgkmcnt(0)
v_mfma_f32_16x16x32_bf16 v[0:3], a[0:3], a[64:67], v[80:83]
s_add_u32 m0, m0, 0x1000
v_exp_f32 v32, v32
v_mfma_f32_16x16x32_bf16 v[0:3], a[4:7], a[68:71], v[0:3]
s_add_u32 s25, s25, 0x8000
v_exp_f32 v33, v33
v_mfma_f32_16x16x32_bf16 v[0:3], a[8:11], a[72:75], v[0:3]
ds_read_b128 a[32:35], v251 offset:24576
v_cvt_pk_bf16_f32 v64, v32, v33
v_mfma_f32_16x16x32_bf16 v[0:3], a[12:15], a[76:79], v[0:3]
v_exp_f32 v34, v34
v_mfma_f32_16x16x32_bf16 v[8:11], a[0:3], a[80:83], v[88:91]
s_mov_b32 s28, s27
v_exp_f32 v35, v35
v_mfma_f32_16x16x32_bf16 v[8:11], a[4:7], a[84:87], v[8:11]
s_mov_b32 s27, s26
ds_read_b128 a[36:39], v251 offset:25600
v_cvt_pk_bf16_f32 v65, v34, v35
v_mfma_f32_16x16x32_bf16 v[8:11], a[8:11], a[88:91], v[8:11]
s_add_u32 s26, s26, 0x8000
buffer_load_dwordx4 v252, s[16:19], s30 offen offset:0 sc1 lds
v_mfma_f32_16x16x32_bf16 v[8:11], a[12:15], a[92:95], v[8:11]
v_exp_f32 v36, v36
v_mfma_f32_16x16x32_bf16 v[16:19], a[0:3], a[96:99], v[96:99]
v_exp_f32 v37, v37
v_mfma_f32_16x16x32_bf16 v[16:19], a[4:7], a[100:103], v[16:19]
ds_read_b128 a[40:43], v251 offset:26624
v_cvt_pk_bf16_f32 v66, v36, v37
v_mfma_f32_16x16x32_bf16 v[16:19], a[8:11], a[104:107], v[16:19]
v_exp_f32 v38, v38
v_mfma_f32_16x16x32_bf16 v[16:19], a[12:15], a[108:111], v[16:19]
v_exp_f32 v39, v39
v_mfma_f32_16x16x32_bf16 v[24:27], a[0:3], a[112:115], v[104:107]
ds_read_b128 a[44:47], v251 offset:27648
v_cvt_pk_bf16_f32 v67, v38, v39
v_mfma_f32_16x16x32_bf16 v[24:27], a[4:7], a[116:119], v[24:27]
v_exp_f32 v40, v40
v_mfma_f32_16x16x32_bf16 v[24:27], a[8:11], a[120:123], v[24:27]
s_cmp_eq_u32 s26, 0x28000
s_cselect_b32 s26, 0, s26
ds_read_b128 a[48:51], v251 offset:28672
v_mfma_f32_16x16x32_bf16 v[24:27], a[12:15], a[124:127], v[24:27]
s_sub_u32 s33, s33, 1
v_exp_f32 v41, v41
v_mfma_f32_16x16x32_bf16 v[4:7], a[16:19], a[64:67], v[84:87]
ds_read_b128 a[52:55], v251 offset:29696
v_cvt_pk_bf16_f32 v68, v40, v41
v_mfma_f32_16x16x32_bf16 v[4:7], a[20:23], a[68:71], v[4:7]
v_exp_f32 v42, v42
v_mfma_f32_16x16x32_bf16 v[4:7], a[24:27], a[72:75], v[4:7]
v_exp_f32 v43, v43
v_mfma_f32_16x16x32_bf16 v[4:7], a[28:31], a[76:79], v[4:7]
ds_read_b128 a[56:59], v251 offset:30720
v_cvt_pk_bf16_f32 v69, v42, v43
v_mfma_f32_16x16x32_bf16 v[12:15], a[16:19], a[80:83], v[92:95]
buffer_load_dwordx4 v252, s[16:19], s30 offen offset:1024 sc1 lds
v_mfma_f32_16x16x32_bf16 v[12:15], a[20:23], a[84:87], v[12:15]
v_exp_f32 v44, v44
v_mfma_f32_16x16x32_bf16 v[12:15], a[24:27], a[88:91], v[12:15]
v_exp_f32 v45, v45
v_mfma_f32_16x16x32_bf16 v[12:15], a[28:31], a[92:95], v[12:15]
ds_read_b128 a[60:63], v251 offset:31744
v_cvt_pk_bf16_f32 v70, v44, v45
v_mfma_f32_16x16x32_bf16 v[20:23], a[16:19], a[96:99], v[100:103]
v_exp_f32 v46, v46
v_mfma_f32_16x16x32_bf16 v[20:23], a[20:23], a[100:103], v[20:23]
v_exp_f32 v47, v47
v_mfma_f32_16x16x32_bf16 v[20:23], a[24:27], a[104:107], v[20:23]
s_cmp_le_u32 s33, 5
s_cselect_b32 s35, s36, s34
v_cvt_pk_bf16_f32 v71, v46, v47
v_mfma_f32_16x16x32_bf16 v[20:23], a[28:31], a[108:111], v[20:23]
v_exp_f32 v48, v48
v_mfma_f32_16x16x32_bf16 v[28:31], a[16:19], a[112:115], v[108:111]
v_exp_f32 v49, v49
v_mfma_f32_16x16x32_bf16 v[28:31], a[20:23], a[116:119], v[28:31]
ds_read_b128 a[0:3], v250 offset:0
v_cvt_pk_bf16_f32 v72, v48, v49
v_mfma_f32_16x16x32_bf16 v[28:31], a[24:27], a[120:123], v[28:31]
v_exp_f32 v50, v50
v_mfma_f32_16x16x32_bf16 v[28:31], a[28:31], a[124:127], v[28:31]
v_max_f32 v244, v0, v1
s_waitcnt lgkmcnt(1)
v_mfma_f32_16x16x32_bf16 v[112:115], a[32:35], v[64:67], v[112:115]
v_exp_f32 v51, v51
v_mfma_f32_16x16x32_bf16 v[116:119], a[36:39], v[64:67], v[116:119]
ds_read_b128 a[4:7], v250 offset:1024
v_cvt_pk_bf16_f32 v73, v50, v51
v_mfma_f32_16x16x32_bf16 v[120:123], a[40:43], v[64:67], v[120:123]
v_exp_f32 v52, v52
v_mfma_f32_16x16x32_bf16 v[124:127], a[44:47], v[64:67], v[124:127]
buffer_load_dwordx4 v252, s[16:19], s30 offen offset:2048 sc1 lds
v_mfma_f32_16x16x32_bf16 v[128:131], a[48:51], v[64:67], v[128:131]
v_exp_f32 v53, v53
v_mfma_f32_16x16x32_bf16 v[132:135], a[52:55], v[64:67], v[132:135]
ds_read_b128 a[8:11], v250 offset:2048
v_cvt_pk_bf16_f32 v74, v52, v53
v_mfma_f32_16x16x32_bf16 v[136:139], a[56:59], v[64:67], v[136:139]
v_exp_f32 v54, v54
v_mfma_f32_16x16x32_bf16 v[140:143], a[60:63], v[64:67], v[140:143]
v_exp_f32 v55, v55
v_mfma_f32_16x16x32_bf16 a[160:163], a[176:179], v[64:67], a[160:163]
ds_read_b128 a[12:15], v250 offset:3072
v_cvt_pk_bf16_f32 v75, v54, v55
v_mfma_f32_16x16x32_bf16 v[144:147], a[32:35], v[68:71], v[144:147]
v_exp_f32 v56, v56
v_mfma_f32_16x16x32_bf16 v[148:151], a[36:39], v[68:71], v[148:151]
v_exp_f32 v57, v57
v_mfma_f32_16x16x32_bf16 v[152:155], a[40:43], v[68:71], v[152:155]
v_cvt_pk_bf16_f32 v76, v56, v57
v_max3_f32 v244, v244, v2, v3
v_mfma_f32_16x16x32_bf16 v[156:159], a[44:47], v[68:71], v[156:159]
v_exp_f32 v58, v58
v_mfma_f32_16x16x32_bf16 v[160:163], a[48:51], v[68:71], v[160:163]
v_exp_f32 v59, v59
v_mfma_f32_16x16x32_bf16 v[164:167], a[52:55], v[68:71], v[164:167]
ds_read_b128 a[16:19], v250 offset:4096
v_cvt_pk_bf16_f32 v77, v58, v59
v_mfma_f32_16x16x32_bf16 v[168:171], a[56:59], v[68:71], v[168:171]
v_exp_f32 v60, v60
v_mfma_f32_16x16x32_bf16 v[172:175], a[60:63], v[68:71], v[172:175]
v_exp_f32 v61, v61
v_mfma_f32_16x16x32_bf16 a[164:167], a[176:179], v[68:71], a[164:167]
buffer_load_dwordx4 v252, s[16:19], s30 offen offset:3072 sc1 lds
v_mfma_f32_16x16x32_bf16 v[176:179], a[32:35], v[72:75], v[176:179]
ds_read_b128 a[20:23], v250 offset:5120
v_cvt_pk_bf16_f32 v78, v60, v61
v_mfma_f32_16x16x32_bf16 v[180:183], a[36:39], v[72:75], v[180:183]
v_exp_f32 v62, v62
v_mfma_f32_16x16x32_bf16 v[184:187], a[40:43], v[72:75], v[184:187]
v_max3_f32 v244, v244, v8, v9
v_max3_f32 v244, v244, v10, v11
v_mfma_f32_16x16x32_bf16 v[188:191], a[44:47], v[72:75], v[188:191]
v_exp_f32 v63, v63
v_mfma_f32_16x16x32_bf16 v[192:195], a[48:51], v[72:75], v[192:195]
v_max_f32 v246, v16, v17
v_cvt_pk_bf16_f32 v79, v62, v63
v_mfma_f32_16x16x32_bf16 v[196:199], a[52:55], v[72:75], v[196:199]
ds_read_b128 a[24:27], v250 offset:6144
v_max3_f32 v246, v246, v18, v19
v_mfma_f32_16x16x32_bf16 v[200:203], a[56:59], v[72:75], v[200:203]
v_max3_f32 v246, v246, v24, v25
v_max3_f32 v246, v246, v26, v27
v_mfma_f32_16x16x32_bf16 v[204:207], a[60:63], v[72:75], v[204:207]
ds_read_b128 a[28:31], v250 offset:7168
v_max3_f32 v244, v244, v4, v5
v_mfma_f32_16x16x32_bf16 a[168:171], a[176:179], v[72:75], a[168:171]
v_max3_f32 v244, v244, v6, v7
v_max3_f32 v244, v244, v12, v13
v_mfma_f32_16x16x32_bf16 v[208:211], a[32:35], v[76:79], v[208:211]
v_max3_f32 v244, v244, v14, v15
v_max3_f32 v246, v246, v20, v21
v_mfma_f32_16x16x32_bf16 v[212:215], a[36:39], v[76:79], v[212:215]
v_max3_f32 v246, v246, v22, v23
v_max3_f32 v246, v246, v28, v29
v_mfma_f32_16x16x32_bf16 v[216:219], a[40:43], v[76:79], v[216:219]
v_max3_f32 v246, v246, v30, v31
v_add_u32 v250, s27, v252
v_mfma_f32_16x16x32_bf16 v[220:223], a[44:47], v[76:79], v[220:223]
v_add_u32 v251, s26, v252
v_max_f32 v255, v244, v246
v_mfma_f32_16x16x32_bf16 v[224:227], a[48:51], v[76:79], v[224:227]
v_cmp_nge_f32 vcc, s35, v255
v_mfma_f32_16x16x32_bf16 v[228:231], a[52:55], v[76:79], v[228:231]
v_mfma_f32_16x16x32_bf16 v[232:235], a[56:59], v[76:79], v[232:235]
v_mfma_f32_16x16x32_bf16 v[236:239], a[60:63], v[76:79], v[236:239]
v_mfma_f32_16x16x32_bf16 a[172:175], a[176:179], v[76:79], a[172:175]
s_cbranch_vccz S2_loop1
S2_rare11:
v_cmp_lt_f32 vcc, s34, v255
s_nop 4
s_cbranch_vccz S2_rs11
s_nop 7
v_max3_f32 v244, v0, v1, v2
v_max3_f32 v244, v244, v3, v4
v_max3_f32 v244, v244, v5, v6
v_max_f32 v244, v244, v7
v_mov_b32 v248, v244
s_nop 1
v_permlane16_swap_b32 v244, v248
v_max_f32 v244, v244, v248
v_mov_b32 v248, v244
s_nop 1
v_permlane32_swap_b32 v244, v248
v_max_f32 v244, v244, v248
v_ceil_f32 v244, v244
v_max_f32 v244, 0, v244
v_add_f32 v240, v240, v244
v_sub_f32 v244, 0, v244
v_pk_add_f32 v[0:1], v[0:1], v[244:245] op_sel_hi:[1,0]
v_pk_add_f32 v[2:3], v[2:3], v[244:245] op_sel_hi:[1,0]
v_pk_add_f32 v[4:5], v[4:5], v[244:245] op_sel_hi:[1,0]
v_pk_add_f32 v[6:7], v[6:7], v[244:245] op_sel_hi:[1,0]
v_exp_f32 v244, v244
v_sub_f32 v248, 0, v240
v_mov_b32 v80, v248
v_mov_b32 v81, v248
v_mov_b32 v82, v248
v_mov_b32 v83, v248
v_mov_b32 v84, v248
v_mov_b32 v85, v248
v_mov_b32 v86, v248
v_mov_b32 v87, v248
v_accvgpr_read_b32 v248, a160
v_mul_f32 v248, v248, v244
v_accvgpr_write_b32 a160, v248
v_accvgpr_write_b32 a161, v248
v_accvgpr_write_b32 a162, v248
v_accvgpr_write_b32 a163, v248
v_pk_mul_f32 v[112:113], v[112:113], v[244:245] op_sel_hi:[1,0]
v_pk_mul_f32 v[114:115], v[114:115], v[244:245] op_sel_hi:[1,0]
v_pk_mul_f32 v[116:117], v[116:117], v[244:245] op_sel_hi:[1,0]
v_pk_mul_f32 v[118:119], v[118:119], v[244:245] op_sel_hi:[1,0]
v_pk_mul_f32 v[120:121], v[120:121], v[244:245] op_sel_hi:[1,0]
v_pk_mul_f32 v[122:123], v[122:123], v[244:245] op_sel_hi:[1,0]
v_pk_mul_f32 v[124:125], v[124:125], v[244:245] op_sel_hi:[1,0]
v_pk_mul_f32 v[126:127], v[126:127], v[244:245] op_sel_hi:[1,0]
v_pk_mul_f32 v[128:129], v[128:129], v[244:245] op_sel_hi:[1,0]
v_pk_mul_f32 v[130:131], v[130:131], v[244:245] op_sel_hi:[1,0]
v_pk_mul_f32 v[132:133], v[132:133], v[244:245] op_sel_hi:[1,0]
v_pk_mul_f32 v[134:135], v[134:135], v[244:245] op_sel_hi:[1,0]
v_pk_mul_f32 v[136:137], v[136:137], v[244:245] op_sel_hi:[1,0]
v_pk_mul_f32 v[138:139], v[138:139], v[244:245] op_sel_hi:[1,0]
v_pk_mul_f32 v[140:141], v[140:141], v[244:245] op_sel_hi:[1,0]
v_pk_mul_f32 v[142:143], v[142:143], v[244:245] op_sel_hi:[1,0]
v_max3_f32 v244, v8, v9, v10
v_max3_f32 v244, v244, v11, v12
v_max3_f32 v244, v244, v13, v14
v_max_f32 v244, v244, v15
v_mov_b32 v248, v244
s_nop 1
v_permlane16_swap_b32 v244, v248
v_max_f32 v244, v244, v248
v_mov_b32 v248, v244
s_nop 1
v_permlane32_swap_b32 v244, v248
v_max_f32 v244, v244, v248
v_ceil_f32 v244, v244
v_max_f32 v244, 0, v244
v_add_f32 v241, v241, v244
v_sub_f32 v244, 0, v244
v_pk_add_f32 v[8:9], v[8:9], v[244:245] op_sel_hi:[1,0]
v_pk_add_f32 v[10:11], v[10:11], v[244:245] op_sel_hi:[1,0]
v_pk_add_f32 v[12:13], v[12:13], v[244:245] op_sel_hi:[1,0]
v_pk_add_f32 v[14:15], v[14:15], v[244:245] op_sel_hi:[1,0]
v_exp_f32 v244, v244
v_sub_f32 v248, 0, v241
v_mov_b32 v88, v248
v_mov_b32 v89, v248
v_mov_b32 v90, v248
v_mov_b32 v91, v248
v_mov_b32 v92, v248
v_mov_b32 v93, v248
v_mov_b32 v94, v248
v_mov_b32 v95, v248
v_accvgpr_read_b32 v248, a164
v_mul_f32 v248, v248, v244
v_accvgpr_write_b32 a164, v248
v_accvgpr_write_b32 a165, v248
v_accvgpr_write_b32 a166, v248
v_accvgpr_write_b32 a167, v248
v_pk_mul_f32 v[144:145], v[144:145], v[244:245] op_sel_hi:[1,0]
v_pk_mul_f32 v[146:147], v[146:147], v[244:245] op_sel_hi:[1,0]
v_pk_mul_f32 v[148:149], v[148:149], v[244:245] op_sel_hi:[1,0]
v_pk_mul_f32 v[150:151], v[150:151], v[244:245] op_sel_hi:[1,0]
v_pk_mul_f32 v[152:153], v[152:153], v[244:245] op_sel_hi:[1,0]
v_pk_mul_f32 v[154:155], v[154:155], v[244:245] op_sel_hi:[1,0]
v_pk_mul_f32 v[156:157], v[156:157], v[244:245] op_sel_hi:[1,0]
v_pk_mul_f32 v[158:159], v[158:159], v[244:245] op_sel_hi:[1,0]
v_pk_mul_f32 v[160:161], v[160:161], v[244:245] op_sel_hi:[1,0]
v_pk_mul_f32 v[162:163], v[162:163], v[244:245] op_sel_hi:[1,0]
v_pk_mul_f32 v[164:165], v[164:165], v[244:245] op_sel_hi:[1,0]
v_pk_mul_f32 v[166:167], v[166:167], v[244:245] op_sel_hi:[1,0]
v_pk_mul_f32 v[168:169], v[168:169], v[244:245] op_sel_hi:[1,0]
v_pk_mul_f32 v[170:171], v[170:171], v[244:245] op_sel_hi:[1,0]
v_pk_mul_f32 v[172:173], v[172:173], v[244:245] op_sel_hi:[1,0]
v_pk_mul_f32 v[174:175], v[174:175], v[244:245] op_sel_hi:[1,0]
v_max3_f32 v244, v16, v17, v18
v_max3_f32 v244, v244, v19, v20
v_max3_f32 v244, v244, v21, v22
v_max_f32 v244, v244, v23
v_mov_b32 v248, v244
s_nop 1
v_permlane16_swap_b32 v244, v248
v_max_f32 v244, v244, v248
v_mov_b32 v248, v244
s_nop 1
v_permlane32_swap_b32 v244, v248
v_max_f32 v244, v244, v248
v_ceil_f32 v244, v244
v_max_f32 v244, 0, v244
v_add_f32 v242, v242, v244
v_sub_f32 v244, 0, v244
v_pk_add_f32 v[16:17], v[16:17], v[244:245] op_sel_hi:[1,0]
v_pk_add_f32 v[18:19], v[18:19], v[244:245] op_sel_hi:[1,0]
v_pk_add_f32 v[20:21], v[20:21], v[244:245] op_sel_hi:[1,0]
v_pk_add_f32 v[22:23], v[22:23], v[244:245] op_sel_hi:[1,0]
v_exp_f32 v244, v244
v_sub_f32 v248, 0, v242
v_mov_b32 v96, v248
v_mov_b32 v97, v248
v_mov_b32 v98, v248
v_mov_b32 v99, v248
v_mov_b32 v100, v248
v_mov_b32 v101, v248
v_mov_b32 v102, v248
v_mov_b32 v103, v248
v_accvgpr_read_b32 v248, a168
v_mul_f32 v248, v248, v244
v_accvgpr_write_b32 a168, v248
v_accvgpr_write_b32 a169, v248
v_accvgpr_write_b32 a170, v248
v_accvgpr_write_b32 a171, v248
v_pk_mul_f32 v[176:177], v[176:177], v[244:245] op_sel_hi:[1,0]
v_pk_mul_f32 v[178:179], v[178:179], v[244:245] op_sel_hi:[1,0]
v_pk_mul_f32 v[180:181], v[180:181], v[244:245] op_sel_hi:[1,0]
v_pk_mul_f32 v[182:183], v[182:183], v[244:245] op_sel_hi:[1,0]
v_pk_mul_f32 v[184:185], v[184:185], v[244:245] op_sel_hi:[1,0]
v_pk_mul_f32 v[186:187], v[186:187], v[244:245] op_sel_hi:[1,0]
v_pk_mul_f32 v[188:189], v[188:189], v[244:245] op_sel_hi:[1,0]
v_pk_mul_f32 v[190:191], v[190:191], v[244:245] op_sel_hi:[1,0]
v_pk_mul_f32 v[192:193], v[192:193], v[244:245] op_sel_hi:[1,0]
v_pk_mul_f32 v[194:195], v[194:195], v[244:245] op_sel_hi:[1,0]
v_pk_mul_f32 v[196:197], v[196:197], v[244:245] op_sel_hi:[1,0]
v_pk_mul_f32 v[198:199], v[198:199], v[244:245] op_sel_hi:[1,0]
v_pk_mul_f32 v[200:201], v[200:201], v[244:245] op_sel_hi:[1,0]
v_pk_mul_f32 v[202:203], v[202:203], v[244:245] op_sel_hi:[1,0]
v_pk_mul_f32 v[204:205], v[204:205], v[244:245] op_sel_hi:[1,0]
v_pk_mul_f32 v[206:207], v[206:207], v[244:245] op_sel_hi:[1,0]
v_max3_f32 v244, v24, v25, v26
v_max3_f32 v244, v244, v27, v28
v_max3_f32 v244, v244, v29, v30
v_max_f32 v244, v244, v31
v_mov_b32 v248, v244
s_nop 1
v_permlane16_swap_b32 v244, v248
v_max_f32 v244, v244, v248
v_mov_b32 v248, v244
s_nop 1
v_permlane32_swap_b32 v244, v248
v_max_f32 v244, v244, v248
v_ceil_f32 v244, v244
v_max_f32 v244, 0, v244
v_add_f32 v243, v243, v244
v_sub_f32 v244, 0, v244
v_pk_add_f32 v[24:25], v[24:25], v[244:245] op_sel_hi:[1,0]
v_pk_add_f32 v[26:27], v[26:27], v[244:245] op_sel_hi:[1,0]
v_pk_add_f32 v[28:29], v[28:29], v[244:245] op_sel_hi:[1,0]
v_pk_add_f32 v[30:31], v[30:31], v[244:245] op_sel_hi:[1,0]
v_exp_f32 v244, v244
v_sub_f32 v248, 0, v243
v_mov_b32 v104, v248
v_mov_b32 v105, v248
v_mov_b32 v106, v248
v_mov_b32 v107, v248
v_mov_b32 v108, v248
v_mov_b32 v109, v248
v_mov_b32 v110, v248
v_mov_b32 v111, v248
v_accvgpr_read_b32 v248, a172
v_mul_f32 v248, v248, v244
v_accvgpr_write_b32 a172, v248
v_accvgpr_write_b32 a173, v248
v_accvgpr_write_b32 a174, v248
v_accvgpr_write_b32 a175, v248
v_pk_mul_f32 v[208:209], v[208:209], v[244:245] op_sel_hi:[1,0]
v_pk_mul_f32 v[210:211], v[210:211], v[244:245] op_sel_hi:[1,0]
v_pk_mul_f32 v[212:213], v[212:213], v[244:245] op_sel_hi:[1,0]
v_pk_mul_f32 v[214:215], v[214:215], v[244:245] op_sel_hi:[1,0]
v_pk_mul_f32 v[216:217], v[216:217], v[244:245] op_sel_hi:[1,0]
v_pk_mul_f32 v[218:219], v[218:219], v[244:245] op_sel_hi:[1,0]
v_pk_mul_f32 v[220:221], v[220:221], v[244:245] op_sel_hi:[1,0]
v_pk_mul_f32 v[222:223], v[222:223], v[244:245] op_sel_hi:[1,0]
v_pk_mul_f32 v[224:225], v[224:225], v[244:245] op_sel_hi:[1,0]
v_pk_mul_f32 v[226:227], v[226:227], v[244:245] op_sel_hi:[1,0]
v_pk_mul_f32 v[228:229], v[228:229], v[244:245] op_sel_hi:[1,0]
v_pk_mul_f32 v[230:231], v[230:231], v[244:245] op_sel_hi:[1,0]
v_pk_mul_f32 v[232:233], v[232:233], v[244:245] op_sel_hi:[1,0]
v_pk_mul_f32 v[234:235], v[234:235], v[244:245] op_sel_hi:[1,0]
v_pk_mul_f32 v[236:237], v[236:237], v[244:245] op_sel_hi:[1,0]
v_pk_mul_f32 v[238:239], v[238:239], v[244:245] op_sel_hi:[1,0]
s_nop 1
S2_rs11:
s_cmp_le_u32 s33, 5
s_cbranch_scc0 S2_loop1
S2_h1b:
s_cmp_eq_u32 s33, 0
s_cbranch_scc1 S2_trans
s_sub_u32 s37, 5, s33
s_sub_u32 s37, s37, s20
s_cmp_lt_i32 s37, 0
s_cbranch_scc1 Lme_7006
s_cmp_eq_i32 s37, 0
s_cbranch_scc1 Lmd_7005
v_mov_b32 v96, v254
v_mov_b32 v97, v254
v_mov_b32 v98, v254
v_mov_b32 v99, v254
v_mov_b32 v100, v254
v_mov_b32 v101, v254
v_mov_b32 v102, v254
v_mov_b32 v103, v254
v_mov_b32 v104, v254
v_mov_b32 v105, v254
v_mov_b32 v106, v254
v_mov_b32 v107, v254
v_mov_b32 v108, v254
v_mov_b32 v109, v254
v_mov_b32 v110, v254
v_mov_b32 v111, v254
s_branch Lme_7006
Lmd_7005:
v_cndmask_b32 v96, v96, v254, s[64:65]
v_mov_b32 v100, v254
v_cndmask_b32 v108, v108, v254, s[64:65]
v_cndmask_b32 v97, v97, v254, s[66:67]
v_mov_b32 v101, v254
v_cndmask_b32 v109, v109, v254, s[66:67]
v_cndmask_b32 v98, v98, v254, s[68:69]
v_mov_b32 v102, v254
v_cndmask_b32 v110, v110, v254, s[68:69]
v_cndmask_b32 v99, v99, v254, s[70:71]
v_mov_b32 v103, v254
v_cndmask_b32 v111, v111, v254, s[70:71]
Lme_7006:
s_cmp_eq_u32 s33, 2
s_cbranch_scc0 S2_loop1
v_add_u32 v250, s24, v250
s_branch S2_loop1
S2_rare10:
v_cmp_lt_f32 vcc, s34, v255
s_nop 4
s_cbranch_vccz S2_rs10
s_nop 7
v_max3_f32 v244, v32, v33, v34
v_max3_f32 v244, v244, v35, v36
v_max3_f32 v244, v244, v37, v38
v_max_f32 v244, v244, v39
v_mov_b32 v248, v244
s_nop 1
v_permlane16_swap_b32 v244, v248
v_max_f32 v244, v244, v248
v_mov_b32 v248, v244
s_nop 1
v_permlane32_swap_b32 v244, v248
v_max_f32 v244, v244, v248
v_ceil_f32 v244, v244
v_max_f32 v244, 0, v244
v_add_f32 v240, v240, v244
v_sub_f32 v244, 0, v244
v_pk_add_f32 v[32:33], v[32:33], v[244:245] op_sel_hi:[1,0]
v_pk_add_f32 v[34:35], v[34:35], v[244:245] op_sel_hi:[1,0]
v_pk_add_f32 v[36:37], v[36:37], v[244:245] op_sel_hi:[1,0]
v_pk_add_f32 v[38:39], v[38:39], v[244:245] op_sel_hi:[1,0]
v_exp_f32 v244, v244
v_sub_f32 v248, 0, v240
v_mov_b32 v80, v248
v_mov_b32 v81, v248
v_mov_b32 v82, v248
v_mov_b32 v83, v248
v_mov_b32 v84, v248
v_mov_b32 v85, v248
v_mov_b32 v86, v248
v_mov_b32 v87, v248
v_accvgpr_read_b32 v248, a160
v_mul_f32 v248, v248, v244
v_accvgpr_write_b32 a160, v248
v_accvgpr_write_b32 a161, v248
v_accvgpr_write_b32 a162, v248
v_accvgpr_write_b32 a163, v248
v_pk_mul_f32 v[112:113], v[112:113], v[244:245] op_sel_hi:[1,0]
v_pk_mul_f32 v[114:115], v[114:115], v[244:245] op_sel_hi:[1,0]
v_pk_mul_f32 v[116:117], v[116:117], v[244:245] op_sel_hi:[1,0]
v_pk_mul_f32 v[118:119], v[118:119], v[244:245] op_sel_hi:[1,0]
v_pk_mul_f32 v[120:121], v[120:121], v[244:245] op_sel_hi:[1,0]
v_pk_mul_f32 v[122:123], v[122:123], v[244:245] op_sel_hi:[1,0]
v_pk_mul_f32 v[124:125], v[124:125], v[244:245] op_sel_hi:[1,0]
v_pk_mul_f32 v[126:127], v[126:127], v[244:245] op_sel_hi:[1,0]
v_pk_mul_f32 v[128:129], v[128:129], v[244:245] op_sel_hi:[1,0]
v_pk_mul_f32 v[130:131], v[130:131], v[244:245] op_sel_hi:[1,0]
v_pk_mul_f32 v[132:133], v[132:133], v[244:245] op_sel_hi:[1,0]
v_pk_mul_f32 v[134:135], v[134:135], v[244:245] op_sel_hi:[1,0]
v_pk_mul_f32 v[136:137], v[136:137], v[244:245] op_sel_hi:[1,0]
v_pk_mul_f32 v[138:139], v[138:139], v[244:245] op_sel_hi:[1,0]
v_pk_mul_f32 v[140:141], v[140:141], v[244:245] op_sel_hi:[1,0]
v_pk_mul_f32 v[142:143], v[142:143], v[244:245] op_sel_hi:[1,0]
v_max3_f32 v244, v40, v41, v42
v_max3_f32 v244, v244, v43, v44
v_max3_f32 v244, v244, v45, v46
v_max_f32 v244, v244, v47
v_mov_b32 v248, v244
s_nop 1
v_permlane16_swap_b32 v244, v248
v_max_f32 v244, v244, v248
v_mov_b32 v248, v244
s_nop 1
v_permlane32_swap_b32 v244, v248
v_max_f32 v244, v244, v248
v_ceil_f32 v244, v244
v_max_f32 v244, 0, v244
v_add_f32 v241, v241, v244
v_sub_f32 v244, 0, v244
v_pk_add_f32 v[40:41], v[40:41], v[244:245] op_sel_hi:[1,0]
v_pk_add_f32 v[42:43], v[42:43], v[244:245] op_sel_hi:[1,0]
v_pk_add_f32 v[44:45], v[44:45], v[244:245] op_sel_hi:[1,0]
v_pk_add_f32 v[46:47], v[46:47], v[244:245] op_sel_hi:[1,0]
v_exp_f32 v244, v244
v_sub_f32 v248, 0, v241
v_mov_b32 v88, v248
v_mov_b32 v89, v248
v_mov_b32 v90, v248
v_mov_b32 v91, v248
v_mov_b32 v92, v248
v_mov_b32 v93, v248
v_mov_b32 v94, v248
v_mov_b32 v95, v248
v_accvgpr_read_b32 v248, a164
v_mul_f32 v248, v248, v244
v_accvgpr_write_b32 a164, v248
v_accvgpr_write_b32 a165, v248
v_accvgpr_write_b32 a166, v248
v_accvgpr_write_b32 a167, v248
v_pk_mul_f32 v[144:145], v[144:145], v[244:245] op_sel_hi:[1,0]
v_pk_mul_f32 v[146:147], v[146:147], v[244:245] op_sel_hi:[1,0]
v_pk_mul_f32 v[148:149], v[148:149], v[244:245] op_sel_hi:[1,0]
v_pk_mul_f32 v[150:151], v[150:151], v[244:245] op_sel_hi:[1,0]
v_pk_mul_f32 v[152:153], v[152:153], v[244:245] op_sel_hi:[1,0]
v_pk_mul_f32 v[154:155], v[154:155], v[244:245] op_sel_hi:[1,0]
v_pk_mul_f32 v[156:157], v[156:157], v[244:245] op_sel_hi:[1,0]
v_pk_mul_f32 v[158:159], v[158:159], v[244:245] op_sel_hi:[1,0]
v_pk_mul_f32 v[160:161], v[160:161], v[244:245] op_sel_hi:[1,0]
v_pk_mul_f32 v[162:163], v[162:163], v[244:245] op_sel_hi:[1,0]
v_pk_mul_f32 v[164:165], v[164:165], v[244:245] op_sel_hi:[1,0]
v_pk_mul_f32 v[166:167], v[166:167], v[244:245] op_sel_hi:[1,0]
v_pk_mul_f32 v[168:169], v[168:169], v[244:245] op_sel_hi:[1,0]
v_pk_mul_f32 v[170:171], v[170:171], v[244:245] op_sel_hi:[1,0]
v_pk_mul_f32 v[172:173], v[172:173], v[244:245] op_sel_hi:[1,0]
v_pk_mul_f32 v[174:175], v[174:175], v[244:245] op_sel_hi:[1,0]
v_max3_f32 v244, v48, v49, v50
v_max3_f32 v244, v244, v51, v52
v_max3_f32 v244, v244, v53, v54
v_max_f32 v244, v244, v55
v_mov_b32 v248, v244
s_nop 1
v_permlane16_swap_b32 v244, v248
v_max_f32 v244, v244, v248
v_mov_b32 v248, v244
s_nop 1
v_permlane32_swap_b32 v244, v248
v_max_f32 v244, v244, v248
v_ceil_f32 v244, v244
v_max_f32 v244, 0, v244
v_add_f32 v242, v242, v244
v_sub_f32 v244, 0, v244
v_pk_add_f32 v[48:49], v[48:49], v[244:245] op_sel_hi:[1,0]
v_pk_add_f32 v[50:51], v[50:51], v[244:245] op_sel_hi:[1,0]
v_pk_add_f32 v[52:53], v[52:53], v[244:245] op_sel_hi:[1,0]
v_pk_add_f32 v[54:55], v[54:55], v[244:245] op_sel_hi:[1,0]
v_exp_f32 v244, v244
v_sub_f32 v248, 0, v242
v_mov_b32 v96, v248
v_mov_b32 v97, v248
v_mov_b32 v98, v248
v_mov_b32 v99, v248
v_mov_b32 v100, v248
v_mov_b32 v101, v248
v_mov_b32 v102, v248
v_mov_b32 v103, v248
v_accvgpr_read_b32 v248, a168
v_mul_f32 v248, v248, v244
v_accvgpr_write_b32 a168, v248
v_accvgpr_write_b32 a169, v248
v_accvgpr_write_b32 a170, v248
v_accvgpr_write_b32 a171, v248
v_pk_mul_f32 v[176:177], v[176:177], v[244:245] op_sel_hi:[1,0]
v_pk_mul_f32 v[178:179], v[178:179], v[244:245] op_sel_hi:[1,0]
v_pk_mul_f32 v[180:181], v[180:181], v[244:245] op_sel_hi:[1,0]
v_pk_mul_f32 v[182:183], v[182:183], v[244:245] op_sel_hi:[1,0]
v_pk_mul_f32 v[184:185], v[184:185], v[244:245] op_sel_hi:[1,0]
v_pk_mul_f32 v[186:187], v[186:187], v[244:245] op_sel_hi:[1,0]
v_pk_mul_f32 v[188:189], v[188:189], v[244:245] op_sel_hi:[1,0]
v_pk_mul_f32 v[190:191], v[190:191], v[244:245] op_sel_hi:[1,0]
v_pk_mul_f32 v[192:193], v[192:193], v[244:245] op_sel_hi:[1,0]
v_pk_mul_f32 v[194:195], v[194:195], v[244:245] op_sel_hi:[1,0]
v_pk_mul_f32 v[196:197], v[196:197], v[244:245] op_sel_hi:[1,0]
v_pk_mul_f32 v[198:199], v[198:199], v[244:245] op_sel_hi:[1,0]
v_pk_mul_f32 v[200:201], v[200:201], v[244:245] op_sel_hi:[1,0]
v_pk_mul_f32 v[202:203], v[202:203], v[244:245] op_sel_hi:[1,0]
v_pk_mul_f32 v[204:205], v[204:205], v[244:245] op_sel_hi:[1,0]
v_pk_mul_f32 v[206:207], v[206:207], v[244:245] op_sel_hi:[1,0]
v_max3_f32 v244, v56, v57, v58
v_max3_f32 v244, v244, v59, v60
v_max3_f32 v244, v244, v61, v62
v_max_f32 v244, v244, v63
v_mov_b32 v248, v244
s_nop 1
v_permlane16_swap_b32 v244, v248
v_max_f32 v244, v244, v248
v_mov_b32 v248, v244
s_nop 1
v_permlane32_swap_b32 v244, v248
v_max_f32 v244, v244, v248
v_ceil_f32 v244, v244
v_max_f32 v244, 0, v244
v_add_f32 v243, v243, v244
v_sub_f32 v244, 0, v244
v_pk_add_f32 v[56:57], v[56:57], v[244:245] op_sel_hi:[1,0]
v_pk_add_f32 v[58:59], v[58:59], v[244:245] op_sel_hi:[1,0]
v_pk_add_f32 v[60:61], v[60:61], v[244:245] op_sel_hi:[1,0]
v_pk_add_f32 v[62:63], v[62:63], v[244:245] op_sel_hi:[1,0]
v_exp_f32 v244, v244
v_sub_f32 v248, 0, v243
v_mov_b32 v104, v248
v_mov_b32 v105, v248
v_mov_b32 v106, v248
v_mov_b32 v107, v248
v_mov_b32 v108, v248
v_mov_b32 v109, v248
v_mov_b32 v110, v248
v_mov_b32 v111, v248
v_accvgpr_read_b32 v248, a172
v_mul_f32 v248, v248, v244
v_accvgpr_write_b32 a172, v248
v_accvgpr_write_b32 a173, v248
v_accvgpr_write_b32 a174, v248
v_accvgpr_write_b32 a175, v248
v_pk_mul_f32 v[208:209], v[208:209], v[244:245] op_sel_hi:[1,0]
v_pk_mul_f32 v[210:211], v[210:211], v[244:245] op_sel_hi:[1,0]
v_pk_mul_f32 v[212:213], v[212:213], v[244:245] op_sel_hi:[1,0]
v_pk_mul_f32 v[214:215], v[214:215], v[244:245] op_sel_hi:[1,0]
v_pk_mul_f32 v[216:217], v[216:217], v[244:245] op_sel_hi:[1,0]
v_pk_mul_f32 v[218:219], v[218:219], v[244:245] op_sel_hi:[1,0]
v_pk_mul_f32 v[220:221], v[220:221], v[244:245] op_sel_hi:[1,0]
v_pk_mul_f32 v[222:223], v[222:223], v[244:245] op_sel_hi:[1,0]
v_pk_mul_f32 v[224:225], v[224:225], v[244:245] op_sel_hi:[1,0]
v_pk_mul_f32 v[226:227], v[226:227], v[244:245] op_sel_hi:[1,0]
v_pk_mul_f32 v[228:229], v[228:229], v[244:245] op_sel_hi:[1,0]
v_pk_mul_f32 v[230:231], v[230:231], v[244:245] op_sel_hi:[1,0]
v_pk_mul_f32 v[232:233], v[232:233], v[244:245] op_sel_hi:[1,0]
v_pk_mul_f32 v[234:235], v[234:235], v[244:245] op_sel_hi:[1,0]
v_pk_mul_f32 v[236:237], v[236:237], v[244:245] op_sel_hi:[1,0]
v_pk_mul_f32 v[238:239], v[238:239], v[244:245] op_sel_hi:[1,0]
s_nop 1
S2_rs10:
s_cmp_le_u32 s33, 5
s_cbranch_scc0 S2_c1a
s_cmp_eq_u32 s33, 1
s_cbranch_scc1 S2_swap
s_sub_u32 s37, 5, s33
s_sub_u32 s37, s37, s20
s_cmp_lt_i32 s37, 0
s_cbranch_scc1 Lme_7008
s_cmp_eq_i32 s37, 0
s_cbranch_scc1 Lmd_7007
v_mov_b32 v96, v254
v_mov_b32 v97, v254
v_mov_b32 v98, v254
v_mov_b32 v99, v254
v_mov_b32 v100, v254
v_mov_b32 v101, v254
v_mov_b32 v102, v254
v_mov_b32 v103, v254
v_mov_b32 v104, v254
v_mov_b32 v105, v254
v_mov_b32 v106, v254
v_mov_b32 v107, v254
v_mov_b32 v108, v254
v_mov_b32 v109, v254
v_mov_b32 v110, v254
v_mov_b32 v111, v254
s_branch Lme_7008
Lmd_7007:
v_cndmask_b32 v96, v96, v254, s[64:65]
v_mov_b32 v100, v254
v_cndmask_b32 v108, v108, v254, s[64:65]
v_cndmask_b32 v97, v97, v254, s[66:67]
v_mov_b32 v101, v254
v_cndmask_b32 v109, v109, v254, s[66:67]
v_cndmask_b32 v98, v98, v254, s[68:69]
v_mov_b32 v102, v254
v_cndmask_b32 v110, v110, v254, s[68:69]
v_cndmask_b32 v99, v99, v254, s[70:71]
v_mov_b32 v103, v254
v_cndmask_b32 v111, v111, v254, s[70:71]
Lme_7008:
s_branch S2_c1a
S2_swap:
v_accvgpr_mov_b32 a96, a128
v_accvgpr_mov_b32 a97, a129
v_accvgpr_mov_b32 a98, a130
v_accvgpr_mov_b32 a99, a131
v_accvgpr_mov_b32 a100, a132
v_accvgpr_mov_b32 a101, a133
v_accvgpr_mov_b32 a102, a134
v_accvgpr_mov_b32 a103, a135
v_accvgpr_mov_b32 a104, a136
v_accvgpr_mov_b32 a105, a137
v_accvgpr_mov_b32 a106, a138
v_accvgpr_mov_b32 a107, a139
v_accvgpr_mov_b32 a108, a140
v_accvgpr_mov_b32 a109, a141
v_accvgpr_mov_b32 a110, a142
v_accvgpr_mov_b32 a111, a143
v_accvgpr_mov_b32 a112, a144
v_accvgpr_mov_b32 a113, a145
v_accvgpr_mov_b32 a114, a146
v_accvgpr_mov_b32 a115, a147
v_accvgpr_mov_b32 a116, a148
v_accvgpr_mov_b32 a117, a149
v_accvgpr_mov_b32 a118, a150
v_accvgpr_mov_b32 a119, a151
v_accvgpr_mov_b32 a120, a152
v_accvgpr_mov_b32 a121, a153
v_accvgpr_mov_b32 a122, a154
v_accvgpr_mov_b32 a123, a155
v_accvgpr_mov_b32 a124, a156
v_accvgpr_mov_b32 a125, a157
v_accvgpr_mov_b32 a126, a158
v_accvgpr_mov_b32 a127, a159
v_mov_b32 v96, 0
v_mov_b32 v97, 0
v_mov_b32 v98, 0
v_mov_b32 v99, 0
v_mov_b32 v100, 0
v_mov_b32 v101, 0
v_mov_b32 v102, 0
v_mov_b32 v103, 0
v_mov_b32 v104, 0
v_mov_b32 v105, 0
v_mov_b32 v106, 0
v_mov_b32 v107, 0
v_mov_b32 v108, 0
v_mov_b32 v109, 0
v_mov_b32 v110, 0
v_mov_b32 v111, 0
s_mov_b32 s34, 0x7f800000
s_cmp_eq_u32 s22, 7
s_cbranch_scc0 S2_c1a
s_and_b32 s39, s20, 1
s_add_u32 s39, s39, 0
s_sub_u32 s37, s39, s20
s_cmp_lt_i32 s37, 0
s_cbranch_scc1 Lme_7010
s_cmp_eq_i32 s37, 0
s_cbranch_scc1 Lmd_7009
v_mov_b32 v80, v254
v_mov_b32 v81, v254
v_mov_b32 v82, v254
v_mov_b32 v83, v254
v_mov_b32 v84, v254
v_mov_b32 v85, v254
v_mov_b32 v86, v254
v_mov_b32 v87, v254
v_mov_b32 v88, v254
v_mov_b32 v89, v254
v_mov_b32 v90, v254
v_mov_b32 v91, v254
v_mov_b32 v92, v254
v_mov_b32 v93, v254
v_mov_b32 v94, v254
v_mov_b32 v95, v254
s_branch Lme_7010
Lmd_7009:
v_cndmask_b32 v80, v80, v254, s[64:65]
v_mov_b32 v84, v254
v_cndmask_b32 v92, v92, v254, s[64:65]
v_cndmask_b32 v81, v81, v254, s[66:67]
v_mov_b32 v85, v254
v_cndmask_b32 v93, v93, v254, s[66:67]
v_cndmask_b32 v82, v82, v254, s[68:69]
v_mov_b32 v86, v254
v_cndmask_b32 v94, v94, v254, s[68:69]
v_cndmask_b32 v83, v83, v254, s[70:71]
v_mov_b32 v87, v254
v_cndmask_b32 v95, v95, v254, s[70:71]
Lme_7010:
s_xor_b32 s37, s20, 1
s_sub_u32 s37, s39, s37
s_cmp_lt_i32 s37, 0
s_cbranch_scc1 Lme_7012
s_cmp_eq_i32 s37, 0
s_cbranch_scc1 Lmd_7011
v_mov_b32 v96, v254
v_mov_b32 v97, v254
v_mov_b32 v98, v254
v_mov_b32 v99, v254
v_mov_b32 v100, v254
v_mov_b32 v101, v254
v_mov_b32 v102, v254
v_mov_b32 v103, v254
v_mov_b32 v104, v254
v_mov_b32 v105, v254
v_mov_b32 v106, v254
v_mov_b32 v107, v254
v_mov_b32 v108, v254
v_mov_b32 v109, v254
v_mov_b32 v110, v254
v_mov_b32 v111, v254
s_branch Lme_7012
Lmd_7011:
v_cndmask_b32 v96, v96, v254, s[64:65]
v_mov_b32 v100, v254
v_cndmask_b32 v108, v108, v254, s[64:65]
v_cndmask_b32 v97, v97, v254, s[66:67]
v_mov_b32 v101, v254
v_cndmask_b32 v109, v109, v254, s[66:67]
v_cndmask_b32 v98, v98, v254, s[68:69]
v_mov_b32 v102, v254
v_cndmask_b32 v110, v110, v254, s[68:69]
v_cndmask_b32 v99, v99, v254, s[70:71]
v_mov_b32 v103, v254
v_cndmask_b32 v111, v111, v254, s[70:71]
Lme_7012:
s_branch S2_c1a
S2_trans:
s_lshl_b32 s37, s22, 2
s_add_u32 s37, s37, s20
s_lshl_b32 s37, s37, 18
s_lshl_b32 s38, s21, 12
s_add_u32 s37, s37, s38
s_add_u32 s37, s37, 0x2000000
s_add_u32 s38, s37, 0x20000
s_nop 3
v_accvgpr_read_b32 v248, a168
s_nop 0
v_rcp_f32 v248, v248
s_nop 0
v_pk_mul_f32 v[176:177], v[176:177], v[248:249] op_sel_hi:[1,0]
v_pk_mul_f32 v[178:179], v[178:179], v[248:249] op_sel_hi:[1,0]
v_pk_mul_f32 v[180:181], v[180:181], v[248:249] op_sel_hi:[1,0]
v_pk_mul_f32 v[182:183], v[182:183], v[248:249] op_sel_hi:[1,0]
v_cvt_pk_bf16_f32 v32, v176, v177
v_cvt_pk_bf16_f32 v33, v178, v179
v_cvt_pk_bf16_f32 v34, v180, v181
v_cvt_pk_bf16_f32 v35, v182, v183
buffer_store_dwordx4 v[32:35], v252, s[4:7], s37 offen offset:0 sc1
v_pk_mul_f32 v[184:185], v[184:185], v[248:249] op_sel_hi:[1,0]
v_pk_mul_f32 v[186:187], v[186:187], v[248:249] op_sel_hi:[1,0]
v_pk_mul_f32 v[188:189], v[188:189], v[248:249] op_sel_hi:[1,0]
v_pk_mul_f32 v[190:191], v[190:191], v[248:249] op_sel_hi:[1,0]
v_cvt_pk_bf16_f32 v36, v184, v185
v_cvt_pk_bf16_f32 v37, v186, v187
v_cvt_pk_bf16_f32 v38, v188, v189
v_cvt_pk_bf16_f32 v39, v190, v191
buffer_store_dwordx4 v[36:39], v252, s[4:7], s37 offen offset:1024 sc1
v_pk_mul_f32 v[192:193], v[192:193], v[248:249] op_sel_hi:[1,0]
v_pk_mul_f32 v[194:195], v[194:195], v[248:249] op_sel_hi:[1,0]
v_pk_mul_f32 v[196:197], v[196:197], v[248:249] op_sel_hi:[1,0]
v_pk_mul_f32 v[198:199], v[198:199], v[248:249] op_sel_hi:[1,0]
v_cvt_pk_bf16_f32 v40, v192, v193
v_cvt_pk_bf16_f32 v41, v194, v195
v_cvt_pk_bf16_f32 v42, v196, v197
v_cvt_pk_bf16_f32 v43, v198, v199
buffer_store_dwordx4 v[40:43], v252, s[4:7], s37 offen offset:2048 sc1
v_pk_mul_f32 v[200:201], v[200:201], v[248:249] op_sel_hi:[1,0]
v_pk_mul_f32 v[202:203], v[202:203], v[248:249] op_sel_hi:[1,0]
v_pk_mul_f32 v[204:205], v[204:205], v[248:249] op_sel_hi:[1,0]
v_pk_mul_f32 v[206:207], v[206:207], v[248:249] op_sel_hi:[1,0]
v_cvt_pk_bf16_f32 v44, v200, v201
v_cvt_pk_bf16_f32 v45, v202, v203
v_cvt_pk_bf16_f32 v46, v204, v205
v_cvt_pk_bf16_f32 v47, v206, v207
buffer_store_dwordx4 v[44:47], v252, s[4:7], s37 offen offset:3072 sc1
v_accvgpr_read_b32 v248, a172
s_nop 0
v_rcp_f32 v248, v248
s_nop 0
v_pk_mul_f32 v[208:209], v[208:209], v[248:249] op_sel_hi:[1,0]
v_pk_mul_f32 v[210:211], v[210:211], v[248:249] op_sel_hi:[1,0]
v_pk_mul_f32 v[212:213], v[212:213], v[248:249] op_sel_hi:[1,0]
v_pk_mul_f32 v[214:215], v[214:215], v[248:249] op_sel_hi:[1,0]
v_cvt_pk_bf16_f32 v48, v208, v209
v_cvt_pk_bf16_f32 v49, v210, v211
v_cvt_pk_bf16_f32 v50, v212, v213
v_cvt_pk_bf16_f32 v51, v214, v215
buffer_store_dwordx4 v[48:51], v252, s[4:7], s38 offen offset:0 sc1
v_pk_mul_f32 v[216:217], v[216:217], v[248:249] op_sel_hi:[1,0]
v_pk_mul_f32 v[218:219], v[218:219], v[248:249] op_sel_hi:[1,0]
v_pk_mul_f32 v[220:221], v[220:221], v[248:249] op_sel_hi:[1,0]
v_pk_mul_f32 v[222:223], v[222:223], v[248:249] op_sel_hi:[1,0]
v_cvt_pk_bf16_f32 v52, v216, v217
v_cvt_pk_bf16_f32 v53, v218, v219
v_cvt_pk_bf16_f32 v54, v220, v221
v_cvt_pk_bf16_f32 v55, v222, v223
buffer_store_dwordx4 v[52:55], v252, s[4:7], s38 offen offset:1024 sc1
v_pk_mul_f32 v[224:225], v[224:225], v[248:249] op_sel_hi:[1,0]
v_pk_mul_f32 v[226:227], v[226:227], v[248:249] op_sel_hi:[1,0]
v_pk_mul_f32 v[228:229], v[228:229], v[248:249] op_sel_hi:[1,0]
v_pk_mul_f32 v[230:231], v[230:231], v[248:249] op_sel_hi:[1,0]
v_cvt_pk_bf16_f32 v56, v224, v225
v_cvt_pk_bf16_f32 v57, v226, v227
v_cvt_pk_bf16_f32 v58, v228, v229
v_cvt_pk_bf16_f32 v59, v230, v231
buffer_store_dwordx4 v[56:59], v252, s[4:7], s38 offen offset:2048 sc1
v_pk_mul_f32 v[232:233], v[232:233], v[248:249] op_sel_hi:[1,0]
v_pk_mul_f32 v[234:235], v[234:235], v[248:249] op_sel_hi:[1,0]
v_pk_mul_f32 v[236:237], v[236:237], v[248:249] op_sel_hi:[1,0]
v_pk_mul_f32 v[238:239], v[238:239], v[248:249] op_sel_hi:[1,0]
v_cvt_pk_bf16_f32 v60, v232, v233
v_cvt_pk_bf16_f32 v61, v234, v235
v_cvt_pk_bf16_f32 v62, v236, v237
v_cvt_pk_bf16_f32 v63, v238, v239
buffer_store_dwordx4 v[60:63], v252, s[4:7], s38 offen offset:3072 sc1
v_max3_f32 v246, v16, v17, v18
v_max3_f32 v246, v246, v19, v20
v_max3_f32 v246, v246, v21, v22
v_max_f32 v246, v246, v23
v_mov_b32 v248, v246
s_nop 1
v_permlane16_swap_b32 v246, v248
v_max_f32 v246, v246, v248
v_mov_b32 v248, v246
s_nop 1
v_permlane32_swap_b32 v246, v248
v_max_f32 v246, v246, v248
v_max_f32 v246, 0xf149f2ca, v246
v_ceil_f32 v242, v246
v_sub_f32 v246, 0, v242
v_pk_add_f32 v[16:17], v[16:17], v[246:247] op_sel_hi:[1,0]
v_pk_add_f32 v[18:19], v[18:19], v[246:247] op_sel_hi:[1,0]
v_pk_add_f32 v[20:21], v[20:21], v[246:247] op_sel_hi:[1,0]
v_pk_add_f32 v[22:23], v[22:23], v[246:247] op_sel_hi:[1,0]
v_mov_b32 v96, v246
v_mov_b32 v97, v246
v_mov_b32 v98, v246
v_mov_b32 v99, v246
v_mov_b32 v100, v246
v_mov_b32 v101, v246
v_mov_b32 v102, v246
v_mov_b32 v103, v246
v_max3_f32 v246, v24, v25, v26
v_max3_f32 v246, v246, v27, v28
v_max3_f32 v246, v246, v29, v30
v_max_f32 v246, v246, v31
v_mov_b32 v248, v246
s_nop 1
v_permlane16_swap_b32 v246, v248
v_max_f32 v246, v246, v248
v_mov_b32 v248, v246
s_nop 1
v_permlane32_swap_b32 v246, v248
v_max_f32 v246, v246, v248
v_max_f32 v246, 0xf149f2ca, v246
v_ceil_f32 v243, v246
v_sub_f32 v246, 0, v243
v_pk_add_f32 v[24:25], v[24:25], v[246:247] op_sel_hi:[1,0]
v_pk_add_f32 v[26:27], v[26:27], v[246:247] op_sel_hi:[1,0]
v_pk_add_f32 v[28:29], v[28:29], v[246:247] op_sel_hi:[1,0]
v_pk_add_f32 v[30:31], v[30:31], v[246:247] op_sel_hi:[1,0]
v_mov_b32 v104, v246
v_mov_b32 v105, v246
v_mov_b32 v106, v246
v_mov_b32 v107, v246
v_mov_b32 v108, v246
v_mov_b32 v109, v246
v_mov_b32 v110, v246
v_mov_b32 v111, v246
s_mov_b32 s34, 0x42800000
v_cmp_lt_f32 vcc, s34, v244
s_add_u32 s37, s26, s24
v_add_u32 v250, s37, v252
v_mov_b32 v251, v250
s_lshl_b32 s33, s22, 2
s_sub_u32 s33, 30, s33
s_cbranch_vccz S2_t1
s_nop 7
v_max3_f32 v244, v0, v1, v2
v_max3_f32 v244, v244, v3, v4
v_max3_f32 v244, v244, v5, v6
v_max_f32 v244, v244, v7
v_mov_b32 v248, v244
s_nop 1
v_permlane16_swap_b32 v244, v248
v_max_f32 v244, v244, v248
v_mov_b32 v248, v244
s_nop 1
v_permlane32_swap_b32 v244, v248
v_max_f32 v244, v244, v248
v_ceil_f32 v244, v244
v_max_f32 v244, 0, v244
v_add_f32 v240, v240, v244
v_sub_f32 v244, 0, v244
v_pk_add_f32 v[0:1], v[0:1], v[244:245] op_sel_hi:[1,0]
v_pk_add_f32 v[2:3], v[2:3], v[244:245] op_sel_hi:[1,0]
v_pk_add_f32 v[4:5], v[4:5], v[244:245] op_sel_hi:[1,0]
v_pk_add_f32 v[6:7], v[6:7], v[244:245] op_sel_hi:[1,0]
v_exp_f32 v244, v244
v_sub_f32 v248, 0, v240
v_mov_b32 v80, v248
v_mov_b32 v81, v248
v_mov_b32 v82, v248
v_mov_b32 v83, v248
v_mov_b32 v84, v248
v_mov_b32 v85, v248
v_mov_b32 v86, v248
v_mov_b32 v87, v248
v_accvgpr_read_b32 v248, a160
v_mul_f32 v248, v248, v244
v_accvgpr_write_b32 a160, v248
v_accvgpr_write_b32 a161, v248
v_accvgpr_write_b32 a162, v248
v_accvgpr_write_b32 a163, v248
v_pk_mul_f32 v[112:113], v[112:113], v[244:245] op_sel_hi:[1,0]
v_pk_mul_f32 v[114:115], v[114:115], v[244:245] op_sel_hi:[1,0]
v_pk_mul_f32 v[116:117], v[116:117], v[244:245] op_sel_hi:[1,0]
v_pk_mul_f32 v[118:119], v[118:119], v[244:245] op_sel_hi:[1,0]
v_pk_mul_f32 v[120:121], v[120:121], v[244:245] op_sel_hi:[1,0]
v_pk_mul_f32 v[122:123], v[122:123], v[244:245] op_sel_hi:[1,0]
v_pk_mul_f32 v[124:125], v[124:125], v[244:245] op_sel_hi:[1,0]
v_pk_mul_f32 v[126:127], v[126:127], v[244:245] op_sel_hi:[1,0]
v_pk_mul_f32 v[128:129], v[128:129], v[244:245] op_sel_hi:[1,0]
v_pk_mul_f32 v[130:131], v[130:131], v[244:245] op_sel_hi:[1,0]
v_pk_mul_f32 v[132:133], v[132:133], v[244:245] op_sel_hi:[1,0]
v_pk_mul_f32 v[134:135], v[134:135], v[244:245] op_sel_hi:[1,0]
v_pk_mul_f32 v[136:137], v[136:137], v[244:245] op_sel_hi:[1,0]
v_pk_mul_f32 v[138:139], v[138:139], v[244:245] op_sel_hi:[1,0]
v_pk_mul_f32 v[140:141], v[140:141], v[244:245] op_sel_hi:[1,0]
v_pk_mul_f32 v[142:143], v[142:143], v[244:245] op_sel_hi:[1,0]
v_max3_f32 v244, v8, v9, v10
v_max3_f32 v244, v244, v11, v12
v_max3_f32 v244, v244, v13, v14
v_max_f32 v244, v244, v15
v_mov_b32 v248, v244
s_nop 1
v_permlane16_swap_b32 v244, v248
v_max_f32 v244, v244, v248
v_mov_b32 v248, v244
s_nop 1
v_permlane32_swap_b32 v244, v248
v_max_f32 v244, v244, v248
v_ceil_f32 v244, v244
v_max_f32 v244, 0, v244
v_add_f32 v241, v241, v244
v_sub_f32 v244, 0, v244
v_pk_add_f32 v[8:9], v[8:9], v[244:245] op_sel_hi:[1,0]
v_pk_add_f32 v[10:11], v[10:11], v[244:245] op_sel_hi:[1,0]
v_pk_add_f32 v[12:13], v[12:13], v[244:245] op_sel_hi:[1,0]
v_pk_add_f32 v[14:15], v[14:15], v[244:245] op_sel_hi:[1,0]
v_exp_f32 v244, v244
v_sub_f32 v248, 0, v241
v_mov_b32 v88, v248
v_mov_b32 v89, v248
v_mov_b32 v90, v248
v_mov_b32 v91, v248
v_mov_b32 v92, v248
v_mov_b32 v93, v248
v_mov_b32 v94, v248
v_mov_b32 v95, v248
v_accvgpr_read_b32 v248, a164
v_mul_f32 v248, v248, v244
v_accvgpr_write_b32 a164, v248
v_accvgpr_write_b32 a165, v248
v_accvgpr_write_b32 a166, v248
v_accvgpr_write_b32 a167, v248
v_pk_mul_f32 v[144:145], v[144:145], v[244:245] op_sel_hi:[1,0]
v_pk_mul_f32 v[146:147], v[146:147], v[244:245] op_sel_hi:[1,0]
v_pk_mul_f32 v[148:149], v[148:149], v[244:245] op_sel_hi:[1,0]
v_pk_mul_f32 v[150:151], v[150:151], v[244:245] op_sel_hi:[1,0]
v_pk_mul_f32 v[152:153], v[152:153], v[244:245] op_sel_hi:[1,0]
v_pk_mul_f32 v[154:155], v[154:155], v[244:245] op_sel_hi:[1,0]
v_pk_mul_f32 v[156:157], v[156:157], v[244:245] op_sel_hi:[1,0]
v_pk_mul_f32 v[158:159], v[158:159], v[244:245] op_sel_hi:[1,0]
v_pk_mul_f32 v[160:161], v[160:161], v[244:245] op_sel_hi:[1,0]
v_pk_mul_f32 v[162:163], v[162:163], v[244:245] op_sel_hi:[1,0]
v_pk_mul_f32 v[164:165], v[164:165], v[244:245] op_sel_hi:[1,0]
v_pk_mul_f32 v[166:167], v[166:167], v[244:245] op_sel_hi:[1,0]
v_pk_mul_f32 v[168:169], v[168:169], v[244:245] op_sel_hi:[1,0]
v_pk_mul_f32 v[170:171], v[170:171], v[244:245] op_sel_hi:[1,0]
v_pk_mul_f32 v[172:173], v[172:173], v[244:245] op_sel_hi:[1,0]
v_pk_mul_f32 v[174:175], v[174:175], v[244:245] op_sel_hi:[1,0]
s_nop 1
S2_t1:
s_cmp_eq_u32 s33, 2
s_cbranch_scc0 S2_f2
s_and_b32 s39, s20, 1
s_add_u32 s39, s39, 2
s_sub_u32 s37, s39, s20
s_cmp_lt_i32 s37, 0
s_cbranch_scc1 Lme_7014
s_cmp_eq_i32 s37, 0
s_cbranch_scc1 Lmd_7013
v_mov_b32 v80, v254
v_mov_b32 v81, v254
v_mov_b32 v82, v254
v_mov_b32 v83, v254
v_mov_b32 v84, v254
v_mov_b32 v85, v254
v_mov_b32 v86, v254
v_mov_b32 v87, v254
v_mov_b32 v88, v254
v_mov_b32 v89, v254
v_mov_b32 v90, v254
v_mov_b32 v91, v254
v_mov_b32 v92, v254
v_mov_b32 v93, v254
v_mov_b32 v94, v254
v_mov_b32 v95, v254
s_branch Lme_7014
Lmd_7013:
v_cndmask_b32 v80, v80, v254, s[64:65]
v_mov_b32 v84, v254
v_cndmask_b32 v92, v92, v254, s[64:65]
v_cndmask_b32 v81, v81, v254, s[66:67]
v_mov_b32 v85, v254
v_cndmask_b32 v93, v93, v254, s[66:67]
v_cndmask_b32 v82, v82, v254, s[68:69]
v_mov_b32 v86, v254
v_cndmask_b32 v94, v94, v254, s[68:69]
v_cndmask_b32 v83, v83, v254, s[70:71]
v_mov_b32 v87, v254
v_cndmask_b32 v95, v95, v254, s[70:71]
Lme_7014:
s_xor_b32 s37, s20, 1
s_sub_u32 s37, s39, s37
s_cmp_lt_i32 s37, 0
s_cbranch_scc1 Lme_7016
s_cmp_eq_i32 s37, 0
s_cbranch_scc1 Lmd_7015
v_mov_b32 v96, v254
v_mov_b32 v97, v254
v_mov_b32 v98, v254
v_mov_b32 v99, v254
v_mov_b32 v100, v254
v_mov_b32 v101, v254
v_mov_b32 v102, v254
v_mov_b32 v103, v254
v_mov_b32 v104, v254
v_mov_b32 v105, v254
v_mov_b32 v106, v254
v_mov_b32 v107, v254
v_mov_b32 v108, v254
v_mov_b32 v109, v254
v_mov_b32 v110, v254
v_mov_b32 v111, v254
s_branch Lme_7016
Lmd_7015:
v_cndmask_b32 v96, v96, v254, s[64:65]
v_mov_b32 v100, v254
v_cndmask_b32 v108, v108, v254, s[64:65]
v_cndmask_b32 v97, v97, v254, s[66:67]
v_mov_b32 v101, v254
v_cndmask_b32 v109, v109, v254, s[66:67]
v_cndmask_b32 v98, v98, v254, s[68:69]
v_mov_b32 v102, v254
v_cndmask_b32 v110, v110, v254, s[68:69]
v_cndmask_b32 v99, v99, v254, s[70:71]
v_mov_b32 v103, v254
v_cndmask_b32 v111, v111, v254, s[70:71]
Lme_7016:
s_lshr_b32 s37, s21, 2
s_lshl_b32 s37, s37, 7
s_add_u32 s37, s37, 0x3c03000
v_and_b32 v248, 31, v253
v_lshlrev_b32 v248, 2, v248
buffer_load_dword a253, v248, s[4:7], s37 offen sc1
S2_f2:
s_waitcnt vmcnt(16) lgkmcnt(0)
s_barrier
v_mfma_f32_16x16x32_bf16 v[32:35], a[0:3], a[64:67], v[80:83]
s_add_u32 m0, s29, s28
v_exp_f32 v0, v0
v_mfma_f32_16x16x32_bf16 v[32:35], a[4:7], a[68:71], v[32:35]
s_add_u32 s30, s25, 0x1000
v_exp_f32 v1, v1
v_mfma_f32_16x16x32_bf16 v[32:35], a[8:11], a[72:75], v[32:35]
ds_read_b128 a[32:35], v251 offset:16384
v_cvt_pk_bf16_f32 v64, v0, v1
v_mfma_f32_16x16x32_bf16 v[32:35], a[12:15], a[76:79], v[32:35]
v_exp_f32 v2, v2
v_mfma_f32_16x16x32_bf16 v[40:43], a[0:3], a[80:83], v[88:91]
s_mov_b32 s28, s27
v_exp_f32 v3, v3
v_mfma_f32_16x16x32_bf16 v[40:43], a[4:7], a[84:87], v[40:43]
s_mov_b32 s27, s26
ds_read_b128 a[36:39], v251 offset:17408
v_cvt_pk_bf16_f32 v65, v2, v3
v_mfma_f32_16x16x32_bf16 v[40:43], a[8:11], a[88:91], v[40:43]
s_add_u32 s26, s26, 0x8000
buffer_load_dwordx4 v252, s[16:19], s25 offen offset:0 sc1 lds
v_mfma_f32_16x16x32_bf16 v[40:43], a[12:15], a[92:95], v[40:43]
v_exp_f32 v4, v4
v_mfma_f32_16x16x32_bf16 v[48:51], a[0:3], a[96:99], v[96:99]
v_exp_f32 v5, v5
v_mfma_f32_16x16x32_bf16 v[48:51], a[4:7], a[100:103], v[48:51]
ds_read_b128 a[40:43], v251 offset:18432
v_cvt_pk_bf16_f32 v66, v4, v5
v_mfma_f32_16x16x32_bf16 v[48:51], a[8:11], a[104:107], v[48:51]
v_exp_f32 v6, v6
v_mfma_f32_16x16x32_bf16 v[48:51], a[12:15], a[108:111], v[48:51]
v_exp_f32 v7, v7
v_mfma_f32_16x16x32_bf16 v[56:59], a[0:3], a[112:115], v[104:107]
ds_read_b128 a[44:47], v251 offset:19456
v_cvt_pk_bf16_f32 v67, v6, v7
v_mfma_f32_16x16x32_bf16 v[56:59], a[4:7], a[116:119], v[56:59]
buffer_load_dwordx4 v252, s[16:19], s25 offen offset:1024 sc1 lds
v_mfma_f32_16x16x32_bf16 v[56:59], a[8:11], a[120:123], v[56:59]
v_exp_f32 v8, v8
v_mfma_f32_16x16x32_bf16 v[56:59], a[12:15], a[124:127], v[56:59]
ds_read_b128 a[48:51], v251 offset:20480
ds_read_b128 a[52:55], v251 offset:21504
v_mfma_f32_16x16x32_bf16 v[36:39], a[16:19], a[64:67], v[84:87]
v_exp_f32 v9, v9
v_mfma_f32_16x16x32_bf16 v[36:39], a[20:23], a[68:71], v[36:39]
s_cmp_eq_u32 s26, 0x28000
s_cselect_b32 s26, 0, s26
v_cvt_pk_bf16_f32 v68, v8, v9
v_mfma_f32_16x16x32_bf16 v[36:39], a[24:27], a[72:75], v[36:39]
s_add_u32 s37, s26, s24
v_exp_f32 v10, v10
v_mfma_f32_16x16x32_bf16 v[36:39], a[28:31], a[76:79], v[36:39]
s_sub_u32 s33, s33, 1
v_exp_f32 v11, v11
v_mfma_f32_16x16x32_bf16 v[44:47], a[16:19], a[80:83], v[92:95]
ds_read_b128 a[56:59], v251 offset:22528
v_cvt_pk_bf16_f32 v69, v10, v11
v_mfma_f32_16x16x32_bf16 v[44:47], a[20:23], a[84:87], v[44:47]
buffer_load_dwordx4 v252, s[16:19], s25 offen offset:2048 sc1 lds
v_mfma_f32_16x16x32_bf16 v[44:47], a[24:27], a[88:91], v[44:47]
v_exp_f32 v12, v12
v_mfma_f32_16x16x32_bf16 v[44:47], a[28:31], a[92:95], v[44:47]
v_exp_f32 v13, v13
v_mfma_f32_16x16x32_bf16 v[52:55], a[16:19], a[96:99], v[100:103]
ds_read_b128 a[60:63], v251 offset:23552
v_cvt_pk_bf16_f32 v70, v12, v13
v_mfma_f32_16x16x32_bf16 v[52:55], a[20:23], a[100:103], v[52:55]
v_exp_f32 v14, v14
v_mfma_f32_16x16x32_bf16 v[52:55], a[24:27], a[104:107], v[52:55]
v_exp_f32 v15, v15
v_mfma_f32_16x16x32_bf16 v[52:55], a[28:31], a[108:111], v[52:55]
s_cmp_le_u32 s33, 3
s_cselect_b32 s35, s36, s34
v_cvt_pk_bf16_f32 v71, v14, v15
v_mfma_f32_16x16x32_bf16 v[60:63], a[16:19], a[112:115], v[108:111]
buffer_load_dwordx4 v252, s[16:19], s25 offen offset:3072 sc1 lds
v_mfma_f32_16x16x32_bf16 v[60:63], a[20:23], a[116:119], v[60:63]
s_add_u32 m0, m0, 0x1000
v_exp_f32 v16, v16
v_mfma_f32_16x16x32_bf16 v[60:63], a[24:27], a[120:123], v[60:63]
s_add_u32 s25, s25, 0x8000
v_exp_f32 v17, v17
v_mfma_f32_16x16x32_bf16 v[60:63], a[28:31], a[124:127], v[60:63]
v_cvt_pk_bf16_f32 v72, v16, v17
s_waitcnt lgkmcnt(0)
v_mfma_f32_16x16x32_bf16 v[112:115], a[32:35], v[64:67], v[112:115]
v_exp_f32 v18, v18
v_mfma_f32_16x16x32_bf16 v[116:119], a[36:39], v[64:67], v[116:119]
ds_read_b128 a[0:3], v250 offset:0
ds_read_b128 a[4:7], v250 offset:1024
v_mfma_f32_16x16x32_bf16 v[120:123], a[40:43], v[64:67], v[120:123]
v_exp_f32 v19, v19
v_mfma_f32_16x16x32_bf16 v[124:127], a[44:47], v[64:67], v[124:127]
v_cvt_pk_bf16_f32 v73, v18, v19
v_max_f32 v244, v32, v33
v_mfma_f32_16x16x32_bf16 v[128:131], a[48:51], v[64:67], v[128:131]
v_exp_f32 v20, v20
v_mfma_f32_16x16x32_bf16 v[132:135], a[52:55], v[64:67], v[132:135]
buffer_load_dwordx4 v252, s[16:19], s30 offen offset:0 sc1 lds
v_mfma_f32_16x16x32_bf16 v[136:139], a[56:59], v[64:67], v[136:139]
v_exp_f32 v21, v21
v_mfma_f32_16x16x32_bf16 v[140:143], a[60:63], v[64:67], v[140:143]
ds_read_b128 a[8:11], v250 offset:2048
v_cvt_pk_bf16_f32 v74, v20, v21
v_mfma_f32_16x16x32_bf16 a[160:163], a[176:179], v[64:67], a[160:163]
v_exp_f32 v22, v22
v_mfma_f32_16x16x32_bf16 v[144:147], a[32:35], v[68:71], v[144:147]
v_exp_f32 v23, v23
v_mfma_f32_16x16x32_bf16 v[148:151], a[36:39], v[68:71], v[148:151]
ds_read_b128 a[12:15], v250 offset:3072
v_cvt_pk_bf16_f32 v75, v22, v23
v_mfma_f32_16x16x32_bf16 v[152:155], a[40:43], v[68:71], v[152:155]
v_exp_f32 v24, v24
v_mfma_f32_16x16x32_bf16 v[156:159], a[44:47], v[68:71], v[156:159]
buffer_load_dwordx4 v252, s[16:19], s30 offen offset:1024 sc1 lds
v_mfma_f32_16x16x32_bf16 v[160:163], a[48:51], v[68:71], v[160:163]
v_exp_f32 v25, v25
v_mfma_f32_16x16x32_bf16 v[164:167], a[52:55], v[68:71], v[164:167]
ds_read_b128 a[16:19], v250 offset:4096
v_cvt_pk_bf16_f32 v76, v24, v25
v_mfma_f32_16x16x32_bf16 v[168:171], a[56:59], v[68:71], v[168:171]
v_exp_f32 v26, v26
v_mfma_f32_16x16x32_bf16 v[172:175], a[60:63], v[68:71], v[172:175]
v_exp_f32 v27, v27
v_mfma_f32_16x16x32_bf16 a[164:167], a[176:179], v[68:71], a[164:167]
ds_read_b128 a[20:23], v250 offset:5120
v_cvt_pk_bf16_f32 v77, v26, v27
v_mfma_f32_16x16x32_bf16 v[176:179], a[32:35], v[72:75], 0
v_exp_f32 v28, v28
v_mfma_f32_16x16x32_bf16 v[180:183], a[36:39], v[72:75], 0
v_exp_f32 v29, v29
v_mfma_f32_16x16x32_bf16 v[184:187], a[40:43], v[72:75], 0
buffer_load_dwordx4 v252, s[16:19], s30 offen offset:2048 sc1 lds
v_mfma_f32_16x16x32_bf16 v[188:191], a[44:47], v[72:75], 0
v_max3_f32 v244, v244, v34, v35
v_cvt_pk_bf16_f32 v78, v28, v29
v_mfma_f32_16x16x32_bf16 v[192:195], a[48:51], v[72:75], 0
v_exp_f32 v30, v30
v_mfma_f32_16x16x32_bf16 v[196:199], a[52:55], v[72:75], 0
v_exp_f32 v31, v31
v_mfma_f32_16x16x32_bf16 v[200:203], a[56:59], v[72:75], 0
v_cvt_pk_bf16_f32 v79, v30, v31
v_max3_f32 v244, v244, v40, v41
v_mfma_f32_16x16x32_bf16 v[204:207], a[60:63], v[72:75], 0
v_max3_f32 v244, v244, v42, v43
v_max_f32 v246, v48, v49
v_mfma_f32_16x16x32_bf16 a[168:171], a[176:179], v[72:75], 0
ds_read_b128 a[24:27], v250 offset:6144
v_max3_f32 v246, v246, v50, v51
v_mfma_f32_16x16x32_bf16 v[208:211], a[32:35], v[76:79], 0
v_max3_f32 v246, v246, v56, v57
v_max3_f32 v246, v246, v58, v59
v_mfma_f32_16x16x32_bf16 v[212:215], a[36:39], v[76:79], 0
buffer_load_dwordx4 v252, s[16:19], s30 offen offset:3072 sc1 lds
v_mfma_f32_16x16x32_bf16 v[216:219], a[40:43], v[76:79], 0
ds_read_b128 a[28:31], v250 offset:7168
v_max3_f32 v244, v244, v36, v37
v_mfma_f32_16x16x32_bf16 v[220:223], a[44:47], v[76:79], 0
v_max3_f32 v244, v244, v38, v39
v_max3_f32 v244, v244, v44, v45
v_mfma_f32_16x16x32_bf16 v[224:227], a[48:51], v[76:79], 0
v_max3_f32 v244, v244, v46, v47
v_max3_f32 v246, v246, v52, v53
v_mfma_f32_16x16x32_bf16 v[228:231], a[52:55], v[76:79], 0
v_max3_f32 v246, v246, v54, v55
v_max3_f32 v246, v246, v60, v61
v_mfma_f32_16x16x32_bf16 v[232:235], a[56:59], v[76:79], 0
v_max3_f32 v246, v246, v62, v63
v_add_u32 v250, s37, v252
v_mfma_f32_16x16x32_bf16 v[236:239], a[60:63], v[76:79], 0
v_add_u32 v251, s37, v252
v_max_f32 v255, v244, v246
v_mfma_f32_16x16x32_bf16 a[172:175], a[176:179], v[76:79], 0
v_cmp_nge_f32 vcc, s35, v255
s_cbranch_vccnz S2_rare20
s_branch S2_c2a
.p2align 6
S2_loop2:
s_waitcnt vmcnt(8) lgkmcnt(0)
s_barrier
v_mfma_f32_16x16x32_bf16 v[32:35], a[0:3], a[64:67], v[80:83]
s_add_u32 m0, s29, s28
v_exp_f32 v0, v0
v_mfma_f32_16x16x32_bf16 v[32:35], a[4:7], a[68:71], v[32:35]
s_add_u32 s30, s25, 0x1000
v_exp_f32 v1, v1
v_mfma_f32_16x16x32_bf16 v[32:35], a[8:11], a[72:75], v[32:35]
ds_read_b128 a[32:35], v251 offset:16384
v_cvt_pk_bf16_f32 v64, v0, v1
v_mfma_f32_16x16x32_bf16 v[32:35], a[12:15], a[76:79], v[32:35]
v_exp_f32 v2, v2
v_mfma_f32_16x16x32_bf16 v[40:43], a[0:3], a[80:83], v[88:91]
s_mov_b32 s28, s27
v_exp_f32 v3, v3
v_mfma_f32_16x16x32_bf16 v[40:43], a[4:7], a[84:87], v[40:43]
s_mov_b32 s27, s26
ds_read_b128 a[36:39], v251 offset:17408
v_cvt_pk_bf16_f32 v65, v2, v3
v_mfma_f32_16x16x32_bf16 v[40:43], a[8:11], a[88:91], v[40:43]
s_add_u32 s26, s26, 0x8000
buffer_load_dwordx4 v252, s[16:19], s25 offen offset:0 sc1 lds
v_mfma_f32_16x16x32_bf16 v[40:43], a[12:15], a[92:95], v[40:43]
v_exp_f32 v4, v4
v_mfma_f32_16x16x32_bf16 v[48:51], a[0:3], a[96:99], v[96:99]
v_exp_f32 v5, v5
v_mfma_f32_16x16x32_bf16 v[48:51], a[4:7], a[100:103], v[48:51]
ds_read_b128 a[40:43], v251 offset:18432
v_cvt_pk_bf16_f32 v66, v4, v5
v_mfma_f32_16x16x32_bf16 v[48:51], a[8:11], a[104:107], v[48:51]
v_exp_f32 v6, v6
v_mfma_f32_16x16x32_bf16 v[48:51], a[12:15], a[108:111], v[48:51]
v_exp_f32 v7, v7
v_mfma_f32_16x16x32_bf16 v[56:59], a[0:3], a[112:115], v[104:107]
ds_read_b128 a[44:47], v251 offset:19456
v_cvt_pk_bf16_f32 v67, v6, v7
v_mfma_f32_16x16x32_bf16 v[56:59], a[4:7], a[116:119], v[56:59]
buffer_load_dwordx4 v252, s[16:19], s25 offen offset:1024 sc1 lds
v_mfma_f32_16x16x32_bf16 v[56:59], a[8:11], a[120:123], v[56:59]
v_exp_f32 v8, v8
v_mfma_f32_16x16x32_bf16 v[56:59], a[12:15], a[124:127], v[56:59]
ds_read_b128 a[48:51], v251 offset:20480
ds_read_b128 a[52:55], v251 offset:21504
v_mfma_f32_16x16x32_bf16 v[36:39], a[16:19], a[64:67], v[84:87]
v_exp_f32 v9, v9
v_mfma_f32_16x16x32_bf16 v[36:39], a[20:23], a[68:71], v[36:39]
s_cmp_eq_u32 s26, 0x28000
s_cselect_b32 s26, 0, s26
v_cvt_pk_bf16_f32 v68, v8, v9
v_mfma_f32_16x16x32_bf16 v[36:39], a[24:27], a[72:75], v[36:39]
s_add_u32 s37, s26, s24
v_exp_f32 v10, v10
v_mfma_f32_16x16x32_bf16 v[36:39], a[28:31], a[76:79], v[36:39]
s_sub_u32 s33, s33, 1
v_exp_f32 v11, v11
v_mfma_f32_16x16x32_bf16 v[44:47], a[16:19], a[80:83], v[92:95]
ds_read_b128 a[56:59], v251 offset:22528
v_cvt_pk_bf16_f32 v69, v10, v11
v_mfma_f32_16x16x32_bf16 v[44:47], a[20:23], a[84:87], v[44:47]
buffer_load_dwordx4 v252, s[16:19], s25 offen offset:2048 sc1 lds
v_mfma_f32_16x16x32_bf16 v[44:47], a[24:27], a[88:91], v[44:47]
v_exp_f32 v12, v12
v_mfma_f32_16x16x32_bf16 v[44:47], a[28:31], a[92:95], v[44:47]
v_exp_f32 v13, v13
v_mfma_f32_16x16x32_bf16 v[52:55], a[16:19], a[96:99], v[100:103]
ds_read_b128 a[60:63], v251 offset:23552
v_cvt_pk_bf16_f32 v70, v12, v13
v_mfma_f32_16x16x32_bf16 v[52:55], a[20:23], a[100:103], v[52:55]
v_exp_f32 v14, v14
v_mfma_f32_16x16x32_bf16 v[52:55], a[24:27], a[104:107], v[52:55]
v_exp_f32 v15, v15
v_mfma_f32_16x16x32_bf16 v[52:55], a[28:31], a[108:111], v[52:55]
s_cmp_le_u32 s33, 3
s_cselect_b32 s35, s36, s34
v_cvt_pk_bf16_f32 v71, v14, v15
v_mfma_f32_16x16x32_bf16 v[60:63], a[16:19], a[112:115], v[108:111]
buffer_load_dwordx4 v252, s[16:19], s25 offen offset:3072 sc1 lds
v_mfma_f32_16x16x32_bf16 v[60:63], a[20:23], a[116:119], v[60:63]
s_add_u32 m0, m0, 0x1000
v_exp_f32 v16, v16
v_mfma_f32_16x16x32_bf16 v[60:63], a[24:27], a[120:123], v[60:63]
s_add_u32 s25, s25, 0x8000
v_exp_f32 v17, v17
v_mfma_f32_16x16x32_bf16 v[60:63], a[28:31], a[124:127], v[60:63]
v_cvt_pk_bf16_f32 v72, v16, v17
s_waitcnt lgkmcnt(0)
v_mfma_f32_16x16x32_bf16 v[112:115], a[32:35], v[64:67], v[112:115]
v_exp_f32 v18, v18
v_mfma_f32_16x16x32_bf16 v[116:119], a[36:39], v[64:67], v[116:119]
ds_read_b128 a[0:3], v250 offset:0
ds_read_b128 a[4:7], v250 offset:1024
v_mfma_f32_16x16x32_bf16 v[120:123], a[40:43], v[64:67], v[120:123]
v_exp_f32 v19, v19
v_mfma_f32_16x16x32_bf16 v[124:127], a[44:47], v[64:67], v[124:127]
v_cvt_pk_bf16_f32 v73, v18, v19
v_max_f32 v244, v32, v33
v_mfma_f32_16x16x32_bf16 v[128:131], a[48:51], v[64:67], v[128:131]
v_exp_f32 v20, v20
v_mfma_f32_16x16x32_bf16 v[132:135], a[52:55], v[64:67], v[132:135]
buffer_load_dwordx4 v252, s[16:19], s30 offen offset:0 sc1 lds
v_mfma_f32_16x16x32_bf16 v[136:139], a[56:59], v[64:67], v[136:139]
v_exp_f32 v21, v21
v_mfma_f32_16x16x32_bf16 v[140:143], a[60:63], v[64:67], v[140:143]
ds_read_b128 a[8:11], v250 offset:2048
v_cvt_pk_bf16_f32 v74, v20, v21
v_mfma_f32_16x16x32_bf16 a[160:163], a[176:179], v[64:67], a[160:163]
v_exp_f32 v22, v22
v_mfma_f32_16x16x32_bf16 v[144:147], a[32:35], v[68:71], v[144:147]
v_exp_f32 v23, v23
v_mfma_f32_16x16x32_bf16 v[148:151], a[36:39], v[68:71], v[148:151]
ds_read_b128 a[12:15], v250 offset:3072
v_cvt_pk_bf16_f32 v75, v22, v23
v_mfma_f32_16x16x32_bf16 v[152:155], a[40:43], v[68:71], v[152:155]
v_exp_f32 v24, v24
v_mfma_f32_16x16x32_bf16 v[156:159], a[44:47], v[68:71], v[156:159]
buffer_load_dwordx4 v252, s[16:19], s30 offen offset:1024 sc1 lds
v_mfma_f32_16x16x32_bf16 v[160:163], a[48:51], v[68:71], v[160:163]
v_exp_f32 v25, v25
v_mfma_f32_16x16x32_bf16 v[164:167], a[52:55], v[68:71], v[164:167]
ds_read_b128 a[16:19], v250 offset:4096
v_cvt_pk_bf16_f32 v76, v24, v25
v_mfma_f32_16x16x32_bf16 v[168:171], a[56:59], v[68:71], v[168:171]
v_exp_f32 v26, v26
v_mfma_f32_16x16x32_bf16 v[172:175], a[60:63], v[68:71], v[172:175]
v_exp_f32 v27, v27
v_mfma_f32_16x16x32_bf16 a[164:167], a[176:179], v[68:71], a[164:167]
ds_read_b128 a[20:23], v250 offset:5120
v_cvt_pk_bf16_f32 v77, v26, v27
v_mfma_f32_16x16x32_bf16 v[176:179], a[32:35], v[72:75], v[176:179]
v_exp_f32 v28, v28
v_mfma_f32_16x16x32_bf16 v[180:183], a[36:39], v[72:75], v[180:183]
v_exp_f32 v29, v29
v_mfma_f32_16x16x32_bf16 v[184:187], a[40:43], v[72:75], v[184:187]
buffer_load_dwordx4 v252, s[16:19], s30 offen offset:2048 sc1 lds
v_mfma_f32_16x16x32_bf16 v[188:191], a[44:47], v[72:75], v[188:191]
v_max3_f32 v244, v244, v34, v35
v_cvt_pk_bf16_f32 v78, v28, v29
v_mfma_f32_16x16x32_bf16 v[192:195], a[48:51], v[72:75], v[192:195]
v_exp_f32 v30, v30
v_mfma_f32_16x16x32_bf16 v[196:199], a[52:55], v[72:75], v[196:199]
v_exp_f32 v31, v31
v_mfma_f32_16x16x32_bf16 v[200:203], a[56:59], v[72:75], v[200:203]
v_cvt_pk_bf16_f32 v79, v30, v31
v_max3_f32 v244, v244, v40, v41
v_mfma_f32_16x16x32_bf16 v[204:207], a[60:63], v[72:75], v[204:207]
v_max3_f32 v244, v244, v42, v43
v_max_f32 v246, v48, v49
v_mfma_f32_16x16x32_bf16 a[168:171], a[176:179], v[72:75], a[168:171]
ds_read_b128 a[24:27], v250 offset:6144
v_max3_f32 v246, v246, v50, v51
v_mfma_f32_16x16x32_bf16 v[208:211], a[32:35], v[76:79], v[208:211]
v_max3_f32 v246, v246, v56, v57
v_max3_f32 v246, v246, v58, v59
v_mfma_f32_16x16x32_bf16 v[212:215], a[36:39], v[76:79], v[212:215]
buffer_load_dwordx4 v252, s[16:19], s30 offen offset:3072 sc1 lds
v_mfma_f32_16x16x32_bf16 v[216:219], a[40:43], v[76:79], v[216:219]
ds_read_b128 a[28:31], v250 offset:7168
v_max3_f32 v244, v244, v36, v37
v_mfma_f32_16x16x32_bf16 v[220:223], a[44:47], v[76:79], v[220:223]
v_max3_f32 v244, v244, v38, v39
v_max3_f32 v244, v244, v44, v45
v_mfma_f32_16x16x32_bf16 v[224:227], a[48:51], v[76:79], v[224:227]
v_max3_f32 v244, v244, v46, v47
v_max3_f32 v246, v246, v52, v53
v_mfma_f32_16x16x32_bf16 v[228:231], a[52:55], v[76:79], v[228:231]
v_max3_f32 v246, v246, v54, v55
v_max3_f32 v246, v246, v60, v61
v_mfma_f32_16x16x32_bf16 v[232:235], a[56:59], v[76:79], v[232:235]
v_max3_f32 v246, v246, v62, v63
v_add_u32 v250, s37, v252
v_mfma_f32_16x16x32_bf16 v[236:239], a[60:63], v[76:79], v[236:239]
v_add_u32 v251, s37, v252
v_max_f32 v255, v244, v246
v_mfma_f32_16x16x32_bf16 a[172:175], a[176:179], v[76:79], a[172:175]
v_cmp_nge_f32 vcc, s35, v255
s_cbranch_vccnz S2_rare20
S2_c2a:
s_waitcnt lgkmcnt(0)
v_mfma_f32_16x16x32_bf16 v[0:3], a[0:3], a[64:67], v[80:83]
s_add_u32 m0, s29, s28
v_exp_f32 v32, v32
v_mfma_f32_16x16x32_bf16 v[0:3], a[4:7], a[68:71], v[0:3]
s_add_u32 s30, s25, 0x1000
v_exp_f32 v33, v33
v_mfma_f32_16x16x32_bf16 v[0:3], a[8:11], a[72:75], v[0:3]
ds_read_b128 a[32:35], v251 offset:16384
v_cvt_pk_bf16_f32 v64, v32, v33
v_mfma_f32_16x16x32_bf16 v[0:3], a[12:15], a[76:79], v[0:3]
v_exp_f32 v34, v34
v_mfma_f32_16x16x32_bf16 v[8:11], a[0:3], a[80:83], v[88:91]
s_mov_b32 s28, s27
v_exp_f32 v35, v35
v_mfma_f32_16x16x32_bf16 v[8:11], a[4:7], a[84:87], v[8:11]
s_mov_b32 s27, s26
ds_read_b128 a[36:39], v251 offset:17408
v_cvt_pk_bf16_f32 v65, v34, v35
v_mfma_f32_16x16x32_bf16 v[8:11], a[8:11], a[88:91], v[8:11]
s_add_u32 s26, s26, 0x8000
buffer_load_dwordx4 v252, s[16:19], s25 offen offset:0 sc1 lds
v_mfma_f32_16x16x32_bf16 v[8:11], a[12:15], a[92:95], v[8:11]
v_exp_f32 v36, v36
v_mfma_f32_16x16x32_bf16 v[16:19], a[0:3], a[96:99], v[96:99]
v_exp_f32 v37, v37
v_mfma_f32_16x16x32_bf16 v[16:19], a[4:7], a[100:103], v[16:19]
ds_read_b128 a[40:43], v251 offset:18432
v_cvt_pk_bf16_f32 v66, v36, v37
v_mfma_f32_16x16x32_bf16 v[16:19], a[8:11], a[104:107], v[16:19]
v_exp_f32 v38, v38
v_mfma_f32_16x16x32_bf16 v[16:19], a[12:15], a[108:111], v[16:19]
v_exp_f32 v39, v39
v_mfma_f32_16x16x32_bf16 v[24:27], a[0:3], a[112:115], v[104:107]
ds_read_b128 a[44:47], v251 offset:19456
v_cvt_pk_bf16_f32 v67, v38, v39
v_mfma_f32_16x16x32_bf16 v[24:27], a[4:7], a[116:119], v[24:27]
buffer_load_dwordx4 v252, s[16:19], s25 offen offset:1024 sc1 lds
v_mfma_f32_16x16x32_bf16 v[24:27], a[8:11], a[120:123], v[24:27]
v_exp_f32 v40, v40
v_mfma_f32_16x16x32_bf16 v[24:27], a[12:15], a[124:127], v[24:27]
ds_read_b128 a[48:51], v251 offset:20480
ds_read_b128 a[52:55], v251 offset:21504
v_mfma_f32_16x16x32_bf16 v[4:7], a[16:19], a[64:67], v[84:87]
v_exp_f32 v41, v41
v_mfma_f32_16x16x32_bf16 v[4:7], a[20:23], a[68:71], v[4:7]
s_cmp_eq_u32 s26, 0x28000
s_cselect_b32 s26, 0, s26
v_cvt_pk_bf16_f32 v68, v40, v41
v_mfma_f32_16x16x32_bf16 v[4:7], a[24:27], a[72:75], v[4:7]
s_add_u32 s37, s26, s24
v_exp_f32 v42, v42
v_mfma_f32_16x16x32_bf16 v[4:7], a[28:31], a[76:79], v[4:7]
s_sub_u32 s33, s33, 1
v_exp_f32 v43, v43
v_mfma_f32_16x16x32_bf16 v[12:15], a[16:19], a[80:83], v[92:95]
ds_read_b128 a[56:59], v251 offset:22528
v_cvt_pk_bf16_f32 v69, v42, v43
v_mfma_f32_16x16x32_bf16 v[12:15], a[20:23], a[84:87], v[12:15]
buffer_load_dwordx4 v252, s[16:19], s25 offen offset:2048 sc1 lds
v_mfma_f32_16x16x32_bf16 v[12:15], a[24:27], a[88:91], v[12:15]
v_exp_f32 v44, v44
v_mfma_f32_16x16x32_bf16 v[12:15], a[28:31], a[92:95], v[12:15]
v_exp_f32 v45, v45
v_mfma_f32_16x16x32_bf16 v[20:23], a[16:19], a[96:99], v[100:103]
ds_read_b128 a[60:63], v251 offset:23552
v_cvt_pk_bf16_f32 v70, v44, v45
v_mfma_f32_16x16x32_bf16 v[20:23], a[20:23], a[100:103], v[20:23]
v_exp_f32 v46, v46
v_mfma_f32_16x16x32_bf16 v[20:23], a[24:27], a[104:107], v[20:23]
v_exp_f32 v47, v47
v_mfma_f32_16x16x32_bf16 v[20:23], a[28:31], a[108:111], v[20:23]
s_cmp_le_u32 s33, 3
s_cselect_b32 s35, s36, s34
v_cvt_pk_bf16_f32 v71, v46, v47
v_mfma_f32_16x16x32_bf16 v[28:31], a[16:19], a[112:115], v[108:111]
buffer_load_dwordx4 v252, s[16:19], s25 offen offset:3072 sc1 lds
v_mfma_f32_16x16x32_bf16 v[28:31], a[20:23], a[116:119], v[28:31]
s_add_u32 m0, m0, 0x1000
v_exp_f32 v48, v48
v_mfma_f32_16x16x32_bf16 v[28:31], a[24:27], a[120:123], v[28:31]
s_add_u32 s25, s25, 0x8000
v_exp_f32 v49, v49
v_mfma_f32_16x16x32_bf16 v[28:31], a[28:31], a[124:127], v[28:31]
v_cvt_pk_bf16_f32 v72, v48, v49
s_waitcnt lgkmcnt(0)
v_mfma_f32_16x16x32_bf16 v[112:115], a[32:35], v[64:67], v[112:115]
v_exp_f32 v50, v50
v_mfma_f32_16x16x32_bf16 v[116:119], a[36:39], v[64:67], v[116:119]
ds_read_b128 a[0:3], v250 offset:0
ds_read_b128 a[4:7], v250 offset:1024
v_mfma_f32_16x16x32_bf16 v[120:123], a[40:43], v[64:67], v[120:123]
v_exp_f32 v51, v51
v_mfma_f32_16x16x32_bf16 v[124:127], a[44:47], v[64:67], v[124:127]
v_cvt_pk_bf16_f32 v73, v50, v51
v_max_f32 v244, v0, v1
v_mfma_f32_16x16x32_bf16 v[128:131], a[48:51], v[64:67], v[128:131]
v_exp_f32 v52, v52
v_mfma_f32_16x16x32_bf16 v[132:135], a[52:55], v[64:67], v[132:135]
buffer_load_dwordx4 v252, s[16:19], s30 offen offset:0 sc1 lds
v_mfma_f32_16x16x32_bf16 v[136:139], a[56:59], v[64:67], v[136:139]
v_exp_f32 v53, v53
v_mfma_f32_16x16x32_bf16 v[140:143], a[60:63], v[64:67], v[140:143]
ds_read_b128 a[8:11], v250 offset:2048
v_cvt_pk_bf16_f32 v74, v52, v53
v_mfma_f32_16x16x32_bf16 a[160:163], a[176:179], v[64:67], a[160:163]
v_exp_f32 v54, v54
v_mfma_f32_16x16x32_bf16 v[144:147], a[32:35], v[68:71], v[144:147]
v_exp_f32 v55, v55
v_mfma_f32_16x16x32_bf16 v[148:151], a[36:39], v[68:71], v[148:151]
ds_read_b128 a[12:15], v250 offset:3072
v_cvt_pk_bf16_f32 v75, v54, v55
v_mfma_f32_16x16x32_bf16 v[152:155], a[40:43], v[68:71], v[152:155]
v_exp_f32 v56, v56
v_mfma_f32_16x16x32_bf16 v[156:159], a[44:47], v[68:71], v[156:159]
buffer_load_dwordx4 v252, s[16:19], s30 offen offset:1024 sc1 lds
v_mfma_f32_16x16x32_bf16 v[160:163], a[48:51], v[68:71], v[160:163]
v_exp_f32 v57, v57
v_mfma_f32_16x16x32_bf16 v[164:167], a[52:55], v[68:71], v[164:167]
ds_read_b128 a[16:19], v250 offset:4096
v_cvt_pk_bf16_f32 v76, v56, v57
v_mfma_f32_16x16x32_bf16 v[168:171], a[56:59], v[68:71], v[168:171]
v_exp_f32 v58, v58
v_mfma_f32_16x16x32_bf16 v[172:175], a[60:63], v[68:71], v[172:175]
v_exp_f32 v59, v59
v_mfma_f32_16x16x32_bf16 a[164:167], a[176:179], v[68:71], a[164:167]
ds_read_b128 a[20:23], v250 offset:5120
v_cvt_pk_bf16_f32 v77, v58, v59
v_mfma_f32_16x16x32_bf16 v[176:179], a[32:35], v[72:75], v[176:179]
v_exp_f32 v60, v60
v_mfma_f32_16x16x32_bf16 v[180:183], a[36:39], v[72:75], v[180:183]
v_exp_f32 v61, v61
v_mfma_f32_16x16x32_bf16 v[184:187], a[40:43], v[72:75], v[184:187]
buffer_load_dwordx4 v252, s[16:19], s30 offen offset:2048 sc1 lds
v_mfma_f32_16x16x32_bf16 v[188:191], a[44:47], v[72:75], v[188:191]
v_max3_f32 v244, v244, v2, v3
v_cvt_pk_bf16_f32 v78, v60, v61
v_mfma_f32_16x16x32_bf16 v[192:195], a[48:51], v[72:75], v[192:195]
v_exp_f32 v62, v62
v_mfma_f32_16x16x32_bf16 v[196:199], a[52:55], v[72:75], v[196:199]
v_exp_f32 v63, v63
v_mfma_f32_16x16x32_bf16 v[200:203], a[56:59], v[72:75], v[200:203]
v_cvt_pk_bf16_f32 v79, v62, v63
v_max3_f32 v244, v244, v8, v9
v_mfma_f32_16x16x32_bf16 v[204:207], a[60:63], v[72:75], v[204:207]
v_max3_f32 v244, v244, v10, v11
v_max_f32 v246, v16, v17
v_mfma_f32_16x16x32_bf16 a[168:171], a[176:179], v[72:75], a[168:171]
ds_read_b128 a[24:27], v250 offset:6144
v_max3_f32 v246, v246, v18, v19
v_mfma_f32_16x16x32_bf16 v[208:211], a[32:35], v[76:79], v[208:211]
v_max3_f32 v246, v246, v24, v25
v_max3_f32 v246, v246, v26, v27
v_mfma_f32_16x16x32_bf16 v[212:215], a[36:39], v[76:79], v[212:215]
buffer_load_dwordx4 v252, s[16:19], s30 offen offset:3072 sc1 lds
v_mfma_f32_16x16x32_bf16 v[216:219], a[40:43], v[76:79], v[216:219]
ds_read_b128 a[28:31], v250 offset:7168
v_max3_f32 v244, v244, v4, v5
v_mfma_f32_16x16x32_bf16 v[220:223], a[44:47], v[76:79], v[220:223]
v_max3_f32 v244, v244, v6, v7
v_max3_f32 v244, v244, v12, v13
v_mfma_f32_16x16x32_bf16 v[224:227], a[48:51], v[76:79], v[224:227]
v_max3_f32 v244, v244, v14, v15
v_max3_f32 v246, v246, v20, v21
v_mfma_f32_16x16x32_bf16 v[228:231], a[52:55], v[76:79], v[228:231]
v_max3_f32 v246, v246, v22, v23
v_max3_f32 v246, v246, v28, v29
v_mfma_f32_16x16x32_bf16 v[232:235], a[56:59], v[76:79], v[232:235]
v_max3_f32 v246, v246, v30, v31
v_add_u32 v250, s37, v252
v_mfma_f32_16x16x32_bf16 v[236:239], a[60:63], v[76:79], v[236:239]
v_add_u32 v251, s37, v252
v_max_f32 v255, v244, v246
v_mfma_f32_16x16x32_bf16 a[172:175], a[176:179], v[76:79], a[172:175]
v_cmp_nge_f32 vcc, s35, v255
s_cbranch_vccz S2_loop2
S2_rare21:
v_cmp_lt_f32 vcc, s34, v255
s_nop 4
s_cbranch_vccz S2_rs21
s_nop 7
v_max3_f32 v244, v0, v1, v2
v_max3_f32 v244, v244, v3, v4
v_max3_f32 v244, v244, v5, v6
v_max_f32 v244, v244, v7
v_mov_b32 v248, v244
s_nop 1
v_permlane16_swap_b32 v244, v248
v_max_f32 v244, v244, v248
v_mov_b32 v248, v244
s_nop 1
v_permlane32_swap_b32 v244, v248
v_max_f32 v244, v244, v248
v_ceil_f32 v244, v244
v_max_f32 v244, 0, v244
v_add_f32 v240, v240, v244
v_sub_f32 v244, 0, v244
v_pk_add_f32 v[0:1], v[0:1], v[244:245] op_sel_hi:[1,0]
v_pk_add_f32 v[2:3], v[2:3], v[244:245] op_sel_hi:[1,0]
v_pk_add_f32 v[4:5], v[4:5], v[244:245] op_sel_hi:[1,0]
v_pk_add_f32 v[6:7], v[6:7], v[244:245] op_sel_hi:[1,0]
v_exp_f32 v244, v244
v_sub_f32 v248, 0, v240
v_mov_b32 v80, v248
v_mov_b32 v81, v248
v_mov_b32 v82, v248
v_mov_b32 v83, v248
v_mov_b32 v84, v248
v_mov_b32 v85, v248
v_mov_b32 v86, v248
v_mov_b32 v87, v248
v_accvgpr_read_b32 v248, a160
v_mul_f32 v248, v248, v244
v_accvgpr_write_b32 a160, v248
v_accvgpr_write_b32 a161, v248
v_accvgpr_write_b32 a162, v248
v_accvgpr_write_b32 a163, v248
v_pk_mul_f32 v[112:113], v[112:113], v[244:245] op_sel_hi:[1,0]
v_pk_mul_f32 v[114:115], v[114:115], v[244:245] op_sel_hi:[1,0]
v_pk_mul_f32 v[116:117], v[116:117], v[244:245] op_sel_hi:[1,0]
v_pk_mul_f32 v[118:119], v[118:119], v[244:245] op_sel_hi:[1,0]
v_pk_mul_f32 v[120:121], v[120:121], v[244:245] op_sel_hi:[1,0]
v_pk_mul_f32 v[122:123], v[122:123], v[244:245] op_sel_hi:[1,0]
v_pk_mul_f32 v[124:125], v[124:125], v[244:245] op_sel_hi:[1,0]
v_pk_mul_f32 v[126:127], v[126:127], v[244:245] op_sel_hi:[1,0]
v_pk_mul_f32 v[128:129], v[128:129], v[244:245] op_sel_hi:[1,0]
v_pk_mul_f32 v[130:131], v[130:131], v[244:245] op_sel_hi:[1,0]
v_pk_mul_f32 v[132:133], v[132:133], v[244:245] op_sel_hi:[1,0]
v_pk_mul_f32 v[134:135], v[134:135], v[244:245] op_sel_hi:[1,0]
v_pk_mul_f32 v[136:137], v[136:137], v[244:245] op_sel_hi:[1,0]
v_pk_mul_f32 v[138:139], v[138:139], v[244:245] op_sel_hi:[1,0]
v_pk_mul_f32 v[140:141], v[140:141], v[244:245] op_sel_hi:[1,0]
v_pk_mul_f32 v[142:143], v[142:143], v[244:245] op_sel_hi:[1,0]
v_max3_f32 v244, v8, v9, v10
v_max3_f32 v244, v244, v11, v12
v_max3_f32 v244, v244, v13, v14
v_max_f32 v244, v244, v15
v_mov_b32 v248, v244
s_nop 1
v_permlane16_swap_b32 v244, v248
v_max_f32 v244, v244, v248
v_mov_b32 v248, v244
s_nop 1
v_permlane32_swap_b32 v244, v248
v_max_f32 v244, v244, v248
v_ceil_f32 v244, v244
v_max_f32 v244, 0, v244
v_add_f32 v241, v241, v244
v_sub_f32 v244, 0, v244
v_pk_add_f32 v[8:9], v[8:9], v[244:245] op_sel_hi:[1,0]
v_pk_add_f32 v[10:11], v[10:11], v[244:245] op_sel_hi:[1,0]
v_pk_add_f32 v[12:13], v[12:13], v[244:245] op_sel_hi:[1,0]
v_pk_add_f32 v[14:15], v[14:15], v[244:245] op_sel_hi:[1,0]
v_exp_f32 v244, v244
v_sub_f32 v248, 0, v241
v_mov_b32 v88, v248
v_mov_b32 v89, v248
v_mov_b32 v90, v248
v_mov_b32 v91, v248
v_mov_b32 v92, v248
v_mov_b32 v93, v248
v_mov_b32 v94, v248
v_mov_b32 v95, v248
v_accvgpr_read_b32 v248, a164
v_mul_f32 v248, v248, v244
v_accvgpr_write_b32 a164, v248
v_accvgpr_write_b32 a165, v248
v_accvgpr_write_b32 a166, v248
v_accvgpr_write_b32 a167, v248
v_pk_mul_f32 v[144:145], v[144:145], v[244:245] op_sel_hi:[1,0]
v_pk_mul_f32 v[146:147], v[146:147], v[244:245] op_sel_hi:[1,0]
v_pk_mul_f32 v[148:149], v[148:149], v[244:245] op_sel_hi:[1,0]
v_pk_mul_f32 v[150:151], v[150:151], v[244:245] op_sel_hi:[1,0]
v_pk_mul_f32 v[152:153], v[152:153], v[244:245] op_sel_hi:[1,0]
v_pk_mul_f32 v[154:155], v[154:155], v[244:245] op_sel_hi:[1,0]
v_pk_mul_f32 v[156:157], v[156:157], v[244:245] op_sel_hi:[1,0]
v_pk_mul_f32 v[158:159], v[158:159], v[244:245] op_sel_hi:[1,0]
v_pk_mul_f32 v[160:161], v[160:161], v[244:245] op_sel_hi:[1,0]
v_pk_mul_f32 v[162:163], v[162:163], v[244:245] op_sel_hi:[1,0]
v_pk_mul_f32 v[164:165], v[164:165], v[244:245] op_sel_hi:[1,0]
v_pk_mul_f32 v[166:167], v[166:167], v[244:245] op_sel_hi:[1,0]
v_pk_mul_f32 v[168:169], v[168:169], v[244:245] op_sel_hi:[1,0]
v_pk_mul_f32 v[170:171], v[170:171], v[244:245] op_sel_hi:[1,0]
v_pk_mul_f32 v[172:173], v[172:173], v[244:245] op_sel_hi:[1,0]
v_pk_mul_f32 v[174:175], v[174:175], v[244:245] op_sel_hi:[1,0]
v_max3_f32 v244, v16, v17, v18
v_max3_f32 v244, v244, v19, v20
v_max3_f32 v244, v244, v21, v22
v_max_f32 v244, v244, v23
v_mov_b32 v248, v244
s_nop 1
v_permlane16_swap_b32 v244, v248
v_max_f32 v244, v244, v248
v_mov_b32 v248, v244
s_nop 1
v_permlane32_swap_b32 v244, v248
v_max_f32 v244, v244, v248
v_ceil_f32 v244, v244
v_max_f32 v244, 0, v244
v_add_f32 v242, v242, v244
v_sub_f32 v244, 0, v244
v_pk_add_f32 v[16:17], v[16:17], v[244:245] op_sel_hi:[1,0]
v_pk_add_f32 v[18:19], v[18:19], v[244:245] op_sel_hi:[1,0]
v_pk_add_f32 v[20:21], v[20:21], v[244:245] op_sel_hi:[1,0]
v_pk_add_f32 v[22:23], v[22:23], v[244:245] op_sel_hi:[1,0]
v_exp_f32 v244, v244
v_sub_f32 v248, 0, v242
v_mov_b32 v96, v248
v_mov_b32 v97, v248
v_mov_b32 v98, v248
v_mov_b32 v99, v248
v_mov_b32 v100, v248
v_mov_b32 v101, v248
v_mov_b32 v102, v248
v_mov_b32 v103, v248
v_accvgpr_read_b32 v248, a168
v_mul_f32 v248, v248, v244
v_accvgpr_write_b32 a168, v248
v_accvgpr_write_b32 a169, v248
v_accvgpr_write_b32 a170, v248
v_accvgpr_write_b32 a171, v248
v_pk_mul_f32 v[176:177], v[176:177], v[244:245] op_sel_hi:[1,0]
v_pk_mul_f32 v[178:179], v[178:179], v[244:245] op_sel_hi:[1,0]
v_pk_mul_f32 v[180:181], v[180:181], v[244:245] op_sel_hi:[1,0]
v_pk_mul_f32 v[182:183], v[182:183], v[244:245] op_sel_hi:[1,0]
v_pk_mul_f32 v[184:185], v[184:185], v[244:245] op_sel_hi:[1,0]
v_pk_mul_f32 v[186:187], v[186:187], v[244:245] op_sel_hi:[1,0]
v_pk_mul_f32 v[188:189], v[188:189], v[244:245] op_sel_hi:[1,0]
v_pk_mul_f32 v[190:191], v[190:191], v[244:245] op_sel_hi:[1,0]
v_pk_mul_f32 v[192:193], v[192:193], v[244:245] op_sel_hi:[1,0]
v_pk_mul_f32 v[194:195], v[194:195], v[244:245] op_sel_hi:[1,0]
v_pk_mul_f32 v[196:197], v[196:197], v[244:245] op_sel_hi:[1,0]
v_pk_mul_f32 v[198:199], v[198:199], v[244:245] op_sel_hi:[1,0]
v_pk_mul_f32 v[200:201], v[200:201], v[244:245] op_sel_hi:[1,0]
v_pk_mul_f32 v[202:203], v[202:203], v[244:245] op_sel_hi:[1,0]
v_pk_mul_f32 v[204:205], v[204:205], v[244:245] op_sel_hi:[1,0]
v_pk_mul_f32 v[206:207], v[206:207], v[244:245] op_sel_hi:[1,0]
v_max3_f32 v244, v24, v25, v26
v_max3_f32 v244, v244, v27, v28
v_max3_f32 v244, v244, v29, v30
v_max_f32 v244, v244, v31
v_mov_b32 v248, v244
s_nop 1
v_permlane16_swap_b32 v244, v248
v_max_f32 v244, v244, v248
v_mov_b32 v248, v244
s_nop 1
v_permlane32_swap_b32 v244, v248
v_max_f32 v244, v244, v248
v_ceil_f32 v244, v244
v_max_f32 v244, 0, v244
v_add_f32 v243, v243, v244
v_sub_f32 v244, 0, v244
v_pk_add_f32 v[24:25], v[24:25], v[244:245] op_sel_hi:[1,0]
v_pk_add_f32 v[26:27], v[26:27], v[244:245] op_sel_hi:[1,0]
v_pk_add_f32 v[28:29], v[28:29], v[244:245] op_sel_hi:[1,0]
v_pk_add_f32 v[30:31], v[30:31], v[244:245] op_sel_hi:[1,0]
v_exp_f32 v244, v244
v_sub_f32 v248, 0, v243
v_mov_b32 v104, v248
v_mov_b32 v105, v248
v_mov_b32 v106, v248
v_mov_b32 v107, v248
v_mov_b32 v108, v248
v_mov_b32 v109, v248
v_mov_b32 v110, v248
v_mov_b32 v111, v248
v_accvgpr_read_b32 v248, a172
v_mul_f32 v248, v248, v244
v_accvgpr_write_b32 a172, v248
v_accvgpr_write_b32 a173, v248
v_accvgpr_write_b32 a174, v248
v_accvgpr_write_b32 a175, v248
v_pk_mul_f32 v[208:209], v[208:209], v[244:245] op_sel_hi:[1,0]
v_pk_mul_f32 v[210:211], v[210:211], v[244:245] op_sel_hi:[1,0]
v_pk_mul_f32 v[212:213], v[212:213], v[244:245] op_sel_hi:[1,0]
v_pk_mul_f32 v[214:215], v[214:215], v[244:245] op_sel_hi:[1,0]
v_pk_mul_f32 v[216:217], v[216:217], v[244:245] op_sel_hi:[1,0]
v_pk_mul_f32 v[218:219], v[218:219], v[244:245] op_sel_hi:[1,0]
v_pk_mul_f32 v[220:221], v[220:221], v[244:245] op_sel_hi:[1,0]
v_pk_mul_f32 v[222:223], v[222:223], v[244:245] op_sel_hi:[1,0]
v_pk_mul_f32 v[224:225], v[224:225], v[244:245] op_sel_hi:[1,0]
v_pk_mul_f32 v[226:227], v[226:227], v[244:245] op_sel_hi:[1,0]
v_pk_mul_f32 v[228:229], v[228:229], v[244:245] op_sel_hi:[1,0]
v_pk_mul_f32 v[230:231], v[230:231], v[244:245] op_sel_hi:[1,0]
v_pk_mul_f32 v[232:233], v[232:233], v[244:245] op_sel_hi:[1,0]
v_pk_mul_f32 v[234:235], v[234:235], v[244:245] op_sel_hi:[1,0]
v_pk_mul_f32 v[236:237], v[236:237], v[244:245] op_sel_hi:[1,0]
v_pk_mul_f32 v[238:239], v[238:239], v[244:245] op_sel_hi:[1,0]
s_nop 1
S2_rs21:
s_cmp_le_u32 s33, 3
s_cbranch_scc0 S2_loop2
S2_h2b:
s_and_b32 s39, s20, 1
s_add_u32 s39, s39, 2
s_sub_u32 s37, s39, s20
s_cmp_lt_i32 s37, 0
s_cbranch_scc1 Lme_7018
s_cmp_eq_i32 s37, 0
s_cbranch_scc1 Lmd_7017
v_mov_b32 v80, v254
v_mov_b32 v81, v254
v_mov_b32 v82, v254
v_mov_b32 v83, v254
v_mov_b32 v84, v254
v_mov_b32 v85, v254
v_mov_b32 v86, v254
v_mov_b32 v87, v254
v_mov_b32 v88, v254
v_mov_b32 v89, v254
v_mov_b32 v90, v254
v_mov_b32 v91, v254
v_mov_b32 v92, v254
v_mov_b32 v93, v254
v_mov_b32 v94, v254
v_mov_b32 v95, v254
s_branch Lme_7018
Lmd_7017:
v_cndmask_b32 v80, v80, v254, s[64:65]
v_mov_b32 v84, v254
v_cndmask_b32 v92, v92, v254, s[64:65]
v_cndmask_b32 v81, v81, v254, s[66:67]
v_mov_b32 v85, v254
v_cndmask_b32 v93, v93, v254, s[66:67]
v_cndmask_b32 v82, v82, v254, s[68:69]
v_mov_b32 v86, v254
v_cndmask_b32 v94, v94, v254, s[68:69]
v_cndmask_b32 v83, v83, v254, s[70:71]
v_mov_b32 v87, v254
v_cndmask_b32 v95, v95, v254, s[70:71]
Lme_7018:
s_xor_b32 s37, s20, 1
s_sub_u32 s37, s39, s37
s_cmp_lt_i32 s37, 0
s_cbranch_scc1 Lme_7020
s_cmp_eq_i32 s37, 0
s_cbranch_scc1 Lmd_7019
v_mov_b32 v96, v254
v_mov_b32 v97, v254
v_mov_b32 v98, v254
v_mov_b32 v99, v254
v_mov_b32 v100, v254
v_mov_b32 v101, v254
v_mov_b32 v102, v254
v_mov_b32 v103, v254
v_mov_b32 v104, v254
v_mov_b32 v105, v254
v_mov_b32 v106, v254
v_mov_b32 v107, v254
v_mov_b32 v108, v254
v_mov_b32 v109, v254
v_mov_b32 v110, v254
v_mov_b32 v111, v254
s_branch Lme_7020
Lmd_7019:
v_cndmask_b32 v96, v96, v254, s[64:65]
v_mov_b32 v100, v254
v_cndmask_b32 v108, v108, v254, s[64:65]
v_cndmask_b32 v97, v97, v254, s[66:67]
v_mov_b32 v101, v254
v_cndmask_b32 v109, v109, v254, s[66:67]
v_cndmask_b32 v98, v98, v254, s[68:69]
v_mov_b32 v102, v254
v_cndmask_b32 v110, v110, v254, s[68:69]
v_cndmask_b32 v99, v99, v254, s[70:71]
v_mov_b32 v103, v254
v_cndmask_b32 v111, v111, v254, s[70:71]
Lme_7020:
s_lshr_b32 s37, s21, 2
s_lshl_b32 s37, s37, 7
s_add_u32 s37, s37, 0x3c03000
v_and_b32 v248, 31, v253
v_lshlrev_b32 v248, 2, v248
buffer_load_dword a253, v248, s[4:7], s37 offen sc1
s_branch S2_loop2
S2_rare20:
v_cmp_lt_f32 vcc, s34, v255
s_nop 4
s_cbranch_vccz S2_rs20
s_nop 7
v_max3_f32 v244, v32, v33, v34
v_max3_f32 v244, v244, v35, v36
v_max3_f32 v244, v244, v37, v38
v_max_f32 v244, v244, v39
v_mov_b32 v248, v244
s_nop 1
v_permlane16_swap_b32 v244, v248
v_max_f32 v244, v244, v248
v_mov_b32 v248, v244
s_nop 1
v_permlane32_swap_b32 v244, v248
v_max_f32 v244, v244, v248
v_ceil_f32 v244, v244
v_max_f32 v244, 0, v244
v_add_f32 v240, v240, v244
v_sub_f32 v244, 0, v244
v_pk_add_f32 v[32:33], v[32:33], v[244:245] op_sel_hi:[1,0]
v_pk_add_f32 v[34:35], v[34:35], v[244:245] op_sel_hi:[1,0]
v_pk_add_f32 v[36:37], v[36:37], v[244:245] op_sel_hi:[1,0]
v_pk_add_f32 v[38:39], v[38:39], v[244:245] op_sel_hi:[1,0]
v_exp_f32 v244, v244
v_sub_f32 v248, 0, v240
v_mov_b32 v80, v248
v_mov_b32 v81, v248
v_mov_b32 v82, v248
v_mov_b32 v83, v248
v_mov_b32 v84, v248
v_mov_b32 v85, v248
v_mov_b32 v86, v248
v_mov_b32 v87, v248
v_accvgpr_read_b32 v248, a160
v_mul_f32 v248, v248, v244
v_accvgpr_write_b32 a160, v248
v_accvgpr_write_b32 a161, v248
v_accvgpr_write_b32 a162, v248
v_accvgpr_write_b32 a163, v248
v_pk_mul_f32 v[112:113], v[112:113], v[244:245] op_sel_hi:[1,0]
v_pk_mul_f32 v[114:115], v[114:115], v[244:245] op_sel_hi:[1,0]
v_pk_mul_f32 v[116:117], v[116:117], v[244:245] op_sel_hi:[1,0]
v_pk_mul_f32 v[118:119], v[118:119], v[244:245] op_sel_hi:[1,0]
v_pk_mul_f32 v[120:121], v[120:121], v[244:245] op_sel_hi:[1,0]
v_pk_mul_f32 v[122:123], v[122:123], v[244:245] op_sel_hi:[1,0]
v_pk_mul_f32 v[124:125], v[124:125], v[244:245] op_sel_hi:[1,0]
v_pk_mul_f32 v[126:127], v[126:127], v[244:245] op_sel_hi:[1,0]
v_pk_mul_f32 v[128:129], v[128:129], v[244:245] op_sel_hi:[1,0]
v_pk_mul_f32 v[130:131], v[130:131], v[244:245] op_sel_hi:[1,0]
v_pk_mul_f32 v[132:133], v[132:133], v[244:245] op_sel_hi:[1,0]
v_pk_mul_f32 v[134:135], v[134:135], v[244:245] op_sel_hi:[1,0]
v_pk_mul_f32 v[136:137], v[136:137], v[244:245] op_sel_hi:[1,0]
v_pk_mul_f32 v[138:139], v[138:139], v[244:245] op_sel_hi:[1,0]
v_pk_mul_f32 v[140:141], v[140:141], v[244:245] op_sel_hi:[1,0]
v_pk_mul_f32 v[142:143], v[142:143], v[244:245] op_sel_hi:[1,0]
v_max3_f32 v244, v40, v41, v42
v_max3_f32 v244, v244, v43, v44
v_max3_f32 v244, v244, v45, v46
v_max_f32 v244, v244, v47
v_mov_b32 v248, v244
s_nop 1
v_permlane16_swap_b32 v244, v248
v_max_f32 v244, v244, v248
v_mov_b32 v248, v244
s_nop 1
v_permlane32_swap_b32 v244, v248
v_max_f32 v244, v244, v248
v_ceil_f32 v244, v244
v_max_f32 v244, 0, v244
v_add_f32 v241, v241, v244
v_sub_f32 v244, 0, v244
v_pk_add_f32 v[40:41], v[40:41], v[244:245] op_sel_hi:[1,0]
v_pk_add_f32 v[42:43], v[42:43], v[244:245] op_sel_hi:[1,0]
v_pk_add_f32 v[44:45], v[44:45], v[244:245] op_sel_hi:[1,0]
v_pk_add_f32 v[46:47], v[46:47], v[244:245] op_sel_hi:[1,0]
v_exp_f32 v244, v244
v_sub_f32 v248, 0, v241
v_mov_b32 v88, v248
v_mov_b32 v89, v248
v_mov_b32 v90, v248
v_mov_b32 v91, v248
v_mov_b32 v92, v248
v_mov_b32 v93, v248
v_mov_b32 v94, v248
v_mov_b32 v95, v248
v_accvgpr_read_b32 v248, a164
v_mul_f32 v248, v248, v244
v_accvgpr_write_b32 a164, v248
v_accvgpr_write_b32 a165, v248
v_accvgpr_write_b32 a166, v248
v_accvgpr_write_b32 a167, v248
v_pk_mul_f32 v[144:145], v[144:145], v[244:245] op_sel_hi:[1,0]
v_pk_mul_f32 v[146:147], v[146:147], v[244:245] op_sel_hi:[1,0]
v_pk_mul_f32 v[148:149], v[148:149], v[244:245] op_sel_hi:[1,0]
v_pk_mul_f32 v[150:151], v[150:151], v[244:245] op_sel_hi:[1,0]
v_pk_mul_f32 v[152:153], v[152:153], v[244:245] op_sel_hi:[1,0]
v_pk_mul_f32 v[154:155], v[154:155], v[244:245] op_sel_hi:[1,0]
v_pk_mul_f32 v[156:157], v[156:157], v[244:245] op_sel_hi:[1,0]
v_pk_mul_f32 v[158:159], v[158:159], v[244:245] op_sel_hi:[1,0]
v_pk_mul_f32 v[160:161], v[160:161], v[244:245] op_sel_hi:[1,0]
v_pk_mul_f32 v[162:163], v[162:163], v[244:245] op_sel_hi:[1,0]
v_pk_mul_f32 v[164:165], v[164:165], v[244:245] op_sel_hi:[1,0]
v_pk_mul_f32 v[166:167], v[166:167], v[244:245] op_sel_hi:[1,0]
v_pk_mul_f32 v[168:169], v[168:169], v[244:245] op_sel_hi:[1,0]
v_pk_mul_f32 v[170:171], v[170:171], v[244:245] op_sel_hi:[1,0]
v_pk_mul_f32 v[172:173], v[172:173], v[244:245] op_sel_hi:[1,0]
v_pk_mul_f32 v[174:175], v[174:175], v[244:245] op_sel_hi:[1,0]
v_max3_f32 v244, v48, v49, v50
v_max3_f32 v244, v244, v51, v52
v_max3_f32 v244, v244, v53, v54
v_max_f32 v244, v244, v55
v_mov_b32 v248, v244
s_nop 1
v_permlane16_swap_b32 v244, v248
v_max_f32 v244, v244, v248
v_mov_b32 v248, v244
s_nop 1
v_permlane32_swap_b32 v244, v248
v_max_f32 v244, v244, v248
v_ceil_f32 v244, v244
v_max_f32 v244, 0, v244
v_add_f32 v242, v242, v244
v_sub_f32 v244, 0, v244
v_pk_add_f32 v[48:49], v[48:49], v[244:245] op_sel_hi:[1,0]
v_pk_add_f32 v[50:51], v[50:51], v[244:245] op_sel_hi:[1,0]
v_pk_add_f32 v[52:53], v[52:53], v[244:245] op_sel_hi:[1,0]
v_pk_add_f32 v[54:55], v[54:55], v[244:245] op_sel_hi:[1,0]
v_exp_f32 v244, v244
v_sub_f32 v248, 0, v242
v_mov_b32 v96, v248
v_mov_b32 v97, v248
v_mov_b32 v98, v248
v_mov_b32 v99, v248
v_mov_b32 v100, v248
v_mov_b32 v101, v248
v_mov_b32 v102, v248
v_mov_b32 v103, v248
v_accvgpr_read_b32 v248, a168
v_mul_f32 v248, v248, v244
v_accvgpr_write_b32 a168, v248
v_accvgpr_write_b32 a169, v248
v_accvgpr_write_b32 a170, v248
v_accvgpr_write_b32 a171, v248
v_pk_mul_f32 v[176:177], v[176:177], v[244:245] op_sel_hi:[1,0]
v_pk_mul_f32 v[178:179], v[178:179], v[244:245] op_sel_hi:[1,0]
v_pk_mul_f32 v[180:181], v[180:181], v[244:245] op_sel_hi:[1,0]
v_pk_mul_f32 v[182:183], v[182:183], v[244:245] op_sel_hi:[1,0]
v_pk_mul_f32 v[184:185], v[184:185], v[244:245] op_sel_hi:[1,0]
v_pk_mul_f32 v[186:187], v[186:187], v[244:245] op_sel_hi:[1,0]
v_pk_mul_f32 v[188:189], v[188:189], v[244:245] op_sel_hi:[1,0]
v_pk_mul_f32 v[190:191], v[190:191], v[244:245] op_sel_hi:[1,0]
v_pk_mul_f32 v[192:193], v[192:193], v[244:245] op_sel_hi:[1,0]
v_pk_mul_f32 v[194:195], v[194:195], v[244:245] op_sel_hi:[1,0]
v_pk_mul_f32 v[196:197], v[196:197], v[244:245] op_sel_hi:[1,0]
v_pk_mul_f32 v[198:199], v[198:199], v[244:245] op_sel_hi:[1,0]
v_pk_mul_f32 v[200:201], v[200:201], v[244:245] op_sel_hi:[1,0]
v_pk_mul_f32 v[202:203], v[202:203], v[244:245] op_sel_hi:[1,0]
v_pk_mul_f32 v[204:205], v[204:205], v[244:245] op_sel_hi:[1,0]
v_pk_mul_f32 v[206:207], v[206:207], v[244:245] op_sel_hi:[1,0]
v_max3_f32 v244, v56, v57, v58
v_max3_f32 v244, v244, v59, v60
v_max3_f32 v244, v244, v61, v62
v_max_f32 v244, v244, v63
v_mov_b32 v248, v244
s_nop 1
v_permlane16_swap_b32 v244, v248
v_max_f32 v244, v244, v248
v_mov_b32 v248, v244
s_nop 1
v_permlane32_swap_b32 v244, v248
v_max_f32 v244, v244, v248
v_ceil_f32 v244, v244
v_max_f32 v244, 0, v244
v_add_f32 v243, v243, v244
v_sub_f32 v244, 0, v244
v_pk_add_f32 v[56:57], v[56:57], v[244:245] op_sel_hi:[1,0]
v_pk_add_f32 v[58:59], v[58:59], v[244:245] op_sel_hi:[1,0]
v_pk_add_f32 v[60:61], v[60:61], v[244:245] op_sel_hi:[1,0]
v_pk_add_f32 v[62:63], v[62:63], v[244:245] op_sel_hi:[1,0]
v_exp_f32 v244, v244
v_sub_f32 v248, 0, v243
v_mov_b32 v104, v248
v_mov_b32 v105, v248
v_mov_b32 v106, v248
v_mov_b32 v107, v248
v_mov_b32 v108, v248
v_mov_b32 v109, v248
v_mov_b32 v110, v248
v_mov_b32 v111, v248
v_accvgpr_read_b32 v248, a172
v_mul_f32 v248, v248, v244
v_accvgpr_write_b32 a172, v248
v_accvgpr_write_b32 a173, v248
v_accvgpr_write_b32 a174, v248
v_accvgpr_write_b32 a175, v248
v_pk_mul_f32 v[208:209], v[208:209], v[244:245] op_sel_hi:[1,0]
v_pk_mul_f32 v[210:211], v[210:211], v[244:245] op_sel_hi:[1,0]
v_pk_mul_f32 v[212:213], v[212:213], v[244:245] op_sel_hi:[1,0]
v_pk_mul_f32 v[214:215], v[214:215], v[244:245] op_sel_hi:[1,0]
v_pk_mul_f32 v[216:217], v[216:217], v[244:245] op_sel_hi:[1,0]
v_pk_mul_f32 v[218:219], v[218:219], v[244:245] op_sel_hi:[1,0]
v_pk_mul_f32 v[220:221], v[220:221], v[244:245] op_sel_hi:[1,0]
v_pk_mul_f32 v[222:223], v[222:223], v[244:245] op_sel_hi:[1,0]
v_pk_mul_f32 v[224:225], v[224:225], v[244:245] op_sel_hi:[1,0]
v_pk_mul_f32 v[226:227], v[226:227], v[244:245] op_sel_hi:[1,0]
v_pk_mul_f32 v[228:229], v[228:229], v[244:245] op_sel_hi:[1,0]
v_pk_mul_f32 v[230:231], v[230:231], v[244:245] op_sel_hi:[1,0]
v_pk_mul_f32 v[232:233], v[232:233], v[244:245] op_sel_hi:[1,0]
v_pk_mul_f32 v[234:235], v[234:235], v[244:245] op_sel_hi:[1,0]
v_pk_mul_f32 v[236:237], v[236:237], v[244:245] op_sel_hi:[1,0]
v_pk_mul_f32 v[238:239], v[238:239], v[244:245] op_sel_hi:[1,0]
s_nop 1
S2_rs20:
s_cmp_le_u32 s33, 3
s_cbranch_scc0 S2_c2a
s_cmp_eq_u32 s33, 1
s_cbranch_scc1 S2_tail
s_and_b32 s39, s20, 1
s_add_u32 s39, s39, 0
s_sub_u32 s37, s39, s20
s_cmp_lt_i32 s37, 0
s_cbranch_scc1 Lme_7022
s_cmp_eq_i32 s37, 0
s_cbranch_scc1 Lmd_7021
v_mov_b32 v80, v254
v_mov_b32 v81, v254
v_mov_b32 v82, v254
v_mov_b32 v83, v254
v_mov_b32 v84, v254
v_mov_b32 v85, v254
v_mov_b32 v86, v254
v_mov_b32 v87, v254
v_mov_b32 v88, v254
v_mov_b32 v89, v254
v_mov_b32 v90, v254
v_mov_b32 v91, v254
v_mov_b32 v92, v254
v_mov_b32 v93, v254
v_mov_b32 v94, v254
v_mov_b32 v95, v254
s_branch Lme_7022
Lmd_7021:
v_cndmask_b32 v80, v80, v254, s[64:65]
v_mov_b32 v84, v254
v_cndmask_b32 v92, v92, v254, s[64:65]
v_cndmask_b32 v81, v81, v254, s[66:67]
v_mov_b32 v85, v254
v_cndmask_b32 v93, v93, v254, s[66:67]
v_cndmask_b32 v82, v82, v254, s[68:69]
v_mov_b32 v86, v254
v_cndmask_b32 v94, v94, v254, s[68:69]
v_cndmask_b32 v83, v83, v254, s[70:71]
v_mov_b32 v87, v254
v_cndmask_b32 v95, v95, v254, s[70:71]
Lme_7022:
s_xor_b32 s37, s20, 1
s_sub_u32 s37, s39, s37
s_cmp_lt_i32 s37, 0
s_cbranch_scc1 Lme_7024
s_cmp_eq_i32 s37, 0
s_cbranch_scc1 Lmd_7023
v_mov_b32 v96, v254
v_mov_b32 v97, v254
v_mov_b32 v98, v254
v_mov_b32 v99, v254
v_mov_b32 v100, v254
v_mov_b32 v101, v254
v_mov_b32 v102, v254
v_mov_b32 v103, v254
v_mov_b32 v104, v254
v_mov_b32 v105, v254
v_mov_b32 v106, v254
v_mov_b32 v107, v254
v_mov_b32 v108, v254
v_mov_b32 v109, v254
v_mov_b32 v110, v254
v_mov_b32 v111, v254
s_branch Lme_7024
Lmd_7023:
v_cndmask_b32 v96, v96, v254, s[64:65]
v_mov_b32 v100, v254
v_cndmask_b32 v108, v108, v254, s[64:65]
v_cndmask_b32 v97, v97, v254, s[66:67]
v_mov_b32 v101, v254
v_cndmask_b32 v109, v109, v254, s[66:67]
v_cndmask_b32 v98, v98, v254, s[68:69]
v_mov_b32 v102, v254
v_cndmask_b32 v110, v110, v254, s[68:69]
v_cndmask_b32 v99, v99, v254, s[70:71]
v_mov_b32 v103, v254
v_cndmask_b32 v111, v111, v254, s[70:71]
Lme_7024:
s_branch S2_c2a
S2_tail:
s_lshr_b32 s37, s21, 2
s_lshl_b32 s37, s37, 7
s_add_u32 s37, s37, 0x3c03000
v_and_b32 v0, 31, v253
v_lshlrev_b32 v0, 2, v0
s_mov_b32 s38, 0
s_waitcnt vmcnt(8)
v_accvgpr_read_b32 v1, a253
S3_poll:
v_cmp_ne_u32 vcc, 1, v1
s_add_u32 s38, s38, 1
s_nop 3
s_cbranch_vccz S3_go
s_sleep 2
buffer_load_dword v1, v0, s[4:7], s37 offen sc1
s_waitcnt vmcnt(0)
s_cmp_lt_u32 s38, 0x40000
s_cbranch_scc1 S3_poll
S3_go:
s_branch BACK_entry
.section .rodata,"a"
.p2align 6
.amdhsa_kernel concat_heads__compressed_kv_cla__linear_kernel_hedgehog__prompt_kernel
  .amdhsa_next_free_vgpr 512
  .amdhsa_next_free_sgpr 102
  .amdhsa_accum_offset 256
  .amdhsa_group_segment_fixed_size 0
  .amdhsa_kernarg_size 104
  .amdhsa_user_sgpr_count 2
  .amdhsa_user_sgpr_kernarg_segment_ptr 1
  .amdhsa_system_sgpr_workgroup_id_x 1
.end_amdhsa_kernel
```
